```python
import torch

def _softmax(x, axis=-1):
    return torch.softmax(x, dim=axis)

def _gelu(x):
    return torch.nn.functional.gelu(x, approximate='tanh')

def _silu(x):
    return torch.nn.functional.silu(x)

def _sigmoid(x):
    return torch.sigmoid(x)

def _layernorm(x, axis=-1, eps=1e-05):
    m = x.mean(dim=axis, keepdim=True)
    v = x.var(dim=axis, keepdim=True, unbiased=False)
    return (x - m) / torch.sqrt(v + eps)

def _scatter_add(tgt, idx, src, axis=0):
    return tgt.clone().index_add_(axis, idx, src)

def _segment_sum(src, seg, n):
    out = torch.zeros((n,) + src.shape[1:], dtype=src.dtype)
    return out.index_add_(0, seg, src)

def _pad(x, pw):
    flat = tuple((v for pair in reversed(pw) for v in pair))
    return torch.nn.functional.pad(x, flat)
kernel_name = 'adaLN_cond__memory_aug_recurrent_mem_tr__dense_activation_relu__prompt'

def setup_inputs():

    _w = lambda a: (lambda t: t.to(torch.bfloat16) if t.is_floating_point() else t)(torch.as_tensor(a))

    def _A_setup():
        B, S, Dm = (1, 2048, 512)
        H, Dh = (32, 128)
        M, seg = (8, 32)
        seg = min(seg, S)
        S = S // seg * seg
        return {'x': _w((lambda *s: torch.randn(*s, dtype=torch.bfloat16) * 0.05)(B, S, Dm)), 'mem0': _w((lambda *s: torch.randn(*s, dtype=torch.bfloat16) * 0.4)(B, M, Dm)), 'Wq': _w((lambda *s: torch.randn(*s, dtype=torch.bfloat16) * 3.2)(Dm, H, Dh) * Dm ** (-0.5)), 'Wk': _w((lambda *s: torch.randn(*s, dtype=torch.bfloat16) * 3.2)(Dm, H, Dh) * Dm ** (-0.5)), 'Wv': _w((lambda *s: torch.randn(*s, dtype=torch.bfloat16) * 0.4)(Dm, H, Dh) * Dm ** (-0.5)), 'Wo': _w((lambda *s: torch.randn(*s, dtype=torch.bfloat16) * 0.4)(H, Dh, Dm) * (H * Dh) ** (-0.5)), 'seg_len': seg}
    _A_in = _A_setup()

    def _B_setup():
        B, S, D, Dff = (1, 2048, 512, 1792)
        return {'x': _w((lambda *s: torch.randn(*s, dtype=torch.bfloat16) * 0.05)(B, S, D)), 'w1': _w((lambda *s: torch.randn(*s, dtype=torch.bfloat16) * 0.05)(D, Dff)), 'w2': _w((lambda *s: torch.randn(*s, dtype=torch.bfloat16) * 0.05)(Dff, D))}
    _B_in = _B_setup()
    return {'A_x': _A_in['x'], 'A_mem0': _A_in['mem0'], 'A_Wq': _A_in['Wq'], 'A_Wk': _A_in['Wk'], 'A_Wv': _A_in['Wv'], 'A_Wo': _A_in['Wo'], 'A_seg_len': _A_in['seg_len'], 'B_x': _B_in['x'], 'B_w1': _B_in['w1'], 'B_w2': _B_in['w2'], 'c': _w((lambda *s: torch.randn(*s, dtype=torch.bfloat16) * 0.1)(1, 512) * 8.0), 'w_mod': _w((lambda *s: torch.randn(*s, dtype=torch.bfloat16) * 0.1)(512, 6 * 512) * 512 ** (-0.5) * 8.0)}

def reference(A_x, A_mem0, A_Wq, A_Wk, A_Wv, A_Wo, A_seg_len, B_x, B_w1, B_w2, c, w_mod):

    def _A_ref(x, mem0, Wq, Wk, Wv, Wo, seg_len):
        B, S, Dm = x.shape
        H, Dh = (Wq.shape[1], Wq.shape[2])
        M = mem0.shape[1]
        scale = Dh ** (-0.5)
        n_seg = S // seg_len
        L = M + seg_len
        idx = torch.arange(L)
        mask = (idx[:, None] < M) | (idx[:, None] >= idx[None, :])
        mem = mem0
        outs = []
        for s in range(n_seg):
            xs = x[:, s * seg_len:(s + 1) * seg_len, :].clone()
            h = torch.concatenate([mem, xs], axis=1)
            q = torch.einsum('btd,dhe->bhte', h, Wq)
            k = torch.einsum('btd,dhe->bhte', h, Wk)
            v = torch.einsum('btd,dhe->bhte', h, Wv)
            scores = torch.einsum('bhqe,bhke->bhqk', q, k) * scale
            scores = torch.where(mask[None, None], scores, -1000000000.0)
            p = _softmax(scores, axis=-1)
            o = torch.einsum('bhqk,bhke->bhqe', p, v)
            o = torch.einsum('bhte,hed->btd', o, Wo)
            mem = o[:, :M, :].clone()
            outs.append(o[:, M:, :])
        return torch.concatenate(outs, axis=1)

    def _B_ref(x, w1, w2):
        h = torch.einsum('bsd,df->bsf', x, w1)
        zero = torch.zeros_like(h)
        h = torch.maximum(h, zero)
        return torch.einsum('bsf,fd->bsd', h, w2)
    x = A_x
    mod = (_silu(c) @ w_mod).reshape(c.shape[0], 6, 1, -1)
    sa, ca, ga, sb, cb, gb = (mod[:, 0].clone(), mod[:, 1].clone(), mod[:, 2].clone(), mod[:, 3].clone(), mod[:, 4].clone(), mod[:, 5].clone())
    h = _layernorm(x, axis=-1) * (1 + ca) + sa
    x = x + ga * _A_ref(h, A_mem0, A_Wq, A_Wk, A_Wv, A_Wo, A_seg_len)
    h = _layernorm(x, axis=-1) * (1 + cb) + sb
    x = x + gb * _B_ref(h, B_w1, B_w2)
    return x
```

```asm
; @launch grid=(256,1,1) block=(256,1,1) lds=163840
.amdgcn_target "amdgcn-amd-amdhsa--gfx950"
.text
.globl adaLN_cond__memory_aug_recurrent_mem_tr__dense_activation_relu__prompt_kernel
.p2align 8
.type adaLN_cond__memory_aug_recurrent_mem_tr__dense_activation_relu__prompt_kernel,@function
adaLN_cond__memory_aug_recurrent_mem_tr__dense_activation_relu__prompt_kernel:
    s_cmp_ge_u32 s2, 256
    s_cbranch_scc1 L_end
    s_load_dwordx4 s[24:27], s[0:1], 96
    s_load_dwordx8 s[4:11], s[0:1], 0
    s_load_dwordx4 s[12:15], s[0:1], 32
    s_load_dwordx8 s[16:23], s[0:1], 64
    s_load_dwordx2 s[28:29], s[0:1], 112
    s_getreg_b32 s32, hwreg(HW_REG_XCC_ID, 0, 4)
    v_lshrrev_b32 v1, 6, v0
    s_nop 0
    v_readfirstlane_b32 s30, v1
    s_mov_b32 s33, 0
    s_mov_b32 s55, 0
    s_lshr_b32 s31, s2, 3
    s_lshl_b32 s56, s32, 2
    s_lshr_b32 s56, 0x36250417, s56
    s_and_b32 s56, s56, 7
    s_cmp_gt_u32 s32, 7
    s_cselect_b32 s32, s32, s56
    s_getpc_b64 s[40:41]
L_pc:
    s_lshl_b32 s42, s31, 12
    v_lshlrev_b32 v2, 4, v0
    v_add_u32 v2, s42, v2
    v_min_u32 v2, L_end-L_pc, v2
    global_load_dword v255, v2, s[40:41]
    s_waitcnt lgkmcnt(0)
    s_cmp_gt_u32 s32, 7
    s_cbranch_scc1 L_lost
    s_cmp_lg_u32 s30, 0
    s_cbranch_scc1 L_tk0
    s_cmp_eq_u32 s32, 0
    s_cbranch_scc1 L_role
    s_lshl_b32 s56, s32, 5
    s_lshl_b32 s57, 1, s31
    v_mov_b32 v252, s56
    v_mov_b32 v251, s57
    s_mov_b64 exec, 1
    global_atomic_or v253, v252, v251, s[26:27] offset:16 sc0
    s_mov_b64 exec, -1
    s_branch L_role
L_tk0:
    s_branch L_role
L_lost:
    s_waitcnt vmcnt(0) lgkmcnt(0)
    s_cmp_gt_u32 s32, 7
    s_cselect_b32 s57, 0x10000, 1
    s_min_u32 s56, s32, 7
    v_mov_b32 v250, 163836
    s_cmp_lg_u32 s30, 0
    s_cbranch_scc1 L_ls1
    s_lshl_b32 s56, s56, 5
    v_mov_b32 v252, s56
    v_mov_b32 v251, s57
    s_mov_b64 exec, 1
    global_atomic_add v253, v252, v251, s[26:27] offset:20 sc0
    s_waitcnt vmcnt(0)
    ds_write_b32 v250, v253
    s_waitcnt lgkmcnt(0)
    s_mov_b64 exec, -1
L_ls1:
    s_barrier
    ds_read_b32 v253, v250
    s_waitcnt lgkmcnt(0)
    v_readfirstlane_b32 s42, v253
    s_barrier
    v_mbcnt_lo_u32_b32 v248, -1, 0
    v_and_b32 v248, 7, v248
    v_lshlrev_b32 v248, 5, v248
    s_mov_b32 s54, 0
    s_branch L_cm1
L_cn1:
    s_sleep 8
L_cm1:
    global_load_dwordx2 v[250:251], v248, s[26:27] offset:16 sc1
    s_add_u32 s54, s54, 1
    s_cmp_gt_u32 s54, 400000
    s_cbranch_scc1 L_end
    s_waitcnt vmcnt(0)
    v_bcnt_u32_b32 v249, v250, v251
    s_nop 0
    v_readlane_b32 s70, v249, 0
    v_readlane_b32 s71, v249, 1
    v_readlane_b32 s72, v249, 2
    v_readlane_b32 s73, v249, 3
    v_readlane_b32 s74, v249, 4
    v_readlane_b32 s75, v249, 5
    v_readlane_b32 s76, v249, 6
    v_readlane_b32 s77, v249, 7
    s_lshr_b32 s56, s77, 16
    s_and_b32 s77, s77, 0xffff
    s_add_u32 s56, s56, s70
    s_add_u32 s56, s56, s71
    s_add_u32 s56, s56, s72
    s_add_u32 s56, s56, s73
    s_add_u32 s56, s56, s74
    s_add_u32 s56, s56, s75
    s_add_u32 s56, s56, s76
    s_add_u32 s56, s56, s77
    s_cmp_lt_u32 s56, 256
    s_cbranch_scc1 L_cn1
    v_mov_b32 v253, v250
    s_mov_b32 s55, 1
    s_cmp_gt_u32 s32, 7
    s_cbranch_scc1 L_ls2
    s_and_b32 s42, s42, 0xffff
    v_readlane_b32 s43, v253, s32
    s_bcnt0_i32_b32 s56, s43
    s_cmp_lt_u32 s42, s56
    s_cbranch_scc1 L_ls4
    s_sub_u32 s42, s42, s56
    s_branch L_ls3
L_ls2:
    s_lshr_b32 s42, s42, 16
L_ls3:
    s_max_u32 s57, s70, 32
    s_sub_u32 s57, s57, 32
    s_cmp_gt_u32 s32, 0
    s_cselect_b32 s57, s57, 0
    s_add_u32 s42, s42, s57
    s_max_u32 s57, s71, 32
    s_sub_u32 s57, s57, 32
    s_cmp_gt_u32 s32, 1
    s_cselect_b32 s57, s57, 0
    s_add_u32 s42, s42, s57
    s_max_u32 s57, s72, 32
    s_sub_u32 s57, s57, 32
    s_cmp_gt_u32 s32, 2
    s_cselect_b32 s57, s57, 0
    s_add_u32 s42, s42, s57
    s_max_u32 s57, s73, 32
    s_sub_u32 s57, s57, 32
    s_cmp_gt_u32 s32, 3
    s_cselect_b32 s57, s57, 0
    s_add_u32 s42, s42, s57
    s_max_u32 s57, s74, 32
    s_sub_u32 s57, s57, 32
    s_cmp_gt_u32 s32, 4
    s_cselect_b32 s57, s57, 0
    s_add_u32 s42, s42, s57
    s_max_u32 s57, s75, 32
    s_sub_u32 s57, s57, 32
    s_cmp_gt_u32 s32, 5
    s_cselect_b32 s57, s57, 0
    s_add_u32 s42, s42, s57
    s_max_u32 s57, s76, 32
    s_sub_u32 s57, s57, 32
    s_cmp_gt_u32 s32, 6
    s_cselect_b32 s57, s57, 0
    s_add_u32 s42, s42, s57
    s_max_u32 s57, s77, 32
    s_sub_u32 s57, s57, 32
    s_cmp_gt_u32 s32, 7
    s_cselect_b32 s57, s57, 0
    s_add_u32 s42, s42, s57
    s_mov_b32 s33, 1
    s_mov_b32 s32, 0
    s_mov_b32 s57, s70
    s_min_u32 s56, s70, 32
    s_sub_u32 s56, 32, s56
    s_cmp_lt_u32 s42, s56
    s_cbranch_scc1 L_ls5
    s_sub_u32 s42, s42, s56
    s_mov_b32 s32, 1
    s_mov_b32 s57, s71
    s_min_u32 s56, s71, 32
    s_sub_u32 s56, 32, s56
    s_cmp_lt_u32 s42, s56
    s_cbranch_scc1 L_ls5
    s_sub_u32 s42, s42, s56
    s_mov_b32 s32, 2
    s_mov_b32 s57, s72
    s_min_u32 s56, s72, 32
    s_sub_u32 s56, 32, s56
    s_cmp_lt_u32 s42, s56
    s_cbranch_scc1 L_ls5
    s_sub_u32 s42, s42, s56
    s_mov_b32 s32, 3
    s_mov_b32 s57, s73
    s_min_u32 s56, s73, 32
    s_sub_u32 s56, 32, s56
    s_cmp_lt_u32 s42, s56
    s_cbranch_scc1 L_ls5
    s_sub_u32 s42, s42, s56
    s_mov_b32 s32, 4
    s_mov_b32 s57, s74
    s_min_u32 s56, s74, 32
    s_sub_u32 s56, 32, s56
    s_cmp_lt_u32 s42, s56
    s_cbranch_scc1 L_ls5
    s_sub_u32 s42, s42, s56
    s_mov_b32 s32, 5
    s_mov_b32 s57, s75
    s_min_u32 s56, s75, 32
    s_sub_u32 s56, 32, s56
    s_cmp_lt_u32 s42, s56
    s_cbranch_scc1 L_ls5
    s_sub_u32 s42, s42, s56
    s_mov_b32 s32, 6
    s_mov_b32 s57, s76
    s_min_u32 s56, s76, 32
    s_sub_u32 s56, 32, s56
    s_cmp_lt_u32 s42, s56
    s_cbranch_scc1 L_ls5
    s_sub_u32 s42, s42, s56
    s_mov_b32 s32, 7
    s_mov_b32 s57, s77
    s_min_u32 s56, s77, 32
    s_sub_u32 s56, 32, s56
    s_cmp_lt_u32 s42, s56
    s_cbranch_scc1 L_ls5
    s_sub_u32 s42, s42, s56
    s_branch L_end
L_ls5:
    v_readlane_b32 s43, v253, s32
    s_bcnt1_i32_b32 s56, s43
    s_sub_u32 s56, s57, s56
    s_add_u32 s42, s42, s56
L_ls4:
    s_ff0_i32_b32 s31, s43
    s_bitset1_b32 s43, s31
    s_sub_u32 s42, s42, 1
    s_cbranch_scc0 L_ls4
    s_and_b32 s31, s31, 31
    s_lshl_b32 s56, s30, 6
    v_mbcnt_lo_u32_b32 v0, -1, 0
    v_mbcnt_hi_u32_b32 v0, -1, v0
    v_add_u32 v0, s56, v0
L_role:
    s_cmp_lg_u32 s32, 0
    s_cbranch_scc1 L_worker
    v_and_b32 v102, 63, v0
    v_lshlrev_b32 v127, 4, v102
    v_mov_b32 v80, v0
    v_bfe_u32 v103, v102, 4, 1
    v_lshlrev_b32 v103, 5, v103
    v_bfe_u32 v104, v102, 5, 1
    v_lshl_add_u32 v103, v104, 4, v103
    s_lshl_b32 s56, s30, 2
    v_add_u32 v103, s56, v103
    v_lshlrev_b32 v103, 13, v103
    v_and_b32 v104, 0xf0, v127
    v_add_u32 v103, v103, v104
    s_lshl_b32 s56, s31, 8
    v_add_u32 v96, s56, v103
    s_lshr_b32 s56, s30, 1
    s_lshl_b32 s56, s56, 15
    s_and_b32 s57, s30, 1
    s_lshl_b32 s58, s57, 11
    s_add_u32 s56, s56, s58
    s_lshl_b32 s58, s31, 17
    s_add_u32 s56, s56, s58
    v_add_u32 v97, s56, v127
    s_lshl_b32 s57, s57, 7
    v_xor_b32 v94, s57, v127
    s_lshl_b32 s56, s30, 12
    s_add_u32 s56, s56, 147456
    v_add_u32 v94, s56, v94
    v_xor_b32 v95, 64, v94
    v_lshrrev_b32 v103, 4, v102
    v_lshlrev_b32 v104, 5, v103
    v_xor_b32 v104, v104, v127
    s_lshl_b32 s56, s30, 12
    s_add_u32 s56, s56, 147456
    v_add_u32 v98, s56, v104
    v_xor_b32 v99, 0x80, v98
    v_bfe_u32 v104, v102, 2, 2
    v_lshl_add_u32 v100, v103, 3, v104
    v_lshlrev_b32 v100, 8, v100
    v_bfe_u32 v104, v102, 2, 3
    v_lshl_add_u32 v100, v104, 5, v100
    v_and_b32 v104, 3, v102
    v_lshl_add_u32 v100, v104, 3, v100
    v_add_u32 v100, 147456, v100
    v_bfe_u32 v104, v102, 2, 1
    v_lshl_add_u32 v105, v103, 2, v104
    v_lshlrev_b32 v105, 10, v105
    v_and_b32 v106, 1, v103
    v_lshl_add_u32 v104, v106, 1, v104
    v_lshl_add_u32 v105, v104, 6, v105
    v_bfe_u32 v104, v102, 3, 1
    v_lshl_add_u32 v105, v104, 5, v105
    v_and_b32 v104, 3, v102
    v_lshl_add_u32 v105, v104, 3, v105
    s_lshl_b32 s56, s30, 8
    s_add_u32 s56, s56, 147456
    v_add_u32 v105, s56, v105
    v_bfe_u32 v84, v102, 2, 2
    v_and_b32 v85, 1, v102
    v_lshl_add_u32 v84, v84, 1, v85
    v_lshlrev_b32 v84, 10, v84
    v_lshrrev_b32 v85, 4, v102
    v_lshl_add_u32 v84, v85, 3, v84
    v_and_b32 v85, 2, v102
    v_lshl_add_u32 v84, v85, 4, v84
    s_lshl_b32 s56, s30, 8
    v_add_u32 v84, s56, v84
    global_load_dwordx2 v[8:9], v84, s[6:7] offset:0
    global_load_dwordx2 v[10:11], v84, s[6:7] offset:64
    global_load_dwordx2 v[12:13], v84, s[6:7] offset:128
    global_load_dwordx2 v[14:15], v84, s[6:7] offset:192
    s_add_u32 s56, s10, 0
    s_addc_u32 s57, s11, 0
    global_load_dwordx4 v[16:19], v96, s[56:57]
    s_add_u32 s56, s10, 8192
    s_addc_u32 s57, s11, 0
    global_load_dwordx4 v[20:23], v96, s[56:57]
    s_add_u32 s56, s10, 16384
    s_addc_u32 s57, s11, 0
    global_load_dwordx4 v[24:27], v96, s[56:57]
    s_add_u32 s56, s10, 24576
    s_addc_u32 s57, s11, 0
    global_load_dwordx4 v[28:31], v96, s[56:57]
    s_add_u32 s56, s10, 524288
    s_addc_u32 s57, s11, 0
    global_load_dwordx4 v[32:35], v96, s[56:57]
    s_add_u32 s56, s10, 532480
    s_addc_u32 s57, s11, 0
    global_load_dwordx4 v[36:39], v96, s[56:57]
    s_add_u32 s56, s10, 540672
    s_addc_u32 s57, s11, 0
    global_load_dwordx4 v[40:43], v96, s[56:57]
    s_add_u32 s56, s10, 548864
    s_addc_u32 s57, s11, 0
    global_load_dwordx4 v[44:47], v96, s[56:57]
    s_add_u32 s56, s10, 1048576
    s_addc_u32 s57, s11, 0
    global_load_dwordx4 v[48:51], v96, s[56:57]
    s_add_u32 s56, s10, 1056768
    s_addc_u32 s57, s11, 0
    global_load_dwordx4 v[52:55], v96, s[56:57]
    s_add_u32 s56, s10, 1064960
    s_addc_u32 s57, s11, 0
    global_load_dwordx4 v[56:59], v96, s[56:57]
    s_add_u32 s56, s10, 1073152
    s_addc_u32 s57, s11, 0
    global_load_dwordx4 v[60:63], v96, s[56:57]
    s_add_u32 s56, s10, 1572864
    s_addc_u32 s57, s11, 0
    global_load_dwordx4 v[64:67], v96, s[56:57]
    s_add_u32 s56, s10, 1581056
    s_addc_u32 s57, s11, 0
    global_load_dwordx4 v[68:71], v96, s[56:57]
    s_add_u32 s56, s10, 1589248
    s_addc_u32 s57, s11, 0
    global_load_dwordx4 v[72:75], v96, s[56:57]
    s_add_u32 s56, s10, 1597440
    s_addc_u32 s57, s11, 0
    global_load_dwordx4 v[76:79], v96, s[56:57]
    v_and_b32 v81, 63, v80
    v_and_b32 v82, 15, v80
    v_bfe_u32 v83, v80, 4, 2
    v_lshlrev_b32 v127, 4, v81
    v_and_b32 v84, 2, v82
    v_cmp_ne_u32 vcc, 0, v84
    v_mov_b32 v84, 0x4444
    v_mov_b32 v85, 0xeeee
    v_cndmask_b32 v110, v84, v85, vcc
    v_cmp_lt_u32 vcc, 7, v82
    s_nop 1
    v_cndmask_b32 v84, v84, v85, vcc
    v_lshl_or_b32 v110, v84, 16, v110
    v_cmp_lt_u32 vcc, 7, v82
    v_mov_b32 v84, 0
    v_mov_b32 v85, 0xf149f2ca
    v_cndmask_b32 v111, v84, v85, vcc
    v_and_b32 v84, 1, v82
    v_lshlrev_b32 v84, 4, v84
    v_mov_b32 v85, 0x3f80
    v_lshlrev_b32 v85, v84, v85
    v_lshrrev_b32 v84, 1, v82
    v_lshlrev_b32 v86, 1, v83
    v_mov_b32 v87, 0
    v_cmp_eq_u32 vcc, v84, v86
    s_nop 1
    v_cndmask_b32 v108, v87, v85, vcc
    v_add_u32 v86, 1, v86
    v_cmp_eq_u32 vcc, v84, v86
    s_nop 1
    v_cndmask_b32 v109, v87, v85, vcc
    v_bfe_u32 v84, v82, 2, 1
    v_lshlrev_b32 v84, 4, v84
    v_mov_b32 v85, 0x3f80
    v_lshlrev_b32 v85, v84, v85
    v_and_b32 v84, 11, v82
    v_cmp_eq_u32 vcc, 0, v84
    s_nop 1
    v_cndmask_b32 v112, v87, v85, vcc
    v_cmp_eq_u32 vcc, 8, v84
    s_nop 1
    v_cndmask_b32 v113, v87, v85, vcc
    v_cmp_eq_u32 vcc, 1, v84
    s_nop 1
    v_cndmask_b32 v114, v87, v85, vcc
    v_cmp_eq_u32 vcc, 9, v84
    s_nop 1
    v_cndmask_b32 v115, v87, v85, vcc
    s_mul_i32 s56, s30, 34816
    v_add_u32 v120, s56, v127
    s_add_u32 s56, s30, 0
    s_and_b32 s56, s56, 3
    s_lshl_b32 s56, s56, 10
    s_add_u32 s56, s56, 147456
    v_add_u32 v116, s56, v127
    s_add_u32 s56, s30, 1
    s_and_b32 s56, s56, 3
    s_lshl_b32 s56, s56, 10
    s_add_u32 s56, s56, 147456
    v_add_u32 v117, s56, v127
    s_add_u32 s56, s30, 2
    s_and_b32 s56, s56, 3
    s_lshl_b32 s56, s56, 10
    s_add_u32 s56, s56, 147456
    v_add_u32 v118, s56, v127
    s_add_u32 s56, s30, 3
    s_and_b32 s56, s56, 3
    s_lshl_b32 s56, s56, 10
    s_add_u32 s56, s56, 147456
    v_add_u32 v119, s56, v127
    v_lshrrev_b32 v84, 2, v82
    v_xor_b32 v84, v84, v83
    v_lshlrev_b32 v84, 3, v84
    v_lshl_add_u32 v84, v82, 5, v84
    s_lshl_b32 s56, s30, 9
    s_add_u32 s56, s56, 155648
    v_add_u32 v121, s56, v84
    v_and_b32 v84, 3, v81
    v_xor_b32 v84, v84, v83
    v_lshlrev_b32 v84, 3, v84
    v_lshrrev_b32 v85, 2, v81
    v_lshl_add_u32 v84, v85, 5, v84
    v_add_u32 v122, 155648, v84
    v_mul_u32_u24 v84, 40, v82
    v_lshl_add_u32 v84, v83, 2, v84
    s_mul_i32 s56, s30, 640
    s_add_u32 s56, s56, 157696
    v_add_u32 v123, s56, v84
    v_and_b32 v84, 1, v83
    v_lshlrev_b32 v84, 4, v84
    v_lshrrev_b32 v85, 1, v83
    v_lshl_add_u32 v84, v85, 2, v84
    v_bfe_u32 v85, v81, 2, 1
    v_add_u32 v84, v84, v85
    v_mul_u32_u24 v84, 40, v84
    v_bfe_u32 v85, v81, 3, 1
    v_lshl_add_u32 v84, v85, 4, v84
    v_and_b32 v85, 1, v81
    v_lshl_add_u32 v84, v85, 3, v84
    v_add_u32 v124, 157696, v84
    v_lshrrev_b32 v84, 1, v83
    v_lshlrev_b32 v84, 9, v84
    v_lshl_add_u32 v84, v82, 4, v84
    v_and_b32 v85, 1, v83
    v_lshl_add_u32 v128, v85, 10, v84
    v_lshl_add_u32 v84, v85, 11, v84
    v_add_u32 v125, 139264, v84
    v_lshrrev_b32 v84, 2, v82
    v_lshrrev_b32 v85, 1, v83
    v_lshl_add_u32 v84, v85, 4, v84
    v_lshlrev_b32 v84, 13, v84
    v_and_b32 v85, 1, v83
    v_lshl_add_u32 v84, v85, 11, v84
    v_and_b32 v85, 3, v82
    v_lshl_add_u32 v84, v85, 4, v84
    s_lshl_b32 s56, s30, 15
    s_lshl_b32 s57, s31, 6
    s_add_u32 s56, s56, s57
    v_add_u32 v126, s56, v84
    v_lshrrev_b32 v84, 1, v83
    v_and_b32 v85, 1, v83
    v_lshl_add_u32 v84, v84, 2, v85
    v_lshlrev_b32 v84, 4, v84
    v_and_b32 v85, 3, v82
    v_lshl_add_u32 v84, v85, 2, v84
    s_and_b32 s56, s31, 15
    s_lshl_b32 s56, s56, 8
    s_and_b32 s57, s30, 1
    s_lshl_b32 s57, s57, 7
    s_add_u32 s56, s56, s57
    s_lshr_b32 s57, s30, 1
    s_lshl_b32 s57, s57, 12
    s_add_u32 s56, s56, s57
    s_lshr_b32 s57, s31, 4
    s_lshl_b32 s57, s57, 5
    s_add_u32 s56, s56, s57
    v_add_u32 v129, s56, v84
    s_add_u32 s36, s28, 0
    s_addc_u32 s37, s29, 0
    s_add_u32 s38, s28, 4096
    s_addc_u32 s39, s29, 0
    s_add_u32 s40, s28, 0
    s_addc_u32 s41, s29, 0
    s_lshl_b32 s56, s31, 13
    s_add_u32 s40, s40, s56
    s_addc_u32 s41, s41, 0
    s_lshl_b32 s56, s30, 11
    s_add_u32 s40, s40, s56
    s_addc_u32 s41, s41, 0
    s_add_u32 s42, s28, 270336
    s_addc_u32 s43, s29, 0
    s_add_u32 s44, s28, 262144
    s_addc_u32 s45, s29, 0
    s_add_u32 s46, s28, 4194304
    s_addc_u32 s47, s29, 0
    s_lshl_b32 s56, s31, 18
    s_add_u32 s46, s46, s56
    s_addc_u32 s47, s47, 0
    s_lshl_b32 s56, s31, 12
    s_add_u32 s46, s46, s56
    s_addc_u32 s47, s47, 0
    s_lshl_b32 s56, s30, 10
    s_add_u32 s46, s46, s56
    s_addc_u32 s47, s47, 0
    s_add_u32 s48, s28, 33554432
    s_addc_u32 s49, s29, 0
    s_lshl_b32 s56, s31, 20
    s_add_u32 s48, s48, s56
    s_addc_u32 s49, s49, 0
    s_lshl_b32 s56, s31, 14
    s_add_u32 s48, s48, s56
    s_addc_u32 s49, s49, 0
    s_lshl_b32 s56, s30, 11
    s_add_u32 s48, s48, s56
    s_addc_u32 s49, s49, 0
    s_add_u32 s66, s28, 33570816
    s_addc_u32 s67, s29, 0
    s_lshl_b32 s56, s31, 20
    s_add_u32 s66, s66, s56
    s_addc_u32 s67, s67, 0
    s_lshl_b32 s56, s31, 14
    s_add_u32 s66, s66, s56
    s_addc_u32 s67, s67, 0
    s_lshl_b32 s56, s30, 12
    s_add_u32 s66, s66, s56
    s_addc_u32 s67, s67, 0
    s_add_u32 s50, s28, 33562624
    s_addc_u32 s51, s29, 0
    s_lshl_b32 s56, s31, 20
    s_add_u32 s50, s50, s56
    s_addc_u32 s51, s51, 0
    s_lshl_b32 s56, s31, 14
    s_add_u32 s50, s50, s56
    s_addc_u32 s51, s51, 0
    s_lshl_b32 s56, s30, 11
    s_add_u32 s50, s50, s56
    s_addc_u32 s51, s51, 0
    s_lshl_b32 s56, s30, 11
    s_add_u32 s62, s56, 139264
    s_mov_b32 s64, 0x000f000f
    s_mov_b32 s65, 0x000f000f
    s_mov_b32 s52, 0x3e0293ee
    s_mov_b32 s53, s52
    s_mov_b32 s34, 0
    s_mov_b32 s35, 0
    s_add_u32 s68, s28, 589568
    s_addc_u32 s69, s29, 0
    s_lshl_b32 s56, s31, 7
    s_add_u32 s68, s68, s56
    s_addc_u32 s69, s69, 0
    s_cmp_eq_u32 s30, 1
    s_cbranch_scc1 L_rwa_1
    s_cmp_eq_u32 s30, 2
    s_cbranch_scc1 L_rwa_2
    s_cmp_eq_u32 s30, 3
    s_cbranch_scc1 L_rwa_3
    s_waitcnt vmcnt(15)
    ds_write_b128 v98, v[16:19] offset:0
    s_waitcnt vmcnt(14)
    ds_write_b128 v98, v[20:23] offset:1024
    s_waitcnt vmcnt(13)
    ds_write_b128 v99, v[24:27] offset:2048
    s_waitcnt vmcnt(12)
    ds_write_b128 v99, v[28:31] offset:3072
    s_waitcnt lgkmcnt(0)
    s_add_u32 s56, s10, 2097152
    s_addc_u32 s57, s11, 0
    global_load_dwordx4 v[16:19], v96, s[56:57]
    s_add_u32 s56, s10, 2105344
    s_addc_u32 s57, s11, 0
    global_load_dwordx4 v[20:23], v96, s[56:57]
    s_add_u32 s56, s10, 2113536
    s_addc_u32 s57, s11, 0
    global_load_dwordx4 v[24:27], v96, s[56:57]
    s_add_u32 s56, s10, 2121728
    s_addc_u32 s57, s11, 0
    global_load_dwordx4 v[28:31], v96, s[56:57]
    s_barrier
    v_xor_b32 v101, 0, v100
    ds_read_b64_tr_b16 v[80:81], v101 offset:0
    ds_read_b64_tr_b16 v[82:83], v101 offset:1024
    ds_read_b64_tr_b16 v[84:85], v101 offset:8192
    ds_read_b64_tr_b16 v[86:87], v101 offset:9216
    s_waitcnt lgkmcnt(2)
    ds_write_b128 v120, v[80:83] offset:12288
    s_waitcnt lgkmcnt(1)
    ds_write_b128 v120, v[84:87] offset:13312
    v_xor_b32 v101, 32, v100
    ds_read_b64_tr_b16 v[80:81], v101 offset:0
    ds_read_b64_tr_b16 v[82:83], v101 offset:1024
    ds_read_b64_tr_b16 v[84:85], v101 offset:8192
    ds_read_b64_tr_b16 v[86:87], v101 offset:9216
    s_waitcnt lgkmcnt(2)
    ds_write_b128 v120, v[80:83] offset:16384
    s_waitcnt lgkmcnt(1)
    ds_write_b128 v120, v[84:87] offset:17408
    s_waitcnt lgkmcnt(0)
    s_barrier
    s_waitcnt vmcnt(15)
    ds_write_b128 v98, v[32:35] offset:0
    s_waitcnt vmcnt(14)
    ds_write_b128 v98, v[36:39] offset:1024
    s_waitcnt vmcnt(13)
    ds_write_b128 v99, v[40:43] offset:2048
    s_waitcnt vmcnt(12)
    ds_write_b128 v99, v[44:47] offset:3072
    s_waitcnt lgkmcnt(0)
    s_add_u32 s56, s10, 2621440
    s_addc_u32 s57, s11, 0
    global_load_dwordx4 v[32:35], v96, s[56:57]
    s_add_u32 s56, s10, 2629632
    s_addc_u32 s57, s11, 0
    global_load_dwordx4 v[36:39], v96, s[56:57]
    s_add_u32 s56, s10, 2637824
    s_addc_u32 s57, s11, 0
    global_load_dwordx4 v[40:43], v96, s[56:57]
    s_add_u32 s56, s10, 2646016
    s_addc_u32 s57, s11, 0
    global_load_dwordx4 v[44:47], v96, s[56:57]
    s_barrier
    v_xor_b32 v101, 0, v100
    ds_read_b64_tr_b16 v[80:81], v101 offset:0
    ds_read_b64_tr_b16 v[82:83], v101 offset:1024
    ds_read_b64_tr_b16 v[84:85], v101 offset:8192
    ds_read_b64_tr_b16 v[86:87], v101 offset:9216
    s_waitcnt lgkmcnt(2)
    ds_write_b128 v120, v[80:83] offset:14336
    s_waitcnt lgkmcnt(1)
    ds_write_b128 v120, v[84:87] offset:15360
    v_xor_b32 v101, 32, v100
    ds_read_b64_tr_b16 a[0:1], v101 offset:0
    ds_read_b64_tr_b16 a[2:3], v101 offset:1024
    ds_read_b64_tr_b16 a[4:5], v101 offset:8192
    ds_read_b64_tr_b16 a[6:7], v101 offset:9216
    s_waitcnt lgkmcnt(0)
    s_barrier
    s_waitcnt vmcnt(15)
    ds_write_b128 v98, v[48:51] offset:0
    s_waitcnt vmcnt(14)
    ds_write_b128 v98, v[52:55] offset:1024
    s_waitcnt vmcnt(13)
    ds_write_b128 v99, v[56:59] offset:2048
    s_waitcnt vmcnt(12)
    ds_write_b128 v99, v[60:63] offset:3072
    s_waitcnt lgkmcnt(0)
    s_add_u32 s56, s10, 3145728
    s_addc_u32 s57, s11, 0
    global_load_dwordx4 v[48:51], v96, s[56:57]
    s_add_u32 s56, s10, 3153920
    s_addc_u32 s57, s11, 0
    global_load_dwordx4 v[52:55], v96, s[56:57]
    s_add_u32 s56, s10, 3162112
    s_addc_u32 s57, s11, 0
    global_load_dwordx4 v[56:59], v96, s[56:57]
    s_add_u32 s56, s10, 3170304
    s_addc_u32 s57, s11, 0
    global_load_dwordx4 v[60:63], v96, s[56:57]
    s_barrier
    v_xor_b32 v101, 0, v100
    ds_read_b64_tr_b16 a[120:121], v101 offset:0
    ds_read_b64_tr_b16 a[122:123], v101 offset:1024
    ds_read_b64_tr_b16 a[124:125], v101 offset:8192
    ds_read_b64_tr_b16 a[126:127], v101 offset:9216
    v_xor_b32 v101, 32, v100
    ds_read_b64_tr_b16 a[168:169], v101 offset:0
    ds_read_b64_tr_b16 a[170:171], v101 offset:1024
    ds_read_b64_tr_b16 a[172:173], v101 offset:8192
    ds_read_b64_tr_b16 a[174:175], v101 offset:9216
    s_waitcnt lgkmcnt(0)
    s_barrier
    s_waitcnt vmcnt(15)
    ds_write_b128 v98, v[64:67] offset:0
    s_waitcnt vmcnt(14)
    ds_write_b128 v98, v[68:71] offset:1024
    s_waitcnt vmcnt(13)
    ds_write_b128 v99, v[72:75] offset:2048
    s_waitcnt vmcnt(12)
    ds_write_b128 v99, v[76:79] offset:3072
    s_waitcnt lgkmcnt(0)
    s_add_u32 s56, s10, 3670016
    s_addc_u32 s57, s11, 0
    global_load_dwordx4 v[64:67], v96, s[56:57]
    s_add_u32 s56, s10, 3678208
    s_addc_u32 s57, s11, 0
    global_load_dwordx4 v[68:71], v96, s[56:57]
    s_add_u32 s56, s10, 3686400
    s_addc_u32 s57, s11, 0
    global_load_dwordx4 v[72:75], v96, s[56:57]
    s_add_u32 s56, s10, 3694592
    s_addc_u32 s57, s11, 0
    global_load_dwordx4 v[76:79], v96, s[56:57]
    s_barrier
    v_xor_b32 v101, 0, v100
    ds_read_b64_tr_b16 a[144:145], v101 offset:0
    ds_read_b64_tr_b16 a[146:147], v101 offset:1024
    ds_read_b64_tr_b16 a[148:149], v101 offset:8192
    ds_read_b64_tr_b16 a[150:151], v101 offset:9216
    v_xor_b32 v101, 32, v100
    ds_read_b64_tr_b16 a[192:193], v101 offset:0
    ds_read_b64_tr_b16 a[194:195], v101 offset:1024
    ds_read_b64_tr_b16 a[196:197], v101 offset:8192
    ds_read_b64_tr_b16 a[198:199], v101 offset:9216
    s_waitcnt lgkmcnt(0)
    s_barrier
    s_waitcnt vmcnt(15)
    ds_write_b128 v98, v[16:19] offset:0
    s_waitcnt vmcnt(14)
    ds_write_b128 v98, v[20:23] offset:1024
    s_waitcnt vmcnt(13)
    ds_write_b128 v99, v[24:27] offset:2048
    s_waitcnt vmcnt(12)
    ds_write_b128 v99, v[28:31] offset:3072
    s_waitcnt lgkmcnt(0)
    s_add_u32 s56, s12, 0
    s_addc_u32 s57, s13, 0
    global_load_dwordx4 v[16:19], v96, s[56:57]
    s_add_u32 s56, s12, 8192
    s_addc_u32 s57, s13, 0
    global_load_dwordx4 v[20:23], v96, s[56:57]
    s_add_u32 s56, s12, 16384
    s_addc_u32 s57, s13, 0
    global_load_dwordx4 v[24:27], v96, s[56:57]
    s_add_u32 s56, s12, 24576
    s_addc_u32 s57, s13, 0
    global_load_dwordx4 v[28:31], v96, s[56:57]
    s_barrier
    v_xor_b32 v101, 0, v100
    ds_read_b64_tr_b16 a[128:129], v101 offset:0
    ds_read_b64_tr_b16 a[130:131], v101 offset:1024
    ds_read_b64_tr_b16 a[132:133], v101 offset:8192
    ds_read_b64_tr_b16 a[134:135], v101 offset:9216
    v_xor_b32 v101, 32, v100
    ds_read_b64_tr_b16 a[176:177], v101 offset:0
    ds_read_b64_tr_b16 a[178:179], v101 offset:1024
    ds_read_b64_tr_b16 a[180:181], v101 offset:8192
    ds_read_b64_tr_b16 a[182:183], v101 offset:9216
    s_waitcnt lgkmcnt(0)
    s_barrier
    s_waitcnt vmcnt(15)
    ds_write_b128 v98, v[32:35] offset:0
    s_waitcnt vmcnt(14)
    ds_write_b128 v98, v[36:39] offset:1024
    s_waitcnt vmcnt(13)
    ds_write_b128 v99, v[40:43] offset:2048
    s_waitcnt vmcnt(12)
    ds_write_b128 v99, v[44:47] offset:3072
    s_waitcnt lgkmcnt(0)
    s_cmp_eq_u32 s55, 1
    s_cbranch_scc1 L_rcl
    s_lshl_b32 s56, s32, 5
    s_lshl_b32 s57, 1, s31
    v_mov_b32 v252, s56
    v_mov_b32 v251, s57
    s_mov_b64 exec, 1
    global_atomic_or v253, v252, v251, s[26:27] offset:16 sc0
    s_mov_b64 exec, -1
L_rcl:
    s_add_u32 s56, s12, 524288
    s_addc_u32 s57, s13, 0
    global_load_dwordx4 v[32:35], v96, s[56:57]
    s_add_u32 s56, s12, 532480
    s_addc_u32 s57, s13, 0
    global_load_dwordx4 v[36:39], v96, s[56:57]
    s_add_u32 s56, s12, 540672
    s_addc_u32 s57, s13, 0
    global_load_dwordx4 v[40:43], v96, s[56:57]
    s_add_u32 s56, s12, 548864
    s_addc_u32 s57, s13, 0
    global_load_dwordx4 v[44:47], v96, s[56:57]
    s_barrier
    v_xor_b32 v101, 0, v100
    ds_read_b64_tr_b16 a[152:153], v101 offset:0
    ds_read_b64_tr_b16 a[154:155], v101 offset:1024
    ds_read_b64_tr_b16 a[156:157], v101 offset:8192
    ds_read_b64_tr_b16 a[158:159], v101 offset:9216
    v_xor_b32 v101, 32, v100
    ds_read_b64_tr_b16 a[200:201], v101 offset:0
    ds_read_b64_tr_b16 a[202:203], v101 offset:1024
    ds_read_b64_tr_b16 a[204:205], v101 offset:8192
    ds_read_b64_tr_b16 a[206:207], v101 offset:9216
    s_waitcnt lgkmcnt(0)
    s_barrier
    s_waitcnt vmcnt(15)
    ds_write_b128 v98, v[48:51] offset:0
    s_waitcnt vmcnt(14)
    ds_write_b128 v98, v[52:55] offset:1024
    s_waitcnt vmcnt(13)
    ds_write_b128 v99, v[56:59] offset:2048
    s_waitcnt vmcnt(12)
    ds_write_b128 v99, v[60:63] offset:3072
    s_waitcnt lgkmcnt(0)
    s_add_u32 s56, s12, 1048576
    s_addc_u32 s57, s13, 0
    global_load_dwordx4 v[48:51], v96, s[56:57]
    s_add_u32 s56, s12, 1056768
    s_addc_u32 s57, s13, 0
    global_load_dwordx4 v[52:55], v96, s[56:57]
    s_add_u32 s56, s12, 1064960
    s_addc_u32 s57, s13, 0
    global_load_dwordx4 v[56:59], v96, s[56:57]
    s_add_u32 s56, s12, 1073152
    s_addc_u32 s57, s13, 0
    global_load_dwordx4 v[60:63], v96, s[56:57]
    s_barrier
    v_xor_b32 v101, 0, v100
    ds_read_b64_tr_b16 a[136:137], v101 offset:0
    ds_read_b64_tr_b16 a[138:139], v101 offset:1024
    ds_read_b64_tr_b16 a[140:141], v101 offset:8192
    ds_read_b64_tr_b16 a[142:143], v101 offset:9216
    v_xor_b32 v101, 32, v100
    ds_read_b64_tr_b16 a[184:185], v101 offset:0
    ds_read_b64_tr_b16 a[186:187], v101 offset:1024
    ds_read_b64_tr_b16 a[188:189], v101 offset:8192
    ds_read_b64_tr_b16 a[190:191], v101 offset:9216
    s_waitcnt lgkmcnt(0)
    s_barrier
    s_waitcnt vmcnt(15)
    ds_write_b128 v98, v[64:67] offset:0
    s_waitcnt vmcnt(14)
    ds_write_b128 v98, v[68:71] offset:1024
    s_waitcnt vmcnt(13)
    ds_write_b128 v99, v[72:75] offset:2048
    s_waitcnt vmcnt(12)
    ds_write_b128 v99, v[76:79] offset:3072
    s_waitcnt lgkmcnt(0)
    s_add_u32 s56, s12, 1572864
    s_addc_u32 s57, s13, 0
    global_load_dwordx4 v[64:67], v96, s[56:57]
    s_add_u32 s56, s12, 1581056
    s_addc_u32 s57, s13, 0
    global_load_dwordx4 v[68:71], v96, s[56:57]
    s_add_u32 s56, s12, 1589248
    s_addc_u32 s57, s13, 0
    global_load_dwordx4 v[72:75], v96, s[56:57]
    s_add_u32 s56, s12, 1597440
    s_addc_u32 s57, s13, 0
    global_load_dwordx4 v[76:79], v96, s[56:57]
    s_barrier
    v_xor_b32 v101, 0, v100
    ds_read_b64_tr_b16 a[160:161], v101 offset:0
    ds_read_b64_tr_b16 a[162:163], v101 offset:1024
    ds_read_b64_tr_b16 a[164:165], v101 offset:8192
    ds_read_b64_tr_b16 a[166:167], v101 offset:9216
    v_xor_b32 v101, 32, v100
    ds_read_b64_tr_b16 a[208:209], v101 offset:0
    ds_read_b64_tr_b16 a[210:211], v101 offset:1024
    ds_read_b64_tr_b16 a[212:213], v101 offset:8192
    ds_read_b64_tr_b16 a[214:215], v101 offset:9216
    s_waitcnt lgkmcnt(0)
    s_barrier
    s_waitcnt vmcnt(15)
    ds_write_b128 v98, v[16:19] offset:0
    s_waitcnt vmcnt(14)
    ds_write_b128 v98, v[20:23] offset:1024
    s_waitcnt vmcnt(13)
    ds_write_b128 v99, v[24:27] offset:2048
    s_waitcnt vmcnt(12)
    ds_write_b128 v99, v[28:31] offset:3072
    s_waitcnt lgkmcnt(0)
    s_add_u32 s56, s12, 2097152
    s_addc_u32 s57, s13, 0
    global_load_dwordx4 v[16:19], v96, s[56:57]
    s_add_u32 s56, s12, 2105344
    s_addc_u32 s57, s13, 0
    global_load_dwordx4 v[20:23], v96, s[56:57]
    s_add_u32 s56, s12, 2113536
    s_addc_u32 s57, s13, 0
    global_load_dwordx4 v[24:27], v96, s[56:57]
    s_add_u32 s56, s12, 2121728
    s_addc_u32 s57, s13, 0
    global_load_dwordx4 v[28:31], v96, s[56:57]
    s_barrier
    v_xor_b32 v101, 0, v100
    ds_read_b64_tr_b16 v[80:81], v101 offset:0
    ds_read_b64_tr_b16 v[82:83], v101 offset:1024
    ds_read_b64_tr_b16 v[84:85], v101 offset:8192
    ds_read_b64_tr_b16 v[86:87], v101 offset:9216
    s_waitcnt lgkmcnt(2)
    ds_write_b128 v120, v[80:83] offset:0
    s_waitcnt lgkmcnt(1)
    ds_write_b128 v120, v[84:87] offset:1024
    v_xor_b32 v101, 32, v100
    ds_read_b64_tr_b16 v[80:81], v101 offset:0
    ds_read_b64_tr_b16 v[82:83], v101 offset:1024
    ds_read_b64_tr_b16 v[84:85], v101 offset:8192
    ds_read_b64_tr_b16 v[86:87], v101 offset:9216
    s_waitcnt lgkmcnt(2)
    ds_write_b128 v120, v[80:83] offset:2048
    s_waitcnt lgkmcnt(1)
    ds_write_b128 v120, v[84:87] offset:3072
    s_waitcnt lgkmcnt(0)
    s_barrier
    s_waitcnt vmcnt(15)
    ds_write_b128 v98, v[32:35] offset:0
    s_waitcnt vmcnt(14)
    ds_write_b128 v98, v[36:39] offset:1024
    s_waitcnt vmcnt(13)
    ds_write_b128 v99, v[40:43] offset:2048
    s_waitcnt vmcnt(12)
    ds_write_b128 v99, v[44:47] offset:3072
    s_waitcnt lgkmcnt(0)
    s_add_u32 s56, s12, 2621440
    s_addc_u32 s57, s13, 0
    global_load_dwordx4 v[32:35], v96, s[56:57]
    s_add_u32 s56, s12, 2629632
    s_addc_u32 s57, s13, 0
    global_load_dwordx4 v[36:39], v96, s[56:57]
    s_add_u32 s56, s12, 2637824
    s_addc_u32 s57, s13, 0
    global_load_dwordx4 v[40:43], v96, s[56:57]
    s_add_u32 s56, s12, 2646016
    s_addc_u32 s57, s13, 0
    global_load_dwordx4 v[44:47], v96, s[56:57]
    s_barrier
    v_xor_b32 v101, 0, v100
    ds_read_b64_tr_b16 a[8:9], v101 offset:0
    ds_read_b64_tr_b16 a[10:11], v101 offset:1024
    ds_read_b64_tr_b16 a[12:13], v101 offset:8192
    ds_read_b64_tr_b16 a[14:15], v101 offset:9216
    v_xor_b32 v101, 32, v100
    ds_read_b64_tr_b16 a[16:17], v101 offset:0
    ds_read_b64_tr_b16 a[18:19], v101 offset:1024
    ds_read_b64_tr_b16 a[20:21], v101 offset:8192
    ds_read_b64_tr_b16 a[22:23], v101 offset:9216
    s_waitcnt lgkmcnt(0)
    s_barrier
    s_waitcnt vmcnt(15)
    ds_write_b128 v98, v[48:51] offset:0
    s_waitcnt vmcnt(14)
    ds_write_b128 v98, v[52:55] offset:1024
    s_waitcnt vmcnt(13)
    ds_write_b128 v99, v[56:59] offset:2048
    s_waitcnt vmcnt(12)
    ds_write_b128 v99, v[60:63] offset:3072
    s_waitcnt lgkmcnt(0)
    s_cmp_eq_u32 s55, 1
    s_cbranch_scc1 L_cf2
    v_mov_b32 v252, 139264
    s_cmp_lg_u32 s30, 0
    s_cbranch_scc1 L_cg2
    s_waitcnt vmcnt(12)
    s_mov_b64 exec, 1
    ds_write_b32 v252, v253
    s_waitcnt lgkmcnt(0)
    s_mov_b64 exec, -1
L_cg2:
    s_barrier
    ds_read_b32 v253, v252
    s_waitcnt lgkmcnt(0)
    v_readfirstlane_b32 s56, v253
    s_barrier
    s_bitcmp1_b32 s56, s31
    s_cbranch_scc1 L_lost
L_cf2:
    s_add_u32 s56, s12, 3145728
    s_addc_u32 s57, s13, 0
    global_load_dwordx4 v[48:51], v96, s[56:57]
    s_add_u32 s56, s12, 3153920
    s_addc_u32 s57, s13, 0
    global_load_dwordx4 v[52:55], v96, s[56:57]
    s_add_u32 s56, s12, 3162112
    s_addc_u32 s57, s13, 0
    global_load_dwordx4 v[56:59], v96, s[56:57]
    s_add_u32 s56, s12, 3170304
    s_addc_u32 s57, s13, 0
    global_load_dwordx4 v[60:63], v96, s[56:57]
    s_barrier
    v_xor_b32 v101, 0, v100
    ds_read_b64_tr_b16 a[216:217], v101 offset:0
    ds_read_b64_tr_b16 a[218:219], v101 offset:1024
    ds_read_b64_tr_b16 a[220:221], v101 offset:8192
    ds_read_b64_tr_b16 a[222:223], v101 offset:9216
    v_xor_b32 v101, 32, v100
    ds_read_b64_tr_b16 a[224:225], v101 offset:0
    ds_read_b64_tr_b16 a[226:227], v101 offset:1024
    ds_read_b64_tr_b16 a[228:229], v101 offset:8192
    ds_read_b64_tr_b16 a[230:231], v101 offset:9216
    s_waitcnt lgkmcnt(0)
    s_barrier
    s_waitcnt vmcnt(15)
    ds_write_b128 v98, v[64:67] offset:0
    s_waitcnt vmcnt(14)
    ds_write_b128 v98, v[68:71] offset:1024
    s_waitcnt vmcnt(13)
    ds_write_b128 v99, v[72:75] offset:2048
    s_waitcnt vmcnt(12)
    ds_write_b128 v99, v[76:79] offset:3072
    s_waitcnt lgkmcnt(0)
    s_add_u32 s56, s12, 3670016
    s_addc_u32 s57, s13, 0
    global_load_dwordx4 v[64:67], v96, s[56:57]
    s_add_u32 s56, s12, 3678208
    s_addc_u32 s57, s13, 0
    global_load_dwordx4 v[68:71], v96, s[56:57]
    s_add_u32 s56, s12, 3686400
    s_addc_u32 s57, s13, 0
    global_load_dwordx4 v[72:75], v96, s[56:57]
    s_add_u32 s56, s12, 3694592
    s_addc_u32 s57, s13, 0
    global_load_dwordx4 v[76:79], v96, s[56:57]
    s_barrier
    v_xor_b32 v101, 0, v100
    ds_read_b64_tr_b16 v[144:145], v101 offset:0
    ds_read_b64_tr_b16 v[146:147], v101 offset:1024
    ds_read_b64_tr_b16 v[148:149], v101 offset:8192
    ds_read_b64_tr_b16 v[150:151], v101 offset:9216
    v_xor_b32 v101, 32, v100
    ds_read_b64_tr_b16 v[152:153], v101 offset:0
    ds_read_b64_tr_b16 v[154:155], v101 offset:1024
    ds_read_b64_tr_b16 v[156:157], v101 offset:8192
    ds_read_b64_tr_b16 v[158:159], v101 offset:9216
    s_waitcnt lgkmcnt(0)
    s_barrier
    s_waitcnt vmcnt(15)
    ds_write_b128 v98, v[16:19] offset:0
    s_waitcnt vmcnt(14)
    ds_write_b128 v98, v[20:23] offset:1024
    s_waitcnt vmcnt(13)
    ds_write_b128 v99, v[24:27] offset:2048
    s_waitcnt vmcnt(12)
    ds_write_b128 v99, v[28:31] offset:3072
    s_waitcnt lgkmcnt(0)
    s_add_u32 s56, s8, 0
    s_addc_u32 s57, s9, 0
    global_load_dwordx4 v[16:19], v96, s[56:57]
    s_add_u32 s56, s8, 8192
    s_addc_u32 s57, s9, 0
    global_load_dwordx4 v[20:23], v96, s[56:57]
    s_add_u32 s56, s8, 16384
    s_addc_u32 s57, s9, 0
    global_load_dwordx4 v[24:27], v96, s[56:57]
    s_add_u32 s56, s8, 24576
    s_addc_u32 s57, s9, 0
    global_load_dwordx4 v[28:31], v96, s[56:57]
    s_barrier
    v_xor_b32 v101, 0, v100
    ds_read_b64_tr_b16 a[232:233], v101 offset:0
    ds_read_b64_tr_b16 a[234:235], v101 offset:1024
    ds_read_b64_tr_b16 a[236:237], v101 offset:8192
    ds_read_b64_tr_b16 a[238:239], v101 offset:9216
    v_xor_b32 v101, 32, v100
    ds_read_b64_tr_b16 a[240:241], v101 offset:0
    ds_read_b64_tr_b16 a[242:243], v101 offset:1024
    ds_read_b64_tr_b16 a[244:245], v101 offset:8192
    ds_read_b64_tr_b16 a[246:247], v101 offset:9216
    s_waitcnt lgkmcnt(0)
    s_barrier
    s_waitcnt vmcnt(15)
    ds_write_b128 v98, v[32:35] offset:0
    s_waitcnt vmcnt(14)
    ds_write_b128 v98, v[36:39] offset:1024
    s_waitcnt vmcnt(13)
    ds_write_b128 v99, v[40:43] offset:2048
    s_waitcnt vmcnt(12)
    ds_write_b128 v99, v[44:47] offset:3072
    s_waitcnt lgkmcnt(0)
    s_add_u32 s56, s8, 524288
    s_addc_u32 s57, s9, 0
    global_load_dwordx4 v[32:35], v96, s[56:57]
    s_add_u32 s56, s8, 532480
    s_addc_u32 s57, s9, 0
    global_load_dwordx4 v[36:39], v96, s[56:57]
    s_add_u32 s56, s8, 540672
    s_addc_u32 s57, s9, 0
    global_load_dwordx4 v[40:43], v96, s[56:57]
    s_add_u32 s56, s8, 548864
    s_addc_u32 s57, s9, 0
    global_load_dwordx4 v[44:47], v96, s[56:57]
    s_barrier
    v_xor_b32 v101, 0, v100
    ds_read_b64_tr_b16 v[160:161], v101 offset:0
    ds_read_b64_tr_b16 v[162:163], v101 offset:1024
    ds_read_b64_tr_b16 v[164:165], v101 offset:8192
    ds_read_b64_tr_b16 v[166:167], v101 offset:9216
    v_xor_b32 v101, 32, v100
    ds_read_b64_tr_b16 v[168:169], v101 offset:0
    ds_read_b64_tr_b16 v[170:171], v101 offset:1024
    ds_read_b64_tr_b16 v[172:173], v101 offset:8192
    ds_read_b64_tr_b16 v[174:175], v101 offset:9216
    s_waitcnt lgkmcnt(0)
    s_barrier
    s_waitcnt vmcnt(15)
    ds_write_b128 v98, v[48:51] offset:0
    s_waitcnt vmcnt(14)
    ds_write_b128 v98, v[52:55] offset:1024
    s_waitcnt vmcnt(13)
    ds_write_b128 v99, v[56:59] offset:2048
    s_waitcnt vmcnt(12)
    ds_write_b128 v99, v[60:63] offset:3072
    s_waitcnt lgkmcnt(0)
    s_add_u32 s56, s8, 1048576
    s_addc_u32 s57, s9, 0
    global_load_dwordx4 v[48:51], v96, s[56:57]
    s_add_u32 s56, s8, 1056768
    s_addc_u32 s57, s9, 0
    global_load_dwordx4 v[52:55], v96, s[56:57]
    s_add_u32 s56, s8, 1064960
    s_addc_u32 s57, s9, 0
    global_load_dwordx4 v[56:59], v96, s[56:57]
    s_add_u32 s56, s8, 1073152
    s_addc_u32 s57, s9, 0
    global_load_dwordx4 v[60:63], v96, s[56:57]
    s_barrier
    v_xor_b32 v101, 0, v100
    ds_read_b64_tr_b16 a[248:249], v101 offset:0
    ds_read_b64_tr_b16 a[250:251], v101 offset:1024
    ds_read_b64_tr_b16 a[252:253], v101 offset:8192
    ds_read_b64_tr_b16 a[254:255], v101 offset:9216
    v_xor_b32 v101, 32, v100
    ds_read_b64_tr_b16 v[136:137], v101 offset:0
    ds_read_b64_tr_b16 v[138:139], v101 offset:1024
    ds_read_b64_tr_b16 v[140:141], v101 offset:8192
    ds_read_b64_tr_b16 v[142:143], v101 offset:9216
    s_waitcnt lgkmcnt(0)
    s_barrier
    s_waitcnt vmcnt(15)
    ds_write_b128 v98, v[64:67] offset:0
    s_waitcnt vmcnt(14)
    ds_write_b128 v98, v[68:71] offset:1024
    s_waitcnt vmcnt(13)
    ds_write_b128 v99, v[72:75] offset:2048
    s_waitcnt vmcnt(12)
    ds_write_b128 v99, v[76:79] offset:3072
    s_waitcnt lgkmcnt(0)
    s_add_u32 s56, s8, 1572864
    s_addc_u32 s57, s9, 0
    global_load_dwordx4 v[64:67], v96, s[56:57]
    s_add_u32 s56, s8, 1581056
    s_addc_u32 s57, s9, 0
    global_load_dwordx4 v[68:71], v96, s[56:57]
    s_add_u32 s56, s8, 1589248
    s_addc_u32 s57, s9, 0
    global_load_dwordx4 v[72:75], v96, s[56:57]
    s_add_u32 s56, s8, 1597440
    s_addc_u32 s57, s9, 0
    global_load_dwordx4 v[76:79], v96, s[56:57]
    s_barrier
    v_xor_b32 v101, 0, v100
    ds_read_b64_tr_b16 v[176:177], v101 offset:0
    ds_read_b64_tr_b16 v[178:179], v101 offset:1024
    ds_read_b64_tr_b16 v[180:181], v101 offset:8192
    ds_read_b64_tr_b16 v[182:183], v101 offset:9216
    v_xor_b32 v101, 32, v100
    ds_read_b64_tr_b16 v[184:185], v101 offset:0
    ds_read_b64_tr_b16 v[186:187], v101 offset:1024
    ds_read_b64_tr_b16 v[188:189], v101 offset:8192
    ds_read_b64_tr_b16 v[190:191], v101 offset:9216
    s_waitcnt lgkmcnt(0)
    s_barrier
    s_waitcnt vmcnt(15)
    ds_write_b128 v98, v[16:19] offset:0
    s_waitcnt vmcnt(14)
    ds_write_b128 v98, v[20:23] offset:1024
    s_waitcnt vmcnt(13)
    ds_write_b128 v99, v[24:27] offset:2048
    s_waitcnt vmcnt(12)
    ds_write_b128 v99, v[28:31] offset:3072
    s_waitcnt lgkmcnt(0)
    s_add_u32 s56, s8, 2097152
    s_addc_u32 s57, s9, 0
    global_load_dwordx4 v[16:19], v96, s[56:57]
    s_add_u32 s56, s8, 2105344
    s_addc_u32 s57, s9, 0
    global_load_dwordx4 v[20:23], v96, s[56:57]
    s_add_u32 s56, s8, 2113536
    s_addc_u32 s57, s9, 0
    global_load_dwordx4 v[24:27], v96, s[56:57]
    s_add_u32 s56, s8, 2121728
    s_addc_u32 s57, s9, 0
    global_load_dwordx4 v[28:31], v96, s[56:57]
    s_barrier
    v_xor_b32 v101, 0, v100
    ds_read_b64_tr_b16 v[80:81], v101 offset:0
    ds_read_b64_tr_b16 v[82:83], v101 offset:1024
    ds_read_b64_tr_b16 v[84:85], v101 offset:8192
    ds_read_b64_tr_b16 v[86:87], v101 offset:9216
    s_waitcnt lgkmcnt(2)
    ds_write_b128 v120, v[80:83] offset:8192
    s_waitcnt lgkmcnt(1)
    ds_write_b128 v120, v[84:87] offset:9216
    v_xor_b32 v101, 32, v100
    ds_read_b64_tr_b16 v[80:81], v101 offset:0
    ds_read_b64_tr_b16 v[82:83], v101 offset:1024
    ds_read_b64_tr_b16 v[84:85], v101 offset:8192
    ds_read_b64_tr_b16 v[86:87], v101 offset:9216
    s_waitcnt lgkmcnt(2)
    ds_write_b128 v120, v[80:83] offset:10240
    s_waitcnt lgkmcnt(1)
    ds_write_b128 v120, v[84:87] offset:11264
    s_waitcnt lgkmcnt(0)
    s_barrier
    s_waitcnt vmcnt(15)
    ds_write_b128 v98, v[32:35] offset:0
    s_waitcnt vmcnt(14)
    ds_write_b128 v98, v[36:39] offset:1024
    s_waitcnt vmcnt(13)
    ds_write_b128 v99, v[40:43] offset:2048
    s_waitcnt vmcnt(12)
    ds_write_b128 v99, v[44:47] offset:3072
    s_waitcnt lgkmcnt(0)
    s_add_u32 s56, s8, 2621440
    s_addc_u32 s57, s9, 0
    global_load_dwordx4 v[32:35], v96, s[56:57]
    s_add_u32 s56, s8, 2629632
    s_addc_u32 s57, s9, 0
    global_load_dwordx4 v[36:39], v96, s[56:57]
    s_add_u32 s56, s8, 2637824
    s_addc_u32 s57, s9, 0
    global_load_dwordx4 v[40:43], v96, s[56:57]
    s_add_u32 s56, s8, 2646016
    s_addc_u32 s57, s9, 0
    global_load_dwordx4 v[44:47], v96, s[56:57]
    s_barrier
    v_xor_b32 v101, 0, v100
    ds_read_b64_tr_b16 v[80:81], v101 offset:0
    ds_read_b64_tr_b16 v[82:83], v101 offset:1024
    ds_read_b64_tr_b16 v[84:85], v101 offset:8192
    ds_read_b64_tr_b16 v[86:87], v101 offset:9216
    s_waitcnt lgkmcnt(2)
    ds_write_b128 v120, v[80:83] offset:4096
    s_waitcnt lgkmcnt(1)
    ds_write_b128 v120, v[84:87] offset:5120
    v_xor_b32 v101, 32, v100
    ds_read_b64_tr_b16 v[80:81], v101 offset:0
    ds_read_b64_tr_b16 v[82:83], v101 offset:1024
    ds_read_b64_tr_b16 v[84:85], v101 offset:8192
    ds_read_b64_tr_b16 v[86:87], v101 offset:9216
    s_waitcnt lgkmcnt(2)
    ds_write_b128 v120, v[80:83] offset:6144
    s_waitcnt lgkmcnt(1)
    ds_write_b128 v120, v[84:87] offset:7168
    s_waitcnt lgkmcnt(0)
    s_barrier
    s_waitcnt vmcnt(15)
    ds_write_b128 v98, v[48:51] offset:0
    s_waitcnt vmcnt(14)
    ds_write_b128 v98, v[52:55] offset:1024
    s_waitcnt vmcnt(13)
    ds_write_b128 v99, v[56:59] offset:2048
    s_waitcnt vmcnt(12)
    ds_write_b128 v99, v[60:63] offset:3072
    s_waitcnt lgkmcnt(0)
    s_add_u32 s56, s8, 3145728
    s_addc_u32 s57, s9, 0
    global_load_dwordx4 v[48:51], v96, s[56:57]
    s_add_u32 s56, s8, 3153920
    s_addc_u32 s57, s9, 0
    global_load_dwordx4 v[52:55], v96, s[56:57]
    s_add_u32 s56, s8, 3162112
    s_addc_u32 s57, s9, 0
    global_load_dwordx4 v[56:59], v96, s[56:57]
    s_add_u32 s56, s8, 3170304
    s_addc_u32 s57, s9, 0
    global_load_dwordx4 v[60:63], v96, s[56:57]
    s_barrier
    v_xor_b32 v101, 0, v100
    ds_read_b64_tr_b16 a[24:25], v101 offset:0
    ds_read_b64_tr_b16 a[26:27], v101 offset:1024
    ds_read_b64_tr_b16 a[28:29], v101 offset:8192
    ds_read_b64_tr_b16 a[30:31], v101 offset:9216
    v_xor_b32 v101, 32, v100
    ds_read_b64_tr_b16 a[32:33], v101 offset:0
    ds_read_b64_tr_b16 a[34:35], v101 offset:1024
    ds_read_b64_tr_b16 a[36:37], v101 offset:8192
    ds_read_b64_tr_b16 a[38:39], v101 offset:9216
    s_waitcnt lgkmcnt(0)
    s_barrier
    s_waitcnt vmcnt(15)
    ds_write_b128 v98, v[64:67] offset:0
    s_waitcnt vmcnt(14)
    ds_write_b128 v98, v[68:71] offset:1024
    s_waitcnt vmcnt(13)
    ds_write_b128 v99, v[72:75] offset:2048
    s_waitcnt vmcnt(12)
    ds_write_b128 v99, v[76:79] offset:3072
    s_waitcnt lgkmcnt(0)
    s_add_u32 s56, s8, 3670016
    s_addc_u32 s57, s9, 0
    global_load_dwordx4 v[64:67], v96, s[56:57]
    s_add_u32 s56, s8, 3678208
    s_addc_u32 s57, s9, 0
    global_load_dwordx4 v[68:71], v96, s[56:57]
    s_add_u32 s56, s8, 3686400
    s_addc_u32 s57, s9, 0
    global_load_dwordx4 v[72:75], v96, s[56:57]
    s_add_u32 s56, s8, 3694592
    s_addc_u32 s57, s9, 0
    global_load_dwordx4 v[76:79], v96, s[56:57]
    s_barrier
    v_xor_b32 v101, 0, v100
    ds_read_b64_tr_b16 a[72:73], v101 offset:0
    ds_read_b64_tr_b16 a[74:75], v101 offset:1024
    ds_read_b64_tr_b16 a[76:77], v101 offset:8192
    ds_read_b64_tr_b16 a[78:79], v101 offset:9216
    v_xor_b32 v101, 32, v100
    ds_read_b64_tr_b16 a[80:81], v101 offset:0
    ds_read_b64_tr_b16 a[82:83], v101 offset:1024
    ds_read_b64_tr_b16 a[84:85], v101 offset:8192
    ds_read_b64_tr_b16 a[86:87], v101 offset:9216
    s_waitcnt lgkmcnt(0)
    s_barrier
    s_waitcnt vmcnt(15)
    ds_write_b128 v98, v[16:19] offset:0
    s_waitcnt vmcnt(14)
    ds_write_b128 v98, v[20:23] offset:1024
    s_waitcnt vmcnt(13)
    ds_write_b128 v99, v[24:27] offset:2048
    s_waitcnt vmcnt(12)
    ds_write_b128 v99, v[28:31] offset:3072
    s_waitcnt lgkmcnt(0)
    s_add_u32 s56, s14, 0
    s_addc_u32 s57, s15, 0
    global_load_dwordx4 v[16:19], v97, s[56:57]
    s_add_u32 s56, s14, 1024
    s_addc_u32 s57, s15, 0
    global_load_dwordx4 v[20:23], v97, s[56:57]
    s_add_u32 s56, s14, 16384
    s_addc_u32 s57, s15, 0
    global_load_dwordx4 v[24:27], v97, s[56:57]
    s_add_u32 s56, s14, 17408
    s_addc_u32 s57, s15, 0
    global_load_dwordx4 v[28:31], v97, s[56:57]
    s_barrier
    v_xor_b32 v101, 0, v100
    ds_read_b64_tr_b16 a[40:41], v101 offset:0
    ds_read_b64_tr_b16 a[42:43], v101 offset:1024
    ds_read_b64_tr_b16 a[44:45], v101 offset:8192
    ds_read_b64_tr_b16 a[46:47], v101 offset:9216
    v_xor_b32 v101, 32, v100
    ds_read_b64_tr_b16 a[48:49], v101 offset:0
    ds_read_b64_tr_b16 a[50:51], v101 offset:1024
    ds_read_b64_tr_b16 a[52:53], v101 offset:8192
    ds_read_b64_tr_b16 a[54:55], v101 offset:9216
    s_waitcnt lgkmcnt(0)
    s_barrier
    s_waitcnt vmcnt(15)
    ds_write_b128 v98, v[32:35] offset:0
    s_waitcnt vmcnt(14)
    ds_write_b128 v98, v[36:39] offset:1024
    s_waitcnt vmcnt(13)
    ds_write_b128 v99, v[40:43] offset:2048
    s_waitcnt vmcnt(12)
    ds_write_b128 v99, v[44:47] offset:3072
    s_waitcnt lgkmcnt(0)
    v_lshrrev_b32 v106, 2, v127
    global_load_dword v107, v106, s[26:27] sc1
    s_add_u32 s56, s14, 4096
    s_addc_u32 s57, s15, 0
    global_load_dwordx4 v[32:35], v97, s[56:57]
    s_add_u32 s56, s14, 5120
    s_addc_u32 s57, s15, 0
    global_load_dwordx4 v[36:39], v97, s[56:57]
    s_add_u32 s56, s14, 20480
    s_addc_u32 s57, s15, 0
    global_load_dwordx4 v[40:43], v97, s[56:57]
    s_add_u32 s56, s14, 21504
    s_addc_u32 s57, s15, 0
    global_load_dwordx4 v[44:47], v97, s[56:57]
    s_barrier
    v_xor_b32 v101, 0, v100
    ds_read_b64_tr_b16 a[88:89], v101 offset:0
    ds_read_b64_tr_b16 a[90:91], v101 offset:1024
    ds_read_b64_tr_b16 a[92:93], v101 offset:8192
    ds_read_b64_tr_b16 a[94:95], v101 offset:9216
    v_xor_b32 v101, 32, v100
    ds_read_b64_tr_b16 a[96:97], v101 offset:0
    ds_read_b64_tr_b16 a[98:99], v101 offset:1024
    ds_read_b64_tr_b16 a[100:101], v101 offset:8192
    ds_read_b64_tr_b16 a[102:103], v101 offset:9216
    s_waitcnt lgkmcnt(0)
    s_barrier
    s_waitcnt vmcnt(16)
    ds_write_b128 v98, v[48:51] offset:0
    s_waitcnt vmcnt(15)
    ds_write_b128 v98, v[52:55] offset:1024
    s_waitcnt vmcnt(14)
    ds_write_b128 v99, v[56:59] offset:2048
    s_waitcnt vmcnt(13)
    ds_write_b128 v99, v[60:63] offset:3072
    s_waitcnt lgkmcnt(0)
    s_add_u32 s56, s14, 8192
    s_addc_u32 s57, s15, 0
    global_load_dwordx4 v[48:51], v97, s[56:57]
    s_add_u32 s56, s14, 9216
    s_addc_u32 s57, s15, 0
    global_load_dwordx4 v[52:55], v97, s[56:57]
    s_add_u32 s56, s14, 24576
    s_addc_u32 s57, s15, 0
    global_load_dwordx4 v[56:59], v97, s[56:57]
    s_add_u32 s56, s14, 25600
    s_addc_u32 s57, s15, 0
    global_load_dwordx4 v[60:63], v97, s[56:57]
    s_barrier
    v_xor_b32 v101, 0, v100
    ds_read_b64_tr_b16 a[56:57], v101 offset:0
    ds_read_b64_tr_b16 a[58:59], v101 offset:1024
    ds_read_b64_tr_b16 a[60:61], v101 offset:8192
    ds_read_b64_tr_b16 a[62:63], v101 offset:9216
    v_xor_b32 v101, 32, v100
    ds_read_b64_tr_b16 a[64:65], v101 offset:0
    ds_read_b64_tr_b16 a[66:67], v101 offset:1024
    ds_read_b64_tr_b16 a[68:69], v101 offset:8192
    ds_read_b64_tr_b16 a[70:71], v101 offset:9216
    s_waitcnt lgkmcnt(0)
    s_barrier
    s_waitcnt vmcnt(16)
    ds_write_b128 v98, v[64:67] offset:0
    s_waitcnt vmcnt(15)
    ds_write_b128 v98, v[68:71] offset:1024
    s_waitcnt vmcnt(14)
    ds_write_b128 v99, v[72:75] offset:2048
    s_waitcnt vmcnt(13)
    ds_write_b128 v99, v[76:79] offset:3072
    s_waitcnt lgkmcnt(0)
    s_add_u32 s56, s14, 12288
    s_addc_u32 s57, s15, 0
    global_load_dwordx4 v[64:67], v97, s[56:57]
    s_add_u32 s56, s14, 13312
    s_addc_u32 s57, s15, 0
    global_load_dwordx4 v[68:71], v97, s[56:57]
    s_add_u32 s56, s14, 28672
    s_addc_u32 s57, s15, 0
    global_load_dwordx4 v[72:75], v97, s[56:57]
    s_add_u32 s56, s14, 29696
    s_addc_u32 s57, s15, 0
    global_load_dwordx4 v[76:79], v97, s[56:57]
    s_barrier
    v_xor_b32 v101, 0, v100
    ds_read_b64_tr_b16 a[104:105], v101 offset:0
    ds_read_b64_tr_b16 a[106:107], v101 offset:1024
    ds_read_b64_tr_b16 a[108:109], v101 offset:8192
    ds_read_b64_tr_b16 a[110:111], v101 offset:9216
    v_xor_b32 v101, 32, v100
    ds_read_b64_tr_b16 a[112:113], v101 offset:0
    ds_read_b64_tr_b16 a[114:115], v101 offset:1024
    ds_read_b64_tr_b16 a[116:117], v101 offset:8192
    ds_read_b64_tr_b16 a[118:119], v101 offset:9216
    s_waitcnt lgkmcnt(0)
    s_barrier
    s_waitcnt vmcnt(16)
    ds_write_b128 v94, v[16:19] offset:0
    s_waitcnt vmcnt(15)
    ds_write_b128 v95, v[20:23] offset:1024
    s_waitcnt vmcnt(14)
    ds_write_b128 v94, v[24:27] offset:2048
    s_waitcnt vmcnt(13)
    ds_write_b128 v95, v[28:31] offset:3072
    s_waitcnt lgkmcnt(0)
    s_add_u32 s56, s14, 65536
    s_addc_u32 s57, s15, 0
    global_load_dwordx4 v[16:19], v97, s[56:57]
    s_add_u32 s56, s14, 66560
    s_addc_u32 s57, s15, 0
    global_load_dwordx4 v[20:23], v97, s[56:57]
    s_add_u32 s56, s14, 81920
    s_addc_u32 s57, s15, 0
    global_load_dwordx4 v[24:27], v97, s[56:57]
    s_add_u32 s56, s14, 82944
    s_addc_u32 s57, s15, 0
    global_load_dwordx4 v[28:31], v97, s[56:57]
    s_barrier
    v_xor_b32 v101, 0, v105
    ds_read_b64_tr_b16 v[80:81], v101 offset:0
    ds_read_b64_tr_b16 v[82:83], v101 offset:2048
    v_xor_b32 v101, 64, v105
    ds_read_b64_tr_b16 v[84:85], v101 offset:0
    ds_read_b64_tr_b16 v[86:87], v101 offset:2048
    v_xor_b32 v101, 128, v105
    ds_read_b64_tr_b16 v[224:225], v101 offset:0
    ds_read_b64_tr_b16 v[226:227], v101 offset:2048
    v_xor_b32 v101, 192, v105
    ds_read_b64_tr_b16 v[240:241], v101 offset:0
    ds_read_b64_tr_b16 v[242:243], v101 offset:2048
    s_waitcnt lgkmcnt(6)
    ds_write_b128 v120, v[80:83] offset:18432
    s_waitcnt lgkmcnt(5)
    ds_write_b128 v120, v[84:87] offset:20480
    s_waitcnt lgkmcnt(0)
    s_barrier
    s_waitcnt vmcnt(15)
    ds_write_b128 v94, v[32:35] offset:0
    s_waitcnt vmcnt(14)
    ds_write_b128 v95, v[36:39] offset:1024
    s_waitcnt vmcnt(13)
    ds_write_b128 v94, v[40:43] offset:2048
    s_waitcnt vmcnt(12)
    ds_write_b128 v95, v[44:47] offset:3072
    s_waitcnt lgkmcnt(0)
    s_getpc_b64 s[56:57]
L_rpc0:
    s_add_u32 s56, s56, L_rcode-L_rpc0+0
    s_addc_u32 s57, s57, 0
    v_lshlrev_b32 v130, 1, v127
    global_load_dword v133, v130, s[40:41] sc1
    v_lshlrev_b32 v130, 2, v127
    global_load_dword v132, v130, s[56:57]
    v_add_u32 v130, 0, v130
    global_load_dword v134, v130, s[44:45] sc1
    s_add_u32 s56, s14, 69632
    s_addc_u32 s57, s15, 0
    global_load_dwordx4 v[32:35], v97, s[56:57]
    s_add_u32 s56, s14, 70656
    s_addc_u32 s57, s15, 0
    global_load_dwordx4 v[36:39], v97, s[56:57]
    s_add_u32 s56, s14, 86016
    s_addc_u32 s57, s15, 0
    global_load_dwordx4 v[40:43], v97, s[56:57]
    s_add_u32 s56, s14, 87040
    s_addc_u32 s57, s15, 0
    global_load_dwordx4 v[44:47], v97, s[56:57]
    s_barrier
    v_xor_b32 v101, 0, v105
    ds_read_b64_tr_b16 v[80:81], v101 offset:0
    ds_read_b64_tr_b16 v[82:83], v101 offset:2048
    v_xor_b32 v101, 64, v105
    ds_read_b64_tr_b16 v[84:85], v101 offset:0
    ds_read_b64_tr_b16 v[86:87], v101 offset:2048
    v_xor_b32 v101, 128, v105
    ds_read_b64_tr_b16 v[228:229], v101 offset:0
    ds_read_b64_tr_b16 v[230:231], v101 offset:2048
    v_xor_b32 v101, 192, v105
    ds_read_b64_tr_b16 v[244:245], v101 offset:0
    ds_read_b64_tr_b16 v[246:247], v101 offset:2048
    s_waitcnt lgkmcnt(6)
    ds_write_b128 v120, v[80:83] offset:19456
    s_waitcnt lgkmcnt(5)
    ds_write_b128 v120, v[84:87] offset:21504
    s_waitcnt lgkmcnt(0)
    s_barrier
    s_waitcnt vmcnt(15)
    ds_write_b128 v94, v[48:51] offset:0
    s_waitcnt vmcnt(14)
    ds_write_b128 v95, v[52:55] offset:1024
    s_waitcnt vmcnt(13)
    ds_write_b128 v94, v[56:59] offset:2048
    s_waitcnt vmcnt(12)
    ds_write_b128 v95, v[60:63] offset:3072
    s_waitcnt lgkmcnt(0)
    v_readlane_b32 s63, v107, 4
    s_mov_b32 exec_lo, 0x20200
    s_mov_b32 exec_hi, 0x40000
    v_cmp_gt_u32 vcc, 32, v107
    s_cmp_eq_u32 s63, -1
    s_cselect_b32 s63, 1, 0
    s_cmp_eq_u64 vcc, 0
    s_cselect_b32 s63, s63, 0
    s_mov_b64 exec, 0xff
    global_load_dword v107, v106, s[68:69] offset:256 sc1
    s_mov_b64 exec, -1
    s_add_u32 s56, s14, 73728
    s_addc_u32 s57, s15, 0
    global_load_dwordx4 v[48:51], v97, s[56:57]
    s_add_u32 s56, s14, 74752
    s_addc_u32 s57, s15, 0
    global_load_dwordx4 v[52:55], v97, s[56:57]
    s_add_u32 s56, s14, 90112
    s_addc_u32 s57, s15, 0
    global_load_dwordx4 v[56:59], v97, s[56:57]
    s_add_u32 s56, s14, 91136
    s_addc_u32 s57, s15, 0
    global_load_dwordx4 v[60:63], v97, s[56:57]
    s_barrier
    v_xor_b32 v101, 0, v105
    ds_read_b64_tr_b16 v[80:81], v101 offset:0
    ds_read_b64_tr_b16 v[82:83], v101 offset:2048
    v_xor_b32 v101, 64, v105
    ds_read_b64_tr_b16 v[84:85], v101 offset:0
    ds_read_b64_tr_b16 v[86:87], v101 offset:2048
    v_xor_b32 v101, 128, v105
    ds_read_b64_tr_b16 v[88:89], v101 offset:0
    ds_read_b64_tr_b16 v[90:91], v101 offset:2048
    s_waitcnt lgkmcnt(4)
    ds_write_b128 v120, v[80:83] offset:22528
    v_xor_b32 v101, 192, v105
    ds_read_b64_tr_b16 v[80:81], v101 offset:0
    ds_read_b64_tr_b16 v[82:83], v101 offset:2048
    s_waitcnt lgkmcnt(5)
    ds_write_b128 v120, v[84:87] offset:24576
    s_waitcnt lgkmcnt(4)
    ds_write_b128 v120, v[88:91] offset:26624
    s_waitcnt lgkmcnt(2)
    ds_write_b128 v120, v[80:83] offset:30720
    s_waitcnt lgkmcnt(0)
    s_barrier
    s_waitcnt vmcnt(16)
    ds_write_b128 v94, v[64:67] offset:0
    s_waitcnt vmcnt(15)
    ds_write_b128 v95, v[68:71] offset:1024
    s_waitcnt vmcnt(14)
    ds_write_b128 v94, v[72:75] offset:2048
    s_waitcnt vmcnt(13)
    ds_write_b128 v95, v[76:79] offset:3072
    s_waitcnt lgkmcnt(0)
    s_add_u32 s56, s14, 77824
    s_addc_u32 s57, s15, 0
    global_load_dwordx4 v[64:67], v97, s[56:57]
    s_add_u32 s56, s14, 78848
    s_addc_u32 s57, s15, 0
    global_load_dwordx4 v[68:71], v97, s[56:57]
    s_add_u32 s56, s14, 94208
    s_addc_u32 s57, s15, 0
    global_load_dwordx4 v[72:75], v97, s[56:57]
    s_add_u32 s56, s14, 95232
    s_addc_u32 s57, s15, 0
    global_load_dwordx4 v[76:79], v97, s[56:57]
    s_barrier
    v_xor_b32 v101, 0, v105
    ds_read_b64_tr_b16 v[80:81], v101 offset:0
    ds_read_b64_tr_b16 v[82:83], v101 offset:2048
    v_xor_b32 v101, 64, v105
    ds_read_b64_tr_b16 v[84:85], v101 offset:0
    ds_read_b64_tr_b16 v[86:87], v101 offset:2048
    v_xor_b32 v101, 128, v105
    ds_read_b64_tr_b16 v[88:89], v101 offset:0
    ds_read_b64_tr_b16 v[90:91], v101 offset:2048
    s_waitcnt lgkmcnt(4)
    ds_write_b128 v120, v[80:83] offset:23552
    v_xor_b32 v101, 192, v105
    ds_read_b64_tr_b16 v[80:81], v101 offset:0
    ds_read_b64_tr_b16 v[82:83], v101 offset:2048
    s_waitcnt lgkmcnt(5)
    ds_write_b128 v120, v[84:87] offset:25600
    s_waitcnt lgkmcnt(4)
    ds_write_b128 v120, v[88:91] offset:27648
    s_waitcnt lgkmcnt(2)
    ds_write_b128 v120, v[80:83] offset:31744
    s_waitcnt lgkmcnt(0)
    s_barrier
    s_waitcnt vmcnt(16)
    ds_write_b128 v94, v[16:19] offset:0
    s_waitcnt vmcnt(15)
    ds_write_b128 v95, v[20:23] offset:1024
    s_waitcnt vmcnt(14)
    ds_write_b128 v94, v[24:27] offset:2048
    s_waitcnt vmcnt(13)
    ds_write_b128 v95, v[28:31] offset:3072
    s_waitcnt lgkmcnt(0)
    s_barrier
    v_xor_b32 v101, 0, v105
    ds_read_b64_tr_b16 v[192:193], v101 offset:0
    ds_read_b64_tr_b16 v[194:195], v101 offset:2048
    v_xor_b32 v101, 64, v105
    ds_read_b64_tr_b16 v[208:209], v101 offset:0
    ds_read_b64_tr_b16 v[210:211], v101 offset:2048
    v_xor_b32 v101, 128, v105
    ds_read_b64_tr_b16 v[232:233], v101 offset:0
    ds_read_b64_tr_b16 v[234:235], v101 offset:2048
    v_xor_b32 v101, 192, v105
    ds_read_b64_tr_b16 v[248:249], v101 offset:0
    ds_read_b64_tr_b16 v[250:251], v101 offset:2048
    s_waitcnt lgkmcnt(0)
    s_barrier
    s_waitcnt vmcnt(12)
    ds_write_b128 v94, v[32:35] offset:0
    s_waitcnt vmcnt(11)
    ds_write_b128 v95, v[36:39] offset:1024
    s_waitcnt vmcnt(10)
    ds_write_b128 v94, v[40:43] offset:2048
    s_waitcnt vmcnt(9)
    ds_write_b128 v95, v[44:47] offset:3072
    s_waitcnt lgkmcnt(0)
    s_mov_b64 exec, 6
    s_waitcnt vmcnt(8)
    v_cmp_gt_u32 vcc, 2, v107
    s_mov_b64 exec, -1
    s_cmp_eq_u64 vcc, 0
    s_cselect_b32 s56, s63, 0
    s_add_u32 s63, s63, s56
    s_cmp_lg_u32 s63, 2
    s_cbranch_scc1 L_rnf0
    s_mov_b32 m0, s62
    s_nop 0
    global_load_lds_dwordx4 v127, s[48:49] sc1
    global_load_lds_dwordx4 v127, s[48:49] offset:1024 sc1
    v_lshlrev_b32 v130, 1, v127
    global_load_dword v131, v130, s[50:51] sc1
L_rnf0:
    s_barrier
    v_xor_b32 v101, 0, v105
    ds_read_b64_tr_b16 v[196:197], v101 offset:0
    ds_read_b64_tr_b16 v[198:199], v101 offset:2048
    v_xor_b32 v101, 64, v105
    ds_read_b64_tr_b16 v[212:213], v101 offset:0
    ds_read_b64_tr_b16 v[214:215], v101 offset:2048
    v_xor_b32 v101, 128, v105
    ds_read_b64_tr_b16 v[236:237], v101 offset:0
    ds_read_b64_tr_b16 v[238:239], v101 offset:2048
    v_xor_b32 v101, 192, v105
    ds_read_b64_tr_b16 v[252:253], v101 offset:0
    ds_read_b64_tr_b16 v[254:255], v101 offset:2048
    s_waitcnt lgkmcnt(0)
    s_barrier
    s_waitcnt vmcnt(7)
    ds_write_b128 v94, v[48:51] offset:0
    s_waitcnt vmcnt(6)
    ds_write_b128 v95, v[52:55] offset:1024
    s_waitcnt vmcnt(5)
    ds_write_b128 v94, v[56:59] offset:2048
    s_waitcnt vmcnt(4)
    ds_write_b128 v95, v[60:63] offset:3072
    s_waitcnt lgkmcnt(0)
    s_barrier
    v_xor_b32 v101, 0, v105
    ds_read_b64_tr_b16 v[200:201], v101 offset:0
    ds_read_b64_tr_b16 v[202:203], v101 offset:2048
    v_xor_b32 v101, 64, v105
    ds_read_b64_tr_b16 v[216:217], v101 offset:0
    ds_read_b64_tr_b16 v[218:219], v101 offset:2048
    v_xor_b32 v101, 128, v105
    ds_read_b64_tr_b16 v[80:81], v101 offset:0
    ds_read_b64_tr_b16 v[82:83], v101 offset:2048
    v_xor_b32 v101, 192, v105
    ds_read_b64_tr_b16 v[84:85], v101 offset:0
    ds_read_b64_tr_b16 v[86:87], v101 offset:2048
    s_waitcnt lgkmcnt(2)
    ds_write_b128 v120, v[80:83] offset:28672
    s_waitcnt lgkmcnt(1)
    ds_write_b128 v120, v[84:87] offset:32768
    s_waitcnt lgkmcnt(0)
    s_barrier
    s_waitcnt vmcnt(3)
    ds_write_b128 v94, v[64:67] offset:0
    s_waitcnt vmcnt(2)
    ds_write_b128 v95, v[68:71] offset:1024
    s_waitcnt vmcnt(1)
    ds_write_b128 v94, v[72:75] offset:2048
    s_waitcnt vmcnt(0)
    ds_write_b128 v95, v[76:79] offset:3072
    s_waitcnt lgkmcnt(0)
    s_barrier
    v_xor_b32 v101, 0, v105
    ds_read_b64_tr_b16 v[204:205], v101 offset:0
    ds_read_b64_tr_b16 v[206:207], v101 offset:2048
    v_xor_b32 v101, 64, v105
    ds_read_b64_tr_b16 v[220:221], v101 offset:0
    ds_read_b64_tr_b16 v[222:223], v101 offset:2048
    v_xor_b32 v101, 128, v105
    ds_read_b64_tr_b16 v[80:81], v101 offset:0
    ds_read_b64_tr_b16 v[82:83], v101 offset:2048
    v_xor_b32 v101, 192, v105
    ds_read_b64_tr_b16 v[84:85], v101 offset:0
    ds_read_b64_tr_b16 v[86:87], v101 offset:2048
    s_waitcnt lgkmcnt(2)
    ds_write_b128 v120, v[80:83] offset:29696
    s_waitcnt lgkmcnt(1)
    ds_write_b128 v120, v[84:87] offset:33792
    s_waitcnt lgkmcnt(0)
    s_barrier
    s_branch L_rwdonea
L_rwa_1:
    s_waitcnt vmcnt(15)
    ds_write_b128 v98, v[16:19] offset:0
    s_waitcnt vmcnt(14)
    ds_write_b128 v98, v[20:23] offset:1024
    s_waitcnt vmcnt(13)
    ds_write_b128 v99, v[24:27] offset:2048
    s_waitcnt vmcnt(12)
    ds_write_b128 v99, v[28:31] offset:3072
    s_waitcnt lgkmcnt(0)
    s_add_u32 s56, s10, 2097152
    s_addc_u32 s57, s11, 0
    global_load_dwordx4 v[16:19], v96, s[56:57]
    s_add_u32 s56, s10, 2105344
    s_addc_u32 s57, s11, 0
    global_load_dwordx4 v[20:23], v96, s[56:57]
    s_add_u32 s56, s10, 2113536
    s_addc_u32 s57, s11, 0
    global_load_dwordx4 v[24:27], v96, s[56:57]
    s_add_u32 s56, s10, 2121728
    s_addc_u32 s57, s11, 0
    global_load_dwordx4 v[28:31], v96, s[56:57]
    s_barrier
    v_xor_b32 v101, 64, v100
    ds_read_b64_tr_b16 a[136:137], v101 offset:0
    ds_read_b64_tr_b16 a[138:139], v101 offset:1024
    ds_read_b64_tr_b16 a[140:141], v101 offset:8192
    ds_read_b64_tr_b16 a[142:143], v101 offset:9216
    v_xor_b32 v101, 96, v100
    ds_read_b64_tr_b16 a[184:185], v101 offset:0
    ds_read_b64_tr_b16 a[186:187], v101 offset:1024
    ds_read_b64_tr_b16 a[188:189], v101 offset:8192
    ds_read_b64_tr_b16 a[190:191], v101 offset:9216
    s_waitcnt lgkmcnt(0)
    s_barrier
    s_waitcnt vmcnt(15)
    ds_write_b128 v98, v[32:35] offset:0
    s_waitcnt vmcnt(14)
    ds_write_b128 v98, v[36:39] offset:1024
    s_waitcnt vmcnt(13)
    ds_write_b128 v99, v[40:43] offset:2048
    s_waitcnt vmcnt(12)
    ds_write_b128 v99, v[44:47] offset:3072
    s_waitcnt lgkmcnt(0)
    s_add_u32 s56, s10, 2621440
    s_addc_u32 s57, s11, 0
    global_load_dwordx4 v[32:35], v96, s[56:57]
    s_add_u32 s56, s10, 2629632
    s_addc_u32 s57, s11, 0
    global_load_dwordx4 v[36:39], v96, s[56:57]
    s_add_u32 s56, s10, 2637824
    s_addc_u32 s57, s11, 0
    global_load_dwordx4 v[40:43], v96, s[56:57]
    s_add_u32 s56, s10, 2646016
    s_addc_u32 s57, s11, 0
    global_load_dwordx4 v[44:47], v96, s[56:57]
    s_barrier
    v_xor_b32 v101, 64, v100
    ds_read_b64_tr_b16 a[160:161], v101 offset:0
    ds_read_b64_tr_b16 a[162:163], v101 offset:1024
    ds_read_b64_tr_b16 a[164:165], v101 offset:8192
    ds_read_b64_tr_b16 a[166:167], v101 offset:9216
    v_xor_b32 v101, 96, v100
    ds_read_b64_tr_b16 a[208:209], v101 offset:0
    ds_read_b64_tr_b16 a[210:211], v101 offset:1024
    ds_read_b64_tr_b16 a[212:213], v101 offset:8192
    ds_read_b64_tr_b16 a[214:215], v101 offset:9216
    s_waitcnt lgkmcnt(0)
    s_barrier
    s_waitcnt vmcnt(15)
    ds_write_b128 v98, v[48:51] offset:0
    s_waitcnt vmcnt(14)
    ds_write_b128 v98, v[52:55] offset:1024
    s_waitcnt vmcnt(13)
    ds_write_b128 v99, v[56:59] offset:2048
    s_waitcnt vmcnt(12)
    ds_write_b128 v99, v[60:63] offset:3072
    s_waitcnt lgkmcnt(0)
    s_add_u32 s56, s10, 3145728
    s_addc_u32 s57, s11, 0
    global_load_dwordx4 v[48:51], v96, s[56:57]
    s_add_u32 s56, s10, 3153920
    s_addc_u32 s57, s11, 0
    global_load_dwordx4 v[52:55], v96, s[56:57]
    s_add_u32 s56, s10, 3162112
    s_addc_u32 s57, s11, 0
    global_load_dwordx4 v[56:59], v96, s[56:57]
    s_add_u32 s56, s10, 3170304
    s_addc_u32 s57, s11, 0
    global_load_dwordx4 v[60:63], v96, s[56:57]
    s_barrier
    v_xor_b32 v101, 64, v100
    ds_read_b64_tr_b16 v[80:81], v101 offset:0
    ds_read_b64_tr_b16 v[82:83], v101 offset:1024
    ds_read_b64_tr_b16 v[84:85], v101 offset:8192
    ds_read_b64_tr_b16 v[86:87], v101 offset:9216
    s_waitcnt lgkmcnt(2)
    ds_write_b128 v120, v[80:83] offset:12288
    s_waitcnt lgkmcnt(1)
    ds_write_b128 v120, v[84:87] offset:13312
    v_xor_b32 v101, 96, v100
    ds_read_b64_tr_b16 v[80:81], v101 offset:0
    ds_read_b64_tr_b16 v[82:83], v101 offset:1024
    ds_read_b64_tr_b16 v[84:85], v101 offset:8192
    ds_read_b64_tr_b16 v[86:87], v101 offset:9216
    s_waitcnt lgkmcnt(2)
    ds_write_b128 v120, v[80:83] offset:16384
    s_waitcnt lgkmcnt(1)
    ds_write_b128 v120, v[84:87] offset:17408
    s_waitcnt lgkmcnt(0)
    s_barrier
    s_waitcnt vmcnt(15)
    ds_write_b128 v98, v[64:67] offset:0
    s_waitcnt vmcnt(14)
    ds_write_b128 v98, v[68:71] offset:1024
    s_waitcnt vmcnt(13)
    ds_write_b128 v99, v[72:75] offset:2048
    s_waitcnt vmcnt(12)
    ds_write_b128 v99, v[76:79] offset:3072
    s_waitcnt lgkmcnt(0)
    s_add_u32 s56, s10, 3670016
    s_addc_u32 s57, s11, 0
    global_load_dwordx4 v[64:67], v96, s[56:57]
    s_add_u32 s56, s10, 3678208
    s_addc_u32 s57, s11, 0
    global_load_dwordx4 v[68:71], v96, s[56:57]
    s_add_u32 s56, s10, 3686400
    s_addc_u32 s57, s11, 0
    global_load_dwordx4 v[72:75], v96, s[56:57]
    s_add_u32 s56, s10, 3694592
    s_addc_u32 s57, s11, 0
    global_load_dwordx4 v[76:79], v96, s[56:57]
    s_barrier
    v_xor_b32 v101, 64, v100
    ds_read_b64_tr_b16 v[80:81], v101 offset:0
    ds_read_b64_tr_b16 v[82:83], v101 offset:1024
    ds_read_b64_tr_b16 v[84:85], v101 offset:8192
    ds_read_b64_tr_b16 v[86:87], v101 offset:9216
    s_waitcnt lgkmcnt(2)
    ds_write_b128 v120, v[80:83] offset:14336
    s_waitcnt lgkmcnt(1)
    ds_write_b128 v120, v[84:87] offset:15360
    v_xor_b32 v101, 96, v100
    ds_read_b64_tr_b16 a[0:1], v101 offset:0
    ds_read_b64_tr_b16 a[2:3], v101 offset:1024
    ds_read_b64_tr_b16 a[4:5], v101 offset:8192
    ds_read_b64_tr_b16 a[6:7], v101 offset:9216
    s_waitcnt lgkmcnt(0)
    s_barrier
    s_waitcnt vmcnt(15)
    ds_write_b128 v98, v[16:19] offset:0
    s_waitcnt vmcnt(14)
    ds_write_b128 v98, v[20:23] offset:1024
    s_waitcnt vmcnt(13)
    ds_write_b128 v99, v[24:27] offset:2048
    s_waitcnt vmcnt(12)
    ds_write_b128 v99, v[28:31] offset:3072
    s_waitcnt lgkmcnt(0)
    s_add_u32 s56, s12, 0
    s_addc_u32 s57, s13, 0
    global_load_dwordx4 v[16:19], v96, s[56:57]
    s_add_u32 s56, s12, 8192
    s_addc_u32 s57, s13, 0
    global_load_dwordx4 v[20:23], v96, s[56:57]
    s_add_u32 s56, s12, 16384
    s_addc_u32 s57, s13, 0
    global_load_dwordx4 v[24:27], v96, s[56:57]
    s_add_u32 s56, s12, 24576
    s_addc_u32 s57, s13, 0
    global_load_dwordx4 v[28:31], v96, s[56:57]
    s_barrier
    v_xor_b32 v101, 64, v100
    ds_read_b64_tr_b16 a[120:121], v101 offset:0
    ds_read_b64_tr_b16 a[122:123], v101 offset:1024
    ds_read_b64_tr_b16 a[124:125], v101 offset:8192
    ds_read_b64_tr_b16 a[126:127], v101 offset:9216
    v_xor_b32 v101, 96, v100
    ds_read_b64_tr_b16 a[168:169], v101 offset:0
    ds_read_b64_tr_b16 a[170:171], v101 offset:1024
    ds_read_b64_tr_b16 a[172:173], v101 offset:8192
    ds_read_b64_tr_b16 a[174:175], v101 offset:9216
    s_waitcnt lgkmcnt(0)
    s_barrier
    s_waitcnt vmcnt(15)
    ds_write_b128 v98, v[32:35] offset:0
    s_waitcnt vmcnt(14)
    ds_write_b128 v98, v[36:39] offset:1024
    s_waitcnt vmcnt(13)
    ds_write_b128 v99, v[40:43] offset:2048
    s_waitcnt vmcnt(12)
    ds_write_b128 v99, v[44:47] offset:3072
    s_waitcnt lgkmcnt(0)
    s_add_u32 s56, s12, 524288
    s_addc_u32 s57, s13, 0
    global_load_dwordx4 v[32:35], v96, s[56:57]
    s_add_u32 s56, s12, 532480
    s_addc_u32 s57, s13, 0
    global_load_dwordx4 v[36:39], v96, s[56:57]
    s_add_u32 s56, s12, 540672
    s_addc_u32 s57, s13, 0
    global_load_dwordx4 v[40:43], v96, s[56:57]
    s_add_u32 s56, s12, 548864
    s_addc_u32 s57, s13, 0
    global_load_dwordx4 v[44:47], v96, s[56:57]
    s_barrier
    v_xor_b32 v101, 64, v100
    ds_read_b64_tr_b16 a[144:145], v101 offset:0
    ds_read_b64_tr_b16 a[146:147], v101 offset:1024
    ds_read_b64_tr_b16 a[148:149], v101 offset:8192
    ds_read_b64_tr_b16 a[150:151], v101 offset:9216
    v_xor_b32 v101, 96, v100
    ds_read_b64_tr_b16 a[192:193], v101 offset:0
    ds_read_b64_tr_b16 a[194:195], v101 offset:1024
    ds_read_b64_tr_b16 a[196:197], v101 offset:8192
    ds_read_b64_tr_b16 a[198:199], v101 offset:9216
    s_waitcnt lgkmcnt(0)
    s_barrier
    s_waitcnt vmcnt(15)
    ds_write_b128 v98, v[48:51] offset:0
    s_waitcnt vmcnt(14)
    ds_write_b128 v98, v[52:55] offset:1024
    s_waitcnt vmcnt(13)
    ds_write_b128 v99, v[56:59] offset:2048
    s_waitcnt vmcnt(12)
    ds_write_b128 v99, v[60:63] offset:3072
    s_waitcnt lgkmcnt(0)
    s_add_u32 s56, s12, 1048576
    s_addc_u32 s57, s13, 0
    global_load_dwordx4 v[48:51], v96, s[56:57]
    s_add_u32 s56, s12, 1056768
    s_addc_u32 s57, s13, 0
    global_load_dwordx4 v[52:55], v96, s[56:57]
    s_add_u32 s56, s12, 1064960
    s_addc_u32 s57, s13, 0
    global_load_dwordx4 v[56:59], v96, s[56:57]
    s_add_u32 s56, s12, 1073152
    s_addc_u32 s57, s13, 0
    global_load_dwordx4 v[60:63], v96, s[56:57]
    s_barrier
    v_xor_b32 v101, 64, v100
    ds_read_b64_tr_b16 a[128:129], v101 offset:0
    ds_read_b64_tr_b16 a[130:131], v101 offset:1024
    ds_read_b64_tr_b16 a[132:133], v101 offset:8192
    ds_read_b64_tr_b16 a[134:135], v101 offset:9216
    v_xor_b32 v101, 96, v100
    ds_read_b64_tr_b16 a[176:177], v101 offset:0
    ds_read_b64_tr_b16 a[178:179], v101 offset:1024
    ds_read_b64_tr_b16 a[180:181], v101 offset:8192
    ds_read_b64_tr_b16 a[182:183], v101 offset:9216
    s_waitcnt lgkmcnt(0)
    s_barrier
    s_waitcnt vmcnt(15)
    ds_write_b128 v98, v[64:67] offset:0
    s_waitcnt vmcnt(14)
    ds_write_b128 v98, v[68:71] offset:1024
    s_waitcnt vmcnt(13)
    ds_write_b128 v99, v[72:75] offset:2048
    s_waitcnt vmcnt(12)
    ds_write_b128 v99, v[76:79] offset:3072
    s_waitcnt lgkmcnt(0)
    s_add_u32 s56, s12, 1572864
    s_addc_u32 s57, s13, 0
    global_load_dwordx4 v[64:67], v96, s[56:57]
    s_add_u32 s56, s12, 1581056
    s_addc_u32 s57, s13, 0
    global_load_dwordx4 v[68:71], v96, s[56:57]
    s_add_u32 s56, s12, 1589248
    s_addc_u32 s57, s13, 0
    global_load_dwordx4 v[72:75], v96, s[56:57]
    s_add_u32 s56, s12, 1597440
    s_addc_u32 s57, s13, 0
    global_load_dwordx4 v[76:79], v96, s[56:57]
    s_barrier
    v_xor_b32 v101, 64, v100
    ds_read_b64_tr_b16 a[152:153], v101 offset:0
    ds_read_b64_tr_b16 a[154:155], v101 offset:1024
    ds_read_b64_tr_b16 a[156:157], v101 offset:8192
    ds_read_b64_tr_b16 a[158:159], v101 offset:9216
    v_xor_b32 v101, 96, v100
    ds_read_b64_tr_b16 a[200:201], v101 offset:0
    ds_read_b64_tr_b16 a[202:203], v101 offset:1024
    ds_read_b64_tr_b16 a[204:205], v101 offset:8192
    ds_read_b64_tr_b16 a[206:207], v101 offset:9216
    s_waitcnt lgkmcnt(0)
    s_barrier
    s_waitcnt vmcnt(15)
    ds_write_b128 v98, v[16:19] offset:0
    s_waitcnt vmcnt(14)
    ds_write_b128 v98, v[20:23] offset:1024
    s_waitcnt vmcnt(13)
    ds_write_b128 v99, v[24:27] offset:2048
    s_waitcnt vmcnt(12)
    ds_write_b128 v99, v[28:31] offset:3072
    s_waitcnt lgkmcnt(0)
    s_add_u32 s56, s12, 2097152
    s_addc_u32 s57, s13, 0
    global_load_dwordx4 v[16:19], v96, s[56:57]
    s_add_u32 s56, s12, 2105344
    s_addc_u32 s57, s13, 0
    global_load_dwordx4 v[20:23], v96, s[56:57]
    s_add_u32 s56, s12, 2113536
    s_addc_u32 s57, s13, 0
    global_load_dwordx4 v[24:27], v96, s[56:57]
    s_add_u32 s56, s12, 2121728
    s_addc_u32 s57, s13, 0
    global_load_dwordx4 v[28:31], v96, s[56:57]
    s_barrier
    v_xor_b32 v101, 64, v100
    ds_read_b64_tr_b16 a[248:249], v101 offset:0
    ds_read_b64_tr_b16 a[250:251], v101 offset:1024
    ds_read_b64_tr_b16 a[252:253], v101 offset:8192
    ds_read_b64_tr_b16 a[254:255], v101 offset:9216
    v_xor_b32 v101, 96, v100
    ds_read_b64_tr_b16 v[136:137], v101 offset:0
    ds_read_b64_tr_b16 v[138:139], v101 offset:1024
    ds_read_b64_tr_b16 v[140:141], v101 offset:8192
    ds_read_b64_tr_b16 v[142:143], v101 offset:9216
    s_waitcnt lgkmcnt(0)
    s_barrier
    s_waitcnt vmcnt(15)
    ds_write_b128 v98, v[32:35] offset:0
    s_waitcnt vmcnt(14)
    ds_write_b128 v98, v[36:39] offset:1024
    s_waitcnt vmcnt(13)
    ds_write_b128 v99, v[40:43] offset:2048
    s_waitcnt vmcnt(12)
    ds_write_b128 v99, v[44:47] offset:3072
    s_waitcnt lgkmcnt(0)
    s_add_u32 s56, s12, 2621440
    s_addc_u32 s57, s13, 0
    global_load_dwordx4 v[32:35], v96, s[56:57]
    s_add_u32 s56, s12, 2629632
    s_addc_u32 s57, s13, 0
    global_load_dwordx4 v[36:39], v96, s[56:57]
    s_add_u32 s56, s12, 2637824
    s_addc_u32 s57, s13, 0
    global_load_dwordx4 v[40:43], v96, s[56:57]
    s_add_u32 s56, s12, 2646016
    s_addc_u32 s57, s13, 0
    global_load_dwordx4 v[44:47], v96, s[56:57]
    s_barrier
    v_xor_b32 v101, 64, v100
    ds_read_b64_tr_b16 v[176:177], v101 offset:0
    ds_read_b64_tr_b16 v[178:179], v101 offset:1024
    ds_read_b64_tr_b16 v[180:181], v101 offset:8192
    ds_read_b64_tr_b16 v[182:183], v101 offset:9216
    v_xor_b32 v101, 96, v100
    ds_read_b64_tr_b16 v[184:185], v101 offset:0
    ds_read_b64_tr_b16 v[186:187], v101 offset:1024
    ds_read_b64_tr_b16 v[188:189], v101 offset:8192
    ds_read_b64_tr_b16 v[190:191], v101 offset:9216
    s_waitcnt lgkmcnt(0)
    s_barrier
    s_waitcnt vmcnt(15)
    ds_write_b128 v98, v[48:51] offset:0
    s_waitcnt vmcnt(14)
    ds_write_b128 v98, v[52:55] offset:1024
    s_waitcnt vmcnt(13)
    ds_write_b128 v99, v[56:59] offset:2048
    s_waitcnt vmcnt(12)
    ds_write_b128 v99, v[60:63] offset:3072
    s_waitcnt lgkmcnt(0)
    s_cmp_eq_u32 s55, 1
    s_cbranch_scc1 L_cf3
    v_mov_b32 v252, 139264
    s_cmp_lg_u32 s30, 0
    s_cbranch_scc1 L_cg3
    s_waitcnt vmcnt(12)
    s_mov_b64 exec, 1
    ds_write_b32 v252, v253
    s_waitcnt lgkmcnt(0)
    s_mov_b64 exec, -1
L_cg3:
    s_barrier
    ds_read_b32 v253, v252
    s_waitcnt lgkmcnt(0)
    v_readfirstlane_b32 s56, v253
    s_barrier
    s_bitcmp1_b32 s56, s31
    s_cbranch_scc1 L_lost
L_cf3:
    s_add_u32 s56, s12, 3145728
    s_addc_u32 s57, s13, 0
    global_load_dwordx4 v[48:51], v96, s[56:57]
    s_add_u32 s56, s12, 3153920
    s_addc_u32 s57, s13, 0
    global_load_dwordx4 v[52:55], v96, s[56:57]
    s_add_u32 s56, s12, 3162112
    s_addc_u32 s57, s13, 0
    global_load_dwordx4 v[56:59], v96, s[56:57]
    s_add_u32 s56, s12, 3170304
    s_addc_u32 s57, s13, 0
    global_load_dwordx4 v[60:63], v96, s[56:57]
    s_barrier
    v_xor_b32 v101, 64, v100
    ds_read_b64_tr_b16 v[80:81], v101 offset:0
    ds_read_b64_tr_b16 v[82:83], v101 offset:1024
    ds_read_b64_tr_b16 v[84:85], v101 offset:8192
    ds_read_b64_tr_b16 v[86:87], v101 offset:9216
    s_waitcnt lgkmcnt(2)
    ds_write_b128 v120, v[80:83] offset:0
    s_waitcnt lgkmcnt(1)
    ds_write_b128 v120, v[84:87] offset:1024
    v_xor_b32 v101, 96, v100
    ds_read_b64_tr_b16 v[80:81], v101 offset:0
    ds_read_b64_tr_b16 v[82:83], v101 offset:1024
    ds_read_b64_tr_b16 v[84:85], v101 offset:8192
    ds_read_b64_tr_b16 v[86:87], v101 offset:9216
    s_waitcnt lgkmcnt(2)
    ds_write_b128 v120, v[80:83] offset:2048
    s_waitcnt lgkmcnt(1)
    ds_write_b128 v120, v[84:87] offset:3072
    s_waitcnt lgkmcnt(0)
    s_barrier
    s_waitcnt vmcnt(15)
    ds_write_b128 v98, v[64:67] offset:0
    s_waitcnt vmcnt(14)
    ds_write_b128 v98, v[68:71] offset:1024
    s_waitcnt vmcnt(13)
    ds_write_b128 v99, v[72:75] offset:2048
    s_waitcnt vmcnt(12)
    ds_write_b128 v99, v[76:79] offset:3072
    s_waitcnt lgkmcnt(0)
    s_add_u32 s56, s12, 3670016
    s_addc_u32 s57, s13, 0
    global_load_dwordx4 v[64:67], v96, s[56:57]
    s_add_u32 s56, s12, 3678208
    s_addc_u32 s57, s13, 0
    global_load_dwordx4 v[68:71], v96, s[56:57]
    s_add_u32 s56, s12, 3686400
    s_addc_u32 s57, s13, 0
    global_load_dwordx4 v[72:75], v96, s[56:57]
    s_add_u32 s56, s12, 3694592
    s_addc_u32 s57, s13, 0
    global_load_dwordx4 v[76:79], v96, s[56:57]
    s_barrier
    v_xor_b32 v101, 64, v100
    ds_read_b64_tr_b16 a[8:9], v101 offset:0
    ds_read_b64_tr_b16 a[10:11], v101 offset:1024
    ds_read_b64_tr_b16 a[12:13], v101 offset:8192
    ds_read_b64_tr_b16 a[14:15], v101 offset:9216
    v_xor_b32 v101, 96, v100
    ds_read_b64_tr_b16 a[16:17], v101 offset:0
    ds_read_b64_tr_b16 a[18:19], v101 offset:1024
    ds_read_b64_tr_b16 a[20:21], v101 offset:8192
    ds_read_b64_tr_b16 a[22:23], v101 offset:9216
    s_waitcnt lgkmcnt(0)
    s_barrier
    s_waitcnt vmcnt(15)
    ds_write_b128 v98, v[16:19] offset:0
    s_waitcnt vmcnt(14)
    ds_write_b128 v98, v[20:23] offset:1024
    s_waitcnt vmcnt(13)
    ds_write_b128 v99, v[24:27] offset:2048
    s_waitcnt vmcnt(12)
    ds_write_b128 v99, v[28:31] offset:3072
    s_waitcnt lgkmcnt(0)
    s_add_u32 s56, s8, 0
    s_addc_u32 s57, s9, 0
    global_load_dwordx4 v[16:19], v96, s[56:57]
    s_add_u32 s56, s8, 8192
    s_addc_u32 s57, s9, 0
    global_load_dwordx4 v[20:23], v96, s[56:57]
    s_add_u32 s56, s8, 16384
    s_addc_u32 s57, s9, 0
    global_load_dwordx4 v[24:27], v96, s[56:57]
    s_add_u32 s56, s8, 24576
    s_addc_u32 s57, s9, 0
    global_load_dwordx4 v[28:31], v96, s[56:57]
    s_barrier
    v_xor_b32 v101, 64, v100
    ds_read_b64_tr_b16 a[216:217], v101 offset:0
    ds_read_b64_tr_b16 a[218:219], v101 offset:1024
    ds_read_b64_tr_b16 a[220:221], v101 offset:8192
    ds_read_b64_tr_b16 a[222:223], v101 offset:9216
    v_xor_b32 v101, 96, v100
    ds_read_b64_tr_b16 a[224:225], v101 offset:0
    ds_read_b64_tr_b16 a[226:227], v101 offset:1024
    ds_read_b64_tr_b16 a[228:229], v101 offset:8192
    ds_read_b64_tr_b16 a[230:231], v101 offset:9216
    s_waitcnt lgkmcnt(0)
    s_barrier
    s_waitcnt vmcnt(15)
    ds_write_b128 v98, v[32:35] offset:0
    s_waitcnt vmcnt(14)
    ds_write_b128 v98, v[36:39] offset:1024
    s_waitcnt vmcnt(13)
    ds_write_b128 v99, v[40:43] offset:2048
    s_waitcnt vmcnt(12)
    ds_write_b128 v99, v[44:47] offset:3072
    s_waitcnt lgkmcnt(0)
    s_add_u32 s56, s8, 524288
    s_addc_u32 s57, s9, 0
    global_load_dwordx4 v[32:35], v96, s[56:57]
    s_add_u32 s56, s8, 532480
    s_addc_u32 s57, s9, 0
    global_load_dwordx4 v[36:39], v96, s[56:57]
    s_add_u32 s56, s8, 540672
    s_addc_u32 s57, s9, 0
    global_load_dwordx4 v[40:43], v96, s[56:57]
    s_add_u32 s56, s8, 548864
    s_addc_u32 s57, s9, 0
    global_load_dwordx4 v[44:47], v96, s[56:57]
    s_barrier
    v_xor_b32 v101, 64, v100
    ds_read_b64_tr_b16 v[144:145], v101 offset:0
    ds_read_b64_tr_b16 v[146:147], v101 offset:1024
    ds_read_b64_tr_b16 v[148:149], v101 offset:8192
    ds_read_b64_tr_b16 v[150:151], v101 offset:9216
    v_xor_b32 v101, 96, v100
    ds_read_b64_tr_b16 v[152:153], v101 offset:0
    ds_read_b64_tr_b16 v[154:155], v101 offset:1024
    ds_read_b64_tr_b16 v[156:157], v101 offset:8192
    ds_read_b64_tr_b16 v[158:159], v101 offset:9216
    s_waitcnt lgkmcnt(0)
    s_barrier
    s_waitcnt vmcnt(15)
    ds_write_b128 v98, v[48:51] offset:0
    s_waitcnt vmcnt(14)
    ds_write_b128 v98, v[52:55] offset:1024
    s_waitcnt vmcnt(13)
    ds_write_b128 v99, v[56:59] offset:2048
    s_waitcnt vmcnt(12)
    ds_write_b128 v99, v[60:63] offset:3072
    s_waitcnt lgkmcnt(0)
    s_add_u32 s56, s8, 1048576
    s_addc_u32 s57, s9, 0
    global_load_dwordx4 v[48:51], v96, s[56:57]
    s_add_u32 s56, s8, 1056768
    s_addc_u32 s57, s9, 0
    global_load_dwordx4 v[52:55], v96, s[56:57]
    s_add_u32 s56, s8, 1064960
    s_addc_u32 s57, s9, 0
    global_load_dwordx4 v[56:59], v96, s[56:57]
    s_add_u32 s56, s8, 1073152
    s_addc_u32 s57, s9, 0
    global_load_dwordx4 v[60:63], v96, s[56:57]
    s_barrier
    v_xor_b32 v101, 64, v100
    ds_read_b64_tr_b16 a[232:233], v101 offset:0
    ds_read_b64_tr_b16 a[234:235], v101 offset:1024
    ds_read_b64_tr_b16 a[236:237], v101 offset:8192
    ds_read_b64_tr_b16 a[238:239], v101 offset:9216
    v_xor_b32 v101, 96, v100
    ds_read_b64_tr_b16 a[240:241], v101 offset:0
    ds_read_b64_tr_b16 a[242:243], v101 offset:1024
    ds_read_b64_tr_b16 a[244:245], v101 offset:8192
    ds_read_b64_tr_b16 a[246:247], v101 offset:9216
    s_waitcnt lgkmcnt(0)
    s_barrier
    s_waitcnt vmcnt(15)
    ds_write_b128 v98, v[64:67] offset:0
    s_waitcnt vmcnt(14)
    ds_write_b128 v98, v[68:71] offset:1024
    s_waitcnt vmcnt(13)
    ds_write_b128 v99, v[72:75] offset:2048
    s_waitcnt vmcnt(12)
    ds_write_b128 v99, v[76:79] offset:3072
    s_waitcnt lgkmcnt(0)
    s_add_u32 s56, s8, 1572864
    s_addc_u32 s57, s9, 0
    global_load_dwordx4 v[64:67], v96, s[56:57]
    s_add_u32 s56, s8, 1581056
    s_addc_u32 s57, s9, 0
    global_load_dwordx4 v[68:71], v96, s[56:57]
    s_add_u32 s56, s8, 1589248
    s_addc_u32 s57, s9, 0
    global_load_dwordx4 v[72:75], v96, s[56:57]
    s_add_u32 s56, s8, 1597440
    s_addc_u32 s57, s9, 0
    global_load_dwordx4 v[76:79], v96, s[56:57]
    s_barrier
    v_xor_b32 v101, 64, v100
    ds_read_b64_tr_b16 v[160:161], v101 offset:0
    ds_read_b64_tr_b16 v[162:163], v101 offset:1024
    ds_read_b64_tr_b16 v[164:165], v101 offset:8192
    ds_read_b64_tr_b16 v[166:167], v101 offset:9216
    v_xor_b32 v101, 96, v100
    ds_read_b64_tr_b16 v[168:169], v101 offset:0
    ds_read_b64_tr_b16 v[170:171], v101 offset:1024
    ds_read_b64_tr_b16 v[172:173], v101 offset:8192
    ds_read_b64_tr_b16 v[174:175], v101 offset:9216
    s_waitcnt lgkmcnt(0)
    s_barrier
    s_waitcnt vmcnt(15)
    ds_write_b128 v98, v[16:19] offset:0
    s_waitcnt vmcnt(14)
    ds_write_b128 v98, v[20:23] offset:1024
    s_waitcnt vmcnt(13)
    ds_write_b128 v99, v[24:27] offset:2048
    s_waitcnt vmcnt(12)
    ds_write_b128 v99, v[28:31] offset:3072
    s_waitcnt lgkmcnt(0)
    s_add_u32 s56, s8, 2097152
    s_addc_u32 s57, s9, 0
    global_load_dwordx4 v[16:19], v96, s[56:57]
    s_add_u32 s56, s8, 2105344
    s_addc_u32 s57, s9, 0
    global_load_dwordx4 v[20:23], v96, s[56:57]
    s_add_u32 s56, s8, 2113536
    s_addc_u32 s57, s9, 0
    global_load_dwordx4 v[24:27], v96, s[56:57]
    s_add_u32 s56, s8, 2121728
    s_addc_u32 s57, s9, 0
    global_load_dwordx4 v[28:31], v96, s[56:57]
    s_barrier
    v_xor_b32 v101, 64, v100
    ds_read_b64_tr_b16 a[56:57], v101 offset:0
    ds_read_b64_tr_b16 a[58:59], v101 offset:1024
    ds_read_b64_tr_b16 a[60:61], v101 offset:8192
    ds_read_b64_tr_b16 a[62:63], v101 offset:9216
    v_xor_b32 v101, 96, v100
    ds_read_b64_tr_b16 a[64:65], v101 offset:0
    ds_read_b64_tr_b16 a[66:67], v101 offset:1024
    ds_read_b64_tr_b16 a[68:69], v101 offset:8192
    ds_read_b64_tr_b16 a[70:71], v101 offset:9216
    s_waitcnt lgkmcnt(0)
    s_barrier
    s_waitcnt vmcnt(15)
    ds_write_b128 v98, v[32:35] offset:0
    s_waitcnt vmcnt(14)
    ds_write_b128 v98, v[36:39] offset:1024
    s_waitcnt vmcnt(13)
    ds_write_b128 v99, v[40:43] offset:2048
    s_waitcnt vmcnt(12)
    ds_write_b128 v99, v[44:47] offset:3072
    s_waitcnt lgkmcnt(0)
    s_add_u32 s56, s8, 2621440
    s_addc_u32 s57, s9, 0
    global_load_dwordx4 v[32:35], v96, s[56:57]
    s_add_u32 s56, s8, 2629632
    s_addc_u32 s57, s9, 0
    global_load_dwordx4 v[36:39], v96, s[56:57]
    s_add_u32 s56, s8, 2637824
    s_addc_u32 s57, s9, 0
    global_load_dwordx4 v[40:43], v96, s[56:57]
    s_add_u32 s56, s8, 2646016
    s_addc_u32 s57, s9, 0
    global_load_dwordx4 v[44:47], v96, s[56:57]
    s_barrier
    v_xor_b32 v101, 64, v100
    ds_read_b64_tr_b16 a[104:105], v101 offset:0
    ds_read_b64_tr_b16 a[106:107], v101 offset:1024
    ds_read_b64_tr_b16 a[108:109], v101 offset:8192
    ds_read_b64_tr_b16 a[110:111], v101 offset:9216
    v_xor_b32 v101, 96, v100
    ds_read_b64_tr_b16 a[112:113], v101 offset:0
    ds_read_b64_tr_b16 a[114:115], v101 offset:1024
    ds_read_b64_tr_b16 a[116:117], v101 offset:8192
    ds_read_b64_tr_b16 a[118:119], v101 offset:9216
    s_waitcnt lgkmcnt(0)
    s_barrier
    s_waitcnt vmcnt(15)
    ds_write_b128 v98, v[48:51] offset:0
    s_waitcnt vmcnt(14)
    ds_write_b128 v98, v[52:55] offset:1024
    s_waitcnt vmcnt(13)
    ds_write_b128 v99, v[56:59] offset:2048
    s_waitcnt vmcnt(12)
    ds_write_b128 v99, v[60:63] offset:3072
    s_waitcnt lgkmcnt(0)
    s_add_u32 s56, s8, 3145728
    s_addc_u32 s57, s9, 0
    global_load_dwordx4 v[48:51], v96, s[56:57]
    s_add_u32 s56, s8, 3153920
    s_addc_u32 s57, s9, 0
    global_load_dwordx4 v[52:55], v96, s[56:57]
    s_add_u32 s56, s8, 3162112
    s_addc_u32 s57, s9, 0
    global_load_dwordx4 v[56:59], v96, s[56:57]
    s_add_u32 s56, s8, 3170304
    s_addc_u32 s57, s9, 0
    global_load_dwordx4 v[60:63], v96, s[56:57]
    s_barrier
    v_xor_b32 v101, 64, v100
    ds_read_b64_tr_b16 v[80:81], v101 offset:0
    ds_read_b64_tr_b16 v[82:83], v101 offset:1024
    ds_read_b64_tr_b16 v[84:85], v101 offset:8192
    ds_read_b64_tr_b16 v[86:87], v101 offset:9216
    s_waitcnt lgkmcnt(2)
    ds_write_b128 v120, v[80:83] offset:8192
    s_waitcnt lgkmcnt(1)
    ds_write_b128 v120, v[84:87] offset:9216
    v_xor_b32 v101, 96, v100
    ds_read_b64_tr_b16 v[80:81], v101 offset:0
    ds_read_b64_tr_b16 v[82:83], v101 offset:1024
    ds_read_b64_tr_b16 v[84:85], v101 offset:8192
    ds_read_b64_tr_b16 v[86:87], v101 offset:9216
    s_waitcnt lgkmcnt(2)
    ds_write_b128 v120, v[80:83] offset:10240
    s_waitcnt lgkmcnt(1)
    ds_write_b128 v120, v[84:87] offset:11264
    s_waitcnt lgkmcnt(0)
    s_barrier
    s_waitcnt vmcnt(15)
    ds_write_b128 v98, v[64:67] offset:0
    s_waitcnt vmcnt(14)
    ds_write_b128 v98, v[68:71] offset:1024
    s_waitcnt vmcnt(13)
    ds_write_b128 v99, v[72:75] offset:2048
    s_waitcnt vmcnt(12)
    ds_write_b128 v99, v[76:79] offset:3072
    s_waitcnt lgkmcnt(0)
    s_add_u32 s56, s8, 3670016
    s_addc_u32 s57, s9, 0
    global_load_dwordx4 v[64:67], v96, s[56:57]
    s_add_u32 s56, s8, 3678208
    s_addc_u32 s57, s9, 0
    global_load_dwordx4 v[68:71], v96, s[56:57]
    s_add_u32 s56, s8, 3686400
    s_addc_u32 s57, s9, 0
    global_load_dwordx4 v[72:75], v96, s[56:57]
    s_add_u32 s56, s8, 3694592
    s_addc_u32 s57, s9, 0
    global_load_dwordx4 v[76:79], v96, s[56:57]
    s_barrier
    v_xor_b32 v101, 64, v100
    ds_read_b64_tr_b16 v[80:81], v101 offset:0
    ds_read_b64_tr_b16 v[82:83], v101 offset:1024
    ds_read_b64_tr_b16 v[84:85], v101 offset:8192
    ds_read_b64_tr_b16 v[86:87], v101 offset:9216
    s_waitcnt lgkmcnt(2)
    ds_write_b128 v120, v[80:83] offset:4096
    s_waitcnt lgkmcnt(1)
    ds_write_b128 v120, v[84:87] offset:5120
    v_xor_b32 v101, 96, v100
    ds_read_b64_tr_b16 v[80:81], v101 offset:0
    ds_read_b64_tr_b16 v[82:83], v101 offset:1024
    ds_read_b64_tr_b16 v[84:85], v101 offset:8192
    ds_read_b64_tr_b16 v[86:87], v101 offset:9216
    s_waitcnt lgkmcnt(2)
    ds_write_b128 v120, v[80:83] offset:6144
    s_waitcnt lgkmcnt(1)
    ds_write_b128 v120, v[84:87] offset:7168
    s_waitcnt lgkmcnt(0)
    s_barrier
    s_waitcnt vmcnt(15)
    ds_write_b128 v98, v[16:19] offset:0
    s_waitcnt vmcnt(14)
    ds_write_b128 v98, v[20:23] offset:1024
    s_waitcnt vmcnt(13)
    ds_write_b128 v99, v[24:27] offset:2048
    s_waitcnt vmcnt(12)
    ds_write_b128 v99, v[28:31] offset:3072
    s_waitcnt lgkmcnt(0)
    s_add_u32 s56, s14, 0
    s_addc_u32 s57, s15, 0
    global_load_dwordx4 v[16:19], v97, s[56:57]
    s_add_u32 s56, s14, 1024
    s_addc_u32 s57, s15, 0
    global_load_dwordx4 v[20:23], v97, s[56:57]
    s_add_u32 s56, s14, 16384
    s_addc_u32 s57, s15, 0
    global_load_dwordx4 v[24:27], v97, s[56:57]
    s_add_u32 s56, s14, 17408
    s_addc_u32 s57, s15, 0
    global_load_dwordx4 v[28:31], v97, s[56:57]
    s_barrier
    v_xor_b32 v101, 64, v100
    ds_read_b64_tr_b16 a[24:25], v101 offset:0
    ds_read_b64_tr_b16 a[26:27], v101 offset:1024
    ds_read_b64_tr_b16 a[28:29], v101 offset:8192
    ds_read_b64_tr_b16 a[30:31], v101 offset:9216
    v_xor_b32 v101, 96, v100
    ds_read_b64_tr_b16 a[32:33], v101 offset:0
    ds_read_b64_tr_b16 a[34:35], v101 offset:1024
    ds_read_b64_tr_b16 a[36:37], v101 offset:8192
    ds_read_b64_tr_b16 a[38:39], v101 offset:9216
    s_waitcnt lgkmcnt(0)
    s_barrier
    s_waitcnt vmcnt(15)
    ds_write_b128 v98, v[32:35] offset:0
    s_waitcnt vmcnt(14)
    ds_write_b128 v98, v[36:39] offset:1024
    s_waitcnt vmcnt(13)
    ds_write_b128 v99, v[40:43] offset:2048
    s_waitcnt vmcnt(12)
    ds_write_b128 v99, v[44:47] offset:3072
    s_waitcnt lgkmcnt(0)
    v_lshrrev_b32 v106, 2, v127
    global_load_dword v107, v106, s[26:27] sc1
    s_add_u32 s56, s14, 4096
    s_addc_u32 s57, s15, 0
    global_load_dwordx4 v[32:35], v97, s[56:57]
    s_add_u32 s56, s14, 5120
    s_addc_u32 s57, s15, 0
    global_load_dwordx4 v[36:39], v97, s[56:57]
    s_add_u32 s56, s14, 20480
    s_addc_u32 s57, s15, 0
    global_load_dwordx4 v[40:43], v97, s[56:57]
    s_add_u32 s56, s14, 21504
    s_addc_u32 s57, s15, 0
    global_load_dwordx4 v[44:47], v97, s[56:57]
    s_barrier
    v_xor_b32 v101, 64, v100
    ds_read_b64_tr_b16 a[72:73], v101 offset:0
    ds_read_b64_tr_b16 a[74:75], v101 offset:1024
    ds_read_b64_tr_b16 a[76:77], v101 offset:8192
    ds_read_b64_tr_b16 a[78:79], v101 offset:9216
    v_xor_b32 v101, 96, v100
    ds_read_b64_tr_b16 a[80:81], v101 offset:0
    ds_read_b64_tr_b16 a[82:83], v101 offset:1024
    ds_read_b64_tr_b16 a[84:85], v101 offset:8192
    ds_read_b64_tr_b16 a[86:87], v101 offset:9216
    s_waitcnt lgkmcnt(0)
    s_barrier
    s_waitcnt vmcnt(16)
    ds_write_b128 v98, v[48:51] offset:0
    s_waitcnt vmcnt(15)
    ds_write_b128 v98, v[52:55] offset:1024
    s_waitcnt vmcnt(14)
    ds_write_b128 v99, v[56:59] offset:2048
    s_waitcnt vmcnt(13)
    ds_write_b128 v99, v[60:63] offset:3072
    s_waitcnt lgkmcnt(0)
    s_add_u32 s56, s14, 8192
    s_addc_u32 s57, s15, 0
    global_load_dwordx4 v[48:51], v97, s[56:57]
    s_add_u32 s56, s14, 9216
    s_addc_u32 s57, s15, 0
    global_load_dwordx4 v[52:55], v97, s[56:57]
    s_add_u32 s56, s14, 24576
    s_addc_u32 s57, s15, 0
    global_load_dwordx4 v[56:59], v97, s[56:57]
    s_add_u32 s56, s14, 25600
    s_addc_u32 s57, s15, 0
    global_load_dwordx4 v[60:63], v97, s[56:57]
    s_barrier
    v_xor_b32 v101, 64, v100
    ds_read_b64_tr_b16 a[40:41], v101 offset:0
    ds_read_b64_tr_b16 a[42:43], v101 offset:1024
    ds_read_b64_tr_b16 a[44:45], v101 offset:8192
    ds_read_b64_tr_b16 a[46:47], v101 offset:9216
    v_xor_b32 v101, 96, v100
    ds_read_b64_tr_b16 a[48:49], v101 offset:0
    ds_read_b64_tr_b16 a[50:51], v101 offset:1024
    ds_read_b64_tr_b16 a[52:53], v101 offset:8192
    ds_read_b64_tr_b16 a[54:55], v101 offset:9216
    s_waitcnt lgkmcnt(0)
    s_barrier
    s_waitcnt vmcnt(16)
    ds_write_b128 v98, v[64:67] offset:0
    s_waitcnt vmcnt(15)
    ds_write_b128 v98, v[68:71] offset:1024
    s_waitcnt vmcnt(14)
    ds_write_b128 v99, v[72:75] offset:2048
    s_waitcnt vmcnt(13)
    ds_write_b128 v99, v[76:79] offset:3072
    s_waitcnt lgkmcnt(0)
    s_add_u32 s56, s14, 12288
    s_addc_u32 s57, s15, 0
    global_load_dwordx4 v[64:67], v97, s[56:57]
    s_add_u32 s56, s14, 13312
    s_addc_u32 s57, s15, 0
    global_load_dwordx4 v[68:71], v97, s[56:57]
    s_add_u32 s56, s14, 28672
    s_addc_u32 s57, s15, 0
    global_load_dwordx4 v[72:75], v97, s[56:57]
    s_add_u32 s56, s14, 29696
    s_addc_u32 s57, s15, 0
    global_load_dwordx4 v[76:79], v97, s[56:57]
    s_barrier
    v_xor_b32 v101, 64, v100
    ds_read_b64_tr_b16 a[88:89], v101 offset:0
    ds_read_b64_tr_b16 a[90:91], v101 offset:1024
    ds_read_b64_tr_b16 a[92:93], v101 offset:8192
    ds_read_b64_tr_b16 a[94:95], v101 offset:9216
    v_xor_b32 v101, 96, v100
    ds_read_b64_tr_b16 a[96:97], v101 offset:0
    ds_read_b64_tr_b16 a[98:99], v101 offset:1024
    ds_read_b64_tr_b16 a[100:101], v101 offset:8192
    ds_read_b64_tr_b16 a[102:103], v101 offset:9216
    s_waitcnt lgkmcnt(0)
    s_barrier
    s_waitcnt vmcnt(16)
    ds_write_b128 v94, v[16:19] offset:0
    s_waitcnt vmcnt(15)
    ds_write_b128 v95, v[20:23] offset:1024
    s_waitcnt vmcnt(14)
    ds_write_b128 v94, v[24:27] offset:2048
    s_waitcnt vmcnt(13)
    ds_write_b128 v95, v[28:31] offset:3072
    s_waitcnt lgkmcnt(0)
    s_add_u32 s56, s14, 65536
    s_addc_u32 s57, s15, 0
    global_load_dwordx4 v[16:19], v97, s[56:57]
    s_add_u32 s56, s14, 66560
    s_addc_u32 s57, s15, 0
    global_load_dwordx4 v[20:23], v97, s[56:57]
    s_add_u32 s56, s14, 81920
    s_addc_u32 s57, s15, 0
    global_load_dwordx4 v[24:27], v97, s[56:57]
    s_add_u32 s56, s14, 82944
    s_addc_u32 s57, s15, 0
    global_load_dwordx4 v[28:31], v97, s[56:57]
    s_barrier
    v_xor_b32 v101, 0, v105
    ds_read_b64_tr_b16 v[80:81], v101 offset:0
    ds_read_b64_tr_b16 v[82:83], v101 offset:2048
    v_xor_b32 v101, 64, v105
    ds_read_b64_tr_b16 v[84:85], v101 offset:0
    ds_read_b64_tr_b16 v[86:87], v101 offset:2048
    v_xor_b32 v101, 128, v105
    ds_read_b64_tr_b16 v[224:225], v101 offset:0
    ds_read_b64_tr_b16 v[226:227], v101 offset:2048
    v_xor_b32 v101, 192, v105
    ds_read_b64_tr_b16 v[240:241], v101 offset:0
    ds_read_b64_tr_b16 v[242:243], v101 offset:2048
    s_waitcnt lgkmcnt(6)
    ds_write_b128 v120, v[80:83] offset:18432
    s_waitcnt lgkmcnt(5)
    ds_write_b128 v120, v[84:87] offset:20480
    s_waitcnt lgkmcnt(0)
    s_barrier
    s_waitcnt vmcnt(15)
    ds_write_b128 v94, v[32:35] offset:0
    s_waitcnt vmcnt(14)
    ds_write_b128 v95, v[36:39] offset:1024
    s_waitcnt vmcnt(13)
    ds_write_b128 v94, v[40:43] offset:2048
    s_waitcnt vmcnt(12)
    ds_write_b128 v95, v[44:47] offset:3072
    s_waitcnt lgkmcnt(0)
    s_getpc_b64 s[56:57]
L_rpc1:
    s_add_u32 s56, s56, L_rcode-L_rpc1+4096
    s_addc_u32 s57, s57, 0
    v_lshlrev_b32 v130, 1, v127
    global_load_dword v133, v130, s[40:41] sc1
    v_lshlrev_b32 v130, 2, v127
    global_load_dword v132, v130, s[56:57]
    v_add_u32 v130, 4096, v130
    global_load_dword v134, v130, s[44:45] sc1
    s_add_u32 s56, s14, 69632
    s_addc_u32 s57, s15, 0
    global_load_dwordx4 v[32:35], v97, s[56:57]
    s_add_u32 s56, s14, 70656
    s_addc_u32 s57, s15, 0
    global_load_dwordx4 v[36:39], v97, s[56:57]
    s_add_u32 s56, s14, 86016
    s_addc_u32 s57, s15, 0
    global_load_dwordx4 v[40:43], v97, s[56:57]
    s_add_u32 s56, s14, 87040
    s_addc_u32 s57, s15, 0
    global_load_dwordx4 v[44:47], v97, s[56:57]
    s_barrier
    v_xor_b32 v101, 0, v105
    ds_read_b64_tr_b16 v[80:81], v101 offset:0
    ds_read_b64_tr_b16 v[82:83], v101 offset:2048
    v_xor_b32 v101, 64, v105
    ds_read_b64_tr_b16 v[84:85], v101 offset:0
    ds_read_b64_tr_b16 v[86:87], v101 offset:2048
    v_xor_b32 v101, 128, v105
    ds_read_b64_tr_b16 v[228:229], v101 offset:0
    ds_read_b64_tr_b16 v[230:231], v101 offset:2048
    v_xor_b32 v101, 192, v105
    ds_read_b64_tr_b16 v[244:245], v101 offset:0
    ds_read_b64_tr_b16 v[246:247], v101 offset:2048
    s_waitcnt lgkmcnt(6)
    ds_write_b128 v120, v[80:83] offset:19456
    s_waitcnt lgkmcnt(5)
    ds_write_b128 v120, v[84:87] offset:21504
    s_waitcnt lgkmcnt(0)
    s_barrier
    s_waitcnt vmcnt(15)
    ds_write_b128 v94, v[48:51] offset:0
    s_waitcnt vmcnt(14)
    ds_write_b128 v95, v[52:55] offset:1024
    s_waitcnt vmcnt(13)
    ds_write_b128 v94, v[56:59] offset:2048
    s_waitcnt vmcnt(12)
    ds_write_b128 v95, v[60:63] offset:3072
    s_waitcnt lgkmcnt(0)
    v_readlane_b32 s63, v107, 4
    s_mov_b32 exec_lo, 0x20200
    s_mov_b32 exec_hi, 0x40000
    v_cmp_gt_u32 vcc, 32, v107
    s_cmp_eq_u32 s63, -1
    s_cselect_b32 s63, 1, 0
    s_cmp_eq_u64 vcc, 0
    s_cselect_b32 s63, s63, 0
    s_mov_b64 exec, 0xff
    global_load_dword v107, v106, s[68:69] offset:256 sc1
    s_mov_b64 exec, -1
    s_add_u32 s56, s14, 73728
    s_addc_u32 s57, s15, 0
    global_load_dwordx4 v[48:51], v97, s[56:57]
    s_add_u32 s56, s14, 74752
    s_addc_u32 s57, s15, 0
    global_load_dwordx4 v[52:55], v97, s[56:57]
    s_add_u32 s56, s14, 90112
    s_addc_u32 s57, s15, 0
    global_load_dwordx4 v[56:59], v97, s[56:57]
    s_add_u32 s56, s14, 91136
    s_addc_u32 s57, s15, 0
    global_load_dwordx4 v[60:63], v97, s[56:57]
    s_barrier
    v_xor_b32 v101, 0, v105
    ds_read_b64_tr_b16 v[80:81], v101 offset:0
    ds_read_b64_tr_b16 v[82:83], v101 offset:2048
    v_xor_b32 v101, 64, v105
    ds_read_b64_tr_b16 v[84:85], v101 offset:0
    ds_read_b64_tr_b16 v[86:87], v101 offset:2048
    v_xor_b32 v101, 128, v105
    ds_read_b64_tr_b16 v[88:89], v101 offset:0
    ds_read_b64_tr_b16 v[90:91], v101 offset:2048
    s_waitcnt lgkmcnt(4)
    ds_write_b128 v120, v[80:83] offset:22528
    v_xor_b32 v101, 192, v105
    ds_read_b64_tr_b16 v[80:81], v101 offset:0
    ds_read_b64_tr_b16 v[82:83], v101 offset:2048
    s_waitcnt lgkmcnt(5)
    ds_write_b128 v120, v[84:87] offset:24576
    s_waitcnt lgkmcnt(4)
    ds_write_b128 v120, v[88:91] offset:26624
    s_waitcnt lgkmcnt(2)
    ds_write_b128 v120, v[80:83] offset:30720
    s_waitcnt lgkmcnt(0)
    s_barrier
    s_waitcnt vmcnt(16)
    ds_write_b128 v94, v[64:67] offset:0
    s_waitcnt vmcnt(15)
    ds_write_b128 v95, v[68:71] offset:1024
    s_waitcnt vmcnt(14)
    ds_write_b128 v94, v[72:75] offset:2048
    s_waitcnt vmcnt(13)
    ds_write_b128 v95, v[76:79] offset:3072
    s_waitcnt lgkmcnt(0)
    s_add_u32 s56, s14, 77824
    s_addc_u32 s57, s15, 0
    global_load_dwordx4 v[64:67], v97, s[56:57]
    s_add_u32 s56, s14, 78848
    s_addc_u32 s57, s15, 0
    global_load_dwordx4 v[68:71], v97, s[56:57]
    s_add_u32 s56, s14, 94208
    s_addc_u32 s57, s15, 0
    global_load_dwordx4 v[72:75], v97, s[56:57]
    s_add_u32 s56, s14, 95232
    s_addc_u32 s57, s15, 0
    global_load_dwordx4 v[76:79], v97, s[56:57]
    s_barrier
    v_xor_b32 v101, 0, v105
    ds_read_b64_tr_b16 v[80:81], v101 offset:0
    ds_read_b64_tr_b16 v[82:83], v101 offset:2048
    v_xor_b32 v101, 64, v105
    ds_read_b64_tr_b16 v[84:85], v101 offset:0
    ds_read_b64_tr_b16 v[86:87], v101 offset:2048
    v_xor_b32 v101, 128, v105
    ds_read_b64_tr_b16 v[88:89], v101 offset:0
    ds_read_b64_tr_b16 v[90:91], v101 offset:2048
    s_waitcnt lgkmcnt(4)
    ds_write_b128 v120, v[80:83] offset:23552
    v_xor_b32 v101, 192, v105
    ds_read_b64_tr_b16 v[80:81], v101 offset:0
    ds_read_b64_tr_b16 v[82:83], v101 offset:2048
    s_waitcnt lgkmcnt(5)
    ds_write_b128 v120, v[84:87] offset:25600
    s_waitcnt lgkmcnt(4)
    ds_write_b128 v120, v[88:91] offset:27648
    s_waitcnt lgkmcnt(2)
    ds_write_b128 v120, v[80:83] offset:31744
    s_waitcnt lgkmcnt(0)
    s_barrier
    s_waitcnt vmcnt(16)
    ds_write_b128 v94, v[16:19] offset:0
    s_waitcnt vmcnt(15)
    ds_write_b128 v95, v[20:23] offset:1024
    s_waitcnt vmcnt(14)
    ds_write_b128 v94, v[24:27] offset:2048
    s_waitcnt vmcnt(13)
    ds_write_b128 v95, v[28:31] offset:3072
    s_waitcnt lgkmcnt(0)
    s_barrier
    v_xor_b32 v101, 0, v105
    ds_read_b64_tr_b16 v[192:193], v101 offset:0
    ds_read_b64_tr_b16 v[194:195], v101 offset:2048
    v_xor_b32 v101, 64, v105
    ds_read_b64_tr_b16 v[208:209], v101 offset:0
    ds_read_b64_tr_b16 v[210:211], v101 offset:2048
    v_xor_b32 v101, 128, v105
    ds_read_b64_tr_b16 v[232:233], v101 offset:0
    ds_read_b64_tr_b16 v[234:235], v101 offset:2048
    v_xor_b32 v101, 192, v105
    ds_read_b64_tr_b16 v[248:249], v101 offset:0
    ds_read_b64_tr_b16 v[250:251], v101 offset:2048
    s_waitcnt lgkmcnt(0)
    s_barrier
    s_waitcnt vmcnt(12)
    ds_write_b128 v94, v[32:35] offset:0
    s_waitcnt vmcnt(11)
    ds_write_b128 v95, v[36:39] offset:1024
    s_waitcnt vmcnt(10)
    ds_write_b128 v94, v[40:43] offset:2048
    s_waitcnt vmcnt(9)
    ds_write_b128 v95, v[44:47] offset:3072
    s_waitcnt lgkmcnt(0)
    s_mov_b64 exec, 6
    s_waitcnt vmcnt(8)
    v_cmp_gt_u32 vcc, 2, v107
    s_mov_b64 exec, -1
    s_cmp_eq_u64 vcc, 0
    s_cselect_b32 s56, s63, 0
    s_add_u32 s63, s63, s56
    s_cmp_lg_u32 s63, 2
    s_cbranch_scc1 L_rnf1
    s_mov_b32 m0, s62
    s_nop 0
    global_load_lds_dwordx4 v127, s[48:49] sc1
    global_load_lds_dwordx4 v127, s[48:49] offset:1024 sc1
    v_lshlrev_b32 v130, 1, v127
    global_load_dword v131, v130, s[50:51] sc1
L_rnf1:
    s_barrier
    v_xor_b32 v101, 0, v105
    ds_read_b64_tr_b16 v[196:197], v101 offset:0
    ds_read_b64_tr_b16 v[198:199], v101 offset:2048
    v_xor_b32 v101, 64, v105
    ds_read_b64_tr_b16 v[212:213], v101 offset:0
    ds_read_b64_tr_b16 v[214:215], v101 offset:2048
    v_xor_b32 v101, 128, v105
    ds_read_b64_tr_b16 v[236:237], v101 offset:0
    ds_read_b64_tr_b16 v[238:239], v101 offset:2048
    v_xor_b32 v101, 192, v105
    ds_read_b64_tr_b16 v[252:253], v101 offset:0
    ds_read_b64_tr_b16 v[254:255], v101 offset:2048
    s_waitcnt lgkmcnt(0)
    s_barrier
    s_waitcnt vmcnt(7)
    ds_write_b128 v94, v[48:51] offset:0
    s_waitcnt vmcnt(6)
    ds_write_b128 v95, v[52:55] offset:1024
    s_waitcnt vmcnt(5)
    ds_write_b128 v94, v[56:59] offset:2048
    s_waitcnt vmcnt(4)
    ds_write_b128 v95, v[60:63] offset:3072
    s_waitcnt lgkmcnt(0)
    s_barrier
    v_xor_b32 v101, 0, v105
    ds_read_b64_tr_b16 v[200:201], v101 offset:0
    ds_read_b64_tr_b16 v[202:203], v101 offset:2048
    v_xor_b32 v101, 64, v105
    ds_read_b64_tr_b16 v[216:217], v101 offset:0
    ds_read_b64_tr_b16 v[218:219], v101 offset:2048
    v_xor_b32 v101, 128, v105
    ds_read_b64_tr_b16 v[80:81], v101 offset:0
    ds_read_b64_tr_b16 v[82:83], v101 offset:2048
    v_xor_b32 v101, 192, v105
    ds_read_b64_tr_b16 v[84:85], v101 offset:0
    ds_read_b64_tr_b16 v[86:87], v101 offset:2048
    s_waitcnt lgkmcnt(2)
    ds_write_b128 v120, v[80:83] offset:28672
    s_waitcnt lgkmcnt(1)
    ds_write_b128 v120, v[84:87] offset:32768
    s_waitcnt lgkmcnt(0)
    s_barrier
    s_waitcnt vmcnt(3)
    ds_write_b128 v94, v[64:67] offset:0
    s_waitcnt vmcnt(2)
    ds_write_b128 v95, v[68:71] offset:1024
    s_waitcnt vmcnt(1)
    ds_write_b128 v94, v[72:75] offset:2048
    s_waitcnt vmcnt(0)
    ds_write_b128 v95, v[76:79] offset:3072
    s_waitcnt lgkmcnt(0)
    s_barrier
    v_xor_b32 v101, 0, v105
    ds_read_b64_tr_b16 v[204:205], v101 offset:0
    ds_read_b64_tr_b16 v[206:207], v101 offset:2048
    v_xor_b32 v101, 64, v105
    ds_read_b64_tr_b16 v[220:221], v101 offset:0
    ds_read_b64_tr_b16 v[222:223], v101 offset:2048
    v_xor_b32 v101, 128, v105
    ds_read_b64_tr_b16 v[80:81], v101 offset:0
    ds_read_b64_tr_b16 v[82:83], v101 offset:2048
    v_xor_b32 v101, 192, v105
    ds_read_b64_tr_b16 v[84:85], v101 offset:0
    ds_read_b64_tr_b16 v[86:87], v101 offset:2048
    s_waitcnt lgkmcnt(2)
    ds_write_b128 v120, v[80:83] offset:29696
    s_waitcnt lgkmcnt(1)
    ds_write_b128 v120, v[84:87] offset:33792
    s_waitcnt lgkmcnt(0)
    s_barrier
    s_branch L_rwdonea
L_rwa_2:
    s_waitcnt vmcnt(15)
    ds_write_b128 v98, v[16:19] offset:0
    s_waitcnt vmcnt(14)
    ds_write_b128 v98, v[20:23] offset:1024
    s_waitcnt vmcnt(13)
    ds_write_b128 v99, v[24:27] offset:2048
    s_waitcnt vmcnt(12)
    ds_write_b128 v99, v[28:31] offset:3072
    s_waitcnt lgkmcnt(0)
    s_add_u32 s56, s10, 2097152
    s_addc_u32 s57, s11, 0
    global_load_dwordx4 v[16:19], v96, s[56:57]
    s_add_u32 s56, s10, 2105344
    s_addc_u32 s57, s11, 0
    global_load_dwordx4 v[20:23], v96, s[56:57]
    s_add_u32 s56, s10, 2113536
    s_addc_u32 s57, s11, 0
    global_load_dwordx4 v[24:27], v96, s[56:57]
    s_add_u32 s56, s10, 2121728
    s_addc_u32 s57, s11, 0
    global_load_dwordx4 v[28:31], v96, s[56:57]
    s_barrier
    v_xor_b32 v101, 128, v100
    ds_read_b64_tr_b16 a[128:129], v101 offset:0
    ds_read_b64_tr_b16 a[130:131], v101 offset:1024
    ds_read_b64_tr_b16 a[132:133], v101 offset:8192
    ds_read_b64_tr_b16 a[134:135], v101 offset:9216
    v_xor_b32 v101, 160, v100
    ds_read_b64_tr_b16 a[176:177], v101 offset:0
    ds_read_b64_tr_b16 a[178:179], v101 offset:1024
    ds_read_b64_tr_b16 a[180:181], v101 offset:8192
    ds_read_b64_tr_b16 a[182:183], v101 offset:9216
    s_waitcnt lgkmcnt(0)
    s_barrier
    s_waitcnt vmcnt(15)
    ds_write_b128 v98, v[32:35] offset:0
    s_waitcnt vmcnt(14)
    ds_write_b128 v98, v[36:39] offset:1024
    s_waitcnt vmcnt(13)
    ds_write_b128 v99, v[40:43] offset:2048
    s_waitcnt vmcnt(12)
    ds_write_b128 v99, v[44:47] offset:3072
    s_waitcnt lgkmcnt(0)
    s_add_u32 s56, s10, 2621440
    s_addc_u32 s57, s11, 0
    global_load_dwordx4 v[32:35], v96, s[56:57]
    s_add_u32 s56, s10, 2629632
    s_addc_u32 s57, s11, 0
    global_load_dwordx4 v[36:39], v96, s[56:57]
    s_add_u32 s56, s10, 2637824
    s_addc_u32 s57, s11, 0
    global_load_dwordx4 v[40:43], v96, s[56:57]
    s_add_u32 s56, s10, 2646016
    s_addc_u32 s57, s11, 0
    global_load_dwordx4 v[44:47], v96, s[56:57]
    s_barrier
    v_xor_b32 v101, 128, v100
    ds_read_b64_tr_b16 a[152:153], v101 offset:0
    ds_read_b64_tr_b16 a[154:155], v101 offset:1024
    ds_read_b64_tr_b16 a[156:157], v101 offset:8192
    ds_read_b64_tr_b16 a[158:159], v101 offset:9216
    v_xor_b32 v101, 160, v100
    ds_read_b64_tr_b16 a[200:201], v101 offset:0
    ds_read_b64_tr_b16 a[202:203], v101 offset:1024
    ds_read_b64_tr_b16 a[204:205], v101 offset:8192
    ds_read_b64_tr_b16 a[206:207], v101 offset:9216
    s_waitcnt lgkmcnt(0)
    s_barrier
    s_waitcnt vmcnt(15)
    ds_write_b128 v98, v[48:51] offset:0
    s_waitcnt vmcnt(14)
    ds_write_b128 v98, v[52:55] offset:1024
    s_waitcnt vmcnt(13)
    ds_write_b128 v99, v[56:59] offset:2048
    s_waitcnt vmcnt(12)
    ds_write_b128 v99, v[60:63] offset:3072
    s_waitcnt lgkmcnt(0)
    s_add_u32 s56, s10, 3145728
    s_addc_u32 s57, s11, 0
    global_load_dwordx4 v[48:51], v96, s[56:57]
    s_add_u32 s56, s10, 3153920
    s_addc_u32 s57, s11, 0
    global_load_dwordx4 v[52:55], v96, s[56:57]
    s_add_u32 s56, s10, 3162112
    s_addc_u32 s57, s11, 0
    global_load_dwordx4 v[56:59], v96, s[56:57]
    s_add_u32 s56, s10, 3170304
    s_addc_u32 s57, s11, 0
    global_load_dwordx4 v[60:63], v96, s[56:57]
    s_barrier
    v_xor_b32 v101, 128, v100
    ds_read_b64_tr_b16 a[136:137], v101 offset:0
    ds_read_b64_tr_b16 a[138:139], v101 offset:1024
    ds_read_b64_tr_b16 a[140:141], v101 offset:8192
    ds_read_b64_tr_b16 a[142:143], v101 offset:9216
    v_xor_b32 v101, 160, v100
    ds_read_b64_tr_b16 a[184:185], v101 offset:0
    ds_read_b64_tr_b16 a[186:187], v101 offset:1024
    ds_read_b64_tr_b16 a[188:189], v101 offset:8192
    ds_read_b64_tr_b16 a[190:191], v101 offset:9216
    s_waitcnt lgkmcnt(0)
    s_barrier
    s_waitcnt vmcnt(15)
    ds_write_b128 v98, v[64:67] offset:0
    s_waitcnt vmcnt(14)
    ds_write_b128 v98, v[68:71] offset:1024
    s_waitcnt vmcnt(13)
    ds_write_b128 v99, v[72:75] offset:2048
    s_waitcnt vmcnt(12)
    ds_write_b128 v99, v[76:79] offset:3072
    s_waitcnt lgkmcnt(0)
    s_add_u32 s56, s10, 3670016
    s_addc_u32 s57, s11, 0
    global_load_dwordx4 v[64:67], v96, s[56:57]
    s_add_u32 s56, s10, 3678208
    s_addc_u32 s57, s11, 0
    global_load_dwordx4 v[68:71], v96, s[56:57]
    s_add_u32 s56, s10, 3686400
    s_addc_u32 s57, s11, 0
    global_load_dwordx4 v[72:75], v96, s[56:57]
    s_add_u32 s56, s10, 3694592
    s_addc_u32 s57, s11, 0
    global_load_dwordx4 v[76:79], v96, s[56:57]
    s_barrier
    v_xor_b32 v101, 128, v100
    ds_read_b64_tr_b16 a[160:161], v101 offset:0
    ds_read_b64_tr_b16 a[162:163], v101 offset:1024
    ds_read_b64_tr_b16 a[164:165], v101 offset:8192
    ds_read_b64_tr_b16 a[166:167], v101 offset:9216
    v_xor_b32 v101, 160, v100
    ds_read_b64_tr_b16 a[208:209], v101 offset:0
    ds_read_b64_tr_b16 a[210:211], v101 offset:1024
    ds_read_b64_tr_b16 a[212:213], v101 offset:8192
    ds_read_b64_tr_b16 a[214:215], v101 offset:9216
    s_waitcnt lgkmcnt(0)
    s_barrier
    s_waitcnt vmcnt(15)
    ds_write_b128 v98, v[16:19] offset:0
    s_waitcnt vmcnt(14)
    ds_write_b128 v98, v[20:23] offset:1024
    s_waitcnt vmcnt(13)
    ds_write_b128 v99, v[24:27] offset:2048
    s_waitcnt vmcnt(12)
    ds_write_b128 v99, v[28:31] offset:3072
    s_waitcnt lgkmcnt(0)
    s_add_u32 s56, s12, 0
    s_addc_u32 s57, s13, 0
    global_load_dwordx4 v[16:19], v96, s[56:57]
    s_add_u32 s56, s12, 8192
    s_addc_u32 s57, s13, 0
    global_load_dwordx4 v[20:23], v96, s[56:57]
    s_add_u32 s56, s12, 16384
    s_addc_u32 s57, s13, 0
    global_load_dwordx4 v[24:27], v96, s[56:57]
    s_add_u32 s56, s12, 24576
    s_addc_u32 s57, s13, 0
    global_load_dwordx4 v[28:31], v96, s[56:57]
    s_barrier
    v_xor_b32 v101, 128, v100
    ds_read_b64_tr_b16 v[80:81], v101 offset:0
    ds_read_b64_tr_b16 v[82:83], v101 offset:1024
    ds_read_b64_tr_b16 v[84:85], v101 offset:8192
    ds_read_b64_tr_b16 v[86:87], v101 offset:9216
    s_waitcnt lgkmcnt(2)
    ds_write_b128 v120, v[80:83] offset:12288
    s_waitcnt lgkmcnt(1)
    ds_write_b128 v120, v[84:87] offset:13312
    v_xor_b32 v101, 160, v100
    ds_read_b64_tr_b16 v[80:81], v101 offset:0
    ds_read_b64_tr_b16 v[82:83], v101 offset:1024
    ds_read_b64_tr_b16 v[84:85], v101 offset:8192
    ds_read_b64_tr_b16 v[86:87], v101 offset:9216
    s_waitcnt lgkmcnt(2)
    ds_write_b128 v120, v[80:83] offset:16384
    s_waitcnt lgkmcnt(1)
    ds_write_b128 v120, v[84:87] offset:17408
    s_waitcnt lgkmcnt(0)
    s_barrier
    s_waitcnt vmcnt(15)
    ds_write_b128 v98, v[32:35] offset:0
    s_waitcnt vmcnt(14)
    ds_write_b128 v98, v[36:39] offset:1024
    s_waitcnt vmcnt(13)
    ds_write_b128 v99, v[40:43] offset:2048
    s_waitcnt vmcnt(12)
    ds_write_b128 v99, v[44:47] offset:3072
    s_waitcnt lgkmcnt(0)
    s_add_u32 s56, s12, 524288
    s_addc_u32 s57, s13, 0
    global_load_dwordx4 v[32:35], v96, s[56:57]
    s_add_u32 s56, s12, 532480
    s_addc_u32 s57, s13, 0
    global_load_dwordx4 v[36:39], v96, s[56:57]
    s_add_u32 s56, s12, 540672
    s_addc_u32 s57, s13, 0
    global_load_dwordx4 v[40:43], v96, s[56:57]
    s_add_u32 s56, s12, 548864
    s_addc_u32 s57, s13, 0
    global_load_dwordx4 v[44:47], v96, s[56:57]
    s_barrier
    v_xor_b32 v101, 128, v100
    ds_read_b64_tr_b16 v[80:81], v101 offset:0
    ds_read_b64_tr_b16 v[82:83], v101 offset:1024
    ds_read_b64_tr_b16 v[84:85], v101 offset:8192
    ds_read_b64_tr_b16 v[86:87], v101 offset:9216
    s_waitcnt lgkmcnt(2)
    ds_write_b128 v120, v[80:83] offset:14336
    s_waitcnt lgkmcnt(1)
    ds_write_b128 v120, v[84:87] offset:15360
    v_xor_b32 v101, 160, v100
    ds_read_b64_tr_b16 a[0:1], v101 offset:0
    ds_read_b64_tr_b16 a[2:3], v101 offset:1024
    ds_read_b64_tr_b16 a[4:5], v101 offset:8192
    ds_read_b64_tr_b16 a[6:7], v101 offset:9216
    s_waitcnt lgkmcnt(0)
    s_barrier
    s_waitcnt vmcnt(15)
    ds_write_b128 v98, v[48:51] offset:0
    s_waitcnt vmcnt(14)
    ds_write_b128 v98, v[52:55] offset:1024
    s_waitcnt vmcnt(13)
    ds_write_b128 v99, v[56:59] offset:2048
    s_waitcnt vmcnt(12)
    ds_write_b128 v99, v[60:63] offset:3072
    s_waitcnt lgkmcnt(0)
    s_add_u32 s56, s12, 1048576
    s_addc_u32 s57, s13, 0
    global_load_dwordx4 v[48:51], v96, s[56:57]
    s_add_u32 s56, s12, 1056768
    s_addc_u32 s57, s13, 0
    global_load_dwordx4 v[52:55], v96, s[56:57]
    s_add_u32 s56, s12, 1064960
    s_addc_u32 s57, s13, 0
    global_load_dwordx4 v[56:59], v96, s[56:57]
    s_add_u32 s56, s12, 1073152
    s_addc_u32 s57, s13, 0
    global_load_dwordx4 v[60:63], v96, s[56:57]
    s_barrier
    v_xor_b32 v101, 128, v100
    ds_read_b64_tr_b16 a[120:121], v101 offset:0
    ds_read_b64_tr_b16 a[122:123], v101 offset:1024
    ds_read_b64_tr_b16 a[124:125], v101 offset:8192
    ds_read_b64_tr_b16 a[126:127], v101 offset:9216
    v_xor_b32 v101, 160, v100
    ds_read_b64_tr_b16 a[168:169], v101 offset:0
    ds_read_b64_tr_b16 a[170:171], v101 offset:1024
    ds_read_b64_tr_b16 a[172:173], v101 offset:8192
    ds_read_b64_tr_b16 a[174:175], v101 offset:9216
    s_waitcnt lgkmcnt(0)
    s_barrier
    s_waitcnt vmcnt(15)
    ds_write_b128 v98, v[64:67] offset:0
    s_waitcnt vmcnt(14)
    ds_write_b128 v98, v[68:71] offset:1024
    s_waitcnt vmcnt(13)
    ds_write_b128 v99, v[72:75] offset:2048
    s_waitcnt vmcnt(12)
    ds_write_b128 v99, v[76:79] offset:3072
    s_waitcnt lgkmcnt(0)
    s_add_u32 s56, s12, 1572864
    s_addc_u32 s57, s13, 0
    global_load_dwordx4 v[64:67], v96, s[56:57]
    s_add_u32 s56, s12, 1581056
    s_addc_u32 s57, s13, 0
    global_load_dwordx4 v[68:71], v96, s[56:57]
    s_add_u32 s56, s12, 1589248
    s_addc_u32 s57, s13, 0
    global_load_dwordx4 v[72:75], v96, s[56:57]
    s_add_u32 s56, s12, 1597440
    s_addc_u32 s57, s13, 0
    global_load_dwordx4 v[76:79], v96, s[56:57]
    s_barrier
    v_xor_b32 v101, 128, v100
    ds_read_b64_tr_b16 a[144:145], v101 offset:0
    ds_read_b64_tr_b16 a[146:147], v101 offset:1024
    ds_read_b64_tr_b16 a[148:149], v101 offset:8192
    ds_read_b64_tr_b16 a[150:151], v101 offset:9216
    v_xor_b32 v101, 160, v100
    ds_read_b64_tr_b16 a[192:193], v101 offset:0
    ds_read_b64_tr_b16 a[194:195], v101 offset:1024
    ds_read_b64_tr_b16 a[196:197], v101 offset:8192
    ds_read_b64_tr_b16 a[198:199], v101 offset:9216
    s_waitcnt lgkmcnt(0)
    s_barrier
    s_waitcnt vmcnt(15)
    ds_write_b128 v98, v[16:19] offset:0
    s_waitcnt vmcnt(14)
    ds_write_b128 v98, v[20:23] offset:1024
    s_waitcnt vmcnt(13)
    ds_write_b128 v99, v[24:27] offset:2048
    s_waitcnt vmcnt(12)
    ds_write_b128 v99, v[28:31] offset:3072
    s_waitcnt lgkmcnt(0)
    s_add_u32 s56, s12, 2097152
    s_addc_u32 s57, s13, 0
    global_load_dwordx4 v[16:19], v96, s[56:57]
    s_add_u32 s56, s12, 2105344
    s_addc_u32 s57, s13, 0
    global_load_dwordx4 v[20:23], v96, s[56:57]
    s_add_u32 s56, s12, 2113536
    s_addc_u32 s57, s13, 0
    global_load_dwordx4 v[24:27], v96, s[56:57]
    s_add_u32 s56, s12, 2121728
    s_addc_u32 s57, s13, 0
    global_load_dwordx4 v[28:31], v96, s[56:57]
    s_barrier
    v_xor_b32 v101, 128, v100
    ds_read_b64_tr_b16 a[232:233], v101 offset:0
    ds_read_b64_tr_b16 a[234:235], v101 offset:1024
    ds_read_b64_tr_b16 a[236:237], v101 offset:8192
    ds_read_b64_tr_b16 a[238:239], v101 offset:9216
    v_xor_b32 v101, 160, v100
    ds_read_b64_tr_b16 a[240:241], v101 offset:0
    ds_read_b64_tr_b16 a[242:243], v101 offset:1024
    ds_read_b64_tr_b16 a[244:245], v101 offset:8192
    ds_read_b64_tr_b16 a[246:247], v101 offset:9216
    s_waitcnt lgkmcnt(0)
    s_barrier
    s_waitcnt vmcnt(15)
    ds_write_b128 v98, v[32:35] offset:0
    s_waitcnt vmcnt(14)
    ds_write_b128 v98, v[36:39] offset:1024
    s_waitcnt vmcnt(13)
    ds_write_b128 v99, v[40:43] offset:2048
    s_waitcnt vmcnt(12)
    ds_write_b128 v99, v[44:47] offset:3072
    s_waitcnt lgkmcnt(0)
    s_add_u32 s56, s12, 2621440
    s_addc_u32 s57, s13, 0
    global_load_dwordx4 v[32:35], v96, s[56:57]
    s_add_u32 s56, s12, 2629632
    s_addc_u32 s57, s13, 0
    global_load_dwordx4 v[36:39], v96, s[56:57]
    s_add_u32 s56, s12, 2637824
    s_addc_u32 s57, s13, 0
    global_load_dwordx4 v[40:43], v96, s[56:57]
    s_add_u32 s56, s12, 2646016
    s_addc_u32 s57, s13, 0
    global_load_dwordx4 v[44:47], v96, s[56:57]
    s_barrier
    v_xor_b32 v101, 128, v100
    ds_read_b64_tr_b16 v[160:161], v101 offset:0
    ds_read_b64_tr_b16 v[162:163], v101 offset:1024
    ds_read_b64_tr_b16 v[164:165], v101 offset:8192
    ds_read_b64_tr_b16 v[166:167], v101 offset:9216
    v_xor_b32 v101, 160, v100
    ds_read_b64_tr_b16 v[168:169], v101 offset:0
    ds_read_b64_tr_b16 v[170:171], v101 offset:1024
    ds_read_b64_tr_b16 v[172:173], v101 offset:8192
    ds_read_b64_tr_b16 v[174:175], v101 offset:9216
    s_waitcnt lgkmcnt(0)
    s_barrier
    s_waitcnt vmcnt(15)
    ds_write_b128 v98, v[48:51] offset:0
    s_waitcnt vmcnt(14)
    ds_write_b128 v98, v[52:55] offset:1024
    s_waitcnt vmcnt(13)
    ds_write_b128 v99, v[56:59] offset:2048
    s_waitcnt vmcnt(12)
    ds_write_b128 v99, v[60:63] offset:3072
    s_waitcnt lgkmcnt(0)
    s_cmp_eq_u32 s55, 1
    s_cbranch_scc1 L_cf4
    v_mov_b32 v252, 139264
    s_cmp_lg_u32 s30, 0
    s_cbranch_scc1 L_cg4
    s_waitcnt vmcnt(12)
    s_mov_b64 exec, 1
    ds_write_b32 v252, v253
    s_waitcnt lgkmcnt(0)
    s_mov_b64 exec, -1
L_cg4:
    s_barrier
    ds_read_b32 v253, v252
    s_waitcnt lgkmcnt(0)
    v_readfirstlane_b32 s56, v253
    s_barrier
    s_bitcmp1_b32 s56, s31
    s_cbranch_scc1 L_lost
L_cf4:
    s_add_u32 s56, s12, 3145728
    s_addc_u32 s57, s13, 0
    global_load_dwordx4 v[48:51], v96, s[56:57]
    s_add_u32 s56, s12, 3153920
    s_addc_u32 s57, s13, 0
    global_load_dwordx4 v[52:55], v96, s[56:57]
    s_add_u32 s56, s12, 3162112
    s_addc_u32 s57, s13, 0
    global_load_dwordx4 v[56:59], v96, s[56:57]
    s_add_u32 s56, s12, 3170304
    s_addc_u32 s57, s13, 0
    global_load_dwordx4 v[60:63], v96, s[56:57]
    s_barrier
    v_xor_b32 v101, 128, v100
    ds_read_b64_tr_b16 a[248:249], v101 offset:0
    ds_read_b64_tr_b16 a[250:251], v101 offset:1024
    ds_read_b64_tr_b16 a[252:253], v101 offset:8192
    ds_read_b64_tr_b16 a[254:255], v101 offset:9216
    v_xor_b32 v101, 160, v100
    ds_read_b64_tr_b16 v[136:137], v101 offset:0
    ds_read_b64_tr_b16 v[138:139], v101 offset:1024
    ds_read_b64_tr_b16 v[140:141], v101 offset:8192
    ds_read_b64_tr_b16 v[142:143], v101 offset:9216
    s_waitcnt lgkmcnt(0)
    s_barrier
    s_waitcnt vmcnt(15)
    ds_write_b128 v98, v[64:67] offset:0
    s_waitcnt vmcnt(14)
    ds_write_b128 v98, v[68:71] offset:1024
    s_waitcnt vmcnt(13)
    ds_write_b128 v99, v[72:75] offset:2048
    s_waitcnt vmcnt(12)
    ds_write_b128 v99, v[76:79] offset:3072
    s_waitcnt lgkmcnt(0)
    s_add_u32 s56, s12, 3670016
    s_addc_u32 s57, s13, 0
    global_load_dwordx4 v[64:67], v96, s[56:57]
    s_add_u32 s56, s12, 3678208
    s_addc_u32 s57, s13, 0
    global_load_dwordx4 v[68:71], v96, s[56:57]
    s_add_u32 s56, s12, 3686400
    s_addc_u32 s57, s13, 0
    global_load_dwordx4 v[72:75], v96, s[56:57]
    s_add_u32 s56, s12, 3694592
    s_addc_u32 s57, s13, 0
    global_load_dwordx4 v[76:79], v96, s[56:57]
    s_barrier
    v_xor_b32 v101, 128, v100
    ds_read_b64_tr_b16 v[176:177], v101 offset:0
    ds_read_b64_tr_b16 v[178:179], v101 offset:1024
    ds_read_b64_tr_b16 v[180:181], v101 offset:8192
    ds_read_b64_tr_b16 v[182:183], v101 offset:9216
    v_xor_b32 v101, 160, v100
    ds_read_b64_tr_b16 v[184:185], v101 offset:0
    ds_read_b64_tr_b16 v[186:187], v101 offset:1024
    ds_read_b64_tr_b16 v[188:189], v101 offset:8192
    ds_read_b64_tr_b16 v[190:191], v101 offset:9216
    s_waitcnt lgkmcnt(0)
    s_barrier
    s_waitcnt vmcnt(15)
    ds_write_b128 v98, v[16:19] offset:0
    s_waitcnt vmcnt(14)
    ds_write_b128 v98, v[20:23] offset:1024
    s_waitcnt vmcnt(13)
    ds_write_b128 v99, v[24:27] offset:2048
    s_waitcnt vmcnt(12)
    ds_write_b128 v99, v[28:31] offset:3072
    s_waitcnt lgkmcnt(0)
    s_add_u32 s56, s8, 0
    s_addc_u32 s57, s9, 0
    global_load_dwordx4 v[16:19], v96, s[56:57]
    s_add_u32 s56, s8, 8192
    s_addc_u32 s57, s9, 0
    global_load_dwordx4 v[20:23], v96, s[56:57]
    s_add_u32 s56, s8, 16384
    s_addc_u32 s57, s9, 0
    global_load_dwordx4 v[24:27], v96, s[56:57]
    s_add_u32 s56, s8, 24576
    s_addc_u32 s57, s9, 0
    global_load_dwordx4 v[28:31], v96, s[56:57]
    s_barrier
    v_xor_b32 v101, 128, v100
    ds_read_b64_tr_b16 v[80:81], v101 offset:0
    ds_read_b64_tr_b16 v[82:83], v101 offset:1024
    ds_read_b64_tr_b16 v[84:85], v101 offset:8192
    ds_read_b64_tr_b16 v[86:87], v101 offset:9216
    s_waitcnt lgkmcnt(2)
    ds_write_b128 v120, v[80:83] offset:0
    s_waitcnt lgkmcnt(1)
    ds_write_b128 v120, v[84:87] offset:1024
    v_xor_b32 v101, 160, v100
    ds_read_b64_tr_b16 v[80:81], v101 offset:0
    ds_read_b64_tr_b16 v[82:83], v101 offset:1024
    ds_read_b64_tr_b16 v[84:85], v101 offset:8192
    ds_read_b64_tr_b16 v[86:87], v101 offset:9216
    s_waitcnt lgkmcnt(2)
    ds_write_b128 v120, v[80:83] offset:2048
    s_waitcnt lgkmcnt(1)
    ds_write_b128 v120, v[84:87] offset:3072
    s_waitcnt lgkmcnt(0)
    s_barrier
    s_waitcnt vmcnt(15)
    ds_write_b128 v98, v[32:35] offset:0
    s_waitcnt vmcnt(14)
    ds_write_b128 v98, v[36:39] offset:1024
    s_waitcnt vmcnt(13)
    ds_write_b128 v99, v[40:43] offset:2048
    s_waitcnt vmcnt(12)
    ds_write_b128 v99, v[44:47] offset:3072
    s_waitcnt lgkmcnt(0)
    s_add_u32 s56, s8, 524288
    s_addc_u32 s57, s9, 0
    global_load_dwordx4 v[32:35], v96, s[56:57]
    s_add_u32 s56, s8, 532480
    s_addc_u32 s57, s9, 0
    global_load_dwordx4 v[36:39], v96, s[56:57]
    s_add_u32 s56, s8, 540672
    s_addc_u32 s57, s9, 0
    global_load_dwordx4 v[40:43], v96, s[56:57]
    s_add_u32 s56, s8, 548864
    s_addc_u32 s57, s9, 0
    global_load_dwordx4 v[44:47], v96, s[56:57]
    s_barrier
    v_xor_b32 v101, 128, v100
    ds_read_b64_tr_b16 a[8:9], v101 offset:0
    ds_read_b64_tr_b16 a[10:11], v101 offset:1024
    ds_read_b64_tr_b16 a[12:13], v101 offset:8192
    ds_read_b64_tr_b16 a[14:15], v101 offset:9216
    v_xor_b32 v101, 160, v100
    ds_read_b64_tr_b16 a[16:17], v101 offset:0
    ds_read_b64_tr_b16 a[18:19], v101 offset:1024
    ds_read_b64_tr_b16 a[20:21], v101 offset:8192
    ds_read_b64_tr_b16 a[22:23], v101 offset:9216
    s_waitcnt lgkmcnt(0)
    s_barrier
    s_waitcnt vmcnt(15)
    ds_write_b128 v98, v[48:51] offset:0
    s_waitcnt vmcnt(14)
    ds_write_b128 v98, v[52:55] offset:1024
    s_waitcnt vmcnt(13)
    ds_write_b128 v99, v[56:59] offset:2048
    s_waitcnt vmcnt(12)
    ds_write_b128 v99, v[60:63] offset:3072
    s_waitcnt lgkmcnt(0)
    s_add_u32 s56, s8, 1048576
    s_addc_u32 s57, s9, 0
    global_load_dwordx4 v[48:51], v96, s[56:57]
    s_add_u32 s56, s8, 1056768
    s_addc_u32 s57, s9, 0
    global_load_dwordx4 v[52:55], v96, s[56:57]
    s_add_u32 s56, s8, 1064960
    s_addc_u32 s57, s9, 0
    global_load_dwordx4 v[56:59], v96, s[56:57]
    s_add_u32 s56, s8, 1073152
    s_addc_u32 s57, s9, 0
    global_load_dwordx4 v[60:63], v96, s[56:57]
    s_barrier
    v_xor_b32 v101, 128, v100
    ds_read_b64_tr_b16 a[216:217], v101 offset:0
    ds_read_b64_tr_b16 a[218:219], v101 offset:1024
    ds_read_b64_tr_b16 a[220:221], v101 offset:8192
    ds_read_b64_tr_b16 a[222:223], v101 offset:9216
    v_xor_b32 v101, 160, v100
    ds_read_b64_tr_b16 a[224:225], v101 offset:0
    ds_read_b64_tr_b16 a[226:227], v101 offset:1024
    ds_read_b64_tr_b16 a[228:229], v101 offset:8192
    ds_read_b64_tr_b16 a[230:231], v101 offset:9216
    s_waitcnt lgkmcnt(0)
    s_barrier
    s_waitcnt vmcnt(15)
    ds_write_b128 v98, v[64:67] offset:0
    s_waitcnt vmcnt(14)
    ds_write_b128 v98, v[68:71] offset:1024
    s_waitcnt vmcnt(13)
    ds_write_b128 v99, v[72:75] offset:2048
    s_waitcnt vmcnt(12)
    ds_write_b128 v99, v[76:79] offset:3072
    s_waitcnt lgkmcnt(0)
    s_add_u32 s56, s8, 1572864
    s_addc_u32 s57, s9, 0
    global_load_dwordx4 v[64:67], v96, s[56:57]
    s_add_u32 s56, s8, 1581056
    s_addc_u32 s57, s9, 0
    global_load_dwordx4 v[68:71], v96, s[56:57]
    s_add_u32 s56, s8, 1589248
    s_addc_u32 s57, s9, 0
    global_load_dwordx4 v[72:75], v96, s[56:57]
    s_add_u32 s56, s8, 1597440
    s_addc_u32 s57, s9, 0
    global_load_dwordx4 v[76:79], v96, s[56:57]
    s_barrier
    v_xor_b32 v101, 128, v100
    ds_read_b64_tr_b16 v[144:145], v101 offset:0
    ds_read_b64_tr_b16 v[146:147], v101 offset:1024
    ds_read_b64_tr_b16 v[148:149], v101 offset:8192
    ds_read_b64_tr_b16 v[150:151], v101 offset:9216
    v_xor_b32 v101, 160, v100
    ds_read_b64_tr_b16 v[152:153], v101 offset:0
    ds_read_b64_tr_b16 v[154:155], v101 offset:1024
    ds_read_b64_tr_b16 v[156:157], v101 offset:8192
    ds_read_b64_tr_b16 v[158:159], v101 offset:9216
    s_waitcnt lgkmcnt(0)
    s_barrier
    s_waitcnt vmcnt(15)
    ds_write_b128 v98, v[16:19] offset:0
    s_waitcnt vmcnt(14)
    ds_write_b128 v98, v[20:23] offset:1024
    s_waitcnt vmcnt(13)
    ds_write_b128 v99, v[24:27] offset:2048
    s_waitcnt vmcnt(12)
    ds_write_b128 v99, v[28:31] offset:3072
    s_waitcnt lgkmcnt(0)
    s_add_u32 s56, s8, 2097152
    s_addc_u32 s57, s9, 0
    global_load_dwordx4 v[16:19], v96, s[56:57]
    s_add_u32 s56, s8, 2105344
    s_addc_u32 s57, s9, 0
    global_load_dwordx4 v[20:23], v96, s[56:57]
    s_add_u32 s56, s8, 2113536
    s_addc_u32 s57, s9, 0
    global_load_dwordx4 v[24:27], v96, s[56:57]
    s_add_u32 s56, s8, 2121728
    s_addc_u32 s57, s9, 0
    global_load_dwordx4 v[28:31], v96, s[56:57]
    s_barrier
    v_xor_b32 v101, 128, v100
    ds_read_b64_tr_b16 a[40:41], v101 offset:0
    ds_read_b64_tr_b16 a[42:43], v101 offset:1024
    ds_read_b64_tr_b16 a[44:45], v101 offset:8192
    ds_read_b64_tr_b16 a[46:47], v101 offset:9216
    v_xor_b32 v101, 160, v100
    ds_read_b64_tr_b16 a[48:49], v101 offset:0
    ds_read_b64_tr_b16 a[50:51], v101 offset:1024
    ds_read_b64_tr_b16 a[52:53], v101 offset:8192
    ds_read_b64_tr_b16 a[54:55], v101 offset:9216
    s_waitcnt lgkmcnt(0)
    s_barrier
    s_waitcnt vmcnt(15)
    ds_write_b128 v98, v[32:35] offset:0
    s_waitcnt vmcnt(14)
    ds_write_b128 v98, v[36:39] offset:1024
    s_waitcnt vmcnt(13)
    ds_write_b128 v99, v[40:43] offset:2048
    s_waitcnt vmcnt(12)
    ds_write_b128 v99, v[44:47] offset:3072
    s_waitcnt lgkmcnt(0)
    s_add_u32 s56, s8, 2621440
    s_addc_u32 s57, s9, 0
    global_load_dwordx4 v[32:35], v96, s[56:57]
    s_add_u32 s56, s8, 2629632
    s_addc_u32 s57, s9, 0
    global_load_dwordx4 v[36:39], v96, s[56:57]
    s_add_u32 s56, s8, 2637824
    s_addc_u32 s57, s9, 0
    global_load_dwordx4 v[40:43], v96, s[56:57]
    s_add_u32 s56, s8, 2646016
    s_addc_u32 s57, s9, 0
    global_load_dwordx4 v[44:47], v96, s[56:57]
    s_barrier
    v_xor_b32 v101, 128, v100
    ds_read_b64_tr_b16 a[88:89], v101 offset:0
    ds_read_b64_tr_b16 a[90:91], v101 offset:1024
    ds_read_b64_tr_b16 a[92:93], v101 offset:8192
    ds_read_b64_tr_b16 a[94:95], v101 offset:9216
    v_xor_b32 v101, 160, v100
    ds_read_b64_tr_b16 a[96:97], v101 offset:0
    ds_read_b64_tr_b16 a[98:99], v101 offset:1024
    ds_read_b64_tr_b16 a[100:101], v101 offset:8192
    ds_read_b64_tr_b16 a[102:103], v101 offset:9216
    s_waitcnt lgkmcnt(0)
    s_barrier
    s_waitcnt vmcnt(15)
    ds_write_b128 v98, v[48:51] offset:0
    s_waitcnt vmcnt(14)
    ds_write_b128 v98, v[52:55] offset:1024
    s_waitcnt vmcnt(13)
    ds_write_b128 v99, v[56:59] offset:2048
    s_waitcnt vmcnt(12)
    ds_write_b128 v99, v[60:63] offset:3072
    s_waitcnt lgkmcnt(0)
    s_add_u32 s56, s8, 3145728
    s_addc_u32 s57, s9, 0
    global_load_dwordx4 v[48:51], v96, s[56:57]
    s_add_u32 s56, s8, 3153920
    s_addc_u32 s57, s9, 0
    global_load_dwordx4 v[52:55], v96, s[56:57]
    s_add_u32 s56, s8, 3162112
    s_addc_u32 s57, s9, 0
    global_load_dwordx4 v[56:59], v96, s[56:57]
    s_add_u32 s56, s8, 3170304
    s_addc_u32 s57, s9, 0
    global_load_dwordx4 v[60:63], v96, s[56:57]
    s_barrier
    v_xor_b32 v101, 128, v100
    ds_read_b64_tr_b16 a[56:57], v101 offset:0
    ds_read_b64_tr_b16 a[58:59], v101 offset:1024
    ds_read_b64_tr_b16 a[60:61], v101 offset:8192
    ds_read_b64_tr_b16 a[62:63], v101 offset:9216
    v_xor_b32 v101, 160, v100
    ds_read_b64_tr_b16 a[64:65], v101 offset:0
    ds_read_b64_tr_b16 a[66:67], v101 offset:1024
    ds_read_b64_tr_b16 a[68:69], v101 offset:8192
    ds_read_b64_tr_b16 a[70:71], v101 offset:9216
    s_waitcnt lgkmcnt(0)
    s_barrier
    s_waitcnt vmcnt(15)
    ds_write_b128 v98, v[64:67] offset:0
    s_waitcnt vmcnt(14)
    ds_write_b128 v98, v[68:71] offset:1024
    s_waitcnt vmcnt(13)
    ds_write_b128 v99, v[72:75] offset:2048
    s_waitcnt vmcnt(12)
    ds_write_b128 v99, v[76:79] offset:3072
    s_waitcnt lgkmcnt(0)
    s_add_u32 s56, s8, 3670016
    s_addc_u32 s57, s9, 0
    global_load_dwordx4 v[64:67], v96, s[56:57]
    s_add_u32 s56, s8, 3678208
    s_addc_u32 s57, s9, 0
    global_load_dwordx4 v[68:71], v96, s[56:57]
    s_add_u32 s56, s8, 3686400
    s_addc_u32 s57, s9, 0
    global_load_dwordx4 v[72:75], v96, s[56:57]
    s_add_u32 s56, s8, 3694592
    s_addc_u32 s57, s9, 0
    global_load_dwordx4 v[76:79], v96, s[56:57]
    s_barrier
    v_xor_b32 v101, 128, v100
    ds_read_b64_tr_b16 a[104:105], v101 offset:0
    ds_read_b64_tr_b16 a[106:107], v101 offset:1024
    ds_read_b64_tr_b16 a[108:109], v101 offset:8192
    ds_read_b64_tr_b16 a[110:111], v101 offset:9216
    v_xor_b32 v101, 160, v100
    ds_read_b64_tr_b16 a[112:113], v101 offset:0
    ds_read_b64_tr_b16 a[114:115], v101 offset:1024
    ds_read_b64_tr_b16 a[116:117], v101 offset:8192
    ds_read_b64_tr_b16 a[118:119], v101 offset:9216
    s_waitcnt lgkmcnt(0)
    s_barrier
    s_waitcnt vmcnt(15)
    ds_write_b128 v98, v[16:19] offset:0
    s_waitcnt vmcnt(14)
    ds_write_b128 v98, v[20:23] offset:1024
    s_waitcnt vmcnt(13)
    ds_write_b128 v99, v[24:27] offset:2048
    s_waitcnt vmcnt(12)
    ds_write_b128 v99, v[28:31] offset:3072
    s_waitcnt lgkmcnt(0)
    s_add_u32 s56, s14, 0
    s_addc_u32 s57, s15, 0
    global_load_dwordx4 v[16:19], v97, s[56:57]
    s_add_u32 s56, s14, 1024
    s_addc_u32 s57, s15, 0
    global_load_dwordx4 v[20:23], v97, s[56:57]
    s_add_u32 s56, s14, 16384
    s_addc_u32 s57, s15, 0
    global_load_dwordx4 v[24:27], v97, s[56:57]
    s_add_u32 s56, s14, 17408
    s_addc_u32 s57, s15, 0
    global_load_dwordx4 v[28:31], v97, s[56:57]
    s_barrier
    v_xor_b32 v101, 128, v100
    ds_read_b64_tr_b16 v[80:81], v101 offset:0
    ds_read_b64_tr_b16 v[82:83], v101 offset:1024
    ds_read_b64_tr_b16 v[84:85], v101 offset:8192
    ds_read_b64_tr_b16 v[86:87], v101 offset:9216
    s_waitcnt lgkmcnt(2)
    ds_write_b128 v120, v[80:83] offset:8192
    s_waitcnt lgkmcnt(1)
    ds_write_b128 v120, v[84:87] offset:9216
    v_xor_b32 v101, 160, v100
    ds_read_b64_tr_b16 v[80:81], v101 offset:0
    ds_read_b64_tr_b16 v[82:83], v101 offset:1024
    ds_read_b64_tr_b16 v[84:85], v101 offset:8192
    ds_read_b64_tr_b16 v[86:87], v101 offset:9216
    s_waitcnt lgkmcnt(2)
    ds_write_b128 v120, v[80:83] offset:10240
    s_waitcnt lgkmcnt(1)
    ds_write_b128 v120, v[84:87] offset:11264
    s_waitcnt lgkmcnt(0)
    s_barrier
    s_waitcnt vmcnt(15)
    ds_write_b128 v98, v[32:35] offset:0
    s_waitcnt vmcnt(14)
    ds_write_b128 v98, v[36:39] offset:1024
    s_waitcnt vmcnt(13)
    ds_write_b128 v99, v[40:43] offset:2048
    s_waitcnt vmcnt(12)
    ds_write_b128 v99, v[44:47] offset:3072
    s_waitcnt lgkmcnt(0)
    v_lshrrev_b32 v106, 2, v127
    global_load_dword v107, v106, s[26:27] sc1
    s_add_u32 s56, s14, 4096
    s_addc_u32 s57, s15, 0
    global_load_dwordx4 v[32:35], v97, s[56:57]
    s_add_u32 s56, s14, 5120
    s_addc_u32 s57, s15, 0
    global_load_dwordx4 v[36:39], v97, s[56:57]
    s_add_u32 s56, s14, 20480
    s_addc_u32 s57, s15, 0
    global_load_dwordx4 v[40:43], v97, s[56:57]
    s_add_u32 s56, s14, 21504
    s_addc_u32 s57, s15, 0
    global_load_dwordx4 v[44:47], v97, s[56:57]
    s_barrier
    v_xor_b32 v101, 128, v100
    ds_read_b64_tr_b16 v[80:81], v101 offset:0
    ds_read_b64_tr_b16 v[82:83], v101 offset:1024
    ds_read_b64_tr_b16 v[84:85], v101 offset:8192
    ds_read_b64_tr_b16 v[86:87], v101 offset:9216
    s_waitcnt lgkmcnt(2)
    ds_write_b128 v120, v[80:83] offset:4096
    s_waitcnt lgkmcnt(1)
    ds_write_b128 v120, v[84:87] offset:5120
    v_xor_b32 v101, 160, v100
    ds_read_b64_tr_b16 v[80:81], v101 offset:0
    ds_read_b64_tr_b16 v[82:83], v101 offset:1024
    ds_read_b64_tr_b16 v[84:85], v101 offset:8192
    ds_read_b64_tr_b16 v[86:87], v101 offset:9216
    s_waitcnt lgkmcnt(2)
    ds_write_b128 v120, v[80:83] offset:6144
    s_waitcnt lgkmcnt(1)
    ds_write_b128 v120, v[84:87] offset:7168
    s_waitcnt lgkmcnt(0)
    s_barrier
    s_waitcnt vmcnt(16)
    ds_write_b128 v98, v[48:51] offset:0
    s_waitcnt vmcnt(15)
    ds_write_b128 v98, v[52:55] offset:1024
    s_waitcnt vmcnt(14)
    ds_write_b128 v99, v[56:59] offset:2048
    s_waitcnt vmcnt(13)
    ds_write_b128 v99, v[60:63] offset:3072
    s_waitcnt lgkmcnt(0)
    s_add_u32 s56, s14, 8192
    s_addc_u32 s57, s15, 0
    global_load_dwordx4 v[48:51], v97, s[56:57]
    s_add_u32 s56, s14, 9216
    s_addc_u32 s57, s15, 0
    global_load_dwordx4 v[52:55], v97, s[56:57]
    s_add_u32 s56, s14, 24576
    s_addc_u32 s57, s15, 0
    global_load_dwordx4 v[56:59], v97, s[56:57]
    s_add_u32 s56, s14, 25600
    s_addc_u32 s57, s15, 0
    global_load_dwordx4 v[60:63], v97, s[56:57]
    s_barrier
    v_xor_b32 v101, 128, v100
    ds_read_b64_tr_b16 a[24:25], v101 offset:0
    ds_read_b64_tr_b16 a[26:27], v101 offset:1024
    ds_read_b64_tr_b16 a[28:29], v101 offset:8192
    ds_read_b64_tr_b16 a[30:31], v101 offset:9216
    v_xor_b32 v101, 160, v100
    ds_read_b64_tr_b16 a[32:33], v101 offset:0
    ds_read_b64_tr_b16 a[34:35], v101 offset:1024
    ds_read_b64_tr_b16 a[36:37], v101 offset:8192
    ds_read_b64_tr_b16 a[38:39], v101 offset:9216
    s_waitcnt lgkmcnt(0)
    s_barrier
    s_waitcnt vmcnt(16)
    ds_write_b128 v98, v[64:67] offset:0
    s_waitcnt vmcnt(15)
    ds_write_b128 v98, v[68:71] offset:1024
    s_waitcnt vmcnt(14)
    ds_write_b128 v99, v[72:75] offset:2048
    s_waitcnt vmcnt(13)
    ds_write_b128 v99, v[76:79] offset:3072
    s_waitcnt lgkmcnt(0)
    s_add_u32 s56, s14, 12288
    s_addc_u32 s57, s15, 0
    global_load_dwordx4 v[64:67], v97, s[56:57]
    s_add_u32 s56, s14, 13312
    s_addc_u32 s57, s15, 0
    global_load_dwordx4 v[68:71], v97, s[56:57]
    s_add_u32 s56, s14, 28672
    s_addc_u32 s57, s15, 0
    global_load_dwordx4 v[72:75], v97, s[56:57]
    s_add_u32 s56, s14, 29696
    s_addc_u32 s57, s15, 0
    global_load_dwordx4 v[76:79], v97, s[56:57]
    s_barrier
    v_xor_b32 v101, 128, v100
    ds_read_b64_tr_b16 a[72:73], v101 offset:0
    ds_read_b64_tr_b16 a[74:75], v101 offset:1024
    ds_read_b64_tr_b16 a[76:77], v101 offset:8192
    ds_read_b64_tr_b16 a[78:79], v101 offset:9216
    v_xor_b32 v101, 160, v100
    ds_read_b64_tr_b16 a[80:81], v101 offset:0
    ds_read_b64_tr_b16 a[82:83], v101 offset:1024
    ds_read_b64_tr_b16 a[84:85], v101 offset:8192
    ds_read_b64_tr_b16 a[86:87], v101 offset:9216
    s_waitcnt lgkmcnt(0)
    s_barrier
    s_waitcnt vmcnt(16)
    ds_write_b128 v94, v[16:19] offset:0
    s_waitcnt vmcnt(15)
    ds_write_b128 v95, v[20:23] offset:1024
    s_waitcnt vmcnt(14)
    ds_write_b128 v94, v[24:27] offset:2048
    s_waitcnt vmcnt(13)
    ds_write_b128 v95, v[28:31] offset:3072
    s_waitcnt lgkmcnt(0)
    s_add_u32 s56, s14, 65536
    s_addc_u32 s57, s15, 0
    global_load_dwordx4 v[16:19], v97, s[56:57]
    s_add_u32 s56, s14, 66560
    s_addc_u32 s57, s15, 0
    global_load_dwordx4 v[20:23], v97, s[56:57]
    s_add_u32 s56, s14, 81920
    s_addc_u32 s57, s15, 0
    global_load_dwordx4 v[24:27], v97, s[56:57]
    s_add_u32 s56, s14, 82944
    s_addc_u32 s57, s15, 0
    global_load_dwordx4 v[28:31], v97, s[56:57]
    s_barrier
    v_xor_b32 v101, 0, v105
    ds_read_b64_tr_b16 v[80:81], v101 offset:0
    ds_read_b64_tr_b16 v[82:83], v101 offset:2048
    v_xor_b32 v101, 64, v105
    ds_read_b64_tr_b16 v[84:85], v101 offset:0
    ds_read_b64_tr_b16 v[86:87], v101 offset:2048
    v_xor_b32 v101, 128, v105
    ds_read_b64_tr_b16 v[224:225], v101 offset:0
    ds_read_b64_tr_b16 v[226:227], v101 offset:2048
    v_xor_b32 v101, 192, v105
    ds_read_b64_tr_b16 v[240:241], v101 offset:0
    ds_read_b64_tr_b16 v[242:243], v101 offset:2048
    s_waitcnt lgkmcnt(6)
    ds_write_b128 v120, v[80:83] offset:18432
    s_waitcnt lgkmcnt(5)
    ds_write_b128 v120, v[84:87] offset:20480
    s_waitcnt lgkmcnt(0)
    s_barrier
    s_waitcnt vmcnt(15)
    ds_write_b128 v94, v[32:35] offset:0
    s_waitcnt vmcnt(14)
    ds_write_b128 v95, v[36:39] offset:1024
    s_waitcnt vmcnt(13)
    ds_write_b128 v94, v[40:43] offset:2048
    s_waitcnt vmcnt(12)
    ds_write_b128 v95, v[44:47] offset:3072
    s_waitcnt lgkmcnt(0)
    s_getpc_b64 s[56:57]
L_rpc2:
    s_add_u32 s56, s56, L_rcode-L_rpc2+8192
    s_addc_u32 s57, s57, 0
    v_lshlrev_b32 v130, 1, v127
    global_load_dword v133, v130, s[40:41] sc1
    v_lshlrev_b32 v130, 2, v127
    global_load_dword v132, v130, s[56:57]
    v_add_u32 v130, 8192, v130
    global_load_dword v134, v130, s[44:45] sc1
    s_add_u32 s56, s14, 69632
    s_addc_u32 s57, s15, 0
    global_load_dwordx4 v[32:35], v97, s[56:57]
    s_add_u32 s56, s14, 70656
    s_addc_u32 s57, s15, 0
    global_load_dwordx4 v[36:39], v97, s[56:57]
    s_add_u32 s56, s14, 86016
    s_addc_u32 s57, s15, 0
    global_load_dwordx4 v[40:43], v97, s[56:57]
    s_add_u32 s56, s14, 87040
    s_addc_u32 s57, s15, 0
    global_load_dwordx4 v[44:47], v97, s[56:57]
    s_barrier
    v_xor_b32 v101, 0, v105
    ds_read_b64_tr_b16 v[80:81], v101 offset:0
    ds_read_b64_tr_b16 v[82:83], v101 offset:2048
    v_xor_b32 v101, 64, v105
    ds_read_b64_tr_b16 v[84:85], v101 offset:0
    ds_read_b64_tr_b16 v[86:87], v101 offset:2048
    v_xor_b32 v101, 128, v105
    ds_read_b64_tr_b16 v[228:229], v101 offset:0
    ds_read_b64_tr_b16 v[230:231], v101 offset:2048
    v_xor_b32 v101, 192, v105
    ds_read_b64_tr_b16 v[244:245], v101 offset:0
    ds_read_b64_tr_b16 v[246:247], v101 offset:2048
    s_waitcnt lgkmcnt(6)
    ds_write_b128 v120, v[80:83] offset:19456
    s_waitcnt lgkmcnt(5)
    ds_write_b128 v120, v[84:87] offset:21504
    s_waitcnt lgkmcnt(0)
    s_barrier
    s_waitcnt vmcnt(15)
    ds_write_b128 v94, v[48:51] offset:0
    s_waitcnt vmcnt(14)
    ds_write_b128 v95, v[52:55] offset:1024
    s_waitcnt vmcnt(13)
    ds_write_b128 v94, v[56:59] offset:2048
    s_waitcnt vmcnt(12)
    ds_write_b128 v95, v[60:63] offset:3072
    s_waitcnt lgkmcnt(0)
    v_readlane_b32 s63, v107, 4
    s_mov_b32 exec_lo, 0x20200
    s_mov_b32 exec_hi, 0x40000
    v_cmp_gt_u32 vcc, 32, v107
    s_cmp_eq_u32 s63, -1
    s_cselect_b32 s63, 1, 0
    s_cmp_eq_u64 vcc, 0
    s_cselect_b32 s63, s63, 0
    s_mov_b64 exec, 0xff
    global_load_dword v107, v106, s[68:69] offset:256 sc1
    s_mov_b64 exec, -1
    s_add_u32 s56, s14, 73728
    s_addc_u32 s57, s15, 0
    global_load_dwordx4 v[48:51], v97, s[56:57]
    s_add_u32 s56, s14, 74752
    s_addc_u32 s57, s15, 0
    global_load_dwordx4 v[52:55], v97, s[56:57]
    s_add_u32 s56, s14, 90112
    s_addc_u32 s57, s15, 0
    global_load_dwordx4 v[56:59], v97, s[56:57]
    s_add_u32 s56, s14, 91136
    s_addc_u32 s57, s15, 0
    global_load_dwordx4 v[60:63], v97, s[56:57]
    s_barrier
    v_xor_b32 v101, 0, v105
    ds_read_b64_tr_b16 v[80:81], v101 offset:0
    ds_read_b64_tr_b16 v[82:83], v101 offset:2048
    v_xor_b32 v101, 64, v105
    ds_read_b64_tr_b16 v[84:85], v101 offset:0
    ds_read_b64_tr_b16 v[86:87], v101 offset:2048
    v_xor_b32 v101, 128, v105
    ds_read_b64_tr_b16 v[88:89], v101 offset:0
    ds_read_b64_tr_b16 v[90:91], v101 offset:2048
    s_waitcnt lgkmcnt(4)
    ds_write_b128 v120, v[80:83] offset:22528
    v_xor_b32 v101, 192, v105
    ds_read_b64_tr_b16 v[80:81], v101 offset:0
    ds_read_b64_tr_b16 v[82:83], v101 offset:2048
    s_waitcnt lgkmcnt(5)
    ds_write_b128 v120, v[84:87] offset:24576
    s_waitcnt lgkmcnt(4)
    ds_write_b128 v120, v[88:91] offset:26624
    s_waitcnt lgkmcnt(2)
    ds_write_b128 v120, v[80:83] offset:30720
    s_waitcnt lgkmcnt(0)
    s_barrier
    s_waitcnt vmcnt(16)
    ds_write_b128 v94, v[64:67] offset:0
    s_waitcnt vmcnt(15)
    ds_write_b128 v95, v[68:71] offset:1024
    s_waitcnt vmcnt(14)
    ds_write_b128 v94, v[72:75] offset:2048
    s_waitcnt vmcnt(13)
    ds_write_b128 v95, v[76:79] offset:3072
    s_waitcnt lgkmcnt(0)
    s_add_u32 s56, s14, 77824
    s_addc_u32 s57, s15, 0
    global_load_dwordx4 v[64:67], v97, s[56:57]
    s_add_u32 s56, s14, 78848
    s_addc_u32 s57, s15, 0
    global_load_dwordx4 v[68:71], v97, s[56:57]
    s_add_u32 s56, s14, 94208
    s_addc_u32 s57, s15, 0
    global_load_dwordx4 v[72:75], v97, s[56:57]
    s_add_u32 s56, s14, 95232
    s_addc_u32 s57, s15, 0
    global_load_dwordx4 v[76:79], v97, s[56:57]
    s_barrier
    v_xor_b32 v101, 0, v105
    ds_read_b64_tr_b16 v[80:81], v101 offset:0
    ds_read_b64_tr_b16 v[82:83], v101 offset:2048
    v_xor_b32 v101, 64, v105
    ds_read_b64_tr_b16 v[84:85], v101 offset:0
    ds_read_b64_tr_b16 v[86:87], v101 offset:2048
    v_xor_b32 v101, 128, v105
    ds_read_b64_tr_b16 v[88:89], v101 offset:0
    ds_read_b64_tr_b16 v[90:91], v101 offset:2048
    s_waitcnt lgkmcnt(4)
    ds_write_b128 v120, v[80:83] offset:23552
    v_xor_b32 v101, 192, v105
    ds_read_b64_tr_b16 v[80:81], v101 offset:0
    ds_read_b64_tr_b16 v[82:83], v101 offset:2048
    s_waitcnt lgkmcnt(5)
    ds_write_b128 v120, v[84:87] offset:25600
    s_waitcnt lgkmcnt(4)
    ds_write_b128 v120, v[88:91] offset:27648
    s_waitcnt lgkmcnt(2)
    ds_write_b128 v120, v[80:83] offset:31744
    s_waitcnt lgkmcnt(0)
    s_barrier
    s_waitcnt vmcnt(16)
    ds_write_b128 v94, v[16:19] offset:0
    s_waitcnt vmcnt(15)
    ds_write_b128 v95, v[20:23] offset:1024
    s_waitcnt vmcnt(14)
    ds_write_b128 v94, v[24:27] offset:2048
    s_waitcnt vmcnt(13)
    ds_write_b128 v95, v[28:31] offset:3072
    s_waitcnt lgkmcnt(0)
    s_barrier
    v_xor_b32 v101, 0, v105
    ds_read_b64_tr_b16 v[192:193], v101 offset:0
    ds_read_b64_tr_b16 v[194:195], v101 offset:2048
    v_xor_b32 v101, 64, v105
    ds_read_b64_tr_b16 v[208:209], v101 offset:0
    ds_read_b64_tr_b16 v[210:211], v101 offset:2048
    v_xor_b32 v101, 128, v105
    ds_read_b64_tr_b16 v[232:233], v101 offset:0
    ds_read_b64_tr_b16 v[234:235], v101 offset:2048
    v_xor_b32 v101, 192, v105
    ds_read_b64_tr_b16 v[248:249], v101 offset:0
    ds_read_b64_tr_b16 v[250:251], v101 offset:2048
    s_waitcnt lgkmcnt(0)
    s_barrier
    s_waitcnt vmcnt(12)
    ds_write_b128 v94, v[32:35] offset:0
    s_waitcnt vmcnt(11)
    ds_write_b128 v95, v[36:39] offset:1024
    s_waitcnt vmcnt(10)
    ds_write_b128 v94, v[40:43] offset:2048
    s_waitcnt vmcnt(9)
    ds_write_b128 v95, v[44:47] offset:3072
    s_waitcnt lgkmcnt(0)
    s_mov_b64 exec, 6
    s_waitcnt vmcnt(8)
    v_cmp_gt_u32 vcc, 2, v107
    s_mov_b64 exec, -1
    s_cmp_eq_u64 vcc, 0
    s_cselect_b32 s56, s63, 0
    s_add_u32 s63, s63, s56
    s_cmp_lg_u32 s63, 2
    s_cbranch_scc1 L_rnf2
    s_mov_b32 m0, s62
    s_nop 0
    global_load_lds_dwordx4 v127, s[48:49] sc1
    global_load_lds_dwordx4 v127, s[48:49] offset:1024 sc1
    v_lshlrev_b32 v130, 1, v127
    global_load_dword v131, v130, s[50:51] sc1
L_rnf2:
    s_barrier
    v_xor_b32 v101, 0, v105
    ds_read_b64_tr_b16 v[196:197], v101 offset:0
    ds_read_b64_tr_b16 v[198:199], v101 offset:2048
    v_xor_b32 v101, 64, v105
    ds_read_b64_tr_b16 v[212:213], v101 offset:0
    ds_read_b64_tr_b16 v[214:215], v101 offset:2048
    v_xor_b32 v101, 128, v105
    ds_read_b64_tr_b16 v[236:237], v101 offset:0
    ds_read_b64_tr_b16 v[238:239], v101 offset:2048
    v_xor_b32 v101, 192, v105
    ds_read_b64_tr_b16 v[252:253], v101 offset:0
    ds_read_b64_tr_b16 v[254:255], v101 offset:2048
    s_waitcnt lgkmcnt(0)
    s_barrier
    s_waitcnt vmcnt(7)
    ds_write_b128 v94, v[48:51] offset:0
    s_waitcnt vmcnt(6)
    ds_write_b128 v95, v[52:55] offset:1024
    s_waitcnt vmcnt(5)
    ds_write_b128 v94, v[56:59] offset:2048
    s_waitcnt vmcnt(4)
    ds_write_b128 v95, v[60:63] offset:3072
    s_waitcnt lgkmcnt(0)
    s_barrier
    v_xor_b32 v101, 0, v105
    ds_read_b64_tr_b16 v[200:201], v101 offset:0
    ds_read_b64_tr_b16 v[202:203], v101 offset:2048
    v_xor_b32 v101, 64, v105
    ds_read_b64_tr_b16 v[216:217], v101 offset:0
    ds_read_b64_tr_b16 v[218:219], v101 offset:2048
    v_xor_b32 v101, 128, v105
    ds_read_b64_tr_b16 v[80:81], v101 offset:0
    ds_read_b64_tr_b16 v[82:83], v101 offset:2048
    v_xor_b32 v101, 192, v105
    ds_read_b64_tr_b16 v[84:85], v101 offset:0
    ds_read_b64_tr_b16 v[86:87], v101 offset:2048
    s_waitcnt lgkmcnt(2)
    ds_write_b128 v120, v[80:83] offset:28672
    s_waitcnt lgkmcnt(1)
    ds_write_b128 v120, v[84:87] offset:32768
    s_waitcnt lgkmcnt(0)
    s_barrier
    s_waitcnt vmcnt(3)
    ds_write_b128 v94, v[64:67] offset:0
    s_waitcnt vmcnt(2)
    ds_write_b128 v95, v[68:71] offset:1024
    s_waitcnt vmcnt(1)
    ds_write_b128 v94, v[72:75] offset:2048
    s_waitcnt vmcnt(0)
    ds_write_b128 v95, v[76:79] offset:3072
    s_waitcnt lgkmcnt(0)
    s_barrier
    v_xor_b32 v101, 0, v105
    ds_read_b64_tr_b16 v[204:205], v101 offset:0
    ds_read_b64_tr_b16 v[206:207], v101 offset:2048
    v_xor_b32 v101, 64, v105
    ds_read_b64_tr_b16 v[220:221], v101 offset:0
    ds_read_b64_tr_b16 v[222:223], v101 offset:2048
    v_xor_b32 v101, 128, v105
    ds_read_b64_tr_b16 v[80:81], v101 offset:0
    ds_read_b64_tr_b16 v[82:83], v101 offset:2048
    v_xor_b32 v101, 192, v105
    ds_read_b64_tr_b16 v[84:85], v101 offset:0
    ds_read_b64_tr_b16 v[86:87], v101 offset:2048
    s_waitcnt lgkmcnt(2)
    ds_write_b128 v120, v[80:83] offset:29696
    s_waitcnt lgkmcnt(1)
    ds_write_b128 v120, v[84:87] offset:33792
    s_waitcnt lgkmcnt(0)
    s_barrier
    s_branch L_rwdonea
L_rwa_3:
    s_waitcnt vmcnt(15)
    ds_write_b128 v98, v[16:19] offset:0
    s_waitcnt vmcnt(14)
    ds_write_b128 v98, v[20:23] offset:1024
    s_waitcnt vmcnt(13)
    ds_write_b128 v99, v[24:27] offset:2048
    s_waitcnt vmcnt(12)
    ds_write_b128 v99, v[28:31] offset:3072
    s_waitcnt lgkmcnt(0)
    s_add_u32 s56, s10, 2097152
    s_addc_u32 s57, s11, 0
    global_load_dwordx4 v[16:19], v96, s[56:57]
    s_add_u32 s56, s10, 2105344
    s_addc_u32 s57, s11, 0
    global_load_dwordx4 v[20:23], v96, s[56:57]
    s_add_u32 s56, s10, 2113536
    s_addc_u32 s57, s11, 0
    global_load_dwordx4 v[24:27], v96, s[56:57]
    s_add_u32 s56, s10, 2121728
    s_addc_u32 s57, s11, 0
    global_load_dwordx4 v[28:31], v96, s[56:57]
    s_barrier
    v_xor_b32 v101, 192, v100
    ds_read_b64_tr_b16 a[120:121], v101 offset:0
    ds_read_b64_tr_b16 a[122:123], v101 offset:1024
    ds_read_b64_tr_b16 a[124:125], v101 offset:8192
    ds_read_b64_tr_b16 a[126:127], v101 offset:9216
    v_xor_b32 v101, 224, v100
    ds_read_b64_tr_b16 a[168:169], v101 offset:0
    ds_read_b64_tr_b16 a[170:171], v101 offset:1024
    ds_read_b64_tr_b16 a[172:173], v101 offset:8192
    ds_read_b64_tr_b16 a[174:175], v101 offset:9216
    s_waitcnt lgkmcnt(0)
    s_barrier
    s_waitcnt vmcnt(15)
    ds_write_b128 v98, v[32:35] offset:0
    s_waitcnt vmcnt(14)
    ds_write_b128 v98, v[36:39] offset:1024
    s_waitcnt vmcnt(13)
    ds_write_b128 v99, v[40:43] offset:2048
    s_waitcnt vmcnt(12)
    ds_write_b128 v99, v[44:47] offset:3072
    s_waitcnt lgkmcnt(0)
    s_add_u32 s56, s10, 2621440
    s_addc_u32 s57, s11, 0
    global_load_dwordx4 v[32:35], v96, s[56:57]
    s_add_u32 s56, s10, 2629632
    s_addc_u32 s57, s11, 0
    global_load_dwordx4 v[36:39], v96, s[56:57]
    s_add_u32 s56, s10, 2637824
    s_addc_u32 s57, s11, 0
    global_load_dwordx4 v[40:43], v96, s[56:57]
    s_add_u32 s56, s10, 2646016
    s_addc_u32 s57, s11, 0
    global_load_dwordx4 v[44:47], v96, s[56:57]
    s_barrier
    v_xor_b32 v101, 192, v100
    ds_read_b64_tr_b16 a[144:145], v101 offset:0
    ds_read_b64_tr_b16 a[146:147], v101 offset:1024
    ds_read_b64_tr_b16 a[148:149], v101 offset:8192
    ds_read_b64_tr_b16 a[150:151], v101 offset:9216
    v_xor_b32 v101, 224, v100
    ds_read_b64_tr_b16 a[192:193], v101 offset:0
    ds_read_b64_tr_b16 a[194:195], v101 offset:1024
    ds_read_b64_tr_b16 a[196:197], v101 offset:8192
    ds_read_b64_tr_b16 a[198:199], v101 offset:9216
    s_waitcnt lgkmcnt(0)
    s_barrier
    s_waitcnt vmcnt(15)
    ds_write_b128 v98, v[48:51] offset:0
    s_waitcnt vmcnt(14)
    ds_write_b128 v98, v[52:55] offset:1024
    s_waitcnt vmcnt(13)
    ds_write_b128 v99, v[56:59] offset:2048
    s_waitcnt vmcnt(12)
    ds_write_b128 v99, v[60:63] offset:3072
    s_waitcnt lgkmcnt(0)
    s_add_u32 s56, s10, 3145728
    s_addc_u32 s57, s11, 0
    global_load_dwordx4 v[48:51], v96, s[56:57]
    s_add_u32 s56, s10, 3153920
    s_addc_u32 s57, s11, 0
    global_load_dwordx4 v[52:55], v96, s[56:57]
    s_add_u32 s56, s10, 3162112
    s_addc_u32 s57, s11, 0
    global_load_dwordx4 v[56:59], v96, s[56:57]
    s_add_u32 s56, s10, 3170304
    s_addc_u32 s57, s11, 0
    global_load_dwordx4 v[60:63], v96, s[56:57]
    s_barrier
    v_xor_b32 v101, 192, v100
    ds_read_b64_tr_b16 a[128:129], v101 offset:0
    ds_read_b64_tr_b16 a[130:131], v101 offset:1024
    ds_read_b64_tr_b16 a[132:133], v101 offset:8192
    ds_read_b64_tr_b16 a[134:135], v101 offset:9216
    v_xor_b32 v101, 224, v100
    ds_read_b64_tr_b16 a[176:177], v101 offset:0
    ds_read_b64_tr_b16 a[178:179], v101 offset:1024
    ds_read_b64_tr_b16 a[180:181], v101 offset:8192
    ds_read_b64_tr_b16 a[182:183], v101 offset:9216
    s_waitcnt lgkmcnt(0)
    s_barrier
    s_waitcnt vmcnt(15)
    ds_write_b128 v98, v[64:67] offset:0
    s_waitcnt vmcnt(14)
    ds_write_b128 v98, v[68:71] offset:1024
    s_waitcnt vmcnt(13)
    ds_write_b128 v99, v[72:75] offset:2048
    s_waitcnt vmcnt(12)
    ds_write_b128 v99, v[76:79] offset:3072
    s_waitcnt lgkmcnt(0)
    s_add_u32 s56, s10, 3670016
    s_addc_u32 s57, s11, 0
    global_load_dwordx4 v[64:67], v96, s[56:57]
    s_add_u32 s56, s10, 3678208
    s_addc_u32 s57, s11, 0
    global_load_dwordx4 v[68:71], v96, s[56:57]
    s_add_u32 s56, s10, 3686400
    s_addc_u32 s57, s11, 0
    global_load_dwordx4 v[72:75], v96, s[56:57]
    s_add_u32 s56, s10, 3694592
    s_addc_u32 s57, s11, 0
    global_load_dwordx4 v[76:79], v96, s[56:57]
    s_barrier
    v_xor_b32 v101, 192, v100
    ds_read_b64_tr_b16 a[152:153], v101 offset:0
    ds_read_b64_tr_b16 a[154:155], v101 offset:1024
    ds_read_b64_tr_b16 a[156:157], v101 offset:8192
    ds_read_b64_tr_b16 a[158:159], v101 offset:9216
    v_xor_b32 v101, 224, v100
    ds_read_b64_tr_b16 a[200:201], v101 offset:0
    ds_read_b64_tr_b16 a[202:203], v101 offset:1024
    ds_read_b64_tr_b16 a[204:205], v101 offset:8192
    ds_read_b64_tr_b16 a[206:207], v101 offset:9216
    s_waitcnt lgkmcnt(0)
    s_barrier
    s_waitcnt vmcnt(15)
    ds_write_b128 v98, v[16:19] offset:0
    s_waitcnt vmcnt(14)
    ds_write_b128 v98, v[20:23] offset:1024
    s_waitcnt vmcnt(13)
    ds_write_b128 v99, v[24:27] offset:2048
    s_waitcnt vmcnt(12)
    ds_write_b128 v99, v[28:31] offset:3072
    s_waitcnt lgkmcnt(0)
    s_add_u32 s56, s12, 0
    s_addc_u32 s57, s13, 0
    global_load_dwordx4 v[16:19], v96, s[56:57]
    s_add_u32 s56, s12, 8192
    s_addc_u32 s57, s13, 0
    global_load_dwordx4 v[20:23], v96, s[56:57]
    s_add_u32 s56, s12, 16384
    s_addc_u32 s57, s13, 0
    global_load_dwordx4 v[24:27], v96, s[56:57]
    s_add_u32 s56, s12, 24576
    s_addc_u32 s57, s13, 0
    global_load_dwordx4 v[28:31], v96, s[56:57]
    s_barrier
    v_xor_b32 v101, 192, v100
    ds_read_b64_tr_b16 a[136:137], v101 offset:0
    ds_read_b64_tr_b16 a[138:139], v101 offset:1024
    ds_read_b64_tr_b16 a[140:141], v101 offset:8192
    ds_read_b64_tr_b16 a[142:143], v101 offset:9216
    v_xor_b32 v101, 224, v100
    ds_read_b64_tr_b16 a[184:185], v101 offset:0
    ds_read_b64_tr_b16 a[186:187], v101 offset:1024
    ds_read_b64_tr_b16 a[188:189], v101 offset:8192
    ds_read_b64_tr_b16 a[190:191], v101 offset:9216
    s_waitcnt lgkmcnt(0)
    s_barrier
    s_waitcnt vmcnt(15)
    ds_write_b128 v98, v[32:35] offset:0
    s_waitcnt vmcnt(14)
    ds_write_b128 v98, v[36:39] offset:1024
    s_waitcnt vmcnt(13)
    ds_write_b128 v99, v[40:43] offset:2048
    s_waitcnt vmcnt(12)
    ds_write_b128 v99, v[44:47] offset:3072
    s_waitcnt lgkmcnt(0)
    s_add_u32 s56, s12, 524288
    s_addc_u32 s57, s13, 0
    global_load_dwordx4 v[32:35], v96, s[56:57]
    s_add_u32 s56, s12, 532480
    s_addc_u32 s57, s13, 0
    global_load_dwordx4 v[36:39], v96, s[56:57]
    s_add_u32 s56, s12, 540672
    s_addc_u32 s57, s13, 0
    global_load_dwordx4 v[40:43], v96, s[56:57]
    s_add_u32 s56, s12, 548864
    s_addc_u32 s57, s13, 0
    global_load_dwordx4 v[44:47], v96, s[56:57]
    s_barrier
    v_xor_b32 v101, 192, v100
    ds_read_b64_tr_b16 a[160:161], v101 offset:0
    ds_read_b64_tr_b16 a[162:163], v101 offset:1024
    ds_read_b64_tr_b16 a[164:165], v101 offset:8192
    ds_read_b64_tr_b16 a[166:167], v101 offset:9216
    v_xor_b32 v101, 224, v100
    ds_read_b64_tr_b16 a[208:209], v101 offset:0
    ds_read_b64_tr_b16 a[210:211], v101 offset:1024
    ds_read_b64_tr_b16 a[212:213], v101 offset:8192
    ds_read_b64_tr_b16 a[214:215], v101 offset:9216
    s_waitcnt lgkmcnt(0)
    s_barrier
    s_waitcnt vmcnt(15)
    ds_write_b128 v98, v[48:51] offset:0
    s_waitcnt vmcnt(14)
    ds_write_b128 v98, v[52:55] offset:1024
    s_waitcnt vmcnt(13)
    ds_write_b128 v99, v[56:59] offset:2048
    s_waitcnt vmcnt(12)
    ds_write_b128 v99, v[60:63] offset:3072
    s_waitcnt lgkmcnt(0)
    s_add_u32 s56, s12, 1048576
    s_addc_u32 s57, s13, 0
    global_load_dwordx4 v[48:51], v96, s[56:57]
    s_add_u32 s56, s12, 1056768
    s_addc_u32 s57, s13, 0
    global_load_dwordx4 v[52:55], v96, s[56:57]
    s_add_u32 s56, s12, 1064960
    s_addc_u32 s57, s13, 0
    global_load_dwordx4 v[56:59], v96, s[56:57]
    s_add_u32 s56, s12, 1073152
    s_addc_u32 s57, s13, 0
    global_load_dwordx4 v[60:63], v96, s[56:57]
    s_barrier
    v_xor_b32 v101, 192, v100
    ds_read_b64_tr_b16 v[80:81], v101 offset:0
    ds_read_b64_tr_b16 v[82:83], v101 offset:1024
    ds_read_b64_tr_b16 v[84:85], v101 offset:8192
    ds_read_b64_tr_b16 v[86:87], v101 offset:9216
    s_waitcnt lgkmcnt(2)
    ds_write_b128 v120, v[80:83] offset:12288
    s_waitcnt lgkmcnt(1)
    ds_write_b128 v120, v[84:87] offset:13312
    v_xor_b32 v101, 224, v100
    ds_read_b64_tr_b16 v[80:81], v101 offset:0
    ds_read_b64_tr_b16 v[82:83], v101 offset:1024
    ds_read_b64_tr_b16 v[84:85], v101 offset:8192
    ds_read_b64_tr_b16 v[86:87], v101 offset:9216
    s_waitcnt lgkmcnt(2)
    ds_write_b128 v120, v[80:83] offset:16384
    s_waitcnt lgkmcnt(1)
    ds_write_b128 v120, v[84:87] offset:17408
    s_waitcnt lgkmcnt(0)
    s_barrier
    s_waitcnt vmcnt(15)
    ds_write_b128 v98, v[64:67] offset:0
    s_waitcnt vmcnt(14)
    ds_write_b128 v98, v[68:71] offset:1024
    s_waitcnt vmcnt(13)
    ds_write_b128 v99, v[72:75] offset:2048
    s_waitcnt vmcnt(12)
    ds_write_b128 v99, v[76:79] offset:3072
    s_waitcnt lgkmcnt(0)
    s_add_u32 s56, s12, 1572864
    s_addc_u32 s57, s13, 0
    global_load_dwordx4 v[64:67], v96, s[56:57]
    s_add_u32 s56, s12, 1581056
    s_addc_u32 s57, s13, 0
    global_load_dwordx4 v[68:71], v96, s[56:57]
    s_add_u32 s56, s12, 1589248
    s_addc_u32 s57, s13, 0
    global_load_dwordx4 v[72:75], v96, s[56:57]
    s_add_u32 s56, s12, 1597440
    s_addc_u32 s57, s13, 0
    global_load_dwordx4 v[76:79], v96, s[56:57]
    s_barrier
    v_xor_b32 v101, 192, v100
    ds_read_b64_tr_b16 v[80:81], v101 offset:0
    ds_read_b64_tr_b16 v[82:83], v101 offset:1024
    ds_read_b64_tr_b16 v[84:85], v101 offset:8192
    ds_read_b64_tr_b16 v[86:87], v101 offset:9216
    s_waitcnt lgkmcnt(2)
    ds_write_b128 v120, v[80:83] offset:14336
    s_waitcnt lgkmcnt(1)
    ds_write_b128 v120, v[84:87] offset:15360
    v_xor_b32 v101, 224, v100
    ds_read_b64_tr_b16 a[0:1], v101 offset:0
    ds_read_b64_tr_b16 a[2:3], v101 offset:1024
    ds_read_b64_tr_b16 a[4:5], v101 offset:8192
    ds_read_b64_tr_b16 a[6:7], v101 offset:9216
    s_waitcnt lgkmcnt(0)
    s_barrier
    s_waitcnt vmcnt(15)
    ds_write_b128 v98, v[16:19] offset:0
    s_waitcnt vmcnt(14)
    ds_write_b128 v98, v[20:23] offset:1024
    s_waitcnt vmcnt(13)
    ds_write_b128 v99, v[24:27] offset:2048
    s_waitcnt vmcnt(12)
    ds_write_b128 v99, v[28:31] offset:3072
    s_waitcnt lgkmcnt(0)
    s_add_u32 s56, s12, 2097152
    s_addc_u32 s57, s13, 0
    global_load_dwordx4 v[16:19], v96, s[56:57]
    s_add_u32 s56, s12, 2105344
    s_addc_u32 s57, s13, 0
    global_load_dwordx4 v[20:23], v96, s[56:57]
    s_add_u32 s56, s12, 2113536
    s_addc_u32 s57, s13, 0
    global_load_dwordx4 v[24:27], v96, s[56:57]
    s_add_u32 s56, s12, 2121728
    s_addc_u32 s57, s13, 0
    global_load_dwordx4 v[28:31], v96, s[56:57]
    s_barrier
    v_xor_b32 v101, 192, v100
    ds_read_b64_tr_b16 a[216:217], v101 offset:0
    ds_read_b64_tr_b16 a[218:219], v101 offset:1024
    ds_read_b64_tr_b16 a[220:221], v101 offset:8192
    ds_read_b64_tr_b16 a[222:223], v101 offset:9216
    v_xor_b32 v101, 224, v100
    ds_read_b64_tr_b16 a[224:225], v101 offset:0
    ds_read_b64_tr_b16 a[226:227], v101 offset:1024
    ds_read_b64_tr_b16 a[228:229], v101 offset:8192
    ds_read_b64_tr_b16 a[230:231], v101 offset:9216
    s_waitcnt lgkmcnt(0)
    s_barrier
    s_waitcnt vmcnt(15)
    ds_write_b128 v98, v[32:35] offset:0
    s_waitcnt vmcnt(14)
    ds_write_b128 v98, v[36:39] offset:1024
    s_waitcnt vmcnt(13)
    ds_write_b128 v99, v[40:43] offset:2048
    s_waitcnt vmcnt(12)
    ds_write_b128 v99, v[44:47] offset:3072
    s_waitcnt lgkmcnt(0)
    s_add_u32 s56, s12, 2621440
    s_addc_u32 s57, s13, 0
    global_load_dwordx4 v[32:35], v96, s[56:57]
    s_add_u32 s56, s12, 2629632
    s_addc_u32 s57, s13, 0
    global_load_dwordx4 v[36:39], v96, s[56:57]
    s_add_u32 s56, s12, 2637824
    s_addc_u32 s57, s13, 0
    global_load_dwordx4 v[40:43], v96, s[56:57]
    s_add_u32 s56, s12, 2646016
    s_addc_u32 s57, s13, 0
    global_load_dwordx4 v[44:47], v96, s[56:57]
    s_barrier
    v_xor_b32 v101, 192, v100
    ds_read_b64_tr_b16 v[144:145], v101 offset:0
    ds_read_b64_tr_b16 v[146:147], v101 offset:1024
    ds_read_b64_tr_b16 v[148:149], v101 offset:8192
    ds_read_b64_tr_b16 v[150:151], v101 offset:9216
    v_xor_b32 v101, 224, v100
    ds_read_b64_tr_b16 v[152:153], v101 offset:0
    ds_read_b64_tr_b16 v[154:155], v101 offset:1024
    ds_read_b64_tr_b16 v[156:157], v101 offset:8192
    ds_read_b64_tr_b16 v[158:159], v101 offset:9216
    s_waitcnt lgkmcnt(0)
    s_barrier
    s_waitcnt vmcnt(15)
    ds_write_b128 v98, v[48:51] offset:0
    s_waitcnt vmcnt(14)
    ds_write_b128 v98, v[52:55] offset:1024
    s_waitcnt vmcnt(13)
    ds_write_b128 v99, v[56:59] offset:2048
    s_waitcnt vmcnt(12)
    ds_write_b128 v99, v[60:63] offset:3072
    s_waitcnt lgkmcnt(0)
    s_cmp_eq_u32 s55, 1
    s_cbranch_scc1 L_cf5
    v_mov_b32 v252, 139264
    s_cmp_lg_u32 s30, 0
    s_cbranch_scc1 L_cg5
    s_waitcnt vmcnt(12)
    s_mov_b64 exec, 1
    ds_write_b32 v252, v253
    s_waitcnt lgkmcnt(0)
    s_mov_b64 exec, -1
L_cg5:
    s_barrier
    ds_read_b32 v253, v252
    s_waitcnt lgkmcnt(0)
    v_readfirstlane_b32 s56, v253
    s_barrier
    s_bitcmp1_b32 s56, s31
    s_cbranch_scc1 L_lost
L_cf5:
    s_add_u32 s56, s12, 3145728
    s_addc_u32 s57, s13, 0
    global_load_dwordx4 v[48:51], v96, s[56:57]
    s_add_u32 s56, s12, 3153920
    s_addc_u32 s57, s13, 0
    global_load_dwordx4 v[52:55], v96, s[56:57]
    s_add_u32 s56, s12, 3162112
    s_addc_u32 s57, s13, 0
    global_load_dwordx4 v[56:59], v96, s[56:57]
    s_add_u32 s56, s12, 3170304
    s_addc_u32 s57, s13, 0
    global_load_dwordx4 v[60:63], v96, s[56:57]
    s_barrier
    v_xor_b32 v101, 192, v100
    ds_read_b64_tr_b16 a[232:233], v101 offset:0
    ds_read_b64_tr_b16 a[234:235], v101 offset:1024
    ds_read_b64_tr_b16 a[236:237], v101 offset:8192
    ds_read_b64_tr_b16 a[238:239], v101 offset:9216
    v_xor_b32 v101, 224, v100
    ds_read_b64_tr_b16 a[240:241], v101 offset:0
    ds_read_b64_tr_b16 a[242:243], v101 offset:1024
    ds_read_b64_tr_b16 a[244:245], v101 offset:8192
    ds_read_b64_tr_b16 a[246:247], v101 offset:9216
    s_waitcnt lgkmcnt(0)
    s_barrier
    s_waitcnt vmcnt(15)
    ds_write_b128 v98, v[64:67] offset:0
    s_waitcnt vmcnt(14)
    ds_write_b128 v98, v[68:71] offset:1024
    s_waitcnt vmcnt(13)
    ds_write_b128 v99, v[72:75] offset:2048
    s_waitcnt vmcnt(12)
    ds_write_b128 v99, v[76:79] offset:3072
    s_waitcnt lgkmcnt(0)
    s_add_u32 s56, s12, 3670016
    s_addc_u32 s57, s13, 0
    global_load_dwordx4 v[64:67], v96, s[56:57]
    s_add_u32 s56, s12, 3678208
    s_addc_u32 s57, s13, 0
    global_load_dwordx4 v[68:71], v96, s[56:57]
    s_add_u32 s56, s12, 3686400
    s_addc_u32 s57, s13, 0
    global_load_dwordx4 v[72:75], v96, s[56:57]
    s_add_u32 s56, s12, 3694592
    s_addc_u32 s57, s13, 0
    global_load_dwordx4 v[76:79], v96, s[56:57]
    s_barrier
    v_xor_b32 v101, 192, v100
    ds_read_b64_tr_b16 v[160:161], v101 offset:0
    ds_read_b64_tr_b16 v[162:163], v101 offset:1024
    ds_read_b64_tr_b16 v[164:165], v101 offset:8192
    ds_read_b64_tr_b16 v[166:167], v101 offset:9216
    v_xor_b32 v101, 224, v100
    ds_read_b64_tr_b16 v[168:169], v101 offset:0
    ds_read_b64_tr_b16 v[170:171], v101 offset:1024
    ds_read_b64_tr_b16 v[172:173], v101 offset:8192
    ds_read_b64_tr_b16 v[174:175], v101 offset:9216
    s_waitcnt lgkmcnt(0)
    s_barrier
    s_waitcnt vmcnt(15)
    ds_write_b128 v98, v[16:19] offset:0
    s_waitcnt vmcnt(14)
    ds_write_b128 v98, v[20:23] offset:1024
    s_waitcnt vmcnt(13)
    ds_write_b128 v99, v[24:27] offset:2048
    s_waitcnt vmcnt(12)
    ds_write_b128 v99, v[28:31] offset:3072
    s_waitcnt lgkmcnt(0)
    s_add_u32 s56, s8, 0
    s_addc_u32 s57, s9, 0
    global_load_dwordx4 v[16:19], v96, s[56:57]
    s_add_u32 s56, s8, 8192
    s_addc_u32 s57, s9, 0
    global_load_dwordx4 v[20:23], v96, s[56:57]
    s_add_u32 s56, s8, 16384
    s_addc_u32 s57, s9, 0
    global_load_dwordx4 v[24:27], v96, s[56:57]
    s_add_u32 s56, s8, 24576
    s_addc_u32 s57, s9, 0
    global_load_dwordx4 v[28:31], v96, s[56:57]
    s_barrier
    v_xor_b32 v101, 192, v100
    ds_read_b64_tr_b16 a[248:249], v101 offset:0
    ds_read_b64_tr_b16 a[250:251], v101 offset:1024
    ds_read_b64_tr_b16 a[252:253], v101 offset:8192
    ds_read_b64_tr_b16 a[254:255], v101 offset:9216
    v_xor_b32 v101, 224, v100
    ds_read_b64_tr_b16 v[136:137], v101 offset:0
    ds_read_b64_tr_b16 v[138:139], v101 offset:1024
    ds_read_b64_tr_b16 v[140:141], v101 offset:8192
    ds_read_b64_tr_b16 v[142:143], v101 offset:9216
    s_waitcnt lgkmcnt(0)
    s_barrier
    s_waitcnt vmcnt(15)
    ds_write_b128 v98, v[32:35] offset:0
    s_waitcnt vmcnt(14)
    ds_write_b128 v98, v[36:39] offset:1024
    s_waitcnt vmcnt(13)
    ds_write_b128 v99, v[40:43] offset:2048
    s_waitcnt vmcnt(12)
    ds_write_b128 v99, v[44:47] offset:3072
    s_waitcnt lgkmcnt(0)
    s_add_u32 s56, s8, 524288
    s_addc_u32 s57, s9, 0
    global_load_dwordx4 v[32:35], v96, s[56:57]
    s_add_u32 s56, s8, 532480
    s_addc_u32 s57, s9, 0
    global_load_dwordx4 v[36:39], v96, s[56:57]
    s_add_u32 s56, s8, 540672
    s_addc_u32 s57, s9, 0
    global_load_dwordx4 v[40:43], v96, s[56:57]
    s_add_u32 s56, s8, 548864
    s_addc_u32 s57, s9, 0
    global_load_dwordx4 v[44:47], v96, s[56:57]
    s_barrier
    v_xor_b32 v101, 192, v100
    ds_read_b64_tr_b16 v[176:177], v101 offset:0
    ds_read_b64_tr_b16 v[178:179], v101 offset:1024
    ds_read_b64_tr_b16 v[180:181], v101 offset:8192
    ds_read_b64_tr_b16 v[182:183], v101 offset:9216
    v_xor_b32 v101, 224, v100
    ds_read_b64_tr_b16 v[184:185], v101 offset:0
    ds_read_b64_tr_b16 v[186:187], v101 offset:1024
    ds_read_b64_tr_b16 v[188:189], v101 offset:8192
    ds_read_b64_tr_b16 v[190:191], v101 offset:9216
    s_waitcnt lgkmcnt(0)
    s_barrier
    s_waitcnt vmcnt(15)
    ds_write_b128 v98, v[48:51] offset:0
    s_waitcnt vmcnt(14)
    ds_write_b128 v98, v[52:55] offset:1024
    s_waitcnt vmcnt(13)
    ds_write_b128 v99, v[56:59] offset:2048
    s_waitcnt vmcnt(12)
    ds_write_b128 v99, v[60:63] offset:3072
    s_waitcnt lgkmcnt(0)
    s_add_u32 s56, s8, 1048576
    s_addc_u32 s57, s9, 0
    global_load_dwordx4 v[48:51], v96, s[56:57]
    s_add_u32 s56, s8, 1056768
    s_addc_u32 s57, s9, 0
    global_load_dwordx4 v[52:55], v96, s[56:57]
    s_add_u32 s56, s8, 1064960
    s_addc_u32 s57, s9, 0
    global_load_dwordx4 v[56:59], v96, s[56:57]
    s_add_u32 s56, s8, 1073152
    s_addc_u32 s57, s9, 0
    global_load_dwordx4 v[60:63], v96, s[56:57]
    s_barrier
    v_xor_b32 v101, 192, v100
    ds_read_b64_tr_b16 v[80:81], v101 offset:0
    ds_read_b64_tr_b16 v[82:83], v101 offset:1024
    ds_read_b64_tr_b16 v[84:85], v101 offset:8192
    ds_read_b64_tr_b16 v[86:87], v101 offset:9216
    s_waitcnt lgkmcnt(2)
    ds_write_b128 v120, v[80:83] offset:0
    s_waitcnt lgkmcnt(1)
    ds_write_b128 v120, v[84:87] offset:1024
    v_xor_b32 v101, 224, v100
    ds_read_b64_tr_b16 v[80:81], v101 offset:0
    ds_read_b64_tr_b16 v[82:83], v101 offset:1024
    ds_read_b64_tr_b16 v[84:85], v101 offset:8192
    ds_read_b64_tr_b16 v[86:87], v101 offset:9216
    s_waitcnt lgkmcnt(2)
    ds_write_b128 v120, v[80:83] offset:2048
    s_waitcnt lgkmcnt(1)
    ds_write_b128 v120, v[84:87] offset:3072
    s_waitcnt lgkmcnt(0)
    s_barrier
    s_waitcnt vmcnt(15)
    ds_write_b128 v98, v[64:67] offset:0
    s_waitcnt vmcnt(14)
    ds_write_b128 v98, v[68:71] offset:1024
    s_waitcnt vmcnt(13)
    ds_write_b128 v99, v[72:75] offset:2048
    s_waitcnt vmcnt(12)
    ds_write_b128 v99, v[76:79] offset:3072
    s_waitcnt lgkmcnt(0)
    s_add_u32 s56, s8, 1572864
    s_addc_u32 s57, s9, 0
    global_load_dwordx4 v[64:67], v96, s[56:57]
    s_add_u32 s56, s8, 1581056
    s_addc_u32 s57, s9, 0
    global_load_dwordx4 v[68:71], v96, s[56:57]
    s_add_u32 s56, s8, 1589248
    s_addc_u32 s57, s9, 0
    global_load_dwordx4 v[72:75], v96, s[56:57]
    s_add_u32 s56, s8, 1597440
    s_addc_u32 s57, s9, 0
    global_load_dwordx4 v[76:79], v96, s[56:57]
    s_barrier
    v_xor_b32 v101, 192, v100
    ds_read_b64_tr_b16 a[8:9], v101 offset:0
    ds_read_b64_tr_b16 a[10:11], v101 offset:1024
    ds_read_b64_tr_b16 a[12:13], v101 offset:8192
    ds_read_b64_tr_b16 a[14:15], v101 offset:9216
    v_xor_b32 v101, 224, v100
    ds_read_b64_tr_b16 a[16:17], v101 offset:0
    ds_read_b64_tr_b16 a[18:19], v101 offset:1024
    ds_read_b64_tr_b16 a[20:21], v101 offset:8192
    ds_read_b64_tr_b16 a[22:23], v101 offset:9216
    s_waitcnt lgkmcnt(0)
    s_barrier
    s_waitcnt vmcnt(15)
    ds_write_b128 v98, v[16:19] offset:0
    s_waitcnt vmcnt(14)
    ds_write_b128 v98, v[20:23] offset:1024
    s_waitcnt vmcnt(13)
    ds_write_b128 v99, v[24:27] offset:2048
    s_waitcnt vmcnt(12)
    ds_write_b128 v99, v[28:31] offset:3072
    s_waitcnt lgkmcnt(0)
    s_add_u32 s56, s8, 2097152
    s_addc_u32 s57, s9, 0
    global_load_dwordx4 v[16:19], v96, s[56:57]
    s_add_u32 s56, s8, 2105344
    s_addc_u32 s57, s9, 0
    global_load_dwordx4 v[20:23], v96, s[56:57]
    s_add_u32 s56, s8, 2113536
    s_addc_u32 s57, s9, 0
    global_load_dwordx4 v[24:27], v96, s[56:57]
    s_add_u32 s56, s8, 2121728
    s_addc_u32 s57, s9, 0
    global_load_dwordx4 v[28:31], v96, s[56:57]
    s_barrier
    v_xor_b32 v101, 192, v100
    ds_read_b64_tr_b16 a[24:25], v101 offset:0
    ds_read_b64_tr_b16 a[26:27], v101 offset:1024
    ds_read_b64_tr_b16 a[28:29], v101 offset:8192
    ds_read_b64_tr_b16 a[30:31], v101 offset:9216
    v_xor_b32 v101, 224, v100
    ds_read_b64_tr_b16 a[32:33], v101 offset:0
    ds_read_b64_tr_b16 a[34:35], v101 offset:1024
    ds_read_b64_tr_b16 a[36:37], v101 offset:8192
    ds_read_b64_tr_b16 a[38:39], v101 offset:9216
    s_waitcnt lgkmcnt(0)
    s_barrier
    s_waitcnt vmcnt(15)
    ds_write_b128 v98, v[32:35] offset:0
    s_waitcnt vmcnt(14)
    ds_write_b128 v98, v[36:39] offset:1024
    s_waitcnt vmcnt(13)
    ds_write_b128 v99, v[40:43] offset:2048
    s_waitcnt vmcnt(12)
    ds_write_b128 v99, v[44:47] offset:3072
    s_waitcnt lgkmcnt(0)
    s_add_u32 s56, s8, 2621440
    s_addc_u32 s57, s9, 0
    global_load_dwordx4 v[32:35], v96, s[56:57]
    s_add_u32 s56, s8, 2629632
    s_addc_u32 s57, s9, 0
    global_load_dwordx4 v[36:39], v96, s[56:57]
    s_add_u32 s56, s8, 2637824
    s_addc_u32 s57, s9, 0
    global_load_dwordx4 v[40:43], v96, s[56:57]
    s_add_u32 s56, s8, 2646016
    s_addc_u32 s57, s9, 0
    global_load_dwordx4 v[44:47], v96, s[56:57]
    s_barrier
    v_xor_b32 v101, 192, v100
    ds_read_b64_tr_b16 a[72:73], v101 offset:0
    ds_read_b64_tr_b16 a[74:75], v101 offset:1024
    ds_read_b64_tr_b16 a[76:77], v101 offset:8192
    ds_read_b64_tr_b16 a[78:79], v101 offset:9216
    v_xor_b32 v101, 224, v100
    ds_read_b64_tr_b16 a[80:81], v101 offset:0
    ds_read_b64_tr_b16 a[82:83], v101 offset:1024
    ds_read_b64_tr_b16 a[84:85], v101 offset:8192
    ds_read_b64_tr_b16 a[86:87], v101 offset:9216
    s_waitcnt lgkmcnt(0)
    s_barrier
    s_waitcnt vmcnt(15)
    ds_write_b128 v98, v[48:51] offset:0
    s_waitcnt vmcnt(14)
    ds_write_b128 v98, v[52:55] offset:1024
    s_waitcnt vmcnt(13)
    ds_write_b128 v99, v[56:59] offset:2048
    s_waitcnt vmcnt(12)
    ds_write_b128 v99, v[60:63] offset:3072
    s_waitcnt lgkmcnt(0)
    s_add_u32 s56, s8, 3145728
    s_addc_u32 s57, s9, 0
    global_load_dwordx4 v[48:51], v96, s[56:57]
    s_add_u32 s56, s8, 3153920
    s_addc_u32 s57, s9, 0
    global_load_dwordx4 v[52:55], v96, s[56:57]
    s_add_u32 s56, s8, 3162112
    s_addc_u32 s57, s9, 0
    global_load_dwordx4 v[56:59], v96, s[56:57]
    s_add_u32 s56, s8, 3170304
    s_addc_u32 s57, s9, 0
    global_load_dwordx4 v[60:63], v96, s[56:57]
    s_barrier
    v_xor_b32 v101, 192, v100
    ds_read_b64_tr_b16 a[40:41], v101 offset:0
    ds_read_b64_tr_b16 a[42:43], v101 offset:1024
    ds_read_b64_tr_b16 a[44:45], v101 offset:8192
    ds_read_b64_tr_b16 a[46:47], v101 offset:9216
    v_xor_b32 v101, 224, v100
    ds_read_b64_tr_b16 a[48:49], v101 offset:0
    ds_read_b64_tr_b16 a[50:51], v101 offset:1024
    ds_read_b64_tr_b16 a[52:53], v101 offset:8192
    ds_read_b64_tr_b16 a[54:55], v101 offset:9216
    s_waitcnt lgkmcnt(0)
    s_barrier
    s_waitcnt vmcnt(15)
    ds_write_b128 v98, v[64:67] offset:0
    s_waitcnt vmcnt(14)
    ds_write_b128 v98, v[68:71] offset:1024
    s_waitcnt vmcnt(13)
    ds_write_b128 v99, v[72:75] offset:2048
    s_waitcnt vmcnt(12)
    ds_write_b128 v99, v[76:79] offset:3072
    s_waitcnt lgkmcnt(0)
    s_add_u32 s56, s8, 3670016
    s_addc_u32 s57, s9, 0
    global_load_dwordx4 v[64:67], v96, s[56:57]
    s_add_u32 s56, s8, 3678208
    s_addc_u32 s57, s9, 0
    global_load_dwordx4 v[68:71], v96, s[56:57]
    s_add_u32 s56, s8, 3686400
    s_addc_u32 s57, s9, 0
    global_load_dwordx4 v[72:75], v96, s[56:57]
    s_add_u32 s56, s8, 3694592
    s_addc_u32 s57, s9, 0
    global_load_dwordx4 v[76:79], v96, s[56:57]
    s_barrier
    v_xor_b32 v101, 192, v100
    ds_read_b64_tr_b16 a[88:89], v101 offset:0
    ds_read_b64_tr_b16 a[90:91], v101 offset:1024
    ds_read_b64_tr_b16 a[92:93], v101 offset:8192
    ds_read_b64_tr_b16 a[94:95], v101 offset:9216
    v_xor_b32 v101, 224, v100
    ds_read_b64_tr_b16 a[96:97], v101 offset:0
    ds_read_b64_tr_b16 a[98:99], v101 offset:1024
    ds_read_b64_tr_b16 a[100:101], v101 offset:8192
    ds_read_b64_tr_b16 a[102:103], v101 offset:9216
    s_waitcnt lgkmcnt(0)
    s_barrier
    s_waitcnt vmcnt(15)
    ds_write_b128 v98, v[16:19] offset:0
    s_waitcnt vmcnt(14)
    ds_write_b128 v98, v[20:23] offset:1024
    s_waitcnt vmcnt(13)
    ds_write_b128 v99, v[24:27] offset:2048
    s_waitcnt vmcnt(12)
    ds_write_b128 v99, v[28:31] offset:3072
    s_waitcnt lgkmcnt(0)
    s_add_u32 s56, s14, 0
    s_addc_u32 s57, s15, 0
    global_load_dwordx4 v[16:19], v97, s[56:57]
    s_add_u32 s56, s14, 1024
    s_addc_u32 s57, s15, 0
    global_load_dwordx4 v[20:23], v97, s[56:57]
    s_add_u32 s56, s14, 16384
    s_addc_u32 s57, s15, 0
    global_load_dwordx4 v[24:27], v97, s[56:57]
    s_add_u32 s56, s14, 17408
    s_addc_u32 s57, s15, 0
    global_load_dwordx4 v[28:31], v97, s[56:57]
    s_barrier
    v_xor_b32 v101, 192, v100
    ds_read_b64_tr_b16 a[56:57], v101 offset:0
    ds_read_b64_tr_b16 a[58:59], v101 offset:1024
    ds_read_b64_tr_b16 a[60:61], v101 offset:8192
    ds_read_b64_tr_b16 a[62:63], v101 offset:9216
    v_xor_b32 v101, 224, v100
    ds_read_b64_tr_b16 a[64:65], v101 offset:0
    ds_read_b64_tr_b16 a[66:67], v101 offset:1024
    ds_read_b64_tr_b16 a[68:69], v101 offset:8192
    ds_read_b64_tr_b16 a[70:71], v101 offset:9216
    s_waitcnt lgkmcnt(0)
    s_barrier
    s_waitcnt vmcnt(15)
    ds_write_b128 v98, v[32:35] offset:0
    s_waitcnt vmcnt(14)
    ds_write_b128 v98, v[36:39] offset:1024
    s_waitcnt vmcnt(13)
    ds_write_b128 v99, v[40:43] offset:2048
    s_waitcnt vmcnt(12)
    ds_write_b128 v99, v[44:47] offset:3072
    s_waitcnt lgkmcnt(0)
    v_lshrrev_b32 v106, 2, v127
    global_load_dword v107, v106, s[26:27] sc1
    s_add_u32 s56, s14, 4096
    s_addc_u32 s57, s15, 0
    global_load_dwordx4 v[32:35], v97, s[56:57]
    s_add_u32 s56, s14, 5120
    s_addc_u32 s57, s15, 0
    global_load_dwordx4 v[36:39], v97, s[56:57]
    s_add_u32 s56, s14, 20480
    s_addc_u32 s57, s15, 0
    global_load_dwordx4 v[40:43], v97, s[56:57]
    s_add_u32 s56, s14, 21504
    s_addc_u32 s57, s15, 0
    global_load_dwordx4 v[44:47], v97, s[56:57]
    s_barrier
    v_xor_b32 v101, 192, v100
    ds_read_b64_tr_b16 a[104:105], v101 offset:0
    ds_read_b64_tr_b16 a[106:107], v101 offset:1024
    ds_read_b64_tr_b16 a[108:109], v101 offset:8192
    ds_read_b64_tr_b16 a[110:111], v101 offset:9216
    v_xor_b32 v101, 224, v100
    ds_read_b64_tr_b16 a[112:113], v101 offset:0
    ds_read_b64_tr_b16 a[114:115], v101 offset:1024
    ds_read_b64_tr_b16 a[116:117], v101 offset:8192
    ds_read_b64_tr_b16 a[118:119], v101 offset:9216
    s_waitcnt lgkmcnt(0)
    s_barrier
    s_waitcnt vmcnt(16)
    ds_write_b128 v98, v[48:51] offset:0
    s_waitcnt vmcnt(15)
    ds_write_b128 v98, v[52:55] offset:1024
    s_waitcnt vmcnt(14)
    ds_write_b128 v99, v[56:59] offset:2048
    s_waitcnt vmcnt(13)
    ds_write_b128 v99, v[60:63] offset:3072
    s_waitcnt lgkmcnt(0)
    s_add_u32 s56, s14, 8192
    s_addc_u32 s57, s15, 0
    global_load_dwordx4 v[48:51], v97, s[56:57]
    s_add_u32 s56, s14, 9216
    s_addc_u32 s57, s15, 0
    global_load_dwordx4 v[52:55], v97, s[56:57]
    s_add_u32 s56, s14, 24576
    s_addc_u32 s57, s15, 0
    global_load_dwordx4 v[56:59], v97, s[56:57]
    s_add_u32 s56, s14, 25600
    s_addc_u32 s57, s15, 0
    global_load_dwordx4 v[60:63], v97, s[56:57]
    s_barrier
    v_xor_b32 v101, 192, v100
    ds_read_b64_tr_b16 v[80:81], v101 offset:0
    ds_read_b64_tr_b16 v[82:83], v101 offset:1024
    ds_read_b64_tr_b16 v[84:85], v101 offset:8192
    ds_read_b64_tr_b16 v[86:87], v101 offset:9216
    s_waitcnt lgkmcnt(2)
    ds_write_b128 v120, v[80:83] offset:8192
    s_waitcnt lgkmcnt(1)
    ds_write_b128 v120, v[84:87] offset:9216
    v_xor_b32 v101, 224, v100
    ds_read_b64_tr_b16 v[80:81], v101 offset:0
    ds_read_b64_tr_b16 v[82:83], v101 offset:1024
    ds_read_b64_tr_b16 v[84:85], v101 offset:8192
    ds_read_b64_tr_b16 v[86:87], v101 offset:9216
    s_waitcnt lgkmcnt(2)
    ds_write_b128 v120, v[80:83] offset:10240
    s_waitcnt lgkmcnt(1)
    ds_write_b128 v120, v[84:87] offset:11264
    s_waitcnt lgkmcnt(0)
    s_barrier
    s_waitcnt vmcnt(16)
    ds_write_b128 v98, v[64:67] offset:0
    s_waitcnt vmcnt(15)
    ds_write_b128 v98, v[68:71] offset:1024
    s_waitcnt vmcnt(14)
    ds_write_b128 v99, v[72:75] offset:2048
    s_waitcnt vmcnt(13)
    ds_write_b128 v99, v[76:79] offset:3072
    s_waitcnt lgkmcnt(0)
    s_add_u32 s56, s14, 12288
    s_addc_u32 s57, s15, 0
    global_load_dwordx4 v[64:67], v97, s[56:57]
    s_add_u32 s56, s14, 13312
    s_addc_u32 s57, s15, 0
    global_load_dwordx4 v[68:71], v97, s[56:57]
    s_add_u32 s56, s14, 28672
    s_addc_u32 s57, s15, 0
    global_load_dwordx4 v[72:75], v97, s[56:57]
    s_add_u32 s56, s14, 29696
    s_addc_u32 s57, s15, 0
    global_load_dwordx4 v[76:79], v97, s[56:57]
    s_barrier
    v_xor_b32 v101, 192, v100
    ds_read_b64_tr_b16 v[80:81], v101 offset:0
    ds_read_b64_tr_b16 v[82:83], v101 offset:1024
    ds_read_b64_tr_b16 v[84:85], v101 offset:8192
    ds_read_b64_tr_b16 v[86:87], v101 offset:9216
    s_waitcnt lgkmcnt(2)
    ds_write_b128 v120, v[80:83] offset:4096
    s_waitcnt lgkmcnt(1)
    ds_write_b128 v120, v[84:87] offset:5120
    v_xor_b32 v101, 224, v100
    ds_read_b64_tr_b16 v[80:81], v101 offset:0
    ds_read_b64_tr_b16 v[82:83], v101 offset:1024
    ds_read_b64_tr_b16 v[84:85], v101 offset:8192
    ds_read_b64_tr_b16 v[86:87], v101 offset:9216
    s_waitcnt lgkmcnt(2)
    ds_write_b128 v120, v[80:83] offset:6144
    s_waitcnt lgkmcnt(1)
    ds_write_b128 v120, v[84:87] offset:7168
    s_waitcnt lgkmcnt(0)
    s_barrier
    s_waitcnt vmcnt(16)
    ds_write_b128 v94, v[16:19] offset:0
    s_waitcnt vmcnt(15)
    ds_write_b128 v95, v[20:23] offset:1024
    s_waitcnt vmcnt(14)
    ds_write_b128 v94, v[24:27] offset:2048
    s_waitcnt vmcnt(13)
    ds_write_b128 v95, v[28:31] offset:3072
    s_waitcnt lgkmcnt(0)
    s_add_u32 s56, s14, 65536
    s_addc_u32 s57, s15, 0
    global_load_dwordx4 v[16:19], v97, s[56:57]
    s_add_u32 s56, s14, 66560
    s_addc_u32 s57, s15, 0
    global_load_dwordx4 v[20:23], v97, s[56:57]
    s_add_u32 s56, s14, 81920
    s_addc_u32 s57, s15, 0
    global_load_dwordx4 v[24:27], v97, s[56:57]
    s_add_u32 s56, s14, 82944
    s_addc_u32 s57, s15, 0
    global_load_dwordx4 v[28:31], v97, s[56:57]
    s_barrier
    v_xor_b32 v101, 0, v105
    ds_read_b64_tr_b16 v[80:81], v101 offset:0
    ds_read_b64_tr_b16 v[82:83], v101 offset:2048
    v_xor_b32 v101, 64, v105
    ds_read_b64_tr_b16 v[84:85], v101 offset:0
    ds_read_b64_tr_b16 v[86:87], v101 offset:2048
    v_xor_b32 v101, 128, v105
    ds_read_b64_tr_b16 v[224:225], v101 offset:0
    ds_read_b64_tr_b16 v[226:227], v101 offset:2048
    v_xor_b32 v101, 192, v105
    ds_read_b64_tr_b16 v[240:241], v101 offset:0
    ds_read_b64_tr_b16 v[242:243], v101 offset:2048
    s_waitcnt lgkmcnt(6)
    ds_write_b128 v120, v[80:83] offset:18432
    s_waitcnt lgkmcnt(5)
    ds_write_b128 v120, v[84:87] offset:20480
    s_waitcnt lgkmcnt(0)
    s_barrier
    s_waitcnt vmcnt(15)
    ds_write_b128 v94, v[32:35] offset:0
    s_waitcnt vmcnt(14)
    ds_write_b128 v95, v[36:39] offset:1024
    s_waitcnt vmcnt(13)
    ds_write_b128 v94, v[40:43] offset:2048
    s_waitcnt vmcnt(12)
    ds_write_b128 v95, v[44:47] offset:3072
    s_waitcnt lgkmcnt(0)
    s_getpc_b64 s[56:57]
L_rpc3:
    s_add_u32 s56, s56, L_rcode-L_rpc3+12288
    s_addc_u32 s57, s57, 0
    v_lshlrev_b32 v130, 1, v127
    global_load_dword v133, v130, s[40:41] sc1
    v_lshlrev_b32 v130, 2, v127
    global_load_dword v132, v130, s[56:57]
    v_add_u32 v130, 12288, v130
    global_load_dword v134, v130, s[44:45] sc1
    s_add_u32 s56, s14, 69632
    s_addc_u32 s57, s15, 0
    global_load_dwordx4 v[32:35], v97, s[56:57]
    s_add_u32 s56, s14, 70656
    s_addc_u32 s57, s15, 0
    global_load_dwordx4 v[36:39], v97, s[56:57]
    s_add_u32 s56, s14, 86016
    s_addc_u32 s57, s15, 0
    global_load_dwordx4 v[40:43], v97, s[56:57]
    s_add_u32 s56, s14, 87040
    s_addc_u32 s57, s15, 0
    global_load_dwordx4 v[44:47], v97, s[56:57]
    s_barrier
    v_xor_b32 v101, 0, v105
    ds_read_b64_tr_b16 v[80:81], v101 offset:0
    ds_read_b64_tr_b16 v[82:83], v101 offset:2048
    v_xor_b32 v101, 64, v105
    ds_read_b64_tr_b16 v[84:85], v101 offset:0
    ds_read_b64_tr_b16 v[86:87], v101 offset:2048
    v_xor_b32 v101, 128, v105
    ds_read_b64_tr_b16 v[228:229], v101 offset:0
    ds_read_b64_tr_b16 v[230:231], v101 offset:2048
    v_xor_b32 v101, 192, v105
    ds_read_b64_tr_b16 v[244:245], v101 offset:0
    ds_read_b64_tr_b16 v[246:247], v101 offset:2048
    s_waitcnt lgkmcnt(6)
    ds_write_b128 v120, v[80:83] offset:19456
    s_waitcnt lgkmcnt(5)
    ds_write_b128 v120, v[84:87] offset:21504
    s_waitcnt lgkmcnt(0)
    s_barrier
    s_waitcnt vmcnt(15)
    ds_write_b128 v94, v[48:51] offset:0
    s_waitcnt vmcnt(14)
    ds_write_b128 v95, v[52:55] offset:1024
    s_waitcnt vmcnt(13)
    ds_write_b128 v94, v[56:59] offset:2048
    s_waitcnt vmcnt(12)
    ds_write_b128 v95, v[60:63] offset:3072
    s_waitcnt lgkmcnt(0)
    v_readlane_b32 s63, v107, 4
    s_mov_b32 exec_lo, 0x20200
    s_mov_b32 exec_hi, 0x40000
    v_cmp_gt_u32 vcc, 32, v107
    s_cmp_eq_u32 s63, -1
    s_cselect_b32 s63, 1, 0
    s_cmp_eq_u64 vcc, 0
    s_cselect_b32 s63, s63, 0
    s_mov_b64 exec, 0xff
    global_load_dword v107, v106, s[68:69] offset:256 sc1
    s_mov_b64 exec, -1
    s_add_u32 s56, s14, 73728
    s_addc_u32 s57, s15, 0
    global_load_dwordx4 v[48:51], v97, s[56:57]
    s_add_u32 s56, s14, 74752
    s_addc_u32 s57, s15, 0
    global_load_dwordx4 v[52:55], v97, s[56:57]
    s_add_u32 s56, s14, 90112
    s_addc_u32 s57, s15, 0
    global_load_dwordx4 v[56:59], v97, s[56:57]
    s_add_u32 s56, s14, 91136
    s_addc_u32 s57, s15, 0
    global_load_dwordx4 v[60:63], v97, s[56:57]
    s_barrier
    v_xor_b32 v101, 0, v105
    ds_read_b64_tr_b16 v[80:81], v101 offset:0
    ds_read_b64_tr_b16 v[82:83], v101 offset:2048
    v_xor_b32 v101, 64, v105
    ds_read_b64_tr_b16 v[84:85], v101 offset:0
    ds_read_b64_tr_b16 v[86:87], v101 offset:2048
    v_xor_b32 v101, 128, v105
    ds_read_b64_tr_b16 v[88:89], v101 offset:0
    ds_read_b64_tr_b16 v[90:91], v101 offset:2048
    s_waitcnt lgkmcnt(4)
    ds_write_b128 v120, v[80:83] offset:22528
    v_xor_b32 v101, 192, v105
    ds_read_b64_tr_b16 v[80:81], v101 offset:0
    ds_read_b64_tr_b16 v[82:83], v101 offset:2048
    s_waitcnt lgkmcnt(5)
    ds_write_b128 v120, v[84:87] offset:24576
    s_waitcnt lgkmcnt(4)
    ds_write_b128 v120, v[88:91] offset:26624
    s_waitcnt lgkmcnt(2)
    ds_write_b128 v120, v[80:83] offset:30720
    s_waitcnt lgkmcnt(0)
    s_barrier
    s_waitcnt vmcnt(16)
    ds_write_b128 v94, v[64:67] offset:0
    s_waitcnt vmcnt(15)
    ds_write_b128 v95, v[68:71] offset:1024
    s_waitcnt vmcnt(14)
    ds_write_b128 v94, v[72:75] offset:2048
    s_waitcnt vmcnt(13)
    ds_write_b128 v95, v[76:79] offset:3072
    s_waitcnt lgkmcnt(0)
    s_add_u32 s56, s14, 77824
    s_addc_u32 s57, s15, 0
    global_load_dwordx4 v[64:67], v97, s[56:57]
    s_add_u32 s56, s14, 78848
    s_addc_u32 s57, s15, 0
    global_load_dwordx4 v[68:71], v97, s[56:57]
    s_add_u32 s56, s14, 94208
    s_addc_u32 s57, s15, 0
    global_load_dwordx4 v[72:75], v97, s[56:57]
    s_add_u32 s56, s14, 95232
    s_addc_u32 s57, s15, 0
    global_load_dwordx4 v[76:79], v97, s[56:57]
    s_barrier
    v_xor_b32 v101, 0, v105
    ds_read_b64_tr_b16 v[80:81], v101 offset:0
    ds_read_b64_tr_b16 v[82:83], v101 offset:2048
    v_xor_b32 v101, 64, v105
    ds_read_b64_tr_b16 v[84:85], v101 offset:0
    ds_read_b64_tr_b16 v[86:87], v101 offset:2048
    v_xor_b32 v101, 128, v105
    ds_read_b64_tr_b16 v[88:89], v101 offset:0
    ds_read_b64_tr_b16 v[90:91], v101 offset:2048
    s_waitcnt lgkmcnt(4)
    ds_write_b128 v120, v[80:83] offset:23552
    v_xor_b32 v101, 192, v105
    ds_read_b64_tr_b16 v[80:81], v101 offset:0
    ds_read_b64_tr_b16 v[82:83], v101 offset:2048
    s_waitcnt lgkmcnt(5)
    ds_write_b128 v120, v[84:87] offset:25600
    s_waitcnt lgkmcnt(4)
    ds_write_b128 v120, v[88:91] offset:27648
    s_waitcnt lgkmcnt(2)
    ds_write_b128 v120, v[80:83] offset:31744
    s_waitcnt lgkmcnt(0)
    s_barrier
    s_waitcnt vmcnt(16)
    ds_write_b128 v94, v[16:19] offset:0
    s_waitcnt vmcnt(15)
    ds_write_b128 v95, v[20:23] offset:1024
    s_waitcnt vmcnt(14)
    ds_write_b128 v94, v[24:27] offset:2048
    s_waitcnt vmcnt(13)
    ds_write_b128 v95, v[28:31] offset:3072
    s_waitcnt lgkmcnt(0)
    s_barrier
    v_xor_b32 v101, 0, v105
    ds_read_b64_tr_b16 v[192:193], v101 offset:0
    ds_read_b64_tr_b16 v[194:195], v101 offset:2048
    v_xor_b32 v101, 64, v105
    ds_read_b64_tr_b16 v[208:209], v101 offset:0
    ds_read_b64_tr_b16 v[210:211], v101 offset:2048
    v_xor_b32 v101, 128, v105
    ds_read_b64_tr_b16 v[232:233], v101 offset:0
    ds_read_b64_tr_b16 v[234:235], v101 offset:2048
    v_xor_b32 v101, 192, v105
    ds_read_b64_tr_b16 v[248:249], v101 offset:0
    ds_read_b64_tr_b16 v[250:251], v101 offset:2048
    s_waitcnt lgkmcnt(0)
    s_barrier
    s_waitcnt vmcnt(12)
    ds_write_b128 v94, v[32:35] offset:0
    s_waitcnt vmcnt(11)
    ds_write_b128 v95, v[36:39] offset:1024
    s_waitcnt vmcnt(10)
    ds_write_b128 v94, v[40:43] offset:2048
    s_waitcnt vmcnt(9)
    ds_write_b128 v95, v[44:47] offset:3072
    s_waitcnt lgkmcnt(0)
    s_mov_b64 exec, 6
    s_waitcnt vmcnt(8)
    v_cmp_gt_u32 vcc, 2, v107
    s_mov_b64 exec, -1
    s_cmp_eq_u64 vcc, 0
    s_cselect_b32 s56, s63, 0
    s_add_u32 s63, s63, s56
    s_cmp_lg_u32 s63, 2
    s_cbranch_scc1 L_rnf3
    s_mov_b32 m0, s62
    s_nop 0
    global_load_lds_dwordx4 v127, s[48:49] sc1
    global_load_lds_dwordx4 v127, s[48:49] offset:1024 sc1
    v_lshlrev_b32 v130, 1, v127
    global_load_dword v131, v130, s[50:51] sc1
L_rnf3:
    s_barrier
    v_xor_b32 v101, 0, v105
    ds_read_b64_tr_b16 v[196:197], v101 offset:0
    ds_read_b64_tr_b16 v[198:199], v101 offset:2048
    v_xor_b32 v101, 64, v105
    ds_read_b64_tr_b16 v[212:213], v101 offset:0
    ds_read_b64_tr_b16 v[214:215], v101 offset:2048
    v_xor_b32 v101, 128, v105
    ds_read_b64_tr_b16 v[236:237], v101 offset:0
    ds_read_b64_tr_b16 v[238:239], v101 offset:2048
    v_xor_b32 v101, 192, v105
    ds_read_b64_tr_b16 v[252:253], v101 offset:0
    ds_read_b64_tr_b16 v[254:255], v101 offset:2048
    s_waitcnt lgkmcnt(0)
    s_barrier
    s_waitcnt vmcnt(7)
    ds_write_b128 v94, v[48:51] offset:0
    s_waitcnt vmcnt(6)
    ds_write_b128 v95, v[52:55] offset:1024
    s_waitcnt vmcnt(5)
    ds_write_b128 v94, v[56:59] offset:2048
    s_waitcnt vmcnt(4)
    ds_write_b128 v95, v[60:63] offset:3072
    s_waitcnt lgkmcnt(0)
    s_barrier
    v_xor_b32 v101, 0, v105
    ds_read_b64_tr_b16 v[200:201], v101 offset:0
    ds_read_b64_tr_b16 v[202:203], v101 offset:2048
    v_xor_b32 v101, 64, v105
    ds_read_b64_tr_b16 v[216:217], v101 offset:0
    ds_read_b64_tr_b16 v[218:219], v101 offset:2048
    v_xor_b32 v101, 128, v105
    ds_read_b64_tr_b16 v[80:81], v101 offset:0
    ds_read_b64_tr_b16 v[82:83], v101 offset:2048
    v_xor_b32 v101, 192, v105
    ds_read_b64_tr_b16 v[84:85], v101 offset:0
    ds_read_b64_tr_b16 v[86:87], v101 offset:2048
    s_waitcnt lgkmcnt(2)
    ds_write_b128 v120, v[80:83] offset:28672
    s_waitcnt lgkmcnt(1)
    ds_write_b128 v120, v[84:87] offset:32768
    s_waitcnt lgkmcnt(0)
    s_barrier
    s_waitcnt vmcnt(3)
    ds_write_b128 v94, v[64:67] offset:0
    s_waitcnt vmcnt(2)
    ds_write_b128 v95, v[68:71] offset:1024
    s_waitcnt vmcnt(1)
    ds_write_b128 v94, v[72:75] offset:2048
    s_waitcnt vmcnt(0)
    ds_write_b128 v95, v[76:79] offset:3072
    s_waitcnt lgkmcnt(0)
    s_barrier
    v_xor_b32 v101, 0, v105
    ds_read_b64_tr_b16 v[204:205], v101 offset:0
    ds_read_b64_tr_b16 v[206:207], v101 offset:2048
    v_xor_b32 v101, 64, v105
    ds_read_b64_tr_b16 v[220:221], v101 offset:0
    ds_read_b64_tr_b16 v[222:223], v101 offset:2048
    v_xor_b32 v101, 128, v105
    ds_read_b64_tr_b16 v[80:81], v101 offset:0
    ds_read_b64_tr_b16 v[82:83], v101 offset:2048
    v_xor_b32 v101, 192, v105
    ds_read_b64_tr_b16 v[84:85], v101 offset:0
    ds_read_b64_tr_b16 v[86:87], v101 offset:2048
    s_waitcnt lgkmcnt(2)
    ds_write_b128 v120, v[80:83] offset:29696
    s_waitcnt lgkmcnt(1)
    ds_write_b128 v120, v[84:87] offset:33792
    s_waitcnt lgkmcnt(0)
    s_barrier
L_rwdonea:
    s_cmp_eq_u32 s63, 2
    s_cbranch_scc1 L_rgo
    s_cmp_eq_u32 s63, 1
    s_cbranch_scc1 L_rg1
    s_cmp_lg_u32 s33, 0
    s_cbranch_scc1 L_rm6
    v_mbcnt_lo_u32_b32 v16, -1, 0
    v_and_b32 v16, 7, v16
    v_lshlrev_b32 v16, 5, v16
    s_mov_b32 s54, 0
    s_branch L_cm7
L_cn7:
    s_sleep 8
L_cm7:
    global_load_dwordx2 v[18:19], v16, s[26:27] offset:16 sc1
    s_add_u32 s54, s54, 1
    s_cmp_gt_u32 s54, 400000
    s_cbranch_scc1 L_end
    s_waitcnt vmcnt(0)
    v_bcnt_u32_b32 v17, v18, v19
    s_nop 0
    v_readlane_b32 s56, v17, s32
    s_and_b32 s56, s56, 0xffff
    s_cmp_ge_u32 s56, 32
    s_cbranch_scc1 L_rm6
    v_readlane_b32 s70, v17, 0
    v_readlane_b32 s71, v17, 1
    v_readlane_b32 s72, v17, 2
    v_readlane_b32 s73, v17, 3
    v_readlane_b32 s74, v17, 4
    v_readlane_b32 s75, v17, 5
    v_readlane_b32 s76, v17, 6
    v_readlane_b32 s77, v17, 7
    s_lshr_b32 s56, s77, 16
    s_and_b32 s77, s77, 0xffff
    s_add_u32 s56, s56, s70
    s_add_u32 s56, s56, s71
    s_add_u32 s56, s56, s72
    s_add_u32 s56, s56, s73
    s_add_u32 s56, s56, s74
    s_add_u32 s56, s56, s75
    s_add_u32 s56, s56, s76
    s_add_u32 s56, s56, s77
    s_cmp_lt_u32 s56, 256
    s_cbranch_scc1 L_cn7
    s_mov_b32 s33, 1
L_rm6:
    s_mov_b32 exec_lo, 0x20200
    s_mov_b32 exec_hi, 0x40000
    s_mov_b32 s54, 0
L_rfw:
    global_load_dword v107, v106, s[26:27] sc1
    s_add_u32 s54, s54, 1
    s_cmp_gt_u32 s54, 400000
    s_cbranch_scc1 L_end
    s_waitcnt vmcnt(0)
    v_cmp_gt_u32 vcc, 32, v107
    s_cbranch_vccnz L_rfw
L_rg1:
    s_mov_b64 exec, 6
    s_mov_b32 s54, 0
L_rfx:
    global_load_dword v107, v106, s[68:69] offset:256 sc1
    s_add_u32 s54, s54, 1
    s_cmp_gt_u32 s54, 400000
    s_cbranch_scc1 L_end
    s_waitcnt vmcnt(0)
    v_cmp_gt_u32 vcc, 2, v107
    s_cbranch_vccnz L_rfx
    s_mov_b64 exec, -1
    s_mov_b32 m0, s62
    s_nop 0
    global_load_lds_dwordx4 v127, s[48:49] sc1
    global_load_lds_dwordx4 v127, s[48:49] offset:1024 sc1
    v_lshlrev_b32 v130, 1, v127
    global_load_dword v131, v130, s[50:51] sc1
L_rgo:
    s_mov_b32 s56, 0x05040100
    s_mov_b32 s57, 0x07060302
    v_perm_b32 v0, v10, v8, s56
    v_perm_b32 v1, v10, v8, s57
    v_perm_b32 v2, v11, v9, s56
    v_perm_b32 v3, v11, v9, s57
    v_perm_b32 v4, v14, v12, s56
    v_perm_b32 v5, v14, v12, s57
    v_perm_b32 v6, v15, v13, s56
    v_perm_b32 v7, v15, v13, s57
    ds_read_b128 v[64:67], v120 offset:0
    ds_read_b128 v[68:71], v120 offset:1024
    ds_read_b128 v[72:75], v120 offset:2048
    ds_read_b128 v[76:79], v120 offset:3072
    ds_read_b128 v[80:83], v120 offset:4096
    ds_read_b128 v[84:87], v120 offset:5120
    ds_read_b128 v[88:91], v120 offset:6144
    ds_read_b128 v[92:95], v120 offset:7168
    ds_read_b128 v[8:11], v120 offset:8192
    ds_read_b128 v[12:15], v120 offset:9216
    ds_read_b128 v[16:19], v120 offset:10240
    ds_read_b128 v[20:23], v120 offset:11264
    ds_read_b128 v[24:27], v120 offset:12288
    ds_read_b128 v[28:31], v120 offset:13312
    ds_read_b128 v[56:59], v120 offset:14336
    ds_read_b128 v[60:63], v120 offset:15360
    ds_read_b128 v[96:99], v120 offset:16384
    ds_read_b128 v[100:103], v120 offset:17408
    s_add_u32 s48, s48, 16384
    s_addc_u32 s49, s49, 0
    v_mov_b64 v[32:33], 0
    v_mov_b64 v[34:35], 0
    v_mov_b64 v[36:37], 0
    v_mov_b64 v[38:39], 0
    v_mov_b64 v[40:41], 0
    v_mov_b64 v[42:43], 0
    v_mov_b64 v[44:45], 0
    v_mov_b64 v[46:47], 0
    v_mov_b64 v[48:49], 0
    v_mov_b64 v[50:51], 0
    v_mov_b64 v[52:53], 0
    v_mov_b64 v[54:55], 0
    v_readfirstlane_b32 s4, v116
    v_readfirstlane_b32 s5, v117
    v_readfirstlane_b32 s6, v118
    v_readfirstlane_b32 s7, v119
    v_cmp_ne_u32 s[8:9], 0, v112
    v_cmp_ne_u32 s[10:11], 0, v113
    v_cmp_ne_u32 s[12:13], 0, v114
    v_cmp_ne_u32 s[14:15], 0, v115
    s_mov_b32 s16, 0xf0f0f0f0
    s_mov_b32 s17, 0xf0f0f0f0
    v_lshrrev_b32 v130, 2, v127
    v_add_u32 v130, 163072, v130
    ds_write_b32 v130, v32
    s_waitcnt vmcnt(0) lgkmcnt(0)
    s_cmp_lg_u32 s33, 0
    s_cbranch_scc1 L_rslow
L_rcode:
    s_cmp_eq_u32 s30, 1
    s_cbranch_scc1 L_rwvf1
    s_cmp_eq_u32 s30, 2
    s_cbranch_scc1 L_rwvf2
    s_cmp_eq_u32 s30, 3
    s_cbranch_scc1 L_rwvf3
    s_mov_b64 s[56:57], s[42:43]
    s_mov_b64 s[58:59], s[42:43]
    s_mov_b32 s54, 0
    s_getpc_b64 s[18:19]
L_rzcf0:
    s_add_u32 s18, s18, L_rqzf0-L_rzcf0
    s_addc_u32 s19, s19, 0
    s_add_u32 s66, s50, 16384
    s_addc_u32 s67, s51, 0
    s_branch L_rpmf0
.p2align 6
    s_nop 0
    s_nop 0
    s_nop 0
L_rqmf0:
    global_load_dwordx4 v[0:3], v127, s[56:57] sc1
    global_load_dwordx4 v[4:7], v127, s[58:59] sc1
    s_add_u32 s54, s54, 1
    s_cmp_gt_u32 s54, 400000
    s_cbranch_scc1 L_rdonef0
    s_branch L_rpmf0
L_rtmf0:
    global_load_dwordx4 v[0:3], v127, s[56:57] sc1
    global_load_dwordx4 v[4:7], v127, s[58:59] sc1
    s_nop 15
    s_nop 13
    global_load_dwordx4 v[0:3], v127, s[56:57] sc1
    global_load_dwordx4 v[4:7], v127, s[58:59] sc1
    s_waitcnt lgkmcnt(0)
L_rpmf0:
    s_waitcnt vmcnt(3)
    v_max3_u32 v130, v0, v1, v2
    v_max_u32 v130, v130, v3
    s_waitcnt vmcnt(2)
    v_max3_u32 v130, v130, v4, v5
    v_max3_u32 v130, v130, v6, v7
    v_cmp_eq_u32 vcc, -1, v130
    ds_write_b128 v116, v[0:3]
    s_cbranch_vccnz L_rqmf0
    v_smfmac_f32_16x16x64_bf16 v[32:35], v[0:3], v[8:15], v110
    ds_write_b128 v116, v[4:7] offset:4096
    v_smfmac_f32_16x16x64_bf16 v[36:39], v[0:3], v[16:23], v110
    v_smfmac_f32_16x16x64_bf16 v[40:43], v[0:3], v[24:31], v110
    v_smfmac_f32_16x16x64_bf16 v[44:47], v[0:3], v[96:103], v110
    s_mov_b32 m0, 162816
    v_lshlrev_b32_e64 v130, 3, v127
    v_smfmac_f32_16x16x64_bf16 v[48:51], v[0:3], v[64:71], v110
    global_load_dwordx4 v[96:99], v128, s[50:51] sc1
    global_load_dwordx4 v[102:105], v128, s[50:51] offset:256 sc1
    v_smfmac_f32_16x16x64_bf16 v[52:55], v[0:3], v[72:79], v110
    s_waitcnt lgkmcnt(0)
    s_barrier
    ds_read_b128 v[8:11], v117 offset:0
    v_smfmac_f32_16x16x64_bf16 v[32:35], v[4:7], v[80:87], v110
    ds_read_b128 v[12:15], v118 offset:0
    global_load_lds_dword v130, s[66:67] sc1
    v_smfmac_f32_16x16x64_bf16 v[36:39], v[4:7], v[88:95], v110
    ds_read_b128 v[16:19], v119 offset:0
    v_smfmac_f32_16x16x64_bf16 v[40:43], v[4:7], v[56:63], v110
    ds_read_b128 v[20:23], v117 offset:4096
    v_smfmac_f32_16x16x64_bf16 v[44:47], v[4:7], a[0:7], v110
    ds_read_b128 v[24:27], v118 offset:4096
    v_smfmac_f32_16x16x64_bf16 v[48:51], v[4:7], a[8:15], v110
    ds_read_b128 v[28:31], v119 offset:4096
    v_smfmac_f32_16x16x64_bf16 v[52:55], v[4:7], a[16:23], v110
    s_waitcnt lgkmcnt(5)
    v_smfmac_f32_16x16x64_bf16 v[32:35], v[8:11], a[24:31], v110
    s_waitcnt vmcnt(3)
    ds_read_b128 v[64:67], v125 offset:0
    v_mov_b64 v[0:1], 0
    v_smfmac_f32_16x16x64_bf16 v[36:39], v[8:11], a[32:39], v110
    s_waitcnt lgkmcnt(5)
    global_store_dwordx4 v127, v[132:135], s[46:47] sc1
    v_smfmac_f32_16x16x64_bf16 v[32:35], v[12:15], a[40:47], v110
    ds_read_b128 v[68:71], v125 offset:1024
    v_mov_b64_e64 v[112:113], 0
    v_smfmac_f32_16x16x64_bf16 v[36:39], v[12:15], a[48:55], v110
    s_waitcnt lgkmcnt(5)
    v_mov_b64 v[2:3], 0
    v_smfmac_f32_16x16x64_bf16 v[32:35], v[16:19], a[56:63], v110
    ds_read_b128 v[72:75], v125 offset:4096
    v_mov_b64 v[114:115], 0
    v_smfmac_f32_16x16x64_bf16 v[36:39], v[16:19], a[64:71], v110
    s_waitcnt lgkmcnt(5)
    v_mov_b64_e64 v[4:5], 0
    v_smfmac_f32_16x16x64_bf16 v[32:35], v[20:23], a[72:79], v110
    ds_read_b128 v[76:79], v125 offset:5120
    v_mov_b64 v[116:117], 0
    v_smfmac_f32_16x16x64_bf16 v[36:39], v[20:23], a[80:87], v110
    s_waitcnt lgkmcnt(5)
    v_mov_b64_e64 v[6:7], 0
    v_smfmac_f32_16x16x64_bf16 v[32:35], v[24:27], a[88:95], v110
    ds_read_b128 v[80:83], v125 offset:256
    v_mov_b64 v[118:119], 0
    v_smfmac_f32_16x16x64_bf16 v[36:39], v[24:27], a[96:103], v110
    s_waitcnt lgkmcnt(5)
    v_smfmac_f32_16x16x64_bf16 v[32:35], v[28:31], a[104:111], v110
    s_nop 0
    ds_read_b128 v[84:87], v125 offset:1280
    v_smfmac_f32_16x16x64_bf16 v[36:39], v[28:31], a[112:119], v110
    s_nop 2
    v_smfmac_f32_16x16x64_bf16 v[40:43], v[8:11], a[120:127], v110
    s_nop 0
    ds_read_b128 v[88:91], v125 offset:4352
    v_add_f32 v32, v32, v34
    v_smfmac_f32_16x16x64_bf16 v[40:43], v[12:15], a[128:135], v110
    v_add_f32 v33, v33, v35
    v_smfmac_f32_16x16x64_bf16 v[40:43], v[16:19], a[136:143], v110
    ds_read_b128 v[92:95], v125 offset:5376
    v_add_f32 v36, v36, v38
    v_smfmac_f32_16x16x64_bf16 v[40:43], v[20:23], a[144:151], v110
    v_add_f32 v37, v37, v39
    v_smfmac_f32_16x16x64_bf16 v[40:43], v[24:27], a[152:159], v110
    v_cvt_pk_bf16_f32 v56, v32, v33
    v_smfmac_f32_16x16x64_bf16 v[40:43], v[28:31], a[160:167], v110
    s_nop 0
    s_nop 0
    v_cvt_pk_bf16_f32 v57, v36, v37
    v_smfmac_f32_16x16x64_bf16 v[44:47], v[8:11], a[168:175], v110
    s_nop 0
    ds_write_b32 v121, v56
    v_smfmac_f32_16x16x64_bf16 v[44:47], v[12:15], a[176:183], v110
    ds_write_b32 v121, v57 offset:4
    v_smfmac_f32_16x16x64_bf16 v[44:47], v[16:19], a[184:191], v110
    s_add_u32 s66, s66, 16384
    s_addc_u32 s67, s67, 0
    v_add_f32_e64 v40, v40, v42
    v_smfmac_f32_16x16x64_bf16 v[44:47], v[20:23], a[192:199], v110
    s_add_u32 s50, s50, 16384
    s_addc_u32 s51, s51, 0
    v_add_f32_e64 v41, v41, v43
    v_smfmac_f32_16x16x64_bf16 v[44:47], v[24:27], a[200:207], v110
    s_add_u32 s46, s46, 4096
    s_addc_u32 s47, s47, 0
    v_cvt_pk_bf16_f32 v132, v40, v41
    v_smfmac_f32_16x16x64_bf16 v[44:47], v[28:31], a[208:215], v110
    s_waitcnt lgkmcnt(0)
    s_barrier
    ds_read_b64_tr_b16 v[56:57], v122 offset:0
    v_smfmac_f32_16x16x64_bf16 v[48:51], v[8:11], a[216:223], v110
    s_nop 0
    ds_read_b64_tr_b16 v[58:59], v122 offset:512
    ds_write_b32 v123, v132 offset:2560
    v_smfmac_f32_16x16x64_bf16 v[52:55], v[8:11], a[224:231], v110
    ds_read_b64_tr_b16 v[60:61], v122 offset:1024
    v_add_f32 v44, v44, v46
    v_smfmac_f32_16x16x64_bf16 v[48:51], v[12:15], a[232:239], v110
    s_mov_b32 m0, s62
    ds_read_b64_tr_b16 v[62:63], v122 offset:1536
    v_add_f32_e64 v45, v45, v47
    v_smfmac_f32_16x16x64_bf16 v[52:55], v[12:15], a[240:247], v110
    global_load_lds_dwordx4 v127, s[48:49] sc1
    v_cvt_pk_bf16_f32 v133, v44, v45
    v_smfmac_f32_16x16x64_bf16 v[48:51], v[16:19], a[248:255], v110
    ds_write_b32 v123, v133 offset:2576
    v_smfmac_f32_16x16x64_bf16 v[52:55], v[16:19], v[136:143], v110
    s_waitcnt lgkmcnt(4)
    global_load_lds_dwordx4 v127, s[48:49] offset:1024 sc1
    v_mov_b64 v[8:9], 0
    v_smfmac_f32_16x16x64_bf16 v[0:3], v[56:59], v[64:71], v110
    s_waitcnt lgkmcnt(1)
    ds_read_b128 v[64:67], v120 offset:18432
    v_mov_b64 v[10:11], 0
    v_smfmac_f32_16x16x64_bf16 v[0:3], v[60:63], v[72:79], v110
    s_waitcnt vmcnt(4)
    ds_read_b128 v[68:71], v120 offset:19456
    v_mov_b64 v[100:101], v[98:99]
    v_smfmac_f32_16x16x64_bf16 v[4:7], v[56:59], v[80:87], v110
    s_waitcnt lgkmcnt(2)
    s_barrier
    ds_read_b64_tr_b16 v[32:33], v124 offset:2560
    v_smfmac_f32_16x16x64_bf16 v[4:7], v[60:63], v[88:95], v110
    ds_read_b64_tr_b16 v[34:35], v124 offset:2640
    ds_read_b64_tr_b16 v[36:37], v124 offset:2880
    v_smfmac_f32_16x16x64_bf16 v[48:51], v[20:23], v[144:151], v110
    ds_read_b64_tr_b16 v[38:39], v124 offset:2960
    v_add_f32_e64 v0, v0, v2
    v_smfmac_f32_16x16x64_bf16 v[52:55], v[20:23], v[152:159], v110
    ds_read_b64_tr_b16 v[40:41], v124 offset:3840
    ds_read_b64_tr_b16 v[42:43], v124 offset:3920
    v_smfmac_f32_16x16x64_bf16 v[48:51], v[24:27], v[160:167], v110
    ds_read_b64_tr_b16 v[44:45], v124 offset:4160
    ds_read_b64_tr_b16 v[46:47], v124 offset:4240
    v_smfmac_f32_16x16x64_bf16 v[52:55], v[24:27], v[168:175], v110
    ds_read_b128 v[72:75], v120 offset:20480
    v_add_f32 v1, v1, v3
    v_smfmac_f32_16x16x64_bf16 v[48:51], v[28:31], v[176:183], v110
    ds_read_b128 v[76:79], v120 offset:21504
    v_add_f32 v4, v4, v6
    v_smfmac_f32_16x16x64_bf16 v[52:55], v[28:31], v[184:191], v110
    s_waitcnt lgkmcnt(6)
    ds_read_b128 v[80:83], v120 offset:22528
    v_add_f32_e64 v5, v5, v7
    v_smfmac_f32_16x16x64_bf16 v[8:11], v[56:59], v[32:39], v110
    s_waitcnt lgkmcnt(3)
    ds_read_b128 v[84:87], v120 offset:23552
    v_max_f32 v16, v0, v4
    v_smfmac_f32_16x16x64_bf16 v[8:11], v[60:63], v[40:47], v110
    s_nop 1
    v_max_f32 v17, v1, v5
    v_mov_b64 v[106:107], v[104:105]
    v_max_f32_dpp v16, v16, v16 row_ror:8 row_mask:0xf bank_mask:0xf
    v_max_f32_dpp v17, v17, v17 row_ror:8 row_mask:0xf bank_mask:0xf
    v_mov_b32_e64 v15, 0
    v_pk_add_f32 v[48:49], v[48:49], v[50:51]
    v_pk_add_f32 v[8:9], v[8:9], v[10:11]
    v_max_f32 v16, v16, v8
    v_max_f32 v17, v17, v9
    v_pk_add_f32 v[52:53], v[52:53], v[54:55]
    v_max_f32_dpp v16, v16, v16 row_ror:4 row_mask:0xf bank_mask:0xf
    v_max_f32_dpp v17, v17, v17 row_ror:4 row_mask:0xf bank_mask:0xf
    v_cvt_pk_bf16_f32 v98, v48, v49
    v_max_f32_dpp v16, v16, v16 row_ror:2 row_mask:0xf bank_mask:0xf
    v_max_f32_dpp v17, v17, v17 row_ror:2 row_mask:0xf bank_mask:0xf
    v_cvt_pk_bf16_f32 v104, v52, v53
    v_max_f32_dpp v16, v16, v16 row_ror:1 row_mask:0xf bank_mask:0xf
    v_max_f32_dpp v17, v17, v17 row_ror:1 row_mask:0xf bank_mask:0xf
    v_pk_mul_f32 v[18:19], v[16:17], s[52:53] neg_lo:[1,0] neg_hi:[1,0]
    v_pk_fma_f32 v[0:1], v[0:1], s[52:53], v[18:19]
    v_pk_fma_f32 v[4:5], v[4:5], s[52:53], v[18:19]
    v_pk_add_f32 v[20:21], v[18:19], v[110:111] op_sel:[0,1] op_sel_hi:[1,1]
    v_exp_f32_e64 v0, v0
    v_pk_fma_f32 v[8:9], v[8:9], s[52:53], v[20:21]
    v_exp_f32 v1, v1
    v_exp_f32 v4, v4
    v_exp_f32_e64 v5, v5
    v_cvt_pk_bf16_f32 v12, v0, v1
    v_cvt_pk_bf16_f32 v13, v4, v5
    v_exp_f32 v8, v8
    v_exp_f32_e64 v9, v9
    v_mfma_f32_16x16x16_bf16 v[56:59], v[12:13], v[108:109], 0
    s_nop 0
    v_cvt_pk_bf16_f32 v14, v8, v9
    v_add_f32 v22, v0, v4
    v_add_f32 v23, v1, v5
    v_mfma_f32_16x16x16_bf16 v[60:63], v[14:15], v[108:109], 0
    s_nop 0
    v_add_f32 v22, v22, v8
    v_add_f32_e64 v23, v23, v9
    v_cvt_pk_bf16_f32 v40, v56, v57
    v_add_f32_dpp v22, v22, v22 row_ror:8 row_mask:0xf bank_mask:0xf
    v_add_f32_dpp v23, v23, v23 row_ror:8 row_mask:0xf bank_mask:0xf
    v_cvt_pk_bf16_f32 v42, v58, v59
    v_add_f32_dpp v22, v22, v22 row_ror:4 row_mask:0xf bank_mask:0xf
    v_cvt_pk_bf16_f32 v41, v60, v61
    v_cvt_pk_bf16_f32 v43, v62, v63
    v_add_f32_dpp v23, v23, v23 row_ror:4 row_mask:0xf bank_mask:0xf
    v_add_f32_dpp v22, v22, v22 row_ror:2 row_mask:0xf bank_mask:0xf
    v_smfmac_f32_16x16x64_bf16 v[112:115], v[40:43], v[96:103], v110
    s_nop 0
    ds_read_b128 v[88:91], v120 offset:24576
    v_add_f32_dpp v23, v23, v23 row_ror:2 row_mask:0xf bank_mask:0xf
    v_smfmac_f32_16x16x64_bf16 v[116:119], v[40:43], v[102:109], v110
    s_nop 0
    ds_read_b128 v[92:95], v120 offset:25600
    v_add_f32_dpp v22, v22, v22 row_ror:1 row_mask:0xf bank_mask:0xf
    v_add_f32_dpp v23, v23, v23 row_ror:1 row_mask:0xf bank_mask:0xf
    v_rcp_f32 v22, v22
    v_rcp_f32 v23, v23
    v_pk_add_f32 v[112:113], v[112:113], v[114:115]
    v_pk_mul_f32 v[112:113], v[112:113], v[22:23]
    v_pk_add_f32 v[116:117], v[116:117], v[118:119]
    v_cvt_pk_bf16_f32 v130, v112, v113
    v_pk_mul_f32 v[116:117], v[116:117], v[22:23]
    v_cvt_pk_bf16_f32 v131, v116, v117
    ds_write2_b32 v123, v130, v131 offset0:0 offset1:4
    v_mov_b64 v[0:1], 0
    v_mov_b64 v[2:3], 0
    v_mov_b64 v[4:5], 0
    v_mov_b64 v[6:7], 0
    v_mov_b64 v[8:9], 0
    v_mov_b64 v[10:11], 0
    v_mov_b64 v[12:13], 0
    v_mov_b64 v[14:15], 0
    s_waitcnt lgkmcnt(0)
    s_barrier
    ds_read_b64_tr_b16 v[16:17], v124 offset:0
    ds_read_b64_tr_b16 v[18:19], v124 offset:80
    ds_read_b64_tr_b16 v[20:21], v124 offset:320
    ds_read_b64_tr_b16 v[22:23], v124 offset:400
    ds_read_b64_tr_b16 v[24:25], v124 offset:1280
    ds_read_b64_tr_b16 v[26:27], v124 offset:1360
    ds_read_b64_tr_b16 v[28:29], v124 offset:1600
    ds_read_b64_tr_b16 v[30:31], v124 offset:1680
    s_waitcnt lgkmcnt(6)
    v_smfmac_f32_16x16x64_bf16 v[0:3], v[16:19], v[64:71], v110 abid:1
    v_mov_b32_e64 v134, v98
    v_smfmac_f32_16x16x64_bf16 v[4:7], v[16:19], v[72:79], v110 abid:1
    s_waitcnt lgkmcnt(4)
    ds_read_b128 v[64:67], v120 offset:26624
    v_smfmac_f32_16x16x64_bf16 v[0:3], v[20:23], v[80:87], v110 abid:1
    ds_read_b128 v[68:71], v120 offset:27648
    v_mov_b32_e64 v135, v104
    v_smfmac_f32_16x16x64_bf16 v[4:7], v[20:23], v[88:95], v110 abid:1
    s_waitcnt lgkmcnt(4)
    ds_read_b128 v[72:75], v120 offset:28672
    v_smfmac_f32_16x16x64_bf16 v[0:3], v[24:27], v[192:199], v110 abid:1
    s_waitcnt lgkmcnt(3)
    ds_read_b128 v[76:79], v120 offset:29696
    v_smfmac_f32_16x16x64_bf16 v[0:3], v[28:31], v[200:207], v110 abid:1
    s_nop 0
    ds_read_b128 v[80:83], v120 offset:30720
    v_mov_b64 v[32:33], 0
    v_smfmac_f32_16x16x64_bf16 v[4:7], v[24:27], v[208:215], v110 abid:1
    s_nop 0
    ds_read_b128 v[84:87], v120 offset:31744
    v_mov_b64_e64 v[34:35], 0
    v_smfmac_f32_16x16x64_bf16 v[4:7], v[28:31], v[216:223], v110 abid:1
    s_nop 0
    ds_read_b128 v[88:91], v120 offset:32768
    v_cvt_pk_bf16_f32 v56, v0, v1
    v_smfmac_f32_16x16x64_bf16 v[8:11], v[16:19], v[224:231], v110 abid:1
    s_waitcnt lgkmcnt(5)
    ds_read_b128 v[92:95], v120 offset:33792
    v_cvt_pk_bf16_f32 v57, v2, v3
    v_and_or_b32 v56, v56, -2, s35
    v_cvt_pk_bf16_f32 v58, v4, v5
    v_cvt_pk_bf16_f32 v59, v6, v7
    v_smfmac_f32_16x16x64_bf16 v[8:11], v[20:23], v[64:71], v110 abid:1
    global_store_dwordx4 v126, v[56:59], s[36:37]
    v_smfmac_f32_16x16x64_bf16 v[8:11], v[24:27], v[232:239], v110 abid:1
    s_waitcnt lgkmcnt(4)
    v_smfmac_f32_16x16x64_bf16 v[8:11], v[28:31], v[72:79], v110 abid:1
    s_nop 1
    v_mov_b64 v[36:37], 0
    v_smfmac_f32_16x16x64_bf16 v[12:15], v[16:19], v[240:247], v110 abid:1
    s_waitcnt lgkmcnt(2)
    s_nop 0
    v_mov_b64 v[38:39], 0
    v_smfmac_f32_16x16x64_bf16 v[12:15], v[20:23], v[80:87], v110 abid:1
    s_add_u32 s48, s48, 16384
    s_addc_u32 s49, s49, 0
    v_cvt_pk_bf16_f32 v60, v8, v9
    v_smfmac_f32_16x16x64_bf16 v[12:15], v[24:27], v[248:255], v110 abid:1
    s_waitcnt lgkmcnt(0)
    v_cvt_pk_bf16_f32 v61, v10, v11
    v_smfmac_f32_16x16x64_bf16 v[12:15], v[28:31], v[88:95], v110 abid:1
    s_cmp_ge_u32 s30, 2
    s_nop 0
    v_and_or_b32 v60, v60, -2, s35
    v_mov_b64 v[40:41], 0
    v_mov_b64 v[42:43], 0
    v_mov_b64 v[44:45], 0
    v_mov_b64 v[46:47], 0
    v_mov_b64 v[48:49], 0
    v_cvt_pk_bf16_f32 v62, v12, v13
    v_cvt_pk_bf16_f32 v63, v14, v15
    global_store_dwordx4 v126, v[60:63], s[38:39]
    v_mov_b32 v130, 0x3f80
    v_cndmask_b32 v130, v130, 1.0, s[16:17]
    v_cndmask_b32 v112, 0, v130, s[8:9]
    v_cndmask_b32 v113, 0, v130, s[10:11]
    v_cndmask_b32 v114, 0, v130, s[12:13]
    v_cndmask_b32 v115, 0, v130, s[14:15]
    v_add_u32 v116, s4, v127
    v_add_u32 v117, s5, v127
    v_add_u32 v118, s6, v127
    v_add_u32 v119, s7, v127
    v_mov_b64 v[50:51], 0
    v_mov_b64 v[52:53], 0
    v_mov_b64 v[54:55], 0
    v_lshrrev_b32 v130, 2, v127
    v_add_u32 v131, 163072, v130
    s_add_u32 s20, s34, 3
    s_min_u32 s20, s20, 64
    ds_read_b32 v131, v131
    s_mov_b64 exec, 6
    s_waitcnt lgkmcnt(0)
    v_cmp_gt_u32 vcc, s20, v131
    s_cbranch_vccnz L_rlv2ef0
L_rlvbef0:
    s_mov_b64 exec, -1
    s_nop 7
    global_load_dwordx4 v[16:19], v127, s[40:41] sc1
    global_load_dwordx4 v[20:23], v127, s[40:41] offset:1024 sc1
    s_lshl_b32 s58, s30, 10
    s_add_u32 s56, s42, s58
    s_addc_u32 s57, s43, 0
    s_add_u32 s58, s56, 4096
    s_addc_u32 s59, s57, 0
    s_mov_b32 s54, 0
    s_add_u32 s34, s34, 1
    v_mov_b32_e64 v12, -1
    ds_read_b128 v[64:67], v120 offset:0
    ds_read_b128 v[68:71], v120 offset:1024
    ds_read_b128 v[72:75], v120 offset:2048
    ds_read_b128 v[76:79], v120 offset:3072
    ds_read_b128 v[80:83], v120 offset:4096
    ds_read_b128 v[84:87], v120 offset:5120
    ds_read_b128 v[88:91], v120 offset:6144
    ds_read_b128 v[92:95], v120 offset:7168
    ds_read_b128 v[96:99], v120 offset:16384
    ds_read_b128 v[100:103], v120 offset:17408
    s_waitcnt vmcnt(1)
    v_mfma_f32_16x16x32_bf16 v[8:11], v[112:115], v[16:19], 0
    v_xor_b32 v130, s35, v16
    s_waitcnt vmcnt(0)
    v_mfma_f32_16x16x32_bf16 v[8:11], v[112:115], v[20:23], v[8:11]
    s_nop 0
    v_bitop3_b32 v130, v130, s35, v20 bitop3:0xf6
    v_and_b32 v130, 1, v130
    v_cmp_ne_u32 vcc, 0, v130
    s_nop 0
    s_nop 2
    v_add_f32_dpp v8, v8, v8 row_ror:4 row_mask:0xf bank_mask:0xf
    v_add_f32_dpp v9, v9, v9 row_ror:4 row_mask:0xf bank_mask:0xf
    s_cbranch_vccnz L_rfef0
L_rokef0:
    v_add_f32_dpp v8, v8, v8 row_ror:8 row_mask:0xf bank_mask:0xf
    v_add_f32_dpp v9, v9, v9 row_ror:8 row_mask:0xf bank_mask:0xf
    v_cvt_pk_bf16_f32 v130, v8, v9
    s_mov_b64 exec, s[64:65]
    s_xor_b32 s35, s35, 1
    global_store_dword v129, v130, s[42:43]
    global_store_dword v129, v12, s[44:45]
    s_mov_b64 exec, -1
    ds_read_b128 v[8:11], v120 offset:8192
    ds_read_b128 v[12:15], v120 offset:9216
    ds_read_b128 v[16:19], v120 offset:10240
    ds_read_b128 v[20:23], v120 offset:11264
    ds_read_b128 v[24:27], v120 offset:12288
    ds_read_b128 v[28:31], v120 offset:13312
    ds_read_b128 v[56:59], v120 offset:14336
    ds_read_b128 v[60:63], v120 offset:15360
    s_barrier
    s_mov_b64 s[60:61], s[42:43]
    s_mov_b64 s[42:43], s[44:45]
    s_mov_b64 s[44:45], s[60:61]
    s_waitcnt lgkmcnt(0)
    s_nop 2
    s_cmp_lt_u32 s34, 63
    s_cbranch_scc1 L_rtmf0
    s_branch L_rtzf0
L_rfef0:
    global_load_dwordx4 v[16:19], v127, s[40:41] sc1
    global_load_dwordx4 v[20:23], v127, s[40:41] offset:1024 sc1
    s_waitcnt vmcnt(1)
    v_mfma_f32_16x16x32_bf16 v[8:11], v[112:115], v[16:19], 0
    v_xor_b32 v130, s35, v16
    s_waitcnt vmcnt(0)
    v_mfma_f32_16x16x32_bf16 v[8:11], v[112:115], v[20:23], v[8:11]
    s_nop 0
    v_bitop3_b32 v130, v130, s35, v20 bitop3:0xf6
    v_and_b32 v130, 1, v130
    v_cmp_ne_u32 vcc, 0, v130
    s_nop 0
    s_nop 2
    v_add_f32_dpp v8, v8, v8 row_ror:4 row_mask:0xf bank_mask:0xf
    v_add_f32_dpp v9, v9, v9 row_ror:4 row_mask:0xf bank_mask:0xf
    s_cbranch_vccz L_rokef0
    s_add_u32 s54, s54, 1
    s_cmp_gt_u32 s54, 400000
    s_cbranch_scc1 L_rdonef0
    s_branch L_rfef0
L_rlatef0:
L_rlv2ef0:
    global_load_dword v131, v130, s[68:69] offset:256 sc1
    s_add_u32 s54, s54, 1
    s_cmp_gt_u32 s54, 400000
    s_cbranch_scc1 L_rdonef0
    s_waitcnt vmcnt(0)
    v_cmp_gt_u32_e64 vcc, s20, v131
    s_cbranch_vccnz L_rlv2ef0
    s_branch L_rlvbef0
L_rqzf0:
    global_load_dwordx4 v[0:3], v127, s[56:57] sc1
    global_load_dwordx4 v[4:7], v127, s[58:59] sc1
    s_add_u32 s54, s54, 1
    s_cmp_gt_u32 s54, 400000
    s_cbranch_scc1 L_rdonef0
    s_branch L_rpzf0
L_rtzf0:
    global_load_dwordx4 v[0:3], v127, s[56:57] sc1
    global_load_dwordx4 v[4:7], v127, s[58:59] sc1
    s_nop 15
    s_nop 0
    s_nop 12
    global_load_dwordx4 v[0:3], v127, s[56:57] sc1
    global_load_dwordx4 v[4:7], v127, s[58:59] sc1
    s_waitcnt lgkmcnt(0)
L_rpzf0:
    s_waitcnt vmcnt(3)
    v_max3_u32 v130, v0, v1, v2
    v_max_u32 v130, v130, v3
    s_waitcnt vmcnt(2)
    v_max3_u32 v130, v130, v4, v5
    v_max3_u32 v130, v130, v6, v7
    v_cmp_eq_u32_e64 vcc, -1, v130
    ds_write_b128 v116, v[0:3]
    s_cbranch_vccnz L_rqzf0
    v_smfmac_f32_16x16x64_bf16 v[40:43], v[0:3], v[24:31], v110
    ds_write_b128 v116, v[4:7] offset:4096
    v_smfmac_f32_16x16x64_bf16 v[44:47], v[0:3], v[96:103], v110
    v_smfmac_f32_16x16x64_bf16 v[48:51], v[0:3], v[64:71], v110
    v_smfmac_f32_16x16x64_bf16 v[52:55], v[0:3], v[72:79], v110
    v_smfmac_f32_16x16x64_bf16 v[40:43], v[4:7], v[56:63], v110
    v_smfmac_f32_16x16x64_bf16 v[44:47], v[4:7], a[0:7], v110
    v_smfmac_f32_16x16x64_bf16 v[48:51], v[4:7], a[8:15], v110
    v_smfmac_f32_16x16x64_bf16 v[52:55], v[4:7], a[16:23], v110
    s_waitcnt lgkmcnt(0)
    s_barrier
    ds_read_b128 v[8:11], v117 offset:0
    ds_read_b128 v[12:15], v118 offset:0
    ds_read_b128 v[16:19], v119 offset:0
    ds_read_b128 v[20:23], v117 offset:4096
    ds_read_b128 v[24:27], v118 offset:4096
    ds_read_b128 v[28:31], v119 offset:4096
    global_store_dwordx4 v127, v[132:135], s[46:47] sc1
    s_add_u32 s46, s46, 4096
    s_addc_u32 s47, s47, 0
    s_waitcnt lgkmcnt(5)
    v_smfmac_f32_16x16x64_bf16 v[40:43], v[8:11], a[120:127], v110
    s_waitcnt lgkmcnt(4)
    v_smfmac_f32_16x16x64_bf16 v[40:43], v[12:15], a[128:135], v110
    s_waitcnt lgkmcnt(3)
    v_smfmac_f32_16x16x64_bf16 v[40:43], v[16:19], a[136:143], v110
    s_waitcnt lgkmcnt(2)
    v_smfmac_f32_16x16x64_bf16 v[40:43], v[20:23], a[144:151], v110
    s_waitcnt lgkmcnt(1)
    v_smfmac_f32_16x16x64_bf16 v[40:43], v[24:27], a[152:159], v110
    s_waitcnt lgkmcnt(0)
    v_smfmac_f32_16x16x64_bf16 v[40:43], v[28:31], a[160:167], v110
    v_smfmac_f32_16x16x64_bf16 v[44:47], v[8:11], a[168:175], v110
    v_smfmac_f32_16x16x64_bf16 v[44:47], v[12:15], a[176:183], v110
    v_smfmac_f32_16x16x64_bf16 v[44:47], v[16:19], a[184:191], v110
    v_smfmac_f32_16x16x64_bf16 v[44:47], v[20:23], a[192:199], v110
    v_smfmac_f32_16x16x64_bf16 v[44:47], v[24:27], a[200:207], v110
    v_smfmac_f32_16x16x64_bf16 v[44:47], v[28:31], a[208:215], v110
    v_smfmac_f32_16x16x64_bf16 v[48:51], v[8:11], a[216:223], v110
    v_smfmac_f32_16x16x64_bf16 v[52:55], v[8:11], a[224:231], v110
    v_smfmac_f32_16x16x64_bf16 v[48:51], v[12:15], a[232:239], v110
    v_smfmac_f32_16x16x64_bf16 v[52:55], v[12:15], a[240:247], v110
    v_smfmac_f32_16x16x64_bf16 v[48:51], v[16:19], a[248:255], v110
    v_smfmac_f32_16x16x64_bf16 v[52:55], v[16:19], v[136:143], v110
    v_smfmac_f32_16x16x64_bf16 v[48:51], v[20:23], v[144:151], v110
    v_smfmac_f32_16x16x64_bf16 v[52:55], v[20:23], v[152:159], v110
    v_smfmac_f32_16x16x64_bf16 v[48:51], v[24:27], v[160:167], v110
    v_smfmac_f32_16x16x64_bf16 v[52:55], v[24:27], v[168:175], v110
    v_smfmac_f32_16x16x64_bf16 v[48:51], v[28:31], v[176:183], v110
    v_smfmac_f32_16x16x64_bf16 v[52:55], v[28:31], v[184:191], v110
    v_pk_add_f32 v[40:41], v[40:41], v[42:43]
    v_pk_add_f32 v[44:45], v[44:45], v[46:47]
    s_nop 0
    s_nop 3
    v_pk_add_f32 v[48:49], v[48:49], v[50:51]
    v_pk_add_f32 v[52:53], v[52:53], v[54:55]
    v_cvt_pk_bf16_f32 v132, v40, v41
    v_cvt_pk_bf16_f32 v133, v44, v45
    v_cvt_pk_bf16_f32 v134, v48, v49
    v_cvt_pk_bf16_f32 v135, v52, v53
    global_store_dwordx4 v127, v[132:135], s[46:47] sc1
L_rdonef0:
    s_branch L_rend
L_rwvf1:
    s_mov_b64 s[56:57], s[42:43]
    s_mov_b64 s[58:59], s[42:43]
    s_mov_b32 s54, 0
    s_getpc_b64 s[18:19]
L_rzcf1:
    s_add_u32 s18, s18, L_rqzf1-L_rzcf1
    s_addc_u32 s19, s19, 0
    s_add_u32 s66, s50, 16384
    s_addc_u32 s67, s51, 0
    s_branch L_rpmf1
.p2align 6
    s_nop 0
    s_nop 0
    s_nop 0
L_rqmf1:
    global_load_dwordx4 v[0:3], v127, s[56:57] sc1
    global_load_dwordx4 v[4:7], v127, s[58:59] sc1
    s_add_u32 s54, s54, 1
    s_cmp_gt_u32 s54, 400000
    s_cbranch_scc1 L_rdonef1
    s_branch L_rpmf1
L_rtmf1:
    global_load_dwordx4 v[0:3], v127, s[56:57] sc1
    global_load_dwordx4 v[4:7], v127, s[58:59] sc1
    s_nop 15
    s_nop 13
    global_load_dwordx4 v[0:3], v127, s[56:57] sc1
    global_load_dwordx4 v[4:7], v127, s[58:59] sc1
    s_waitcnt lgkmcnt(0)
L_rpmf1:
    s_waitcnt vmcnt(3)
    v_max3_u32 v130, v0, v1, v2
    v_max_u32 v130, v130, v3
    s_waitcnt vmcnt(2)
    v_max3_u32 v130, v130, v4, v5
    v_max3_u32 v130, v130, v6, v7
    v_cmp_eq_u32 vcc, -1, v130
    ds_write_b128 v116, v[0:3]
    s_cbranch_vccnz L_rqmf1
    v_smfmac_f32_16x16x64_bf16 v[32:35], v[0:3], v[8:15], v110
    ds_write_b128 v116, v[4:7] offset:4096
    v_smfmac_f32_16x16x64_bf16 v[36:39], v[0:3], v[16:23], v110
    v_smfmac_f32_16x16x64_bf16 v[40:43], v[0:3], v[24:31], v110
    v_smfmac_f32_16x16x64_bf16 v[44:47], v[0:3], v[96:103], v110
    s_mov_b32 m0, 162816
    v_smfmac_f32_16x16x64_bf16 v[48:51], v[0:3], v[64:71], v110
    global_load_dwordx4 v[96:99], v128, s[50:51] sc1
    global_load_dwordx4 v[102:105], v128, s[50:51] offset:256 sc1
    v_smfmac_f32_16x16x64_bf16 v[52:55], v[0:3], v[72:79], v110
    s_waitcnt lgkmcnt(0)
    s_barrier
    ds_read_b128 v[8:11], v117 offset:0
    v_smfmac_f32_16x16x64_bf16 v[32:35], v[4:7], v[80:87], v110
    ds_read_b128 v[12:15], v118 offset:0
    v_smfmac_f32_16x16x64_bf16 v[36:39], v[4:7], v[88:95], v110
    ds_read_b128 v[16:19], v119 offset:0
    v_smfmac_f32_16x16x64_bf16 v[40:43], v[4:7], v[56:63], v110
    ds_read_b128 v[20:23], v117 offset:4096
    v_smfmac_f32_16x16x64_bf16 v[44:47], v[4:7], a[0:7], v110
    ds_read_b128 v[24:27], v118 offset:4096
    v_smfmac_f32_16x16x64_bf16 v[48:51], v[4:7], a[8:15], v110
    ds_read_b128 v[28:31], v119 offset:4096
    v_smfmac_f32_16x16x64_bf16 v[52:55], v[4:7], a[16:23], v110
    s_waitcnt lgkmcnt(5)
    ds_read_b128 v[64:67], v125 offset:0
    v_smfmac_f32_16x16x64_bf16 v[32:35], v[8:11], a[24:31], v110
    s_waitcnt vmcnt(2)
    v_mov_b64 v[0:1], 0
    v_smfmac_f32_16x16x64_bf16 v[36:39], v[8:11], a[32:39], v110
    s_waitcnt lgkmcnt(5)
    ds_read_b128 v[68:71], v125 offset:1024
    v_mov_b64_e64 v[112:113], 0
    v_smfmac_f32_16x16x64_bf16 v[32:35], v[12:15], a[40:47], v110
    v_mov_b64 v[2:3], 0
    v_smfmac_f32_16x16x64_bf16 v[36:39], v[12:15], a[48:55], v110
    s_waitcnt lgkmcnt(5)
    ds_read_b128 v[72:75], v125 offset:4096
    v_mov_b64 v[114:115], 0
    v_smfmac_f32_16x16x64_bf16 v[32:35], v[16:19], a[56:63], v110
    global_store_dwordx4 v127, v[132:135], s[46:47] sc1
    v_smfmac_f32_16x16x64_bf16 v[36:39], v[16:19], a[64:71], v110
    s_waitcnt lgkmcnt(5)
    ds_read_b128 v[76:79], v125 offset:5120
    v_mov_b64 v[4:5], 0
    v_smfmac_f32_16x16x64_bf16 v[32:35], v[20:23], a[72:79], v110
    v_mov_b64 v[116:117], 0
    v_smfmac_f32_16x16x64_bf16 v[36:39], v[20:23], a[80:87], v110
    s_waitcnt lgkmcnt(5)
    ds_read_b128 v[80:83], v125 offset:256
    v_mov_b64 v[6:7], 0
    v_smfmac_f32_16x16x64_bf16 v[32:35], v[24:27], a[88:95], v110
    v_mov_b64_e64 v[118:119], 0
    v_smfmac_f32_16x16x64_bf16 v[36:39], v[24:27], a[96:103], v110
    s_waitcnt lgkmcnt(5)
    ds_read_b128 v[84:87], v125 offset:1280
    v_smfmac_f32_16x16x64_bf16 v[32:35], v[28:31], a[104:111], v110
    s_nop 2
    v_smfmac_f32_16x16x64_bf16 v[36:39], v[28:31], a[112:119], v110
    s_nop 2
    v_smfmac_f32_16x16x64_bf16 v[40:43], v[8:11], a[120:127], v110
    s_nop 0
    v_add_f32_e64 v32, v32, v34
    v_smfmac_f32_16x16x64_bf16 v[40:43], v[12:15], a[128:135], v110
    ds_read_b128 v[88:91], v125 offset:4352
    v_add_f32 v33, v33, v35
    v_smfmac_f32_16x16x64_bf16 v[40:43], v[16:19], a[136:143], v110
    v_add_f32 v36, v36, v38
    v_smfmac_f32_16x16x64_bf16 v[40:43], v[20:23], a[144:151], v110
    ds_read_b128 v[92:95], v125 offset:5376
    v_add_f32_e64 v37, v37, v39
    v_smfmac_f32_16x16x64_bf16 v[40:43], v[24:27], a[152:159], v110
    v_cvt_pk_bf16_f32 v56, v32, v33
    v_smfmac_f32_16x16x64_bf16 v[40:43], v[28:31], a[160:167], v110
    s_nop 0
    s_nop 0
    v_cvt_pk_bf16_f32 v57, v36, v37
    v_smfmac_f32_16x16x64_bf16 v[44:47], v[8:11], a[168:175], v110
    s_nop 0
    ds_write_b32 v121, v56
    v_smfmac_f32_16x16x64_bf16 v[44:47], v[12:15], a[176:183], v110
    ds_write_b32 v121, v57 offset:4
    v_smfmac_f32_16x16x64_bf16 v[44:47], v[16:19], a[184:191], v110
    v_add_f32 v40, v40, v42
    v_smfmac_f32_16x16x64_bf16 v[44:47], v[20:23], a[192:199], v110
    s_add_u32 s50, s50, 16384
    s_addc_u32 s51, s51, 0
    v_add_f32_e64 v41, v41, v43
    v_smfmac_f32_16x16x64_bf16 v[44:47], v[24:27], a[200:207], v110
    s_add_u32 s46, s46, 4096
    s_addc_u32 s47, s47, 0
    v_cvt_pk_bf16_f32 v132, v40, v41
    v_smfmac_f32_16x16x64_bf16 v[44:47], v[28:31], a[208:215], v110
    s_waitcnt lgkmcnt(0)
    s_barrier
    ds_read_b64_tr_b16 v[56:57], v122 offset:0
    v_smfmac_f32_16x16x64_bf16 v[48:51], v[8:11], a[216:223], v110
    s_nop 0
    ds_read_b64_tr_b16 v[58:59], v122 offset:512
    ds_write_b32 v123, v132 offset:2560
    v_smfmac_f32_16x16x64_bf16 v[52:55], v[8:11], a[224:231], v110
    ds_read_b64_tr_b16 v[60:61], v122 offset:1024
    v_add_f32_e64 v44, v44, v46
    v_smfmac_f32_16x16x64_bf16 v[48:51], v[12:15], a[232:239], v110
    s_mov_b32 m0, s62
    ds_read_b64_tr_b16 v[62:63], v122 offset:1536
    v_add_f32_e64 v45, v45, v47
    v_smfmac_f32_16x16x64_bf16 v[52:55], v[12:15], a[240:247], v110
    global_load_lds_dwordx4 v127, s[48:49] sc1
    v_cvt_pk_bf16_f32 v133, v44, v45
    v_smfmac_f32_16x16x64_bf16 v[48:51], v[16:19], a[248:255], v110
    ds_write_b32 v123, v133 offset:2576
    v_smfmac_f32_16x16x64_bf16 v[52:55], v[16:19], v[136:143], v110
    s_waitcnt lgkmcnt(4)
    global_load_lds_dwordx4 v127, s[48:49] offset:1024 sc1
    v_mov_b64_e64 v[8:9], 0
    v_smfmac_f32_16x16x64_bf16 v[0:3], v[56:59], v[64:71], v110
    s_waitcnt lgkmcnt(1)
    ds_read_b128 v[64:67], v120 offset:18432
    v_mov_b64 v[10:11], 0
    v_smfmac_f32_16x16x64_bf16 v[0:3], v[60:63], v[72:79], v110
    s_waitcnt vmcnt(3)
    ds_read_b128 v[68:71], v120 offset:19456
    v_mov_b64_e64 v[100:101], v[98:99]
    v_smfmac_f32_16x16x64_bf16 v[4:7], v[56:59], v[80:87], v110
    s_waitcnt lgkmcnt(2)
    s_barrier
    ds_read_b64_tr_b16 v[32:33], v124 offset:2560
    v_smfmac_f32_16x16x64_bf16 v[4:7], v[60:63], v[88:95], v110
    ds_read_b64_tr_b16 v[34:35], v124 offset:2640
    ds_read_b64_tr_b16 v[36:37], v124 offset:2880
    v_smfmac_f32_16x16x64_bf16 v[48:51], v[20:23], v[144:151], v110
    ds_read_b64_tr_b16 v[38:39], v124 offset:2960
    v_add_f32_e64 v0, v0, v2
    v_smfmac_f32_16x16x64_bf16 v[52:55], v[20:23], v[152:159], v110
    ds_read_b64_tr_b16 v[40:41], v124 offset:3840
    ds_read_b64_tr_b16 v[42:43], v124 offset:3920
    v_smfmac_f32_16x16x64_bf16 v[48:51], v[24:27], v[160:167], v110
    ds_read_b64_tr_b16 v[44:45], v124 offset:4160
    ds_read_b64_tr_b16 v[46:47], v124 offset:4240
    v_smfmac_f32_16x16x64_bf16 v[52:55], v[24:27], v[168:175], v110
    ds_read_b128 v[72:75], v120 offset:20480
    v_add_f32_e64 v1, v1, v3
    v_smfmac_f32_16x16x64_bf16 v[48:51], v[28:31], v[176:183], v110
    ds_read_b128 v[76:79], v120 offset:21504
    v_add_f32 v4, v4, v6
    v_smfmac_f32_16x16x64_bf16 v[52:55], v[28:31], v[184:191], v110
    s_waitcnt lgkmcnt(6)
    ds_read_b128 v[80:83], v120 offset:22528
    v_add_f32 v5, v5, v7
    v_smfmac_f32_16x16x64_bf16 v[8:11], v[56:59], v[32:39], v110
    s_waitcnt lgkmcnt(3)
    ds_read_b128 v[84:87], v120 offset:23552
    v_max_f32_e64 v16, v0, v4
    v_smfmac_f32_16x16x64_bf16 v[8:11], v[60:63], v[40:47], v110
    s_nop 1
    v_max_f32 v17, v1, v5
    v_mov_b64_e64 v[106:107], v[104:105]
    v_max_f32_dpp v16, v16, v16 row_ror:8 row_mask:0xf bank_mask:0xf
    v_max_f32_dpp v17, v17, v17 row_ror:8 row_mask:0xf bank_mask:0xf
    v_mov_b32 v15, 0
    v_pk_add_f32 v[48:49], v[48:49], v[50:51]
    v_pk_add_f32 v[8:9], v[8:9], v[10:11]
    v_max_f32 v16, v16, v8
    v_max_f32_e64 v17, v17, v9
    v_pk_add_f32 v[52:53], v[52:53], v[54:55]
    v_max_f32_dpp v16, v16, v16 row_ror:4 row_mask:0xf bank_mask:0xf
    v_max_f32_dpp v17, v17, v17 row_ror:4 row_mask:0xf bank_mask:0xf
    v_cvt_pk_bf16_f32 v98, v48, v49
    v_max_f32_dpp v16, v16, v16 row_ror:2 row_mask:0xf bank_mask:0xf
    v_max_f32_dpp v17, v17, v17 row_ror:2 row_mask:0xf bank_mask:0xf
    v_cvt_pk_bf16_f32 v104, v52, v53
    v_max_f32_dpp v16, v16, v16 row_ror:1 row_mask:0xf bank_mask:0xf
    v_max_f32_dpp v17, v17, v17 row_ror:1 row_mask:0xf bank_mask:0xf
    v_pk_mul_f32 v[18:19], v[16:17], s[52:53] neg_lo:[1,0] neg_hi:[1,0]
    v_pk_fma_f32 v[0:1], v[0:1], s[52:53], v[18:19]
    v_pk_fma_f32 v[4:5], v[4:5], s[52:53], v[18:19]
    v_pk_add_f32 v[20:21], v[18:19], v[110:111] op_sel:[0,1] op_sel_hi:[1,1]
    v_exp_f32 v0, v0
    v_pk_fma_f32 v[8:9], v[8:9], s[52:53], v[20:21]
    v_exp_f32 v1, v1
    v_exp_f32 v4, v4
    v_exp_f32 v5, v5
    v_cvt_pk_bf16_f32 v12, v0, v1
    v_cvt_pk_bf16_f32 v13, v4, v5
    v_exp_f32 v8, v8
    v_exp_f32 v9, v9
    v_mfma_f32_16x16x16_bf16 v[56:59], v[12:13], v[108:109], 0
    s_nop 0
    v_cvt_pk_bf16_f32 v14, v8, v9
    v_add_f32 v22, v0, v4
    v_add_f32_e64 v23, v1, v5
    v_mfma_f32_16x16x16_bf16 v[60:63], v[14:15], v[108:109], 0
    s_nop 0
    v_add_f32 v22, v22, v8
    v_add_f32_e64 v23, v23, v9
    v_cvt_pk_bf16_f32 v40, v56, v57
    v_add_f32_dpp v22, v22, v22 row_ror:8 row_mask:0xf bank_mask:0xf
    v_add_f32_dpp v23, v23, v23 row_ror:8 row_mask:0xf bank_mask:0xf
    v_cvt_pk_bf16_f32 v42, v58, v59
    v_add_f32_dpp v22, v22, v22 row_ror:4 row_mask:0xf bank_mask:0xf
    v_cvt_pk_bf16_f32 v41, v60, v61
    v_cvt_pk_bf16_f32 v43, v62, v63
    v_add_f32_dpp v23, v23, v23 row_ror:4 row_mask:0xf bank_mask:0xf
    v_add_f32_dpp v22, v22, v22 row_ror:2 row_mask:0xf bank_mask:0xf
    v_smfmac_f32_16x16x64_bf16 v[112:115], v[40:43], v[96:103], v110
    s_nop 0
    ds_read_b128 v[88:91], v120 offset:24576
    v_add_f32_dpp v23, v23, v23 row_ror:2 row_mask:0xf bank_mask:0xf
    v_smfmac_f32_16x16x64_bf16 v[116:119], v[40:43], v[102:109], v110
    s_nop 0
    ds_read_b128 v[92:95], v120 offset:25600
    v_add_f32_dpp v22, v22, v22 row_ror:1 row_mask:0xf bank_mask:0xf
    v_add_f32_dpp v23, v23, v23 row_ror:1 row_mask:0xf bank_mask:0xf
    v_rcp_f32 v22, v22
    v_rcp_f32 v23, v23
    v_pk_add_f32 v[112:113], v[112:113], v[114:115]
    v_pk_mul_f32 v[112:113], v[112:113], v[22:23]
    v_pk_add_f32 v[116:117], v[116:117], v[118:119]
    v_cvt_pk_bf16_f32 v130, v112, v113
    v_pk_mul_f32 v[116:117], v[116:117], v[22:23]
    v_cvt_pk_bf16_f32 v131, v116, v117
    ds_write2_b32 v123, v130, v131 offset0:0 offset1:4
    v_mov_b64 v[0:1], 0
    v_mov_b64 v[2:3], 0
    v_mov_b64 v[4:5], 0
    v_mov_b64 v[6:7], 0
    v_mov_b64 v[8:9], 0
    v_mov_b64 v[10:11], 0
    v_mov_b64 v[12:13], 0
    v_mov_b64 v[14:15], 0
    s_waitcnt lgkmcnt(0)
    s_barrier
    ds_read_b64_tr_b16 v[16:17], v124 offset:0
    ds_read_b64_tr_b16 v[18:19], v124 offset:80
    ds_read_b64_tr_b16 v[20:21], v124 offset:320
    ds_read_b64_tr_b16 v[22:23], v124 offset:400
    ds_read_b64_tr_b16 v[24:25], v124 offset:1280
    ds_read_b64_tr_b16 v[26:27], v124 offset:1360
    ds_read_b64_tr_b16 v[28:29], v124 offset:1600
    ds_read_b64_tr_b16 v[30:31], v124 offset:1680
    s_waitcnt lgkmcnt(6)
    v_smfmac_f32_16x16x64_bf16 v[0:3], v[16:19], v[64:71], v110 abid:1
    v_mov_b32 v134, v98
    v_smfmac_f32_16x16x64_bf16 v[4:7], v[16:19], v[72:79], v110 abid:1
    s_waitcnt lgkmcnt(4)
    ds_read_b128 v[64:67], v120 offset:26624
    v_smfmac_f32_16x16x64_bf16 v[0:3], v[20:23], v[80:87], v110 abid:1
    ds_read_b128 v[68:71], v120 offset:27648
    v_mov_b32 v135, v104
    v_smfmac_f32_16x16x64_bf16 v[4:7], v[20:23], v[88:95], v110 abid:1
    s_waitcnt lgkmcnt(4)
    ds_read_b128 v[72:75], v120 offset:28672
    v_smfmac_f32_16x16x64_bf16 v[0:3], v[24:27], v[192:199], v110 abid:1
    s_waitcnt lgkmcnt(3)
    ds_read_b128 v[76:79], v120 offset:29696
    v_smfmac_f32_16x16x64_bf16 v[0:3], v[28:31], v[200:207], v110 abid:1
    s_nop 0
    ds_read_b128 v[80:83], v120 offset:30720
    v_mov_b64 v[32:33], 0
    v_smfmac_f32_16x16x64_bf16 v[4:7], v[24:27], v[208:215], v110 abid:1
    s_nop 0
    ds_read_b128 v[84:87], v120 offset:31744
    v_mov_b64 v[34:35], 0
    v_smfmac_f32_16x16x64_bf16 v[4:7], v[28:31], v[216:223], v110 abid:1
    s_nop 0
    ds_read_b128 v[88:91], v120 offset:32768
    v_cvt_pk_bf16_f32 v56, v0, v1
    v_smfmac_f32_16x16x64_bf16 v[8:11], v[16:19], v[224:231], v110 abid:1
    s_waitcnt lgkmcnt(5)
    ds_read_b128 v[92:95], v120 offset:33792
    v_cvt_pk_bf16_f32 v57, v2, v3
    v_and_or_b32 v56, v56, -2, s35
    v_cvt_pk_bf16_f32 v58, v4, v5
    v_cvt_pk_bf16_f32 v59, v6, v7
    v_smfmac_f32_16x16x64_bf16 v[8:11], v[20:23], v[64:71], v110 abid:1
    global_store_dwordx4 v126, v[56:59], s[36:37]
    v_smfmac_f32_16x16x64_bf16 v[8:11], v[24:27], v[232:239], v110 abid:1
    s_waitcnt lgkmcnt(4)
    v_smfmac_f32_16x16x64_bf16 v[8:11], v[28:31], v[72:79], v110 abid:1
    s_nop 1
    v_mov_b64_e64 v[36:37], 0
    v_smfmac_f32_16x16x64_bf16 v[12:15], v[16:19], v[240:247], v110 abid:1
    s_waitcnt lgkmcnt(2)
    s_nop 0
    v_mov_b64_e64 v[38:39], 0
    v_smfmac_f32_16x16x64_bf16 v[12:15], v[20:23], v[80:87], v110 abid:1
    s_add_u32 s48, s48, 16384
    s_addc_u32 s49, s49, 0
    v_cvt_pk_bf16_f32 v60, v8, v9
    v_smfmac_f32_16x16x64_bf16 v[12:15], v[24:27], v[248:255], v110 abid:1
    s_waitcnt lgkmcnt(0)
    v_cvt_pk_bf16_f32 v61, v10, v11
    v_smfmac_f32_16x16x64_bf16 v[12:15], v[28:31], v[88:95], v110 abid:1
    s_cmp_ge_u32 s30, 2
    s_nop 0
    v_and_or_b32 v60, v60, -2, s35
    v_mov_b64 v[40:41], 0
    v_mov_b64 v[42:43], 0
    v_mov_b64 v[44:45], 0
    v_mov_b64 v[46:47], 0
    v_mov_b64_e64 v[48:49], 0
    v_cvt_pk_bf16_f32 v62, v12, v13
    v_cvt_pk_bf16_f32 v63, v14, v15
    global_store_dwordx4 v126, v[60:63], s[38:39]
    v_mov_b32 v130, 0x3f80
    v_cndmask_b32 v130, v130, 1.0, s[16:17]
    v_cndmask_b32 v112, 0, v130, s[8:9]
    v_cndmask_b32 v113, 0, v130, s[10:11]
    v_cndmask_b32 v114, 0, v130, s[12:13]
    v_cndmask_b32 v115, 0, v130, s[14:15]
    v_add_u32 v116, s4, v127
    v_add_u32 v117, s5, v127
    v_add_u32 v118, s6, v127
    v_add_u32 v119, s7, v127
    v_mov_b64 v[50:51], 0
    v_mov_b64 v[52:53], 0
    v_mov_b64 v[54:55], 0
    v_lshrrev_b32 v130, 2, v127
    v_add_u32 v131, 163072, v130
    s_add_u32 s20, s34, 3
    s_min_u32 s20, s20, 64
    ds_read_b32 v131, v131
    s_mov_b64 exec, 6
    s_waitcnt lgkmcnt(0)
    v_cmp_gt_u32 vcc, s20, v131
    s_cbranch_vccnz L_rlv2ef1
L_rlvbef1:
    s_mov_b64 exec, -1
    s_nop 7
    global_load_dwordx4 v[16:19], v127, s[40:41] sc1
    global_load_dwordx4 v[20:23], v127, s[40:41] offset:1024 sc1
    s_lshl_b32 s58, s30, 10
    s_add_u32 s56, s42, s58
    s_addc_u32 s57, s43, 0
    s_add_u32 s58, s56, 4096
    s_addc_u32 s59, s57, 0
    s_mov_b32 s54, 0
    s_add_u32 s34, s34, 1
    v_mov_b32_e64 v12, -1
    ds_read_b128 v[64:67], v120 offset:0
    ds_read_b128 v[68:71], v120 offset:1024
    ds_read_b128 v[72:75], v120 offset:2048
    ds_read_b128 v[76:79], v120 offset:3072
    ds_read_b128 v[80:83], v120 offset:4096
    ds_read_b128 v[84:87], v120 offset:5120
    ds_read_b128 v[88:91], v120 offset:6144
    ds_read_b128 v[92:95], v120 offset:7168
    ds_read_b128 v[96:99], v120 offset:16384
    ds_read_b128 v[100:103], v120 offset:17408
    s_waitcnt vmcnt(1)
    v_mfma_f32_16x16x32_bf16 v[8:11], v[112:115], v[16:19], 0
    v_xor_b32 v130, s35, v16
    s_waitcnt vmcnt(0)
    v_mfma_f32_16x16x32_bf16 v[8:11], v[112:115], v[20:23], v[8:11]
    s_nop 0
    v_bitop3_b32 v130, v130, s35, v20 bitop3:0xf6
    v_and_b32 v130, 1, v130
    v_cmp_ne_u32 vcc, 0, v130
    s_nop 3
    v_add_f32_dpp v8, v8, v8 row_ror:4 row_mask:0xf bank_mask:0xf
    v_add_f32_dpp v9, v9, v9 row_ror:4 row_mask:0xf bank_mask:0xf
    s_cbranch_vccnz L_rfef1
L_rokef1:
    v_add_f32_dpp v8, v8, v8 row_ror:8 row_mask:0xf bank_mask:0xf
    v_add_f32_dpp v9, v9, v9 row_ror:8 row_mask:0xf bank_mask:0xf
    v_cvt_pk_bf16_f32 v130, v8, v9
    s_mov_b64 exec, s[64:65]
    s_xor_b32 s35, s35, 1
    global_store_dword v129, v130, s[42:43]
    global_store_dword v129, v12, s[44:45]
    s_mov_b64 exec, -1
    ds_read_b128 v[8:11], v120 offset:8192
    ds_read_b128 v[12:15], v120 offset:9216
    ds_read_b128 v[16:19], v120 offset:10240
    ds_read_b128 v[20:23], v120 offset:11264
    ds_read_b128 v[24:27], v120 offset:12288
    ds_read_b128 v[28:31], v120 offset:13312
    ds_read_b128 v[56:59], v120 offset:14336
    ds_read_b128 v[60:63], v120 offset:15360
    s_barrier
    s_mov_b64 s[60:61], s[42:43]
    s_mov_b64 s[42:43], s[44:45]
    s_mov_b64 s[44:45], s[60:61]
    s_waitcnt lgkmcnt(0)
    s_nop 2
    s_cmp_lt_u32 s34, 63
    s_cbranch_scc1 L_rtmf1
    s_branch L_rtzf1
L_rfef1:
    global_load_dwordx4 v[16:19], v127, s[40:41] sc1
    global_load_dwordx4 v[20:23], v127, s[40:41] offset:1024 sc1
    s_waitcnt vmcnt(1)
    v_mfma_f32_16x16x32_bf16 v[8:11], v[112:115], v[16:19], 0
    v_xor_b32 v130, s35, v16
    s_waitcnt vmcnt(0)
    v_mfma_f32_16x16x32_bf16 v[8:11], v[112:115], v[20:23], v[8:11]
    s_nop 0
    v_bitop3_b32 v130, v130, s35, v20 bitop3:0xf6
    v_and_b32 v130, 1, v130
    v_cmp_ne_u32 vcc, 0, v130
    s_nop 0
    s_nop 2
    v_add_f32_dpp v8, v8, v8 row_ror:4 row_mask:0xf bank_mask:0xf
    v_add_f32_dpp v9, v9, v9 row_ror:4 row_mask:0xf bank_mask:0xf
    s_cbranch_vccz L_rokef1
    s_add_u32 s54, s54, 1
    s_cmp_gt_u32 s54, 400000
    s_cbranch_scc1 L_rdonef1
    s_branch L_rfef1
L_rlatef1:
L_rlv2ef1:
    global_load_dword v131, v130, s[68:69] offset:256 sc1
    s_add_u32 s54, s54, 1
    s_cmp_gt_u32 s54, 400000
    s_cbranch_scc1 L_rdonef1
    s_waitcnt vmcnt(0)
    v_cmp_gt_u32_e64 vcc, s20, v131
    s_cbranch_vccnz L_rlv2ef1
    s_branch L_rlvbef1
L_rqzf1:
    global_load_dwordx4 v[0:3], v127, s[56:57] sc1
    global_load_dwordx4 v[4:7], v127, s[58:59] sc1
    s_add_u32 s54, s54, 1
    s_cmp_gt_u32 s54, 400000
    s_cbranch_scc1 L_rdonef1
    s_branch L_rpzf1
L_rtzf1:
    global_load_dwordx4 v[0:3], v127, s[56:57] sc1
    global_load_dwordx4 v[4:7], v127, s[58:59] sc1
    s_nop 15
    s_nop 13
    global_load_dwordx4 v[0:3], v127, s[56:57] sc1
    global_load_dwordx4 v[4:7], v127, s[58:59] sc1
    s_waitcnt lgkmcnt(0)
L_rpzf1:
    s_waitcnt vmcnt(3)
    v_max3_u32 v130, v0, v1, v2
    v_max_u32 v130, v130, v3
    s_waitcnt vmcnt(2)
    v_max3_u32 v130, v130, v4, v5
    v_max3_u32 v130, v130, v6, v7
    v_cmp_eq_u32 vcc, -1, v130
    ds_write_b128 v116, v[0:3]
    s_cbranch_vccnz L_rqzf1
    v_smfmac_f32_16x16x64_bf16 v[40:43], v[0:3], v[24:31], v110
    ds_write_b128 v116, v[4:7] offset:4096
    v_smfmac_f32_16x16x64_bf16 v[44:47], v[0:3], v[96:103], v110
    v_smfmac_f32_16x16x64_bf16 v[48:51], v[0:3], v[64:71], v110
    v_smfmac_f32_16x16x64_bf16 v[52:55], v[0:3], v[72:79], v110
    v_smfmac_f32_16x16x64_bf16 v[40:43], v[4:7], v[56:63], v110
    v_smfmac_f32_16x16x64_bf16 v[44:47], v[4:7], a[0:7], v110
    v_smfmac_f32_16x16x64_bf16 v[48:51], v[4:7], a[8:15], v110
    v_smfmac_f32_16x16x64_bf16 v[52:55], v[4:7], a[16:23], v110
    s_waitcnt lgkmcnt(0)
    s_barrier
    ds_read_b128 v[8:11], v117 offset:0
    ds_read_b128 v[12:15], v118 offset:0
    ds_read_b128 v[16:19], v119 offset:0
    ds_read_b128 v[20:23], v117 offset:4096
    ds_read_b128 v[24:27], v118 offset:4096
    ds_read_b128 v[28:31], v119 offset:4096
    global_store_dwordx4 v127, v[132:135], s[46:47] sc1
    s_add_u32 s46, s46, 4096
    s_addc_u32 s47, s47, 0
    s_waitcnt lgkmcnt(5)
    v_smfmac_f32_16x16x64_bf16 v[40:43], v[8:11], a[120:127], v110
    s_waitcnt lgkmcnt(4)
    v_smfmac_f32_16x16x64_bf16 v[40:43], v[12:15], a[128:135], v110
    s_waitcnt lgkmcnt(3)
    v_smfmac_f32_16x16x64_bf16 v[40:43], v[16:19], a[136:143], v110
    s_waitcnt lgkmcnt(2)
    v_smfmac_f32_16x16x64_bf16 v[40:43], v[20:23], a[144:151], v110
    s_waitcnt lgkmcnt(1)
    v_smfmac_f32_16x16x64_bf16 v[40:43], v[24:27], a[152:159], v110
    s_waitcnt lgkmcnt(0)
    v_smfmac_f32_16x16x64_bf16 v[40:43], v[28:31], a[160:167], v110
    v_smfmac_f32_16x16x64_bf16 v[44:47], v[8:11], a[168:175], v110
    v_smfmac_f32_16x16x64_bf16 v[44:47], v[12:15], a[176:183], v110
    v_smfmac_f32_16x16x64_bf16 v[44:47], v[16:19], a[184:191], v110
    v_smfmac_f32_16x16x64_bf16 v[44:47], v[20:23], a[192:199], v110
    v_smfmac_f32_16x16x64_bf16 v[44:47], v[24:27], a[200:207], v110
    v_smfmac_f32_16x16x64_bf16 v[44:47], v[28:31], a[208:215], v110
    v_smfmac_f32_16x16x64_bf16 v[48:51], v[8:11], a[216:223], v110
    v_smfmac_f32_16x16x64_bf16 v[52:55], v[8:11], a[224:231], v110
    v_smfmac_f32_16x16x64_bf16 v[48:51], v[12:15], a[232:239], v110
    v_smfmac_f32_16x16x64_bf16 v[52:55], v[12:15], a[240:247], v110
    v_smfmac_f32_16x16x64_bf16 v[48:51], v[16:19], a[248:255], v110
    v_smfmac_f32_16x16x64_bf16 v[52:55], v[16:19], v[136:143], v110
    v_smfmac_f32_16x16x64_bf16 v[48:51], v[20:23], v[144:151], v110
    v_smfmac_f32_16x16x64_bf16 v[52:55], v[20:23], v[152:159], v110
    v_smfmac_f32_16x16x64_bf16 v[48:51], v[24:27], v[160:167], v110
    v_smfmac_f32_16x16x64_bf16 v[52:55], v[24:27], v[168:175], v110
    v_smfmac_f32_16x16x64_bf16 v[48:51], v[28:31], v[176:183], v110
    v_smfmac_f32_16x16x64_bf16 v[52:55], v[28:31], v[184:191], v110
    v_pk_add_f32 v[40:41], v[40:41], v[42:43]
    v_pk_add_f32 v[44:45], v[44:45], v[46:47]
    s_nop 4
    v_pk_add_f32 v[48:49], v[48:49], v[50:51]
    v_pk_add_f32 v[52:53], v[52:53], v[54:55]
    v_cvt_pk_bf16_f32 v132, v40, v41
    v_cvt_pk_bf16_f32 v133, v44, v45
    v_cvt_pk_bf16_f32 v134, v48, v49
    v_cvt_pk_bf16_f32 v135, v52, v53
    global_store_dwordx4 v127, v[132:135], s[46:47] sc1
L_rdonef1:
    s_branch L_rend
L_rwvf2:
    s_mov_b64 s[56:57], s[42:43]
    s_mov_b64 s[58:59], s[42:43]
    s_mov_b32 s54, 0
    s_getpc_b64 s[18:19]
L_rzcf2:
    s_add_u32 s18, s18, L_rqzf2-L_rzcf2
    s_addc_u32 s19, s19, 0
    s_add_u32 s66, s50, 16384
    s_addc_u32 s67, s51, 0
    s_branch L_rpmf2
.p2align 6
    s_nop 0
    s_nop 0
    s_nop 0
L_rqmf2:
    global_load_dwordx4 v[0:3], v127, s[56:57] sc1
    global_load_dwordx4 v[4:7], v127, s[58:59] sc1
    s_add_u32 s54, s54, 1
    s_cmp_gt_u32 s54, 400000
    s_cbranch_scc1 L_rdonef2
    s_branch L_rpmf2
L_rtmf2:
    global_load_dwordx4 v[0:3], v127, s[56:57] sc1
    global_load_dwordx4 v[4:7], v127, s[58:59] sc1
    s_nop 15
    s_nop 0
    s_nop 12
    global_load_dwordx4 v[0:3], v127, s[56:57] sc1
    global_load_dwordx4 v[4:7], v127, s[58:59] sc1
    s_waitcnt vmcnt(6)
    ds_read_b128 v[8:11], v120 offset:8192
    ds_read_b128 v[12:15], v120 offset:9216
    ds_read_b128 v[16:19], v120 offset:10240
    ds_read_b128 v[20:23], v120 offset:11264
    ds_read_b128 v[24:27], v120 offset:12288
    ds_read_b128 v[28:31], v120 offset:13312
    ds_read_b128 v[56:59], v120 offset:14336
    ds_read_b128 v[60:63], v120 offset:15360
    s_waitcnt lgkmcnt(0)
L_rpmf2:
    s_waitcnt vmcnt(3)
    v_max3_u32 v130, v0, v1, v2
    v_max_u32 v130, v130, v3
    s_waitcnt vmcnt(2)
    v_max3_u32 v130, v130, v4, v5
    v_max3_u32 v130, v130, v6, v7
    v_cmp_eq_u32 vcc, -1, v130
    ds_write_b128 v116, v[0:3]
    s_cbranch_vccnz L_rqmf2
    v_smfmac_f32_16x16x64_bf16 v[32:35], v[0:3], v[8:15], v110
    ds_write_b128 v116, v[4:7] offset:4096
    v_smfmac_f32_16x16x64_bf16 v[36:39], v[0:3], v[16:23], v110
    v_smfmac_f32_16x16x64_bf16 v[40:43], v[0:3], v[24:31], v110
    v_bfe_u32 v131, v127, 2, 5
    v_smfmac_f32_16x16x64_bf16 v[44:47], v[0:3], v[96:103], v110
    s_mov_b32 m0, 162816
    v_smfmac_f32_16x16x64_bf16 v[48:51], v[0:3], v[64:71], v110
    global_load_dwordx4 v[96:99], v128, s[50:51] sc1
    global_load_dwordx4 v[102:105], v128, s[50:51] offset:256 sc1
    v_smfmac_f32_16x16x64_bf16 v[52:55], v[0:3], v[72:79], v110
    s_waitcnt lgkmcnt(0)
    s_barrier
    ds_read_b128 v[8:11], v117 offset:0
    v_smfmac_f32_16x16x64_bf16 v[32:35], v[4:7], v[80:87], v110
    ds_read_b128 v[12:15], v118 offset:0
    global_load_lds_dword v131, s[68:69] offset:256 sc1
    v_smfmac_f32_16x16x64_bf16 v[36:39], v[4:7], v[88:95], v110
    ds_read_b128 v[16:19], v119 offset:0
    v_smfmac_f32_16x16x64_bf16 v[40:43], v[4:7], v[56:63], v110
    ds_read_b128 v[20:23], v117 offset:4096
    v_smfmac_f32_16x16x64_bf16 v[44:47], v[4:7], a[0:7], v110
    ds_read_b128 v[24:27], v118 offset:4096
    v_smfmac_f32_16x16x64_bf16 v[48:51], v[4:7], a[8:15], v110
    ds_read_b128 v[28:31], v119 offset:4096
    v_smfmac_f32_16x16x64_bf16 v[52:55], v[4:7], a[16:23], v110
    s_waitcnt lgkmcnt(5)
    v_smfmac_f32_16x16x64_bf16 v[32:35], v[8:11], a[24:31], v110
    s_waitcnt vmcnt(3)
    ds_read_b128 v[64:67], v125 offset:0
    v_mov_b64_e64 v[0:1], 0
    v_smfmac_f32_16x16x64_bf16 v[36:39], v[8:11], a[32:39], v110
    s_waitcnt lgkmcnt(5)
    v_mov_b64 v[112:113], 0
    v_smfmac_f32_16x16x64_bf16 v[32:35], v[12:15], a[40:47], v110
    ds_read_b128 v[68:71], v125 offset:1024
    v_mov_b64 v[2:3], 0
    v_smfmac_f32_16x16x64_bf16 v[36:39], v[12:15], a[48:55], v110
    s_waitcnt lgkmcnt(5)
    v_mov_b64_e64 v[114:115], 0
    v_smfmac_f32_16x16x64_bf16 v[32:35], v[16:19], a[56:63], v110
    ds_read_b128 v[72:75], v125 offset:4096
    v_mov_b64 v[4:5], 0
    v_smfmac_f32_16x16x64_bf16 v[36:39], v[16:19], a[64:71], v110
    s_waitcnt lgkmcnt(5)
    v_mov_b64_e64 v[116:117], 0
    v_smfmac_f32_16x16x64_bf16 v[32:35], v[20:23], a[72:79], v110
    ds_read_b128 v[76:79], v125 offset:5120
    v_mov_b64 v[6:7], 0
    v_smfmac_f32_16x16x64_bf16 v[36:39], v[20:23], a[80:87], v110
    s_waitcnt lgkmcnt(5)
    global_store_dwordx4 v127, v[132:135], s[46:47] sc1
    v_smfmac_f32_16x16x64_bf16 v[32:35], v[24:27], a[88:95], v110
    ds_read_b128 v[80:83], v125 offset:256
    v_mov_b64_e64 v[118:119], 0
    v_smfmac_f32_16x16x64_bf16 v[36:39], v[24:27], a[96:103], v110
    s_waitcnt lgkmcnt(5)
    v_smfmac_f32_16x16x64_bf16 v[32:35], v[28:31], a[104:111], v110
    s_nop 0
    ds_read_b128 v[84:87], v125 offset:1280
    v_smfmac_f32_16x16x64_bf16 v[36:39], v[28:31], a[112:119], v110
    s_nop 2
    v_smfmac_f32_16x16x64_bf16 v[40:43], v[8:11], a[120:127], v110
    s_nop 0
    ds_read_b128 v[88:91], v125 offset:4352
    v_add_f32 v32, v32, v34
    v_smfmac_f32_16x16x64_bf16 v[40:43], v[12:15], a[128:135], v110
    v_add_f32 v33, v33, v35
    v_smfmac_f32_16x16x64_bf16 v[40:43], v[16:19], a[136:143], v110
    ds_read_b128 v[92:95], v125 offset:5376
    v_add_f32 v36, v36, v38
    v_smfmac_f32_16x16x64_bf16 v[40:43], v[20:23], a[144:151], v110
    v_add_f32 v37, v37, v39
    v_smfmac_f32_16x16x64_bf16 v[40:43], v[24:27], a[152:159], v110
    v_cvt_pk_bf16_f32 v56, v32, v33
    v_smfmac_f32_16x16x64_bf16 v[40:43], v[28:31], a[160:167], v110
    s_nop 1
    v_cvt_pk_bf16_f32 v57, v36, v37
    v_smfmac_f32_16x16x64_bf16 v[44:47], v[8:11], a[168:175], v110
    s_nop 0
    ds_write_b32 v121, v56
    v_smfmac_f32_16x16x64_bf16 v[44:47], v[12:15], a[176:183], v110
    ds_write_b32 v121, v57 offset:4
    v_smfmac_f32_16x16x64_bf16 v[44:47], v[16:19], a[184:191], v110
    v_add_f32 v40, v40, v42
    v_smfmac_f32_16x16x64_bf16 v[44:47], v[20:23], a[192:199], v110
    s_add_u32 s50, s50, 16384
    s_addc_u32 s51, s51, 0
    v_add_f32_e64 v41, v41, v43
    v_smfmac_f32_16x16x64_bf16 v[44:47], v[24:27], a[200:207], v110
    s_add_u32 s46, s46, 4096
    s_addc_u32 s47, s47, 0
    v_cvt_pk_bf16_f32 v132, v40, v41
    v_smfmac_f32_16x16x64_bf16 v[44:47], v[28:31], a[208:215], v110
    s_waitcnt lgkmcnt(0)
    s_barrier
    ds_read_b64_tr_b16 v[56:57], v122 offset:0
    v_smfmac_f32_16x16x64_bf16 v[48:51], v[8:11], a[216:223], v110
    s_nop 0
    ds_read_b64_tr_b16 v[58:59], v122 offset:512
    ds_write_b32 v123, v132 offset:2560
    v_smfmac_f32_16x16x64_bf16 v[52:55], v[8:11], a[224:231], v110
    ds_read_b64_tr_b16 v[60:61], v122 offset:1024
    v_add_f32 v44, v44, v46
    v_smfmac_f32_16x16x64_bf16 v[48:51], v[12:15], a[232:239], v110
    s_mov_b32 m0, s62
    ds_read_b64_tr_b16 v[62:63], v122 offset:1536
    v_add_f32_e64 v45, v45, v47
    v_smfmac_f32_16x16x64_bf16 v[52:55], v[12:15], a[240:247], v110
    global_load_lds_dwordx4 v127, s[48:49] sc1
    v_cvt_pk_bf16_f32 v133, v44, v45
    v_smfmac_f32_16x16x64_bf16 v[48:51], v[16:19], a[248:255], v110
    ds_write_b32 v123, v133 offset:2576
    v_smfmac_f32_16x16x64_bf16 v[52:55], v[16:19], v[136:143], v110
    s_waitcnt lgkmcnt(4)
    global_load_lds_dwordx4 v127, s[48:49] offset:1024 sc1
    v_mov_b64 v[8:9], 0
    v_smfmac_f32_16x16x64_bf16 v[0:3], v[56:59], v[64:71], v110
    s_waitcnt lgkmcnt(1)
    ds_read_b128 v[64:67], v120 offset:18432
    v_mov_b64 v[10:11], 0
    v_smfmac_f32_16x16x64_bf16 v[0:3], v[60:63], v[72:79], v110
    s_waitcnt vmcnt(4)
    ds_read_b128 v[68:71], v120 offset:19456
    v_mov_b64 v[100:101], v[98:99]
    v_smfmac_f32_16x16x64_bf16 v[4:7], v[56:59], v[80:87], v110
    s_waitcnt lgkmcnt(2)
    s_barrier
    ds_read_b64_tr_b16 v[32:33], v124 offset:2560
    v_smfmac_f32_16x16x64_bf16 v[4:7], v[60:63], v[88:95], v110
    ds_read_b64_tr_b16 v[34:35], v124 offset:2640
    ds_read_b64_tr_b16 v[36:37], v124 offset:2880
    v_smfmac_f32_16x16x64_bf16 v[48:51], v[20:23], v[144:151], v110
    ds_read_b64_tr_b16 v[38:39], v124 offset:2960
    v_add_f32_e64 v0, v0, v2
    v_smfmac_f32_16x16x64_bf16 v[52:55], v[20:23], v[152:159], v110
    ds_read_b64_tr_b16 v[40:41], v124 offset:3840
    ds_read_b64_tr_b16 v[42:43], v124 offset:3920
    v_smfmac_f32_16x16x64_bf16 v[48:51], v[24:27], v[160:167], v110
    ds_read_b64_tr_b16 v[44:45], v124 offset:4160
    ds_read_b64_tr_b16 v[46:47], v124 offset:4240
    v_smfmac_f32_16x16x64_bf16 v[52:55], v[24:27], v[168:175], v110
    ds_read_b128 v[72:75], v120 offset:20480
    v_add_f32_e64 v1, v1, v3
    v_smfmac_f32_16x16x64_bf16 v[48:51], v[28:31], v[176:183], v110
    ds_read_b128 v[76:79], v120 offset:21504
    v_add_f32 v4, v4, v6
    v_smfmac_f32_16x16x64_bf16 v[52:55], v[28:31], v[184:191], v110
    s_waitcnt lgkmcnt(6)
    ds_read_b128 v[80:83], v120 offset:22528
    v_add_f32 v5, v5, v7
    v_smfmac_f32_16x16x64_bf16 v[8:11], v[56:59], v[32:39], v110
    s_waitcnt lgkmcnt(3)
    ds_read_b128 v[84:87], v120 offset:23552
    v_max_f32 v16, v0, v4
    v_smfmac_f32_16x16x64_bf16 v[8:11], v[60:63], v[40:47], v110
    s_nop 1
    v_max_f32 v17, v1, v5
    v_mov_b64 v[106:107], v[104:105]
    v_max_f32_dpp v16, v16, v16 row_ror:8 row_mask:0xf bank_mask:0xf
    v_max_f32_dpp v17, v17, v17 row_ror:8 row_mask:0xf bank_mask:0xf
    v_mov_b32 v15, 0
    v_pk_add_f32 v[48:49], v[48:49], v[50:51]
    v_pk_add_f32 v[8:9], v[8:9], v[10:11]
    v_max_f32 v16, v16, v8
    v_max_f32_e64 v17, v17, v9
    v_pk_add_f32 v[52:53], v[52:53], v[54:55]
    v_max_f32_dpp v16, v16, v16 row_ror:4 row_mask:0xf bank_mask:0xf
    v_max_f32_dpp v17, v17, v17 row_ror:4 row_mask:0xf bank_mask:0xf
    v_cvt_pk_bf16_f32 v98, v48, v49
    v_max_f32_dpp v16, v16, v16 row_ror:2 row_mask:0xf bank_mask:0xf
    v_max_f32_dpp v17, v17, v17 row_ror:2 row_mask:0xf bank_mask:0xf
    v_cvt_pk_bf16_f32 v104, v52, v53
    v_max_f32_dpp v16, v16, v16 row_ror:1 row_mask:0xf bank_mask:0xf
    v_max_f32_dpp v17, v17, v17 row_ror:1 row_mask:0xf bank_mask:0xf
    v_pk_mul_f32 v[18:19], v[16:17], s[52:53] neg_lo:[1,0] neg_hi:[1,0]
    v_pk_fma_f32 v[0:1], v[0:1], s[52:53], v[18:19]
    v_pk_fma_f32 v[4:5], v[4:5], s[52:53], v[18:19]
    v_pk_add_f32 v[20:21], v[18:19], v[110:111] op_sel:[0,1] op_sel_hi:[1,1]
    v_exp_f32 v0, v0
    v_pk_fma_f32 v[8:9], v[8:9], s[52:53], v[20:21]
    v_exp_f32 v1, v1
    v_exp_f32 v4, v4
    v_exp_f32 v5, v5
    v_cvt_pk_bf16_f32 v12, v0, v1
    v_cvt_pk_bf16_f32 v13, v4, v5
    v_exp_f32 v8, v8
    v_exp_f32 v9, v9
    v_mfma_f32_16x16x16_bf16 v[56:59], v[12:13], v[108:109], 0
    s_nop 0
    v_cvt_pk_bf16_f32 v14, v8, v9
    v_add_f32 v22, v0, v4
    v_add_f32_e64 v23, v1, v5
    v_mfma_f32_16x16x16_bf16 v[60:63], v[14:15], v[108:109], 0
    s_nop 0
    v_add_f32 v22, v22, v8
    v_add_f32_e64 v23, v23, v9
    v_cvt_pk_bf16_f32 v40, v56, v57
    v_add_f32_dpp v22, v22, v22 row_ror:8 row_mask:0xf bank_mask:0xf
    v_add_f32_dpp v23, v23, v23 row_ror:8 row_mask:0xf bank_mask:0xf
    v_cvt_pk_bf16_f32 v42, v58, v59
    v_add_f32_dpp v22, v22, v22 row_ror:4 row_mask:0xf bank_mask:0xf
    v_cvt_pk_bf16_f32 v41, v60, v61
    v_cvt_pk_bf16_f32 v43, v62, v63
    v_add_f32_dpp v23, v23, v23 row_ror:4 row_mask:0xf bank_mask:0xf
    v_add_f32_dpp v22, v22, v22 row_ror:2 row_mask:0xf bank_mask:0xf
    v_smfmac_f32_16x16x64_bf16 v[112:115], v[40:43], v[96:103], v110
    s_nop 0
    ds_read_b128 v[88:91], v120 offset:24576
    v_add_f32_dpp v23, v23, v23 row_ror:2 row_mask:0xf bank_mask:0xf
    v_smfmac_f32_16x16x64_bf16 v[116:119], v[40:43], v[102:109], v110
    s_nop 0
    ds_read_b128 v[92:95], v120 offset:25600
    v_add_f32_dpp v22, v22, v22 row_ror:1 row_mask:0xf bank_mask:0xf
    v_add_f32_dpp v23, v23, v23 row_ror:1 row_mask:0xf bank_mask:0xf
    v_rcp_f32 v22, v22
    v_rcp_f32 v23, v23
    v_pk_add_f32 v[112:113], v[112:113], v[114:115]
    v_pk_mul_f32 v[112:113], v[112:113], v[22:23]
    v_pk_add_f32 v[116:117], v[116:117], v[118:119]
    v_cvt_pk_bf16_f32 v130, v112, v113
    v_pk_mul_f32 v[116:117], v[116:117], v[22:23]
    v_cvt_pk_bf16_f32 v131, v116, v117
    ds_write2_b32 v123, v130, v131 offset0:0 offset1:4
    v_mov_b64 v[0:1], 0
    v_mov_b64 v[2:3], 0
    v_mov_b64 v[4:5], 0
    v_mov_b64 v[6:7], 0
    v_mov_b64 v[8:9], 0
    v_mov_b64 v[10:11], 0
    v_mov_b64 v[12:13], 0
    v_mov_b64 v[14:15], 0
    s_waitcnt lgkmcnt(0)
    s_barrier
    ds_read_b64_tr_b16 v[16:17], v124 offset:0
    ds_read_b64_tr_b16 v[18:19], v124 offset:80
    ds_read_b64_tr_b16 v[20:21], v124 offset:320
    ds_read_b64_tr_b16 v[22:23], v124 offset:400
    ds_read_b64_tr_b16 v[24:25], v124 offset:1280
    ds_read_b64_tr_b16 v[26:27], v124 offset:1360
    ds_read_b64_tr_b16 v[28:29], v124 offset:1600
    ds_read_b64_tr_b16 v[30:31], v124 offset:1680
    s_waitcnt lgkmcnt(6)
    v_smfmac_f32_16x16x64_bf16 v[0:3], v[16:19], v[64:71], v110 abid:1
    v_mov_b32 v134, v98
    v_smfmac_f32_16x16x64_bf16 v[4:7], v[16:19], v[72:79], v110 abid:1
    s_waitcnt lgkmcnt(4)
    ds_read_b128 v[64:67], v120 offset:26624
    v_smfmac_f32_16x16x64_bf16 v[0:3], v[20:23], v[80:87], v110 abid:1
    ds_read_b128 v[68:71], v120 offset:27648
    v_mov_b32 v135, v104
    v_smfmac_f32_16x16x64_bf16 v[4:7], v[20:23], v[88:95], v110 abid:1
    s_waitcnt lgkmcnt(4)
    ds_read_b128 v[72:75], v120 offset:28672
    v_smfmac_f32_16x16x64_bf16 v[0:3], v[24:27], v[192:199], v110 abid:1
    s_waitcnt lgkmcnt(3)
    ds_read_b128 v[76:79], v120 offset:29696
    v_smfmac_f32_16x16x64_bf16 v[0:3], v[28:31], v[200:207], v110 abid:1
    s_nop 0
    ds_read_b128 v[80:83], v120 offset:30720
    v_mov_b64 v[32:33], 0
    v_smfmac_f32_16x16x64_bf16 v[4:7], v[24:27], v[208:215], v110 abid:1
    s_nop 0
    ds_read_b128 v[84:87], v120 offset:31744
    v_mov_b64 v[34:35], 0
    v_smfmac_f32_16x16x64_bf16 v[4:7], v[28:31], v[216:223], v110 abid:1
    s_nop 0
    ds_read_b128 v[88:91], v120 offset:32768
    v_cvt_pk_bf16_f32 v56, v0, v1
    v_smfmac_f32_16x16x64_bf16 v[8:11], v[16:19], v[224:231], v110 abid:1
    s_waitcnt lgkmcnt(5)
    ds_read_b128 v[92:95], v120 offset:33792
    v_cvt_pk_bf16_f32 v57, v2, v3
    v_and_or_b32 v56, v56, -2, s35
    v_cvt_pk_bf16_f32 v58, v4, v5
    v_cvt_pk_bf16_f32 v59, v6, v7
    v_smfmac_f32_16x16x64_bf16 v[8:11], v[20:23], v[64:71], v110 abid:1
    global_store_dwordx4 v126, v[56:59], s[36:37]
    v_smfmac_f32_16x16x64_bf16 v[8:11], v[24:27], v[232:239], v110 abid:1
    s_waitcnt lgkmcnt(4)
    v_smfmac_f32_16x16x64_bf16 v[8:11], v[28:31], v[72:79], v110 abid:1
    s_nop 1
    v_mov_b64_e64 v[36:37], 0
    v_smfmac_f32_16x16x64_bf16 v[12:15], v[16:19], v[240:247], v110 abid:1
    s_waitcnt lgkmcnt(2)
    s_nop 0
    v_mov_b64_e64 v[38:39], 0
    v_smfmac_f32_16x16x64_bf16 v[12:15], v[20:23], v[80:87], v110 abid:1
    s_add_u32 s48, s48, 16384
    s_addc_u32 s49, s49, 0
    v_cvt_pk_bf16_f32 v60, v8, v9
    v_smfmac_f32_16x16x64_bf16 v[12:15], v[24:27], v[248:255], v110 abid:1
    s_waitcnt lgkmcnt(0)
    v_cvt_pk_bf16_f32 v61, v10, v11
    v_smfmac_f32_16x16x64_bf16 v[12:15], v[28:31], v[88:95], v110 abid:1
    s_cmp_ge_u32 s30, 2
    s_nop 0
    v_and_or_b32 v60, v60, -2, s35
    v_mov_b64 v[40:41], 0
    v_mov_b64 v[42:43], 0
    v_mov_b64 v[44:45], 0
    v_mov_b64 v[46:47], 0
    v_mov_b64_e64 v[48:49], 0
    v_cvt_pk_bf16_f32 v62, v12, v13
    v_cvt_pk_bf16_f32 v63, v14, v15
    global_store_dwordx4 v126, v[60:63], s[38:39]
L_rlatef2:
    v_mov_b32 v130, 0x3f80
    v_cndmask_b32 v130, v130, 1.0, s[16:17]
    v_cndmask_b32 v112, 0, v130, s[8:9]
    v_cndmask_b32 v113, 0, v130, s[10:11]
    v_cndmask_b32 v114, 0, v130, s[12:13]
    v_cndmask_b32 v115, 0, v130, s[14:15]
    v_add_u32 v116, s4, v127
    v_add_u32 v117, s5, v127
    v_add_u32 v118, s6, v127
    v_add_u32 v119, s7, v127
    v_mov_b64 v[50:51], 0
    v_mov_b64 v[52:53], 0
    v_mov_b64 v[54:55], 0
    v_lshrrev_b32 v130, 2, v127
    v_add_u32 v131, 163072, v130
    s_add_u32 s20, s34, 3
    s_min_u32 s20, s20, 64
    ds_read_b32 v131, v131
    s_mov_b64 exec, 6
    s_waitcnt lgkmcnt(0)
    v_cmp_gt_u32 vcc, s20, v131
    s_cbranch_vccnz L_rlv2lf2
L_rlvblf2:
    s_mov_b64 exec, -1
    s_nop 15
    s_nop 15
    s_nop 1
    global_load_dwordx4 v[16:19], v127, s[40:41] sc1
    global_load_dwordx4 v[20:23], v127, s[40:41] offset:1024 sc1
    s_lshl_b32 s58, s30, 10
    s_add_u32 s56, s42, s58
    s_addc_u32 s57, s43, 0
    s_add_u32 s58, s56, 4096
    s_addc_u32 s59, s57, 0
    s_mov_b32 s54, 0
    s_add_u32 s34, s34, 1
    v_mov_b32 v12, -1
    s_nop 15
    global_load_dwordx4 v[24:27], v127, s[40:41] sc1
    global_load_dwordx4 v[28:31], v127, s[40:41] offset:1024 sc1
    ds_read_b128 v[64:67], v120 offset:0
    ds_read_b128 v[68:71], v120 offset:1024
    ds_read_b128 v[72:75], v120 offset:2048
    ds_read_b128 v[76:79], v120 offset:3072
    ds_read_b128 v[80:83], v120 offset:4096
    ds_read_b128 v[84:87], v120 offset:5120
    ds_read_b128 v[88:91], v120 offset:6144
    ds_read_b128 v[92:95], v120 offset:7168
    ds_read_b128 v[96:99], v120 offset:16384
    ds_read_b128 v[100:103], v120 offset:17408
    s_waitcnt vmcnt(3)
    v_mfma_f32_16x16x32_bf16 v[8:11], v[112:115], v[16:19], 0
    v_xor_b32_e64 v130, s35, v16
    s_waitcnt vmcnt(2)
    v_mfma_f32_16x16x32_bf16 v[8:11], v[112:115], v[20:23], v[8:11]
    s_nop 0
    v_bitop3_b32 v130, v130, s35, v20 bitop3:0xf6
    v_and_b32 v130, 1, v130
    v_cmp_ne_u32 vcc, 0, v130
    s_nop 0
    s_nop 2
    v_add_f32_dpp v8, v8, v8 row_ror:4 row_mask:0xf bank_mask:0xf
    v_add_f32_dpp v9, v9, v9 row_ror:4 row_mask:0xf bank_mask:0xf
    s_cbranch_vccnz L_rflf2
L_roklf2:
    v_add_f32_dpp v8, v8, v8 row_ror:8 row_mask:0xf bank_mask:0xf
    v_add_f32_dpp v9, v9, v9 row_ror:8 row_mask:0xf bank_mask:0xf
    v_cvt_pk_bf16_f32 v130, v8, v9
    s_mov_b64 exec, s[64:65]
    s_xor_b32 s35, s35, 1
    global_store_dword v129, v130, s[42:43]
    global_store_dword v129, v12, s[44:45]
    s_mov_b64 exec, -1
    s_barrier
    s_mov_b64 s[60:61], s[42:43]
    s_mov_b64 s[42:43], s[44:45]
    s_mov_b64 s[44:45], s[60:61]
    s_waitcnt lgkmcnt(0)
    s_nop 2
    s_cmp_lt_u32 s34, 63
    s_cbranch_scc1 L_rtmf2
    s_branch L_rtzf2
L_rflf2:
    global_load_dwordx4 v[16:19], v127, s[40:41] sc1
    global_load_dwordx4 v[20:23], v127, s[40:41] offset:1024 sc1
    s_waitcnt vmcnt(3)
    v_mfma_f32_16x16x32_bf16 v[8:11], v[112:115], v[24:27], 0
    v_xor_b32 v130, s35, v24
    s_waitcnt vmcnt(2)
    v_mfma_f32_16x16x32_bf16 v[8:11], v[112:115], v[28:31], v[8:11]
    s_nop 0
    v_bitop3_b32 v130, v130, s35, v28 bitop3:0xf6
    v_and_b32 v130, 1, v130
    v_cmp_ne_u32 vcc, 0, v130
    s_nop 0
    s_nop 2
    v_add_f32_dpp v8, v8, v8 row_ror:4 row_mask:0xf bank_mask:0xf
    v_add_f32_dpp v9, v9, v9 row_ror:4 row_mask:0xf bank_mask:0xf
    s_cbranch_vccz L_roklf2
    global_load_dwordx4 v[24:27], v127, s[40:41] sc1
    global_load_dwordx4 v[28:31], v127, s[40:41] offset:1024 sc1
    s_waitcnt vmcnt(3)
    v_mfma_f32_16x16x32_bf16 v[8:11], v[112:115], v[16:19], 0
    v_xor_b32_e64 v130, s35, v16
    s_waitcnt vmcnt(2)
    v_mfma_f32_16x16x32_bf16 v[8:11], v[112:115], v[20:23], v[8:11]
    s_nop 0
    v_bitop3_b32 v130, v130, s35, v20 bitop3:0xf6
    v_and_b32 v130, 1, v130
    v_cmp_ne_u32 vcc, 0, v130
    s_nop 0
    s_nop 2
    v_add_f32_dpp v8, v8, v8 row_ror:4 row_mask:0xf bank_mask:0xf
    v_add_f32_dpp v9, v9, v9 row_ror:4 row_mask:0xf bank_mask:0xf
    s_cbranch_vccz L_roklf2
    s_add_u32 s54, s54, 1
    s_cmp_gt_u32 s54, 400000
    s_cbranch_scc1 L_rdonef2
    s_branch L_rflf2
L_rlv2lf2:
    global_load_dword v131, v130, s[68:69] offset:256 sc1
    s_add_u32 s54, s54, 1
    s_cmp_gt_u32 s54, 400000
    s_cbranch_scc1 L_rdonef2
    s_waitcnt vmcnt(0)
    v_cmp_gt_u32_e64 vcc, s20, v131
    s_cbranch_vccnz L_rlv2lf2
    s_branch L_rlvblf2
L_rqzf2:
    global_load_dwordx4 v[0:3], v127, s[56:57] sc1
    global_load_dwordx4 v[4:7], v127, s[58:59] sc1
    s_add_u32 s54, s54, 1
    s_cmp_gt_u32 s54, 400000
    s_cbranch_scc1 L_rdonef2
    s_branch L_rpzf2
L_rtzf2:
    global_load_dwordx4 v[0:3], v127, s[56:57] sc1
    global_load_dwordx4 v[4:7], v127, s[58:59] sc1
    s_nop 15
    s_nop 0
    s_nop 12
    global_load_dwordx4 v[0:3], v127, s[56:57] sc1
    global_load_dwordx4 v[4:7], v127, s[58:59] sc1
    s_waitcnt vmcnt(6)
    ds_read_b128 v[8:11], v120 offset:8192
    ds_read_b128 v[12:15], v120 offset:9216
    ds_read_b128 v[16:19], v120 offset:10240
    ds_read_b128 v[20:23], v120 offset:11264
    ds_read_b128 v[24:27], v120 offset:12288
    ds_read_b128 v[28:31], v120 offset:13312
    ds_read_b128 v[56:59], v120 offset:14336
    ds_read_b128 v[60:63], v120 offset:15360
    s_waitcnt lgkmcnt(0)
L_rpzf2:
    s_waitcnt vmcnt(3)
    v_max3_u32 v130, v0, v1, v2
    v_max_u32 v130, v130, v3
    s_waitcnt vmcnt(2)
    v_max3_u32 v130, v130, v4, v5
    v_max3_u32 v130, v130, v6, v7
    v_cmp_eq_u32 vcc, -1, v130
    ds_write_b128 v116, v[0:3]
    s_cbranch_vccnz L_rqzf2
    v_smfmac_f32_16x16x64_bf16 v[40:43], v[0:3], v[24:31], v110
    ds_write_b128 v116, v[4:7] offset:4096
    v_smfmac_f32_16x16x64_bf16 v[44:47], v[0:3], v[96:103], v110
    v_smfmac_f32_16x16x64_bf16 v[48:51], v[0:3], v[64:71], v110
    v_smfmac_f32_16x16x64_bf16 v[52:55], v[0:3], v[72:79], v110
    v_smfmac_f32_16x16x64_bf16 v[40:43], v[4:7], v[56:63], v110
    v_smfmac_f32_16x16x64_bf16 v[44:47], v[4:7], a[0:7], v110
    v_smfmac_f32_16x16x64_bf16 v[48:51], v[4:7], a[8:15], v110
    v_smfmac_f32_16x16x64_bf16 v[52:55], v[4:7], a[16:23], v110
    s_waitcnt lgkmcnt(0)
    s_barrier
    ds_read_b128 v[8:11], v117 offset:0
    ds_read_b128 v[12:15], v118 offset:0
    ds_read_b128 v[16:19], v119 offset:0
    ds_read_b128 v[20:23], v117 offset:4096
    ds_read_b128 v[24:27], v118 offset:4096
    ds_read_b128 v[28:31], v119 offset:4096
    global_store_dwordx4 v127, v[132:135], s[46:47] sc1
    s_add_u32 s46, s46, 4096
    s_addc_u32 s47, s47, 0
    s_waitcnt lgkmcnt(5)
    v_smfmac_f32_16x16x64_bf16 v[40:43], v[8:11], a[120:127], v110
    s_waitcnt lgkmcnt(4)
    v_smfmac_f32_16x16x64_bf16 v[40:43], v[12:15], a[128:135], v110
    s_waitcnt lgkmcnt(3)
    v_smfmac_f32_16x16x64_bf16 v[40:43], v[16:19], a[136:143], v110
    s_waitcnt lgkmcnt(2)
    v_smfmac_f32_16x16x64_bf16 v[40:43], v[20:23], a[144:151], v110
    s_waitcnt lgkmcnt(1)
    v_smfmac_f32_16x16x64_bf16 v[40:43], v[24:27], a[152:159], v110
    s_waitcnt lgkmcnt(0)
    v_smfmac_f32_16x16x64_bf16 v[40:43], v[28:31], a[160:167], v110
    v_smfmac_f32_16x16x64_bf16 v[44:47], v[8:11], a[168:175], v110
    v_smfmac_f32_16x16x64_bf16 v[44:47], v[12:15], a[176:183], v110
    v_smfmac_f32_16x16x64_bf16 v[44:47], v[16:19], a[184:191], v110
    v_smfmac_f32_16x16x64_bf16 v[44:47], v[20:23], a[192:199], v110
    v_smfmac_f32_16x16x64_bf16 v[44:47], v[24:27], a[200:207], v110
    v_smfmac_f32_16x16x64_bf16 v[44:47], v[28:31], a[208:215], v110
    v_smfmac_f32_16x16x64_bf16 v[48:51], v[8:11], a[216:223], v110
    v_smfmac_f32_16x16x64_bf16 v[52:55], v[8:11], a[224:231], v110
    v_smfmac_f32_16x16x64_bf16 v[48:51], v[12:15], a[232:239], v110
    v_smfmac_f32_16x16x64_bf16 v[52:55], v[12:15], a[240:247], v110
    v_smfmac_f32_16x16x64_bf16 v[48:51], v[16:19], a[248:255], v110
    v_smfmac_f32_16x16x64_bf16 v[52:55], v[16:19], v[136:143], v110
    v_smfmac_f32_16x16x64_bf16 v[48:51], v[20:23], v[144:151], v110
    v_smfmac_f32_16x16x64_bf16 v[52:55], v[20:23], v[152:159], v110
    v_smfmac_f32_16x16x64_bf16 v[48:51], v[24:27], v[160:167], v110
    v_smfmac_f32_16x16x64_bf16 v[52:55], v[24:27], v[168:175], v110
    v_smfmac_f32_16x16x64_bf16 v[48:51], v[28:31], v[176:183], v110
    v_smfmac_f32_16x16x64_bf16 v[52:55], v[28:31], v[184:191], v110
    v_pk_add_f32 v[40:41], v[40:41], v[42:43]
    v_pk_add_f32 v[44:45], v[44:45], v[46:47]
    s_nop 4
    v_pk_add_f32 v[48:49], v[48:49], v[50:51]
    v_pk_add_f32 v[52:53], v[52:53], v[54:55]
    v_cvt_pk_bf16_f32 v132, v40, v41
    v_cvt_pk_bf16_f32 v133, v44, v45
    v_cvt_pk_bf16_f32 v134, v48, v49
    v_cvt_pk_bf16_f32 v135, v52, v53
    global_store_dwordx4 v127, v[132:135], s[46:47] sc1
L_rdonef2:
    s_branch L_rend
L_rwvf3:
    s_mov_b64 s[56:57], s[42:43]
    s_mov_b64 s[58:59], s[42:43]
    s_mov_b32 s54, 0
    s_getpc_b64 s[18:19]
L_rzcf3:
    s_add_u32 s18, s18, L_rqzf3-L_rzcf3
    s_addc_u32 s19, s19, 0
    s_add_u32 s66, s50, 16384
    s_addc_u32 s67, s51, 0
    s_branch L_rpmf3
.p2align 6
    s_nop 0
    s_nop 0
    s_nop 0
L_rqmf3:
    global_load_dwordx4 v[0:3], v127, s[56:57] sc1
    global_load_dwordx4 v[4:7], v127, s[58:59] sc1
    s_add_u32 s54, s54, 1
    s_cmp_gt_u32 s54, 400000
    s_cbranch_scc1 L_rdonef3
    s_branch L_rpmf3
L_rtmf3:
    global_load_dwordx4 v[0:3], v127, s[56:57] sc1
    global_load_dwordx4 v[4:7], v127, s[58:59] sc1
    s_nop 15
    s_nop 0
    s_nop 12
    global_load_dwordx4 v[0:3], v127, s[56:57] sc1
    global_load_dwordx4 v[4:7], v127, s[58:59] sc1
    s_waitcnt vmcnt(6)
    ds_read_b128 v[8:11], v120 offset:8192
    ds_read_b128 v[12:15], v120 offset:9216
    ds_read_b128 v[16:19], v120 offset:10240
    ds_read_b128 v[20:23], v120 offset:11264
    ds_read_b128 v[24:27], v120 offset:12288
    ds_read_b128 v[28:31], v120 offset:13312
    ds_read_b128 v[56:59], v120 offset:14336
    ds_read_b128 v[60:63], v120 offset:15360
    s_waitcnt lgkmcnt(0)
L_rpmf3:
    s_waitcnt vmcnt(3)
    v_max3_u32 v130, v0, v1, v2
    v_max_u32 v130, v130, v3
    s_waitcnt vmcnt(2)
    v_max3_u32 v130, v130, v4, v5
    v_max3_u32 v130, v130, v6, v7
    v_cmp_eq_u32 vcc, -1, v130
    ds_write_b128 v116, v[0:3]
    s_cbranch_vccnz L_rqmf3
    v_smfmac_f32_16x16x64_bf16 v[32:35], v[0:3], v[8:15], v110
    ds_write_b128 v116, v[4:7] offset:4096
    v_smfmac_f32_16x16x64_bf16 v[36:39], v[0:3], v[16:23], v110
    v_smfmac_f32_16x16x64_bf16 v[40:43], v[0:3], v[24:31], v110
    v_smfmac_f32_16x16x64_bf16 v[44:47], v[0:3], v[96:103], v110
    s_mov_b32 m0, 162816
    v_smfmac_f32_16x16x64_bf16 v[48:51], v[0:3], v[64:71], v110
    global_load_dwordx4 v[96:99], v128, s[50:51] sc1
    global_load_dwordx4 v[102:105], v128, s[50:51] offset:256 sc1
    v_smfmac_f32_16x16x64_bf16 v[52:55], v[0:3], v[72:79], v110
    s_waitcnt lgkmcnt(0)
    s_barrier
    ds_read_b128 v[8:11], v117 offset:0
    v_smfmac_f32_16x16x64_bf16 v[32:35], v[4:7], v[80:87], v110
    ds_read_b128 v[12:15], v118 offset:0
    v_smfmac_f32_16x16x64_bf16 v[36:39], v[4:7], v[88:95], v110
    ds_read_b128 v[16:19], v119 offset:0
    v_smfmac_f32_16x16x64_bf16 v[40:43], v[4:7], v[56:63], v110
    ds_read_b128 v[20:23], v117 offset:4096
    v_smfmac_f32_16x16x64_bf16 v[44:47], v[4:7], a[0:7], v110
    ds_read_b128 v[24:27], v118 offset:4096
    v_smfmac_f32_16x16x64_bf16 v[48:51], v[4:7], a[8:15], v110
    ds_read_b128 v[28:31], v119 offset:4096
    v_smfmac_f32_16x16x64_bf16 v[52:55], v[4:7], a[16:23], v110
    s_waitcnt lgkmcnt(5)
    ds_read_b128 v[64:67], v125 offset:0
    v_smfmac_f32_16x16x64_bf16 v[32:35], v[8:11], a[24:31], v110
    s_waitcnt vmcnt(2)
    v_mov_b64 v[0:1], 0
    v_smfmac_f32_16x16x64_bf16 v[36:39], v[8:11], a[32:39], v110
    s_waitcnt lgkmcnt(5)
    ds_read_b128 v[68:71], v125 offset:1024
    v_mov_b64 v[112:113], 0
    v_smfmac_f32_16x16x64_bf16 v[32:35], v[12:15], a[40:47], v110
    v_mov_b64_e64 v[2:3], 0
    v_smfmac_f32_16x16x64_bf16 v[36:39], v[12:15], a[48:55], v110
    s_waitcnt lgkmcnt(5)
    ds_read_b128 v[72:75], v125 offset:4096
    v_mov_b64 v[114:115], 0
    v_smfmac_f32_16x16x64_bf16 v[32:35], v[16:19], a[56:63], v110
    v_mov_b64 v[4:5], 0
    v_smfmac_f32_16x16x64_bf16 v[36:39], v[16:19], a[64:71], v110
    s_waitcnt lgkmcnt(5)
    ds_read_b128 v[76:79], v125 offset:5120
    v_mov_b64 v[116:117], 0
    v_smfmac_f32_16x16x64_bf16 v[32:35], v[20:23], a[72:79], v110
    v_mov_b64_e64 v[6:7], 0
    v_smfmac_f32_16x16x64_bf16 v[36:39], v[20:23], a[80:87], v110
    s_waitcnt lgkmcnt(5)
    ds_read_b128 v[80:83], v125 offset:256
    v_mov_b64 v[118:119], 0
    v_smfmac_f32_16x16x64_bf16 v[32:35], v[24:27], a[88:95], v110
    v_smfmac_f32_16x16x64_bf16 v[36:39], v[24:27], a[96:103], v110
    s_waitcnt lgkmcnt(5)
    ds_read_b128 v[84:87], v125 offset:1280
    v_smfmac_f32_16x16x64_bf16 v[32:35], v[28:31], a[104:111], v110
    global_store_dwordx4 v127, v[132:135], s[46:47] sc1
    v_smfmac_f32_16x16x64_bf16 v[36:39], v[28:31], a[112:119], v110
    s_nop 2
    v_smfmac_f32_16x16x64_bf16 v[40:43], v[8:11], a[120:127], v110
    s_nop 0
    s_nop 0
    v_add_f32 v32, v32, v34
    v_smfmac_f32_16x16x64_bf16 v[40:43], v[12:15], a[128:135], v110
    ds_read_b128 v[88:91], v125 offset:4352
    v_add_f32 v33, v33, v35
    v_smfmac_f32_16x16x64_bf16 v[40:43], v[16:19], a[136:143], v110
    v_add_f32 v36, v36, v38
    v_smfmac_f32_16x16x64_bf16 v[40:43], v[20:23], a[144:151], v110
    ds_read_b128 v[92:95], v125 offset:5376
    v_add_f32 v37, v37, v39
    v_smfmac_f32_16x16x64_bf16 v[40:43], v[24:27], a[152:159], v110
    v_cvt_pk_bf16_f32 v56, v32, v33
    v_smfmac_f32_16x16x64_bf16 v[40:43], v[28:31], a[160:167], v110
    s_nop 0
    s_nop 0
    v_cvt_pk_bf16_f32 v57, v36, v37
    v_smfmac_f32_16x16x64_bf16 v[44:47], v[8:11], a[168:175], v110
    s_nop 0
    ds_write_b32 v121, v56
    v_smfmac_f32_16x16x64_bf16 v[44:47], v[12:15], a[176:183], v110
    ds_write_b32 v121, v57 offset:4
    v_smfmac_f32_16x16x64_bf16 v[44:47], v[16:19], a[184:191], v110
    v_add_f32 v40, v40, v42
    v_smfmac_f32_16x16x64_bf16 v[44:47], v[20:23], a[192:199], v110
    s_add_u32 s50, s50, 16384
    s_addc_u32 s51, s51, 0
    v_add_f32_e64 v41, v41, v43
    v_smfmac_f32_16x16x64_bf16 v[44:47], v[24:27], a[200:207], v110
    s_add_u32 s46, s46, 4096
    s_addc_u32 s47, s47, 0
    v_cvt_pk_bf16_f32 v132, v40, v41
    v_smfmac_f32_16x16x64_bf16 v[44:47], v[28:31], a[208:215], v110
    s_waitcnt lgkmcnt(0)
    s_barrier
    ds_read_b64_tr_b16 v[56:57], v122 offset:0
    v_smfmac_f32_16x16x64_bf16 v[48:51], v[8:11], a[216:223], v110
    s_nop 0
    ds_read_b64_tr_b16 v[58:59], v122 offset:512
    ds_write_b32 v123, v132 offset:2560
    v_smfmac_f32_16x16x64_bf16 v[52:55], v[8:11], a[224:231], v110
    ds_read_b64_tr_b16 v[60:61], v122 offset:1024
    v_add_f32_e64 v44, v44, v46
    v_smfmac_f32_16x16x64_bf16 v[48:51], v[12:15], a[232:239], v110
    s_mov_b32 m0, s62
    ds_read_b64_tr_b16 v[62:63], v122 offset:1536
    v_add_f32_e64 v45, v45, v47
    v_smfmac_f32_16x16x64_bf16 v[52:55], v[12:15], a[240:247], v110
    global_load_lds_dwordx4 v127, s[48:49] sc1
    v_cvt_pk_bf16_f32 v133, v44, v45
    v_smfmac_f32_16x16x64_bf16 v[48:51], v[16:19], a[248:255], v110
    ds_write_b32 v123, v133 offset:2576
    v_smfmac_f32_16x16x64_bf16 v[52:55], v[16:19], v[136:143], v110
    s_waitcnt lgkmcnt(4)
    global_load_lds_dwordx4 v127, s[48:49] offset:1024 sc1
    v_mov_b64_e64 v[8:9], 0
    v_smfmac_f32_16x16x64_bf16 v[0:3], v[56:59], v[64:71], v110
    s_waitcnt lgkmcnt(1)
    ds_read_b128 v[64:67], v120 offset:18432
    v_mov_b64 v[10:11], 0
    v_smfmac_f32_16x16x64_bf16 v[0:3], v[60:63], v[72:79], v110
    s_waitcnt vmcnt(3)
    ds_read_b128 v[68:71], v120 offset:19456
    v_mov_b64_e64 v[100:101], v[98:99]
    v_smfmac_f32_16x16x64_bf16 v[4:7], v[56:59], v[80:87], v110
    s_waitcnt lgkmcnt(2)
    s_barrier
    ds_read_b64_tr_b16 v[32:33], v124 offset:2560
    v_smfmac_f32_16x16x64_bf16 v[4:7], v[60:63], v[88:95], v110
    ds_read_b64_tr_b16 v[34:35], v124 offset:2640
    ds_read_b64_tr_b16 v[36:37], v124 offset:2880
    v_smfmac_f32_16x16x64_bf16 v[48:51], v[20:23], v[144:151], v110
    ds_read_b64_tr_b16 v[38:39], v124 offset:2960
    v_add_f32_e64 v0, v0, v2
    v_smfmac_f32_16x16x64_bf16 v[52:55], v[20:23], v[152:159], v110
    ds_read_b64_tr_b16 v[40:41], v124 offset:3840
    ds_read_b64_tr_b16 v[42:43], v124 offset:3920
    v_smfmac_f32_16x16x64_bf16 v[48:51], v[24:27], v[160:167], v110
    ds_read_b64_tr_b16 v[44:45], v124 offset:4160
    ds_read_b64_tr_b16 v[46:47], v124 offset:4240
    v_smfmac_f32_16x16x64_bf16 v[52:55], v[24:27], v[168:175], v110
    ds_read_b128 v[72:75], v120 offset:20480
    v_add_f32_e64 v1, v1, v3
    v_smfmac_f32_16x16x64_bf16 v[48:51], v[28:31], v[176:183], v110
    ds_read_b128 v[76:79], v120 offset:21504
    v_add_f32 v4, v4, v6
    v_smfmac_f32_16x16x64_bf16 v[52:55], v[28:31], v[184:191], v110
    s_waitcnt lgkmcnt(6)
    ds_read_b128 v[80:83], v120 offset:22528
    v_add_f32 v5, v5, v7
    v_smfmac_f32_16x16x64_bf16 v[8:11], v[56:59], v[32:39], v110
    s_waitcnt lgkmcnt(3)
    ds_read_b128 v[84:87], v120 offset:23552
    v_max_f32_e64 v16, v0, v4
    v_smfmac_f32_16x16x64_bf16 v[8:11], v[60:63], v[40:47], v110
    s_nop 1
    v_max_f32 v17, v1, v5
    v_mov_b64_e64 v[106:107], v[104:105]
    v_max_f32_dpp v16, v16, v16 row_ror:8 row_mask:0xf bank_mask:0xf
    v_max_f32_dpp v17, v17, v17 row_ror:8 row_mask:0xf bank_mask:0xf
    v_mov_b32 v15, 0
    v_pk_add_f32 v[48:49], v[48:49], v[50:51]
    v_pk_add_f32 v[8:9], v[8:9], v[10:11]
    v_max_f32 v16, v16, v8
    v_max_f32_e64 v17, v17, v9
    v_pk_add_f32 v[52:53], v[52:53], v[54:55]
    v_max_f32_dpp v16, v16, v16 row_ror:4 row_mask:0xf bank_mask:0xf
    v_max_f32_dpp v17, v17, v17 row_ror:4 row_mask:0xf bank_mask:0xf
    v_cvt_pk_bf16_f32 v98, v48, v49
    v_max_f32_dpp v16, v16, v16 row_ror:2 row_mask:0xf bank_mask:0xf
    v_max_f32_dpp v17, v17, v17 row_ror:2 row_mask:0xf bank_mask:0xf
    v_cvt_pk_bf16_f32 v104, v52, v53
    v_max_f32_dpp v16, v16, v16 row_ror:1 row_mask:0xf bank_mask:0xf
    v_max_f32_dpp v17, v17, v17 row_ror:1 row_mask:0xf bank_mask:0xf
    v_pk_mul_f32 v[18:19], v[16:17], s[52:53] neg_lo:[1,0] neg_hi:[1,0]
    v_pk_fma_f32 v[0:1], v[0:1], s[52:53], v[18:19]
    v_pk_fma_f32 v[4:5], v[4:5], s[52:53], v[18:19]
    v_pk_add_f32 v[20:21], v[18:19], v[110:111] op_sel:[0,1] op_sel_hi:[1,1]
    v_exp_f32 v0, v0
    v_pk_fma_f32 v[8:9], v[8:9], s[52:53], v[20:21]
    v_exp_f32 v1, v1
    v_exp_f32 v4, v4
    v_exp_f32 v5, v5
    v_cvt_pk_bf16_f32 v12, v0, v1
    v_cvt_pk_bf16_f32 v13, v4, v5
    v_exp_f32 v8, v8
    v_exp_f32 v9, v9
    v_mfma_f32_16x16x16_bf16 v[56:59], v[12:13], v[108:109], 0
    s_nop 0
    v_cvt_pk_bf16_f32 v14, v8, v9
    v_add_f32 v22, v0, v4
    v_add_f32_e64 v23, v1, v5
    v_mfma_f32_16x16x16_bf16 v[60:63], v[14:15], v[108:109], 0
    s_nop 0
    v_add_f32 v22, v22, v8
    v_add_f32_e64 v23, v23, v9
    v_cvt_pk_bf16_f32 v40, v56, v57
    v_add_f32_dpp v22, v22, v22 row_ror:8 row_mask:0xf bank_mask:0xf
    v_add_f32_dpp v23, v23, v23 row_ror:8 row_mask:0xf bank_mask:0xf
    v_cvt_pk_bf16_f32 v42, v58, v59
    v_add_f32_dpp v22, v22, v22 row_ror:4 row_mask:0xf bank_mask:0xf
    v_cvt_pk_bf16_f32 v41, v60, v61
    v_cvt_pk_bf16_f32 v43, v62, v63
    v_add_f32_dpp v23, v23, v23 row_ror:4 row_mask:0xf bank_mask:0xf
    v_add_f32_dpp v22, v22, v22 row_ror:2 row_mask:0xf bank_mask:0xf
    v_smfmac_f32_16x16x64_bf16 v[112:115], v[40:43], v[96:103], v110
    s_nop 0
    ds_read_b128 v[88:91], v120 offset:24576
    v_add_f32_dpp v23, v23, v23 row_ror:2 row_mask:0xf bank_mask:0xf
    v_smfmac_f32_16x16x64_bf16 v[116:119], v[40:43], v[102:109], v110
    s_nop 0
    ds_read_b128 v[92:95], v120 offset:25600
    v_add_f32_dpp v22, v22, v22 row_ror:1 row_mask:0xf bank_mask:0xf
    v_add_f32_dpp v23, v23, v23 row_ror:1 row_mask:0xf bank_mask:0xf
    v_rcp_f32 v22, v22
    v_rcp_f32 v23, v23
    v_pk_add_f32 v[112:113], v[112:113], v[114:115]
    v_pk_mul_f32 v[112:113], v[112:113], v[22:23]
    v_pk_add_f32 v[116:117], v[116:117], v[118:119]
    v_cvt_pk_bf16_f32 v130, v112, v113
    v_pk_mul_f32 v[116:117], v[116:117], v[22:23]
    v_cvt_pk_bf16_f32 v131, v116, v117
    ds_write2_b32 v123, v130, v131 offset0:0 offset1:4
    v_mov_b64 v[0:1], 0
    v_mov_b64 v[2:3], 0
    v_mov_b64 v[4:5], 0
    v_mov_b64 v[6:7], 0
    v_mov_b64 v[8:9], 0
    v_mov_b64 v[10:11], 0
    v_mov_b64 v[12:13], 0
    v_mov_b64 v[14:15], 0
    s_waitcnt lgkmcnt(0)
    s_barrier
    ds_read_b64_tr_b16 v[16:17], v124 offset:0
    ds_read_b64_tr_b16 v[18:19], v124 offset:80
    ds_read_b64_tr_b16 v[20:21], v124 offset:320
    ds_read_b64_tr_b16 v[22:23], v124 offset:400
    ds_read_b64_tr_b16 v[24:25], v124 offset:1280
    ds_read_b64_tr_b16 v[26:27], v124 offset:1360
    ds_read_b64_tr_b16 v[28:29], v124 offset:1600
    ds_read_b64_tr_b16 v[30:31], v124 offset:1680
    s_waitcnt lgkmcnt(6)
    v_smfmac_f32_16x16x64_bf16 v[0:3], v[16:19], v[64:71], v110 abid:1
    v_mov_b32 v134, v98
    v_smfmac_f32_16x16x64_bf16 v[4:7], v[16:19], v[72:79], v110 abid:1
    s_waitcnt lgkmcnt(4)
    ds_read_b128 v[64:67], v120 offset:26624
    v_smfmac_f32_16x16x64_bf16 v[0:3], v[20:23], v[80:87], v110 abid:1
    ds_read_b128 v[68:71], v120 offset:27648
    v_mov_b32 v135, v104
    v_smfmac_f32_16x16x64_bf16 v[4:7], v[20:23], v[88:95], v110 abid:1
    s_waitcnt lgkmcnt(4)
    ds_read_b128 v[72:75], v120 offset:28672
    v_smfmac_f32_16x16x64_bf16 v[0:3], v[24:27], v[192:199], v110 abid:1
    s_waitcnt lgkmcnt(3)
    ds_read_b128 v[76:79], v120 offset:29696
    v_smfmac_f32_16x16x64_bf16 v[0:3], v[28:31], v[200:207], v110 abid:1
    s_nop 0
    ds_read_b128 v[80:83], v120 offset:30720
    v_mov_b64 v[32:33], 0
    v_smfmac_f32_16x16x64_bf16 v[4:7], v[24:27], v[208:215], v110 abid:1
    s_nop 0
    ds_read_b128 v[84:87], v120 offset:31744
    v_mov_b64 v[34:35], 0
    v_smfmac_f32_16x16x64_bf16 v[4:7], v[28:31], v[216:223], v110 abid:1
    s_nop 0
    ds_read_b128 v[88:91], v120 offset:32768
    v_cvt_pk_bf16_f32 v56, v0, v1
    v_smfmac_f32_16x16x64_bf16 v[8:11], v[16:19], v[224:231], v110 abid:1
    s_waitcnt lgkmcnt(5)
    ds_read_b128 v[92:95], v120 offset:33792
    v_cvt_pk_bf16_f32 v57, v2, v3
    v_and_or_b32 v56, v56, -2, s35
    v_cvt_pk_bf16_f32 v58, v4, v5
    v_cvt_pk_bf16_f32 v59, v6, v7
    v_smfmac_f32_16x16x64_bf16 v[8:11], v[20:23], v[64:71], v110 abid:1
    global_store_dwordx4 v126, v[56:59], s[36:37]
    v_smfmac_f32_16x16x64_bf16 v[8:11], v[24:27], v[232:239], v110 abid:1
    s_waitcnt lgkmcnt(4)
    v_smfmac_f32_16x16x64_bf16 v[8:11], v[28:31], v[72:79], v110 abid:1
    s_nop 1
    v_mov_b64_e64 v[36:37], 0
    v_smfmac_f32_16x16x64_bf16 v[12:15], v[16:19], v[240:247], v110 abid:1
    s_waitcnt lgkmcnt(2)
    s_nop 0
    v_mov_b64_e64 v[38:39], 0
    v_smfmac_f32_16x16x64_bf16 v[12:15], v[20:23], v[80:87], v110 abid:1
    s_add_u32 s48, s48, 16384
    s_addc_u32 s49, s49, 0
    v_cvt_pk_bf16_f32 v60, v8, v9
    v_smfmac_f32_16x16x64_bf16 v[12:15], v[24:27], v[248:255], v110 abid:1
    s_waitcnt lgkmcnt(0)
    v_cvt_pk_bf16_f32 v61, v10, v11
    v_smfmac_f32_16x16x64_bf16 v[12:15], v[28:31], v[88:95], v110 abid:1
    s_cmp_ge_u32 s30, 2
    s_nop 0
    v_and_or_b32 v60, v60, -2, s35
    v_mov_b64 v[40:41], 0
    v_mov_b64 v[42:43], 0
    v_mov_b64 v[44:45], 0
    v_mov_b64 v[46:47], 0
    v_mov_b64_e64 v[48:49], 0
    v_cvt_pk_bf16_f32 v62, v12, v13
    v_cvt_pk_bf16_f32 v63, v14, v15
    global_store_dwordx4 v126, v[60:63], s[38:39]
L_rlatef3:
    v_mov_b32 v130, 0x3f80
    v_cndmask_b32 v130, v130, 1.0, s[16:17]
    v_cndmask_b32 v112, 0, v130, s[8:9]
    v_cndmask_b32 v113, 0, v130, s[10:11]
    v_cndmask_b32 v114, 0, v130, s[12:13]
    v_cndmask_b32 v115, 0, v130, s[14:15]
    v_add_u32 v116, s4, v127
    v_add_u32 v117, s5, v127
    v_add_u32 v118, s6, v127
    v_add_u32 v119, s7, v127
    v_mov_b64 v[50:51], 0
    v_mov_b64 v[52:53], 0
    v_mov_b64 v[54:55], 0
    v_lshrrev_b32 v130, 2, v127
    v_add_u32 v131, 163072, v130
    s_add_u32 s20, s34, 3
    s_min_u32 s20, s20, 64
    ds_read_b32 v131, v131
    s_mov_b64 exec, 6
    s_waitcnt lgkmcnt(0)
    v_cmp_gt_u32 vcc, s20, v131
    s_cbranch_vccnz L_rlv2lf3
L_rlvblf3:
    s_mov_b64 exec, -1
    s_nop 15
    s_nop 15
    s_nop 1
    global_load_dwordx4 v[16:19], v127, s[40:41] sc1
    global_load_dwordx4 v[20:23], v127, s[40:41] offset:1024 sc1
    s_lshl_b32 s58, s30, 10
    s_add_u32 s56, s42, s58
    s_addc_u32 s57, s43, 0
    s_add_u32 s58, s56, 4096
    s_addc_u32 s59, s57, 0
    s_mov_b32 s54, 0
    s_add_u32 s34, s34, 1
    v_mov_b32 v12, -1
    s_nop 15
    global_load_dwordx4 v[24:27], v127, s[40:41] sc1
    global_load_dwordx4 v[28:31], v127, s[40:41] offset:1024 sc1
    ds_read_b128 v[64:67], v120 offset:0
    ds_read_b128 v[68:71], v120 offset:1024
    ds_read_b128 v[72:75], v120 offset:2048
    ds_read_b128 v[76:79], v120 offset:3072
    ds_read_b128 v[80:83], v120 offset:4096
    ds_read_b128 v[84:87], v120 offset:5120
    ds_read_b128 v[88:91], v120 offset:6144
    ds_read_b128 v[92:95], v120 offset:7168
    ds_read_b128 v[96:99], v120 offset:16384
    ds_read_b128 v[100:103], v120 offset:17408
    s_waitcnt vmcnt(3)
    v_mfma_f32_16x16x32_bf16 v[8:11], v[112:115], v[16:19], 0
    v_xor_b32_e64 v130, s35, v16
    s_waitcnt vmcnt(2)
    v_mfma_f32_16x16x32_bf16 v[8:11], v[112:115], v[20:23], v[8:11]
    s_nop 0
    v_bitop3_b32 v130, v130, s35, v20 bitop3:0xf6
    v_and_b32 v130, 1, v130
    v_cmp_ne_u32 vcc, 0, v130
    s_nop 0
    s_nop 2
    v_add_f32_dpp v8, v8, v8 row_ror:4 row_mask:0xf bank_mask:0xf
    v_add_f32_dpp v9, v9, v9 row_ror:4 row_mask:0xf bank_mask:0xf
    s_cbranch_vccnz L_rflf3
L_roklf3:
    v_add_f32_dpp v8, v8, v8 row_ror:8 row_mask:0xf bank_mask:0xf
    v_add_f32_dpp v9, v9, v9 row_ror:8 row_mask:0xf bank_mask:0xf
    v_cvt_pk_bf16_f32 v130, v8, v9
    s_mov_b64 exec, s[64:65]
    s_xor_b32 s35, s35, 1
    global_store_dword v129, v130, s[42:43]
    global_store_dword v129, v12, s[44:45]
    s_mov_b64 exec, -1
    s_barrier
    s_mov_b64 s[60:61], s[42:43]
    s_mov_b64 s[42:43], s[44:45]
    s_mov_b64 s[44:45], s[60:61]
    s_waitcnt lgkmcnt(0)
    s_nop 2
    s_cmp_lt_u32 s34, 63
    s_cbranch_scc1 L_rtmf3
    s_branch L_rtzf3
L_rflf3:
    global_load_dwordx4 v[16:19], v127, s[40:41] sc1
    global_load_dwordx4 v[20:23], v127, s[40:41] offset:1024 sc1
    s_waitcnt vmcnt(3)
    v_mfma_f32_16x16x32_bf16 v[8:11], v[112:115], v[24:27], 0
    v_xor_b32 v130, s35, v24
    s_waitcnt vmcnt(2)
    v_mfma_f32_16x16x32_bf16 v[8:11], v[112:115], v[28:31], v[8:11]
    s_nop 0
    v_bitop3_b32 v130, v130, s35, v28 bitop3:0xf6
    v_and_b32 v130, 1, v130
    v_cmp_ne_u32 vcc, 0, v130
    s_nop 0
    s_nop 2
    v_add_f32_dpp v8, v8, v8 row_ror:4 row_mask:0xf bank_mask:0xf
    v_add_f32_dpp v9, v9, v9 row_ror:4 row_mask:0xf bank_mask:0xf
    s_cbranch_vccz L_roklf3
    global_load_dwordx4 v[24:27], v127, s[40:41] sc1
    global_load_dwordx4 v[28:31], v127, s[40:41] offset:1024 sc1
    s_waitcnt vmcnt(3)
    v_mfma_f32_16x16x32_bf16 v[8:11], v[112:115], v[16:19], 0
    v_xor_b32_e64 v130, s35, v16
    s_waitcnt vmcnt(2)
    v_mfma_f32_16x16x32_bf16 v[8:11], v[112:115], v[20:23], v[8:11]
    s_nop 0
    v_bitop3_b32 v130, v130, s35, v20 bitop3:0xf6
    v_and_b32 v130, 1, v130
    v_cmp_ne_u32 vcc, 0, v130
    s_nop 0
    s_nop 2
    v_add_f32_dpp v8, v8, v8 row_ror:4 row_mask:0xf bank_mask:0xf
    v_add_f32_dpp v9, v9, v9 row_ror:4 row_mask:0xf bank_mask:0xf
    s_cbranch_vccz L_roklf3
    s_add_u32 s54, s54, 1
    s_cmp_gt_u32 s54, 400000
    s_cbranch_scc1 L_rdonef3
    s_branch L_rflf3
L_rlv2lf3:
    global_load_dword v131, v130, s[68:69] offset:256 sc1
    s_add_u32 s54, s54, 1
    s_cmp_gt_u32 s54, 400000
    s_cbranch_scc1 L_rdonef3
    s_waitcnt vmcnt(0)
    v_cmp_gt_u32_e64 vcc, s20, v131
    s_cbranch_vccnz L_rlv2lf3
    s_branch L_rlvblf3
L_rqzf3:
    global_load_dwordx4 v[0:3], v127, s[56:57] sc1
    global_load_dwordx4 v[4:7], v127, s[58:59] sc1
    s_add_u32 s54, s54, 1
    s_cmp_gt_u32 s54, 400000
    s_cbranch_scc1 L_rdonef3
    s_branch L_rpzf3
L_rtzf3:
    global_load_dwordx4 v[0:3], v127, s[56:57] sc1
    global_load_dwordx4 v[4:7], v127, s[58:59] sc1
    s_nop 15
    s_nop 0
    s_nop 12
    global_load_dwordx4 v[0:3], v127, s[56:57] sc1
    global_load_dwordx4 v[4:7], v127, s[58:59] sc1
    s_waitcnt vmcnt(6)
    ds_read_b128 v[8:11], v120 offset:8192
    ds_read_b128 v[12:15], v120 offset:9216
    ds_read_b128 v[16:19], v120 offset:10240
    ds_read_b128 v[20:23], v120 offset:11264
    ds_read_b128 v[24:27], v120 offset:12288
    ds_read_b128 v[28:31], v120 offset:13312
    ds_read_b128 v[56:59], v120 offset:14336
    ds_read_b128 v[60:63], v120 offset:15360
    s_waitcnt lgkmcnt(0)
L_rpzf3:
    s_waitcnt vmcnt(3)
    v_max3_u32 v130, v0, v1, v2
    v_max_u32 v130, v130, v3
    s_waitcnt vmcnt(2)
    v_max3_u32 v130, v130, v4, v5
    v_max3_u32 v130, v130, v6, v7
    v_cmp_eq_u32 vcc, -1, v130
    ds_write_b128 v116, v[0:3]
    s_cbranch_vccnz L_rqzf3
    v_smfmac_f32_16x16x64_bf16 v[40:43], v[0:3], v[24:31], v110
    ds_write_b128 v116, v[4:7] offset:4096
    v_smfmac_f32_16x16x64_bf16 v[44:47], v[0:3], v[96:103], v110
    v_smfmac_f32_16x16x64_bf16 v[48:51], v[0:3], v[64:71], v110
    v_smfmac_f32_16x16x64_bf16 v[52:55], v[0:3], v[72:79], v110
    v_smfmac_f32_16x16x64_bf16 v[40:43], v[4:7], v[56:63], v110
    v_smfmac_f32_16x16x64_bf16 v[44:47], v[4:7], a[0:7], v110
    v_smfmac_f32_16x16x64_bf16 v[48:51], v[4:7], a[8:15], v110
    v_smfmac_f32_16x16x64_bf16 v[52:55], v[4:7], a[16:23], v110
    s_waitcnt lgkmcnt(0)
    s_barrier
    ds_read_b128 v[8:11], v117 offset:0
    ds_read_b128 v[12:15], v118 offset:0
    ds_read_b128 v[16:19], v119 offset:0
    ds_read_b128 v[20:23], v117 offset:4096
    ds_read_b128 v[24:27], v118 offset:4096
    ds_read_b128 v[28:31], v119 offset:4096
    global_store_dwordx4 v127, v[132:135], s[46:47] sc1
    s_add_u32 s46, s46, 4096
    s_addc_u32 s47, s47, 0
    s_waitcnt lgkmcnt(5)
    v_smfmac_f32_16x16x64_bf16 v[40:43], v[8:11], a[120:127], v110
    s_waitcnt lgkmcnt(4)
    v_smfmac_f32_16x16x64_bf16 v[40:43], v[12:15], a[128:135], v110
    s_waitcnt lgkmcnt(3)
    v_smfmac_f32_16x16x64_bf16 v[40:43], v[16:19], a[136:143], v110
    s_waitcnt lgkmcnt(2)
    v_smfmac_f32_16x16x64_bf16 v[40:43], v[20:23], a[144:151], v110
    s_waitcnt lgkmcnt(1)
    v_smfmac_f32_16x16x64_bf16 v[40:43], v[24:27], a[152:159], v110
    s_waitcnt lgkmcnt(0)
    v_smfmac_f32_16x16x64_bf16 v[40:43], v[28:31], a[160:167], v110
    v_smfmac_f32_16x16x64_bf16 v[44:47], v[8:11], a[168:175], v110
    v_smfmac_f32_16x16x64_bf16 v[44:47], v[12:15], a[176:183], v110
    v_smfmac_f32_16x16x64_bf16 v[44:47], v[16:19], a[184:191], v110
    v_smfmac_f32_16x16x64_bf16 v[44:47], v[20:23], a[192:199], v110
    v_smfmac_f32_16x16x64_bf16 v[44:47], v[24:27], a[200:207], v110
    v_smfmac_f32_16x16x64_bf16 v[44:47], v[28:31], a[208:215], v110
    v_smfmac_f32_16x16x64_bf16 v[48:51], v[8:11], a[216:223], v110
    v_smfmac_f32_16x16x64_bf16 v[52:55], v[8:11], a[224:231], v110
    v_smfmac_f32_16x16x64_bf16 v[48:51], v[12:15], a[232:239], v110
    v_smfmac_f32_16x16x64_bf16 v[52:55], v[12:15], a[240:247], v110
    v_smfmac_f32_16x16x64_bf16 v[48:51], v[16:19], a[248:255], v110
    v_smfmac_f32_16x16x64_bf16 v[52:55], v[16:19], v[136:143], v110
    v_smfmac_f32_16x16x64_bf16 v[48:51], v[20:23], v[144:151], v110
    v_smfmac_f32_16x16x64_bf16 v[52:55], v[20:23], v[152:159], v110
    v_smfmac_f32_16x16x64_bf16 v[48:51], v[24:27], v[160:167], v110
    v_smfmac_f32_16x16x64_bf16 v[52:55], v[24:27], v[168:175], v110
    v_smfmac_f32_16x16x64_bf16 v[48:51], v[28:31], v[176:183], v110
    v_smfmac_f32_16x16x64_bf16 v[52:55], v[28:31], v[184:191], v110
    v_pk_add_f32 v[40:41], v[40:41], v[42:43]
    v_pk_add_f32 v[44:45], v[44:45], v[46:47]
    s_nop 4
    v_pk_add_f32 v[48:49], v[48:49], v[50:51]
    v_pk_add_f32 v[52:53], v[52:53], v[54:55]
    v_cvt_pk_bf16_f32 v132, v40, v41
    v_cvt_pk_bf16_f32 v133, v44, v45
    v_cvt_pk_bf16_f32 v134, v48, v49
    v_cvt_pk_bf16_f32 v135, v52, v53
    global_store_dwordx4 v127, v[132:135], s[46:47] sc1
L_rdonef3:
    s_branch L_rend
L_rslow:
    s_mov_b64 s[56:57], s[42:43]
    s_mov_b64 s[58:59], s[42:43]
    s_mov_b32 s54, 0
    s_getpc_b64 s[18:19]
L_rzcs:
    s_add_u32 s18, s18, L_rqzs-L_rzcs
    s_addc_u32 s19, s19, 0
    s_add_u32 s66, s50, 16384
    s_addc_u32 s67, s51, 0
    s_branch L_rpms
.p2align 6
    s_nop 0
    s_nop 0
    s_nop 0
L_rqms:
    global_load_dwordx4 v[0:3], v127, s[56:57] sc1
    global_load_dwordx4 v[4:7], v127, s[58:59] sc1
    s_add_u32 s54, s54, 1
    s_cmp_gt_u32 s54, 400000
    s_cbranch_scc1 L_rdones
    s_branch L_rpms
L_rtms:
    global_load_dwordx4 v[0:3], v127, s[56:57] sc1
    global_load_dwordx4 v[4:7], v127, s[58:59] sc1
    s_nop 15
    s_nop 0
    s_nop 12
    global_load_dwordx4 v[0:3], v127, s[56:57] sc1
    global_load_dwordx4 v[4:7], v127, s[58:59] sc1
    s_waitcnt vmcnt(6)
    ds_read_b128 v[8:11], v120 offset:8192
    ds_read_b128 v[12:15], v120 offset:9216
    ds_read_b128 v[16:19], v120 offset:10240
    ds_read_b128 v[20:23], v120 offset:11264
    ds_read_b128 v[24:27], v120 offset:12288
    ds_read_b128 v[28:31], v120 offset:13312
    ds_read_b128 v[56:59], v120 offset:14336
    ds_read_b128 v[60:63], v120 offset:15360
    s_waitcnt lgkmcnt(0)
L_rpms:
    s_waitcnt vmcnt(3)
    v_max3_u32 v130, v0, v1, v2
    v_max_u32 v130, v130, v3
    s_waitcnt vmcnt(2)
    v_max3_u32 v130, v130, v4, v5
    v_max3_u32 v130, v130, v6, v7
    v_cmp_eq_u32 vcc, -1, v130
    ds_write_b128 v116, v[0:3]
    s_cbranch_vccnz L_rqms
    v_smfmac_f32_16x16x64_bf16 v[32:35], v[0:3], v[8:15], v110
    ds_write_b128 v116, v[4:7] offset:4096
    v_smfmac_f32_16x16x64_bf16 v[36:39], v[0:3], v[16:23], v110
    v_smfmac_f32_16x16x64_bf16 v[40:43], v[0:3], v[24:31], v110
    v_bfe_u32 v131, v127, 2, 5
    v_smfmac_f32_16x16x64_bf16 v[44:47], v[0:3], v[96:103], v110
    s_mov_b32 m0, 162816
    v_lshlrev_b32_e64 v130, 1, v127
    v_smfmac_f32_16x16x64_bf16 v[48:51], v[0:3], v[64:71], v110
    global_load_dwordx4 v[96:99], v128, s[50:51] sc1
    global_load_dwordx4 v[102:105], v128, s[50:51] offset:256 sc1
    v_smfmac_f32_16x16x64_bf16 v[52:55], v[0:3], v[72:79], v110
    s_waitcnt lgkmcnt(0)
    s_barrier
    ds_read_b128 v[8:11], v117 offset:0
    v_smfmac_f32_16x16x64_bf16 v[32:35], v[4:7], v[80:87], v110
    ds_read_b128 v[12:15], v118 offset:0
    global_load_lds_dword v130, s[66:67] sc1
    v_smfmac_f32_16x16x64_bf16 v[36:39], v[4:7], v[88:95], v110
    ds_read_b128 v[16:19], v119 offset:0
    global_load_lds_dword v131, s[68:69] offset:256 sc1
    v_smfmac_f32_16x16x64_bf16 v[40:43], v[4:7], v[56:63], v110
    ds_read_b128 v[20:23], v117 offset:4096
    v_smfmac_f32_16x16x64_bf16 v[44:47], v[4:7], a[0:7], v110
    ds_read_b128 v[24:27], v118 offset:4096
    v_smfmac_f32_16x16x64_bf16 v[48:51], v[4:7], a[8:15], v110
    ds_read_b128 v[28:31], v119 offset:4096
    v_smfmac_f32_16x16x64_bf16 v[52:55], v[4:7], a[16:23], v110
    s_waitcnt lgkmcnt(5)
    v_smfmac_f32_16x16x64_bf16 v[32:35], v[8:11], a[24:31], v110
    s_waitcnt vmcnt(4)
    ds_read_b128 v[64:67], v125 offset:0
    v_mov_b64 v[0:1], 0
    v_smfmac_f32_16x16x64_bf16 v[36:39], v[8:11], a[32:39], v110
    s_waitcnt lgkmcnt(5)
    global_store_dwordx4 v127, v[132:135], s[46:47] sc1
    v_smfmac_f32_16x16x64_bf16 v[32:35], v[12:15], a[40:47], v110
    ds_read_b128 v[68:71], v125 offset:1024
    v_mov_b64 v[112:113], 0
    v_smfmac_f32_16x16x64_bf16 v[36:39], v[12:15], a[48:55], v110
    s_waitcnt lgkmcnt(5)
    v_mov_b64 v[2:3], 0
    v_smfmac_f32_16x16x64_bf16 v[32:35], v[16:19], a[56:63], v110
    ds_read_b128 v[72:75], v125 offset:4096
    v_mov_b64 v[114:115], 0
    v_smfmac_f32_16x16x64_bf16 v[36:39], v[16:19], a[64:71], v110
    s_waitcnt lgkmcnt(5)
    v_mov_b64 v[4:5], 0
    v_smfmac_f32_16x16x64_bf16 v[32:35], v[20:23], a[72:79], v110
    ds_read_b128 v[76:79], v125 offset:5120
    v_mov_b64_e64 v[116:117], 0
    v_smfmac_f32_16x16x64_bf16 v[36:39], v[20:23], a[80:87], v110
    s_waitcnt lgkmcnt(5)
    v_mov_b64 v[6:7], 0
    v_smfmac_f32_16x16x64_bf16 v[32:35], v[24:27], a[88:95], v110
    ds_read_b128 v[80:83], v125 offset:256
    v_mov_b64_e64 v[118:119], 0
    v_smfmac_f32_16x16x64_bf16 v[36:39], v[24:27], a[96:103], v110
    s_waitcnt lgkmcnt(5)
    v_smfmac_f32_16x16x64_bf16 v[32:35], v[28:31], a[104:111], v110
    s_nop 0
    ds_read_b128 v[84:87], v125 offset:1280
    v_smfmac_f32_16x16x64_bf16 v[36:39], v[28:31], a[112:119], v110
    s_nop 2
    v_smfmac_f32_16x16x64_bf16 v[40:43], v[8:11], a[120:127], v110
    s_nop 0
    ds_read_b128 v[88:91], v125 offset:4352
    v_add_f32 v32, v32, v34
    v_smfmac_f32_16x16x64_bf16 v[40:43], v[12:15], a[128:135], v110
    v_add_f32 v33, v33, v35
    v_smfmac_f32_16x16x64_bf16 v[40:43], v[16:19], a[136:143], v110
    ds_read_b128 v[92:95], v125 offset:5376
    v_add_f32 v36, v36, v38
    v_smfmac_f32_16x16x64_bf16 v[40:43], v[20:23], a[144:151], v110
    v_add_f32 v37, v37, v39
    v_smfmac_f32_16x16x64_bf16 v[40:43], v[24:27], a[152:159], v110
    v_cvt_pk_bf16_f32 v56, v32, v33
    v_smfmac_f32_16x16x64_bf16 v[40:43], v[28:31], a[160:167], v110
    s_nop 0
    s_nop 0
    v_cvt_pk_bf16_f32 v57, v36, v37
    v_smfmac_f32_16x16x64_bf16 v[44:47], v[8:11], a[168:175], v110
    s_nop 0
    ds_write_b32 v121, v56
    v_smfmac_f32_16x16x64_bf16 v[44:47], v[12:15], a[176:183], v110
    ds_write_b32 v121, v57 offset:4
    v_smfmac_f32_16x16x64_bf16 v[44:47], v[16:19], a[184:191], v110
    s_add_u32 s66, s66, 16384
    s_addc_u32 s67, s67, 0
    v_add_f32_e64 v40, v40, v42
    v_smfmac_f32_16x16x64_bf16 v[44:47], v[20:23], a[192:199], v110
    s_add_u32 s50, s50, 16384
    s_addc_u32 s51, s51, 0
    v_add_f32 v41, v41, v43
    v_smfmac_f32_16x16x64_bf16 v[44:47], v[24:27], a[200:207], v110
    s_add_u32 s46, s46, 4096
    s_addc_u32 s47, s47, 0
    v_cvt_pk_bf16_f32 v132, v40, v41
    v_smfmac_f32_16x16x64_bf16 v[44:47], v[28:31], a[208:215], v110
    s_waitcnt lgkmcnt(0)
    s_barrier
    ds_read_b64_tr_b16 v[56:57], v122 offset:0
    v_smfmac_f32_16x16x64_bf16 v[48:51], v[8:11], a[216:223], v110
    s_nop 0
    ds_read_b64_tr_b16 v[58:59], v122 offset:512
    ds_write_b32 v123, v132 offset:2560
    v_smfmac_f32_16x16x64_bf16 v[52:55], v[8:11], a[224:231], v110
    ds_read_b64_tr_b16 v[60:61], v122 offset:1024
    v_add_f32_e64 v44, v44, v46
    v_smfmac_f32_16x16x64_bf16 v[48:51], v[12:15], a[232:239], v110
    s_mov_b32 m0, s62
    ds_read_b64_tr_b16 v[62:63], v122 offset:1536
    v_add_f32 v45, v45, v47
    v_smfmac_f32_16x16x64_bf16 v[52:55], v[12:15], a[240:247], v110
    global_load_lds_dwordx4 v127, s[48:49] sc1
    v_cvt_pk_bf16_f32 v133, v44, v45
    v_smfmac_f32_16x16x64_bf16 v[48:51], v[16:19], a[248:255], v110
    ds_write_b32 v123, v133 offset:2576
    v_smfmac_f32_16x16x64_bf16 v[52:55], v[16:19], v[136:143], v110
    s_waitcnt lgkmcnt(4)
    global_load_lds_dwordx4 v127, s[48:49] offset:1024 sc1
    v_mov_b64 v[8:9], 0
    v_smfmac_f32_16x16x64_bf16 v[0:3], v[56:59], v[64:71], v110
    s_waitcnt lgkmcnt(1)
    ds_read_b128 v[64:67], v120 offset:18432
    v_mov_b64_e64 v[10:11], 0
    v_smfmac_f32_16x16x64_bf16 v[0:3], v[60:63], v[72:79], v110
    s_waitcnt vmcnt(5)
    ds_read_b128 v[68:71], v120 offset:19456
    v_mov_b64_e64 v[100:101], v[98:99]
    v_smfmac_f32_16x16x64_bf16 v[4:7], v[56:59], v[80:87], v110
    s_waitcnt lgkmcnt(2)
    s_barrier
    ds_read_b64_tr_b16 v[32:33], v124 offset:2560
    v_smfmac_f32_16x16x64_bf16 v[4:7], v[60:63], v[88:95], v110
    ds_read_b64_tr_b16 v[34:35], v124 offset:2640
    ds_read_b64_tr_b16 v[36:37], v124 offset:2880
    v_smfmac_f32_16x16x64_bf16 v[48:51], v[20:23], v[144:151], v110
    ds_read_b64_tr_b16 v[38:39], v124 offset:2960
    v_add_f32_e64 v0, v0, v2
    v_smfmac_f32_16x16x64_bf16 v[52:55], v[20:23], v[152:159], v110
    ds_read_b64_tr_b16 v[40:41], v124 offset:3840
    ds_read_b64_tr_b16 v[42:43], v124 offset:3920
    v_smfmac_f32_16x16x64_bf16 v[48:51], v[24:27], v[160:167], v110
    ds_read_b64_tr_b16 v[44:45], v124 offset:4160
    ds_read_b64_tr_b16 v[46:47], v124 offset:4240
    v_smfmac_f32_16x16x64_bf16 v[52:55], v[24:27], v[168:175], v110
    ds_read_b128 v[72:75], v120 offset:20480
    v_add_f32_e64 v1, v1, v3
    v_smfmac_f32_16x16x64_bf16 v[48:51], v[28:31], v[176:183], v110
    ds_read_b128 v[76:79], v120 offset:21504
    v_add_f32 v4, v4, v6
    v_smfmac_f32_16x16x64_bf16 v[52:55], v[28:31], v[184:191], v110
    s_waitcnt lgkmcnt(6)
    ds_read_b128 v[80:83], v120 offset:22528
    v_add_f32 v5, v5, v7
    v_smfmac_f32_16x16x64_bf16 v[8:11], v[56:59], v[32:39], v110
    s_waitcnt lgkmcnt(3)
    ds_read_b128 v[84:87], v120 offset:23552
    v_max_f32 v16, v0, v4
    v_smfmac_f32_16x16x64_bf16 v[8:11], v[60:63], v[40:47], v110
    s_nop 1
    v_max_f32 v17, v1, v5
    v_mov_b64 v[106:107], v[104:105]
    v_max_f32_dpp v16, v16, v16 row_ror:8 row_mask:0xf bank_mask:0xf
    v_max_f32_dpp v17, v17, v17 row_ror:8 row_mask:0xf bank_mask:0xf
    v_mov_b32 v15, 0
    v_pk_add_f32 v[48:49], v[48:49], v[50:51]
    v_pk_add_f32 v[8:9], v[8:9], v[10:11]
    v_max_f32 v16, v16, v8
    v_max_f32_e64 v17, v17, v9
    v_pk_add_f32 v[52:53], v[52:53], v[54:55]
    v_max_f32_dpp v16, v16, v16 row_ror:4 row_mask:0xf bank_mask:0xf
    v_max_f32_dpp v17, v17, v17 row_ror:4 row_mask:0xf bank_mask:0xf
    v_cvt_pk_bf16_f32 v98, v48, v49
    v_max_f32_dpp v16, v16, v16 row_ror:2 row_mask:0xf bank_mask:0xf
    v_max_f32_dpp v17, v17, v17 row_ror:2 row_mask:0xf bank_mask:0xf
    v_cvt_pk_bf16_f32 v104, v52, v53
    v_max_f32_dpp v16, v16, v16 row_ror:1 row_mask:0xf bank_mask:0xf
    v_max_f32_dpp v17, v17, v17 row_ror:1 row_mask:0xf bank_mask:0xf
    v_pk_mul_f32 v[18:19], v[16:17], s[52:53] neg_lo:[1,0] neg_hi:[1,0]
    v_pk_fma_f32 v[0:1], v[0:1], s[52:53], v[18:19]
    v_pk_fma_f32 v[4:5], v[4:5], s[52:53], v[18:19]
    v_pk_add_f32 v[20:21], v[18:19], v[110:111] op_sel:[0,1] op_sel_hi:[1,1]
    v_exp_f32 v0, v0
    v_pk_fma_f32 v[8:9], v[8:9], s[52:53], v[20:21]
    v_exp_f32 v1, v1
    v_exp_f32 v4, v4
    v_exp_f32 v5, v5
    v_cvt_pk_bf16_f32 v12, v0, v1
    v_cvt_pk_bf16_f32 v13, v4, v5
    v_exp_f32 v8, v8
    v_exp_f32 v9, v9
    v_mfma_f32_16x16x16_bf16 v[56:59], v[12:13], v[108:109], 0
    s_nop 0
    v_cvt_pk_bf16_f32 v14, v8, v9
    v_add_f32 v22, v0, v4
    v_add_f32_e64 v23, v1, v5
    v_mfma_f32_16x16x16_bf16 v[60:63], v[14:15], v[108:109], 0
    s_nop 0
    v_add_f32 v22, v22, v8
    v_add_f32_e64 v23, v23, v9
    v_cvt_pk_bf16_f32 v40, v56, v57
    v_add_f32_dpp v22, v22, v22 row_ror:8 row_mask:0xf bank_mask:0xf
    v_add_f32_dpp v23, v23, v23 row_ror:8 row_mask:0xf bank_mask:0xf
    v_cvt_pk_bf16_f32 v42, v58, v59
    v_add_f32_dpp v22, v22, v22 row_ror:4 row_mask:0xf bank_mask:0xf
    v_cvt_pk_bf16_f32 v41, v60, v61
    v_cvt_pk_bf16_f32 v43, v62, v63
    v_add_f32_dpp v23, v23, v23 row_ror:4 row_mask:0xf bank_mask:0xf
    v_add_f32_dpp v22, v22, v22 row_ror:2 row_mask:0xf bank_mask:0xf
    v_smfmac_f32_16x16x64_bf16 v[112:115], v[40:43], v[96:103], v110
    s_nop 0
    ds_read_b128 v[88:91], v120 offset:24576
    v_add_f32_dpp v23, v23, v23 row_ror:2 row_mask:0xf bank_mask:0xf
    v_smfmac_f32_16x16x64_bf16 v[116:119], v[40:43], v[102:109], v110
    s_nop 0
    ds_read_b128 v[92:95], v120 offset:25600
    v_add_f32_dpp v22, v22, v22 row_ror:1 row_mask:0xf bank_mask:0xf
    v_add_f32_dpp v23, v23, v23 row_ror:1 row_mask:0xf bank_mask:0xf
    v_rcp_f32 v22, v22
    v_rcp_f32 v23, v23
    v_pk_add_f32 v[112:113], v[112:113], v[114:115]
    v_pk_mul_f32 v[112:113], v[112:113], v[22:23]
    v_pk_add_f32 v[116:117], v[116:117], v[118:119]
    v_cvt_pk_bf16_f32 v130, v112, v113
    v_pk_mul_f32 v[116:117], v[116:117], v[22:23]
    v_cvt_pk_bf16_f32 v131, v116, v117
    ds_write2_b32 v123, v130, v131 offset0:0 offset1:4
    v_mov_b64 v[0:1], 0
    v_mov_b64 v[2:3], 0
    v_mov_b64 v[4:5], 0
    v_mov_b64 v[6:7], 0
    v_mov_b64 v[8:9], 0
    v_mov_b64 v[10:11], 0
    v_mov_b64 v[12:13], 0
    v_mov_b64 v[14:15], 0
    s_waitcnt lgkmcnt(0)
    s_barrier
    ds_read_b64_tr_b16 v[16:17], v124 offset:0
    ds_read_b64_tr_b16 v[18:19], v124 offset:80
    ds_read_b64_tr_b16 v[20:21], v124 offset:320
    ds_read_b64_tr_b16 v[22:23], v124 offset:400
    ds_read_b64_tr_b16 v[24:25], v124 offset:1280
    ds_read_b64_tr_b16 v[26:27], v124 offset:1360
    ds_read_b64_tr_b16 v[28:29], v124 offset:1600
    ds_read_b64_tr_b16 v[30:31], v124 offset:1680
    s_waitcnt lgkmcnt(6)
    v_smfmac_f32_16x16x64_bf16 v[0:3], v[16:19], v[64:71], v110 abid:1
    v_mov_b32 v134, v98
    v_smfmac_f32_16x16x64_bf16 v[4:7], v[16:19], v[72:79], v110 abid:1
    s_waitcnt lgkmcnt(4)
    ds_read_b128 v[64:67], v120 offset:26624
    v_smfmac_f32_16x16x64_bf16 v[0:3], v[20:23], v[80:87], v110 abid:1
    ds_read_b128 v[68:71], v120 offset:27648
    v_mov_b32 v135, v104
    v_smfmac_f32_16x16x64_bf16 v[4:7], v[20:23], v[88:95], v110 abid:1
    s_waitcnt lgkmcnt(4)
    ds_read_b128 v[72:75], v120 offset:28672
    v_smfmac_f32_16x16x64_bf16 v[0:3], v[24:27], v[192:199], v110 abid:1
    s_waitcnt lgkmcnt(3)
    ds_read_b128 v[76:79], v120 offset:29696
    v_smfmac_f32_16x16x64_bf16 v[0:3], v[28:31], v[200:207], v110 abid:1
    s_nop 0
    ds_read_b128 v[80:83], v120 offset:30720
    v_mov_b64 v[32:33], 0
    v_smfmac_f32_16x16x64_bf16 v[4:7], v[24:27], v[208:215], v110 abid:1
    s_nop 0
    ds_read_b128 v[84:87], v120 offset:31744
    v_mov_b64 v[34:35], 0
    v_smfmac_f32_16x16x64_bf16 v[4:7], v[28:31], v[216:223], v110 abid:1
    s_nop 0
    ds_read_b128 v[88:91], v120 offset:32768
    v_cvt_pk_bf16_f32 v56, v0, v1
    v_smfmac_f32_16x16x64_bf16 v[8:11], v[16:19], v[224:231], v110 abid:1
    s_waitcnt lgkmcnt(5)
    ds_read_b128 v[92:95], v120 offset:33792
    v_cvt_pk_bf16_f32 v57, v2, v3
    v_and_or_b32 v56, v56, -2, s35
    v_cvt_pk_bf16_f32 v58, v4, v5
    v_cvt_pk_bf16_f32 v59, v6, v7
    v_smfmac_f32_16x16x64_bf16 v[8:11], v[20:23], v[64:71], v110 abid:1
    global_store_dwordx4 v126, v[56:59], s[36:37] sc1
    v_smfmac_f32_16x16x64_bf16 v[8:11], v[24:27], v[232:239], v110 abid:1
    s_waitcnt lgkmcnt(4)
    v_smfmac_f32_16x16x64_bf16 v[8:11], v[28:31], v[72:79], v110 abid:1
    s_nop 1
    v_mov_b64_e64 v[36:37], 0
    v_smfmac_f32_16x16x64_bf16 v[12:15], v[16:19], v[240:247], v110 abid:1
    s_waitcnt lgkmcnt(2)
    s_nop 0
    v_mov_b64_e64 v[38:39], 0
    v_smfmac_f32_16x16x64_bf16 v[12:15], v[20:23], v[80:87], v110 abid:1
    s_add_u32 s48, s48, 16384
    s_addc_u32 s49, s49, 0
    v_cvt_pk_bf16_f32 v60, v8, v9
    v_smfmac_f32_16x16x64_bf16 v[12:15], v[24:27], v[248:255], v110 abid:1
    s_waitcnt lgkmcnt(0)
    v_cvt_pk_bf16_f32 v61, v10, v11
    v_smfmac_f32_16x16x64_bf16 v[12:15], v[28:31], v[88:95], v110 abid:1
    s_cmp_ge_u32 s30, 2
    s_nop 0
    v_and_or_b32 v60, v60, -2, s35
    v_mov_b64 v[40:41], 0
    v_mov_b64 v[42:43], 0
    v_mov_b64 v[44:45], 0
    v_mov_b64 v[46:47], 0
    v_mov_b64_e64 v[48:49], 0
    v_cvt_pk_bf16_f32 v62, v12, v13
    v_cvt_pk_bf16_f32 v63, v14, v15
    global_store_dwordx4 v126, v[60:63], s[38:39] sc1
    s_cbranch_scc1 L_rlates
    v_mov_b32 v130, 0x3f80
    v_cndmask_b32 v130, v130, 1.0, s[16:17]
    v_cndmask_b32 v112, 0, v130, s[8:9]
    v_cndmask_b32 v113, 0, v130, s[10:11]
    v_cndmask_b32 v114, 0, v130, s[12:13]
    v_cndmask_b32 v115, 0, v130, s[14:15]
    v_add_u32 v116, s4, v127
    v_add_u32 v117, s5, v127
    v_add_u32 v118, s6, v127
    v_add_u32 v119, s7, v127
    v_mov_b64 v[50:51], 0
    v_mov_b64 v[52:53], 0
    v_mov_b64 v[54:55], 0
    v_lshrrev_b32_e64 v130, 2, v127
    v_add_u32 v131, 163072, v130
    s_add_u32 s20, s34, 3
    s_min_u32 s20, s20, 64
    ds_read_b32 v131, v131
    s_mov_b64 exec, 6
    s_waitcnt lgkmcnt(0)
    v_cmp_gt_u32 vcc, s20, v131
    s_cbranch_vccnz L_rlv2es
L_rlvbes:
    s_mov_b64 exec, -1
    s_nop 7
    global_load_dwordx4 v[16:19], v127, s[40:41] sc1
    global_load_dwordx4 v[20:23], v127, s[40:41] offset:1024 sc1
    s_lshl_b32 s58, s30, 10
    s_add_u32 s56, s42, s58
    s_addc_u32 s57, s43, 0
    s_add_u32 s58, s56, 4096
    s_addc_u32 s59, s57, 0
    s_mov_b32 s54, 0
    s_add_u32 s34, s34, 1
    v_mov_b32_e64 v12, -1
    ds_read_b128 v[64:67], v120 offset:0
    ds_read_b128 v[68:71], v120 offset:1024
    ds_read_b128 v[72:75], v120 offset:2048
    ds_read_b128 v[76:79], v120 offset:3072
    ds_read_b128 v[80:83], v120 offset:4096
    ds_read_b128 v[84:87], v120 offset:5120
    ds_read_b128 v[88:91], v120 offset:6144
    ds_read_b128 v[92:95], v120 offset:7168
    ds_read_b128 v[96:99], v120 offset:16384
    ds_read_b128 v[100:103], v120 offset:17408
    s_waitcnt vmcnt(1)
    v_mfma_f32_16x16x32_bf16 v[8:11], v[112:115], v[16:19], 0
    v_xor_b32 v130, s35, v16
    s_waitcnt vmcnt(0)
    v_mfma_f32_16x16x32_bf16 v[8:11], v[112:115], v[20:23], v[8:11]
    s_nop 0
    v_bitop3_b32 v130, v130, s35, v20 bitop3:0xf6
    v_and_b32 v130, 1, v130
    v_cmp_ne_u32 vcc, 0, v130
    s_nop 3
    v_add_f32_dpp v8, v8, v8 row_ror:4 row_mask:0xf bank_mask:0xf
    v_add_f32_dpp v9, v9, v9 row_ror:4 row_mask:0xf bank_mask:0xf
    s_cbranch_vccnz L_rfes
L_rokes:
    v_add_f32_dpp v8, v8, v8 row_ror:8 row_mask:0xf bank_mask:0xf
    v_add_f32_dpp v9, v9, v9 row_ror:8 row_mask:0xf bank_mask:0xf
    v_cvt_pk_bf16_f32 v130, v8, v9
    s_mov_b64 exec, s[64:65]
    s_xor_b32 s35, s35, 1
    global_store_dword v129, v130, s[42:43] sc1
    global_store_dword v129, v12, s[44:45] sc1
    s_mov_b64 exec, -1
    s_barrier
    s_mov_b64 s[60:61], s[42:43]
    s_mov_b64 s[42:43], s[44:45]
    s_mov_b64 s[44:45], s[60:61]
    s_waitcnt lgkmcnt(0)
    s_nop 2
    s_cmp_lt_u32 s34, 63
    s_cbranch_scc1 L_rtms
    s_branch L_rtzs
L_rfes:
    global_load_dwordx4 v[16:19], v127, s[40:41] sc1
    global_load_dwordx4 v[20:23], v127, s[40:41] offset:1024 sc1
    s_waitcnt vmcnt(1)
    v_mfma_f32_16x16x32_bf16 v[8:11], v[112:115], v[16:19], 0
    v_xor_b32_e64 v130, s35, v16
    s_waitcnt vmcnt(0)
    v_mfma_f32_16x16x32_bf16 v[8:11], v[112:115], v[20:23], v[8:11]
    s_nop 0
    v_bitop3_b32 v130, v130, s35, v20 bitop3:0xf6
    v_and_b32 v130, 1, v130
    v_cmp_ne_u32 vcc, 0, v130
    s_nop 3
    v_add_f32_dpp v8, v8, v8 row_ror:4 row_mask:0xf bank_mask:0xf
    v_add_f32_dpp v9, v9, v9 row_ror:4 row_mask:0xf bank_mask:0xf
    s_cbranch_vccz L_rokes
    s_add_u32 s54, s54, 1
    s_cmp_gt_u32 s54, 400000
    s_cbranch_scc1 L_rdones
    s_branch L_rfes
L_rlates:
    v_mov_b32 v130, 0x3f80
    v_cndmask_b32 v130, v130, 1.0, s[16:17]
    v_cndmask_b32 v112, 0, v130, s[8:9]
    v_cndmask_b32 v113, 0, v130, s[10:11]
    v_cndmask_b32 v114, 0, v130, s[12:13]
    v_cndmask_b32 v115, 0, v130, s[14:15]
    v_add_u32 v116, s4, v127
    v_add_u32 v117, s5, v127
    v_add_u32 v118, s6, v127
    v_add_u32 v119, s7, v127
    v_mov_b64 v[50:51], 0
    v_mov_b64 v[52:53], 0
    v_mov_b64 v[54:55], 0
    v_lshrrev_b32 v130, 2, v127
    v_add_u32 v131, 163072, v130
    s_add_u32 s20, s34, 3
    s_min_u32 s20, s20, 64
    ds_read_b32 v131, v131
    s_mov_b64 exec, 6
    s_waitcnt lgkmcnt(0)
    v_cmp_gt_u32 vcc, s20, v131
    s_cbranch_vccnz L_rlv2ls
L_rlvbls:
    s_mov_b64 exec, -1
    s_nop 15
    s_nop 15
    s_nop 1
    global_load_dwordx4 v[16:19], v127, s[40:41] sc1
    global_load_dwordx4 v[20:23], v127, s[40:41] offset:1024 sc1
    s_lshl_b32 s58, s30, 10
    s_add_u32 s56, s42, s58
    s_addc_u32 s57, s43, 0
    s_add_u32 s58, s56, 4096
    s_addc_u32 s59, s57, 0
    s_mov_b32 s54, 0
    s_add_u32 s34, s34, 1
    v_mov_b32 v12, -1
    s_nop 15
    global_load_dwordx4 v[24:27], v127, s[40:41] sc1
    global_load_dwordx4 v[28:31], v127, s[40:41] offset:1024 sc1
    ds_read_b128 v[64:67], v120 offset:0
    ds_read_b128 v[68:71], v120 offset:1024
    ds_read_b128 v[72:75], v120 offset:2048
    ds_read_b128 v[76:79], v120 offset:3072
    ds_read_b128 v[80:83], v120 offset:4096
    ds_read_b128 v[84:87], v120 offset:5120
    ds_read_b128 v[88:91], v120 offset:6144
    ds_read_b128 v[92:95], v120 offset:7168
    ds_read_b128 v[96:99], v120 offset:16384
    ds_read_b128 v[100:103], v120 offset:17408
    s_waitcnt vmcnt(3)
    v_mfma_f32_16x16x32_bf16 v[8:11], v[112:115], v[16:19], 0
    v_xor_b32_e64 v130, s35, v16
    s_waitcnt vmcnt(2)
    v_mfma_f32_16x16x32_bf16 v[8:11], v[112:115], v[20:23], v[8:11]
    s_nop 0
    v_bitop3_b32 v130, v130, s35, v20 bitop3:0xf6
    v_and_b32 v130, 1, v130
    v_cmp_ne_u32 vcc, 0, v130
    s_nop 0
    s_nop 2
    v_add_f32_dpp v8, v8, v8 row_ror:4 row_mask:0xf bank_mask:0xf
    v_add_f32_dpp v9, v9, v9 row_ror:4 row_mask:0xf bank_mask:0xf
    s_cbranch_vccnz L_rfls
L_rokls:
    v_add_f32_dpp v8, v8, v8 row_ror:8 row_mask:0xf bank_mask:0xf
    v_add_f32_dpp v9, v9, v9 row_ror:8 row_mask:0xf bank_mask:0xf
    v_cvt_pk_bf16_f32 v130, v8, v9
    s_mov_b64 exec, s[64:65]
    s_xor_b32 s35, s35, 1
    global_store_dword v129, v130, s[42:43] sc1
    global_store_dword v129, v12, s[44:45] sc1
    s_mov_b64 exec, -1
    s_barrier
    s_mov_b64 s[60:61], s[42:43]
    s_mov_b64 s[42:43], s[44:45]
    s_mov_b64 s[44:45], s[60:61]
    s_waitcnt lgkmcnt(0)
    s_nop 2
    s_cmp_lt_u32 s34, 63
    s_cbranch_scc1 L_rtms
    s_branch L_rtzs
L_rfls:
    global_load_dwordx4 v[16:19], v127, s[40:41] sc1
    global_load_dwordx4 v[20:23], v127, s[40:41] offset:1024 sc1
    s_waitcnt vmcnt(3)
    v_mfma_f32_16x16x32_bf16 v[8:11], v[112:115], v[24:27], 0
    v_xor_b32 v130, s35, v24
    s_waitcnt vmcnt(2)
    v_mfma_f32_16x16x32_bf16 v[8:11], v[112:115], v[28:31], v[8:11]
    s_nop 0
    v_bitop3_b32 v130, v130, s35, v28 bitop3:0xf6
    v_and_b32 v130, 1, v130
    v_cmp_ne_u32 vcc, 0, v130
    s_nop 0
    s_nop 2
    v_add_f32_dpp v8, v8, v8 row_ror:4 row_mask:0xf bank_mask:0xf
    v_add_f32_dpp v9, v9, v9 row_ror:4 row_mask:0xf bank_mask:0xf
    s_cbranch_vccz L_rokls
    global_load_dwordx4 v[24:27], v127, s[40:41] sc1
    global_load_dwordx4 v[28:31], v127, s[40:41] offset:1024 sc1
    s_waitcnt vmcnt(3)
    v_mfma_f32_16x16x32_bf16 v[8:11], v[112:115], v[16:19], 0
    v_xor_b32_e64 v130, s35, v16
    s_waitcnt vmcnt(2)
    v_mfma_f32_16x16x32_bf16 v[8:11], v[112:115], v[20:23], v[8:11]
    s_nop 0
    v_bitop3_b32 v130, v130, s35, v20 bitop3:0xf6
    v_and_b32 v130, 1, v130
    v_cmp_ne_u32 vcc, 0, v130
    s_nop 0
    s_nop 2
    v_add_f32_dpp v8, v8, v8 row_ror:4 row_mask:0xf bank_mask:0xf
    v_add_f32_dpp v9, v9, v9 row_ror:4 row_mask:0xf bank_mask:0xf
    s_cbranch_vccz L_rokls
    s_add_u32 s54, s54, 1
    s_cmp_gt_u32 s54, 400000
    s_cbranch_scc1 L_rdones
    s_branch L_rfls
L_rlv2es:
    global_load_dword v131, v130, s[68:69] offset:256 sc1
    s_add_u32 s54, s54, 1
    s_cmp_gt_u32 s54, 400000
    s_cbranch_scc1 L_rdones
    s_waitcnt vmcnt(0)
    v_cmp_gt_u32 vcc, s20, v131
    s_cbranch_vccnz L_rlv2es
    s_branch L_rlvbes
L_rlv2ls:
    global_load_dword v131, v130, s[68:69] offset:256 sc1
    s_add_u32 s54, s54, 1
    s_cmp_gt_u32 s54, 400000
    s_cbranch_scc1 L_rdones
    s_waitcnt vmcnt(0)
    v_cmp_gt_u32 vcc, s20, v131
    s_cbranch_vccnz L_rlv2ls
    s_branch L_rlvbls
L_rqzs:
    global_load_dwordx4 v[0:3], v127, s[56:57] sc1
    global_load_dwordx4 v[4:7], v127, s[58:59] sc1
    s_add_u32 s54, s54, 1
    s_cmp_gt_u32 s54, 400000
    s_cbranch_scc1 L_rdones
    s_branch L_rpzs
L_rtzs:
    global_load_dwordx4 v[0:3], v127, s[56:57] sc1
    global_load_dwordx4 v[4:7], v127, s[58:59] sc1
    s_nop 15
    s_nop 13
    global_load_dwordx4 v[0:3], v127, s[56:57] sc1
    global_load_dwordx4 v[4:7], v127, s[58:59] sc1
    s_waitcnt vmcnt(6)
    ds_read_b128 v[8:11], v120 offset:8192
    ds_read_b128 v[12:15], v120 offset:9216
    ds_read_b128 v[16:19], v120 offset:10240
    ds_read_b128 v[20:23], v120 offset:11264
    ds_read_b128 v[24:27], v120 offset:12288
    ds_read_b128 v[28:31], v120 offset:13312
    ds_read_b128 v[56:59], v120 offset:14336
    ds_read_b128 v[60:63], v120 offset:15360
    s_waitcnt lgkmcnt(0)
L_rpzs:
    s_waitcnt vmcnt(3)
    v_max3_u32 v130, v0, v1, v2
    v_max_u32 v130, v130, v3
    s_waitcnt vmcnt(2)
    v_max3_u32 v130, v130, v4, v5
    v_max3_u32 v130, v130, v6, v7
    v_cmp_eq_u32 vcc, -1, v130
    ds_write_b128 v116, v[0:3]
    s_cbranch_vccnz L_rqzs
    v_smfmac_f32_16x16x64_bf16 v[40:43], v[0:3], v[24:31], v110
    ds_write_b128 v116, v[4:7] offset:4096
    v_smfmac_f32_16x16x64_bf16 v[44:47], v[0:3], v[96:103], v110
    v_smfmac_f32_16x16x64_bf16 v[48:51], v[0:3], v[64:71], v110
    v_smfmac_f32_16x16x64_bf16 v[52:55], v[0:3], v[72:79], v110
    v_smfmac_f32_16x16x64_bf16 v[40:43], v[4:7], v[56:63], v110
    v_smfmac_f32_16x16x64_bf16 v[44:47], v[4:7], a[0:7], v110
    v_smfmac_f32_16x16x64_bf16 v[48:51], v[4:7], a[8:15], v110
    v_smfmac_f32_16x16x64_bf16 v[52:55], v[4:7], a[16:23], v110
    s_waitcnt lgkmcnt(0)
    s_barrier
    ds_read_b128 v[8:11], v117 offset:0
    ds_read_b128 v[12:15], v118 offset:0
    ds_read_b128 v[16:19], v119 offset:0
    ds_read_b128 v[20:23], v117 offset:4096
    ds_read_b128 v[24:27], v118 offset:4096
    ds_read_b128 v[28:31], v119 offset:4096
    global_store_dwordx4 v127, v[132:135], s[46:47] sc1
    s_add_u32 s46, s46, 4096
    s_addc_u32 s47, s47, 0
    s_waitcnt lgkmcnt(5)
    v_smfmac_f32_16x16x64_bf16 v[40:43], v[8:11], a[120:127], v110
    s_waitcnt lgkmcnt(4)
    v_smfmac_f32_16x16x64_bf16 v[40:43], v[12:15], a[128:135], v110
    s_waitcnt lgkmcnt(3)
    v_smfmac_f32_16x16x64_bf16 v[40:43], v[16:19], a[136:143], v110
    s_waitcnt lgkmcnt(2)
    v_smfmac_f32_16x16x64_bf16 v[40:43], v[20:23], a[144:151], v110
    s_waitcnt lgkmcnt(1)
    v_smfmac_f32_16x16x64_bf16 v[40:43], v[24:27], a[152:159], v110
    s_waitcnt lgkmcnt(0)
    v_smfmac_f32_16x16x64_bf16 v[40:43], v[28:31], a[160:167], v110
    v_smfmac_f32_16x16x64_bf16 v[44:47], v[8:11], a[168:175], v110
    v_smfmac_f32_16x16x64_bf16 v[44:47], v[12:15], a[176:183], v110
    v_smfmac_f32_16x16x64_bf16 v[44:47], v[16:19], a[184:191], v110
    v_smfmac_f32_16x16x64_bf16 v[44:47], v[20:23], a[192:199], v110
    v_smfmac_f32_16x16x64_bf16 v[44:47], v[24:27], a[200:207], v110
    v_smfmac_f32_16x16x64_bf16 v[44:47], v[28:31], a[208:215], v110
    v_smfmac_f32_16x16x64_bf16 v[48:51], v[8:11], a[216:223], v110
    v_smfmac_f32_16x16x64_bf16 v[52:55], v[8:11], a[224:231], v110
    v_smfmac_f32_16x16x64_bf16 v[48:51], v[12:15], a[232:239], v110
    v_smfmac_f32_16x16x64_bf16 v[52:55], v[12:15], a[240:247], v110
    v_smfmac_f32_16x16x64_bf16 v[48:51], v[16:19], a[248:255], v110
    v_smfmac_f32_16x16x64_bf16 v[52:55], v[16:19], v[136:143], v110
    v_smfmac_f32_16x16x64_bf16 v[48:51], v[20:23], v[144:151], v110
    v_smfmac_f32_16x16x64_bf16 v[52:55], v[20:23], v[152:159], v110
    v_smfmac_f32_16x16x64_bf16 v[48:51], v[24:27], v[160:167], v110
    v_smfmac_f32_16x16x64_bf16 v[52:55], v[24:27], v[168:175], v110
    v_smfmac_f32_16x16x64_bf16 v[48:51], v[28:31], v[176:183], v110
    v_smfmac_f32_16x16x64_bf16 v[52:55], v[28:31], v[184:191], v110
    v_pk_add_f32 v[40:41], v[40:41], v[42:43]
    v_pk_add_f32 v[44:45], v[44:45], v[46:47]
    s_nop 4
    v_pk_add_f32 v[48:49], v[48:49], v[50:51]
    v_pk_add_f32 v[52:53], v[52:53], v[54:55]
    v_cvt_pk_bf16_f32 v132, v40, v41
    v_cvt_pk_bf16_f32 v133, v44, v45
    v_cvt_pk_bf16_f32 v134, v48, v49
    v_cvt_pk_bf16_f32 v135, v52, v53
    global_store_dwordx4 v127, v[132:135], s[46:47] sc1
L_rdones:
L_rend:
    s_branch L_fin
L_worker:
    v_and_b32 v1, 63, v0
    v_lshlrev_b32 v2, 4, v1
    s_cmp_gt_u32 s32, 3
    s_cbranch_scc1 L_w4
    s_sub_u32 s34, s32, 1
    s_add_u32 s48, s28, 589824
    s_addc_u32 s49, s29, 0
    s_mul_i32 s61, s31, 128
    s_add_u32 s48, s48, s61
    s_addc_u32 s49, s49, 0
    s_mul_i32 s61, s32, 4
    s_add_u32 s48, s48, s61
    s_addc_u32 s49, s49, 0
    s_cmp_lg_u32 s34, 2
    s_cbranch_scc1 L_gw8
    s_cmp_eq_u32 s55, 1
    s_cbranch_scc1 L_cf9
    v_mov_b32 v252, 163836
    s_cmp_lg_u32 s30, 0
    s_cbranch_scc1 L_cg9
    s_waitcnt vmcnt(0)
    s_mov_b64 exec, 1
    ds_write_b32 v252, v253
    s_waitcnt lgkmcnt(0)
    s_mov_b64 exec, -1
L_cg9:
    s_barrier
    ds_read_b32 v253, v252
    s_waitcnt lgkmcnt(0)
    v_readfirstlane_b32 s56, v253
    s_barrier
    s_bitcmp1_b32 s56, s31
    s_cbranch_scc1 L_lost
L_cf9:
    s_mov_b32 s55, 1
    s_cmp_lg_u32 s30, 0
    s_cbranch_scc1 L_wdn10
    v_mbcnt_lo_u32_b32 v6, -1, 0
    v_mbcnt_hi_u32_b32 v6, -1, v6
    v_lshlrev_b32 v6, 2, v6
    s_mov_b32 exec_lo, 0x20200
    s_mov_b32 exec_hi, 0x0
    s_mov_b32 s54, 0
    s_branch L_wf10
L_wd10:
    s_sleep 8
L_wf10:
    global_load_dword v7, v6, s[26:27] sc1
    s_add_u32 s54, s54, 1
    s_cmp_gt_u32 s54, 400000
    s_cbranch_scc1 L_end
    s_waitcnt vmcnt(0)
    v_cmp_gt_u32 vcc, 1, v7
    s_cbranch_vccnz L_wd10
    s_mov_b64 exec, -1
L_wdn10:
    s_barrier
L_gw8:
    s_mov_b64 s[36:37], s[10:11]
    s_cmp_eq_u32 s34, 1
    s_cselect_b32 s36, s12, s36
    s_cselect_b32 s37, s13, s37
    s_cmp_eq_u32 s34, 2
    s_cselect_b32 s36, s8, s36
    s_cselect_b32 s37, s9, s37
    s_add_u32 s36, s36, 0
    s_addc_u32 s37, s37, 0
    s_mul_i32 s61, s31, 256
    s_add_u32 s36, s36, s61
    s_addc_u32 s37, s37, 0
    s_mul_i32 s61, s30, 1048576
    s_add_u32 s36, s36, s61
    s_addc_u32 s37, s37, 0
    v_lshrrev_b32 v4, 4, v1
    v_lshlrev_b32 v5, 6, v4
    v_and_b32 v6, 0xf0, v2
    v_xor_b32 v5, v5, v6
    v_lshl_add_u32 v4, v4, 13, v5
    s_lshl_b32 s58, s30, 15
    s_mov_b32 m0, s58
    s_add_u32 s58, s58, 1024
    global_load_lds_dwordx4 v4, s[36:37]
    s_add_u32 s36, s36, 32768
    s_addc_u32 s37, s37, 0
    s_mov_b32 m0, s58
    s_add_u32 s58, s58, 1024
    global_load_lds_dwordx4 v4, s[36:37]
    s_add_u32 s36, s36, 32768
    s_addc_u32 s37, s37, 0
    s_mov_b32 m0, s58
    s_add_u32 s58, s58, 1024
    global_load_lds_dwordx4 v4, s[36:37]
    s_add_u32 s36, s36, 32768
    s_addc_u32 s37, s37, 0
    s_mov_b32 m0, s58
    s_add_u32 s58, s58, 1024
    global_load_lds_dwordx4 v4, s[36:37]
    s_add_u32 s36, s36, 32768
    s_addc_u32 s37, s37, 0
    s_mov_b32 m0, s58
    s_add_u32 s58, s58, 1024
    global_load_lds_dwordx4 v4, s[36:37]
    s_add_u32 s36, s36, 32768
    s_addc_u32 s37, s37, 0
    s_mov_b32 m0, s58
    s_add_u32 s58, s58, 1024
    global_load_lds_dwordx4 v4, s[36:37]
    s_add_u32 s36, s36, 32768
    s_addc_u32 s37, s37, 0
    s_mov_b32 m0, s58
    s_add_u32 s58, s58, 1024
    global_load_lds_dwordx4 v4, s[36:37]
    s_add_u32 s36, s36, 32768
    s_addc_u32 s37, s37, 0
    s_mov_b32 m0, s58
    s_add_u32 s58, s58, 1024
    global_load_lds_dwordx4 v4, s[36:37]
    s_add_u32 s36, s36, 32768
    s_addc_u32 s37, s37, 0
    s_cmp_eq_u32 s55, 1
    s_cbranch_scc1 L_cf11
    v_mov_b32 v252, 163836
    s_cmp_lg_u32 s30, 0
    s_cbranch_scc1 L_cg11
    s_waitcnt vmcnt(8)
    s_mov_b64 exec, 1
    ds_write_b32 v252, v253
    s_waitcnt lgkmcnt(0)
    s_mov_b64 exec, -1
L_cg11:
    s_barrier
    ds_read_b32 v253, v252
    s_waitcnt lgkmcnt(0)
    v_readfirstlane_b32 s56, v253
    s_barrier
    s_bitcmp1_b32 s56, s31
    s_cbranch_scc1 L_lost
L_cf11:
    s_cmp_lg_u32 s30, 0
    s_cbranch_scc1 L_pg12
    v_mov_b32 v6, 0
    v_mov_b32 v7, 0
    s_mov_b64 exec, 1
    global_store_dword v6, v7, s[48:49] sc1
    s_mov_b64 exec, -1
L_pg12:
    s_mov_b32 m0, s58
    s_add_u32 s58, s58, 1024
    global_load_lds_dwordx4 v4, s[36:37]
    s_add_u32 s36, s36, 32768
    s_addc_u32 s37, s37, 0
    s_mov_b32 m0, s58
    s_add_u32 s58, s58, 1024
    global_load_lds_dwordx4 v4, s[36:37]
    s_add_u32 s36, s36, 32768
    s_addc_u32 s37, s37, 0
    s_mov_b32 m0, s58
    s_add_u32 s58, s58, 1024
    global_load_lds_dwordx4 v4, s[36:37]
    s_add_u32 s36, s36, 32768
    s_addc_u32 s37, s37, 0
    s_mov_b32 m0, s58
    s_add_u32 s58, s58, 1024
    global_load_lds_dwordx4 v4, s[36:37]
    s_add_u32 s36, s36, 32768
    s_addc_u32 s37, s37, 0
    s_mov_b32 m0, s58
    s_add_u32 s58, s58, 1024
    global_load_lds_dwordx4 v4, s[36:37]
    s_add_u32 s36, s36, 32768
    s_addc_u32 s37, s37, 0
    s_mov_b32 m0, s58
    s_add_u32 s58, s58, 1024
    global_load_lds_dwordx4 v4, s[36:37]
    s_add_u32 s36, s36, 32768
    s_addc_u32 s37, s37, 0
    s_mov_b32 m0, s58
    s_add_u32 s58, s58, 1024
    global_load_lds_dwordx4 v4, s[36:37]
    s_add_u32 s36, s36, 32768
    s_addc_u32 s37, s37, 0
    s_mov_b32 m0, s58
    s_add_u32 s58, s58, 1024
    global_load_lds_dwordx4 v4, s[36:37]
    s_add_u32 s36, s36, 32768
    s_addc_u32 s37, s37, 0
    s_mov_b32 m0, s58
    s_add_u32 s58, s58, 1024
    global_load_lds_dwordx4 v4, s[36:37]
    s_add_u32 s36, s36, 32768
    s_addc_u32 s37, s37, 0
    s_mov_b32 m0, s58
    s_add_u32 s58, s58, 1024
    global_load_lds_dwordx4 v4, s[36:37]
    s_add_u32 s36, s36, 32768
    s_addc_u32 s37, s37, 0
    s_mov_b32 m0, s58
    s_add_u32 s58, s58, 1024
    global_load_lds_dwordx4 v4, s[36:37]
    s_add_u32 s36, s36, 32768
    s_addc_u32 s37, s37, 0
    s_mov_b32 m0, s58
    s_add_u32 s58, s58, 1024
    global_load_lds_dwordx4 v4, s[36:37]
    s_add_u32 s36, s36, 32768
    s_addc_u32 s37, s37, 0
    s_mov_b32 m0, s58
    s_add_u32 s58, s58, 1024
    global_load_lds_dwordx4 v4, s[36:37]
    s_add_u32 s36, s36, 32768
    s_addc_u32 s37, s37, 0
    s_mov_b32 m0, s58
    s_add_u32 s58, s58, 1024
    global_load_lds_dwordx4 v4, s[36:37]
    s_add_u32 s36, s36, 32768
    s_addc_u32 s37, s37, 0
    s_mov_b32 m0, s58
    s_add_u32 s58, s58, 1024
    global_load_lds_dwordx4 v4, s[36:37]
    s_add_u32 s36, s36, 32768
    s_addc_u32 s37, s37, 0
    s_mov_b32 m0, s58
    s_add_u32 s58, s58, 1024
    global_load_lds_dwordx4 v4, s[36:37]
    s_add_u32 s36, s36, 32768
    s_addc_u32 s37, s37, 0
    s_mov_b32 m0, s58
    s_add_u32 s58, s58, 1024
    global_load_lds_dwordx4 v4, s[36:37]
    s_add_u32 s36, s36, 32768
    s_addc_u32 s37, s37, 0
    s_mov_b32 m0, s58
    s_add_u32 s58, s58, 1024
    global_load_lds_dwordx4 v4, s[36:37]
    s_add_u32 s36, s36, 32768
    s_addc_u32 s37, s37, 0
    s_mov_b32 m0, s58
    s_add_u32 s58, s58, 1024
    global_load_lds_dwordx4 v4, s[36:37]
    s_add_u32 s36, s36, 32768
    s_addc_u32 s37, s37, 0
    s_mov_b32 m0, s58
    s_add_u32 s58, s58, 1024
    global_load_lds_dwordx4 v4, s[36:37]
    s_add_u32 s36, s36, 32768
    s_addc_u32 s37, s37, 0
    s_mov_b32 m0, s58
    s_add_u32 s58, s58, 1024
    global_load_lds_dwordx4 v4, s[36:37]
    s_add_u32 s36, s36, 32768
    s_addc_u32 s37, s37, 0
    s_mov_b32 m0, s58
    s_add_u32 s58, s58, 1024
    global_load_lds_dwordx4 v4, s[36:37]
    s_add_u32 s36, s36, 32768
    s_addc_u32 s37, s37, 0
    s_mov_b32 m0, s58
    s_add_u32 s58, s58, 1024
    global_load_lds_dwordx4 v4, s[36:37]
    s_add_u32 s36, s36, 32768
    s_addc_u32 s37, s37, 0
    s_mov_b32 m0, s58
    s_add_u32 s58, s58, 1024
    global_load_lds_dwordx4 v4, s[36:37]
    s_add_u32 s36, s36, 32768
    s_addc_u32 s37, s37, 0
    s_waitcnt vmcnt(0)
    s_barrier
    s_cmp_lg_u32 s30, 0
    s_cbranch_scc1 L_arr13
    s_lshl_b32 s56, s32, 5
    v_mov_b32 v6, s56
    v_mov_b32 v7, 1
    s_mov_b64 exec, 1
    global_atomic_add v6, v7, s[26:27] offset:4
    s_mov_b64 exec, -1
L_arr13:
    v_bfe_u32 v4, v1, 2, 2
    v_lshrrev_b32 v5, 5, v1
    v_lshl_add_u32 v5, v5, 3, v4
    v_lshlrev_b32 v5, 8, v5
    v_bfe_u32 v6, v1, 4, 1
    v_and_b32 v7, 3, v1
    v_lshl_add_u32 v6, v6, 2, v7
    v_lshlrev_b32 v6, 3, v6
    v_xor_b32 v4, s30, v4
    v_lshl_add_u32 v6, v4, 6, v6
    v_add_u32 v5, v5, v6
    v_add_u32 v6, 0x10000, v5
    ds_read_b64_tr_b16 a[0:1], v5 offset:0
    ds_read_b64_tr_b16 a[2:3], v5 offset:1024
    ds_read_b64_tr_b16 a[4:5], v5 offset:4096
    ds_read_b64_tr_b16 a[6:7], v5 offset:5120
    ds_read_b64_tr_b16 a[8:9], v5 offset:8192
    ds_read_b64_tr_b16 a[10:11], v5 offset:9216
    ds_read_b64_tr_b16 a[12:13], v5 offset:12288
    ds_read_b64_tr_b16 a[14:15], v5 offset:13312
    ds_read_b64_tr_b16 a[16:17], v5 offset:16384
    ds_read_b64_tr_b16 a[18:19], v5 offset:17408
    ds_read_b64_tr_b16 a[20:21], v5 offset:20480
    ds_read_b64_tr_b16 a[22:23], v5 offset:21504
    ds_read_b64_tr_b16 a[24:25], v5 offset:24576
    ds_read_b64_tr_b16 a[26:27], v5 offset:25600
    ds_read_b64_tr_b16 a[28:29], v5 offset:28672
    ds_read_b64_tr_b16 a[30:31], v5 offset:29696
    ds_read_b64_tr_b16 a[32:33], v5 offset:32768
    ds_read_b64_tr_b16 a[34:35], v5 offset:33792
    ds_read_b64_tr_b16 a[36:37], v5 offset:36864
    ds_read_b64_tr_b16 a[38:39], v5 offset:37888
    ds_read_b64_tr_b16 a[40:41], v5 offset:40960
    ds_read_b64_tr_b16 a[42:43], v5 offset:41984
    ds_read_b64_tr_b16 a[44:45], v5 offset:45056
    ds_read_b64_tr_b16 a[46:47], v5 offset:46080
    ds_read_b64_tr_b16 a[48:49], v5 offset:49152
    ds_read_b64_tr_b16 a[50:51], v5 offset:50176
    ds_read_b64_tr_b16 a[52:53], v5 offset:53248
    ds_read_b64_tr_b16 a[54:55], v5 offset:54272
    ds_read_b64_tr_b16 a[56:57], v5 offset:57344
    ds_read_b64_tr_b16 a[58:59], v5 offset:58368
    ds_read_b64_tr_b16 a[60:61], v5 offset:61440
    ds_read_b64_tr_b16 a[62:63], v5 offset:62464
    ds_read_b64_tr_b16 a[64:65], v6 offset:0
    ds_read_b64_tr_b16 a[66:67], v6 offset:1024
    ds_read_b64_tr_b16 a[68:69], v6 offset:4096
    ds_read_b64_tr_b16 a[70:71], v6 offset:5120
    ds_read_b64_tr_b16 a[72:73], v6 offset:8192
    ds_read_b64_tr_b16 a[74:75], v6 offset:9216
    ds_read_b64_tr_b16 a[76:77], v6 offset:12288
    ds_read_b64_tr_b16 a[78:79], v6 offset:13312
    ds_read_b64_tr_b16 a[80:81], v6 offset:16384
    ds_read_b64_tr_b16 a[82:83], v6 offset:17408
    ds_read_b64_tr_b16 a[84:85], v6 offset:20480
    ds_read_b64_tr_b16 a[86:87], v6 offset:21504
    ds_read_b64_tr_b16 a[88:89], v6 offset:24576
    ds_read_b64_tr_b16 a[90:91], v6 offset:25600
    ds_read_b64_tr_b16 a[92:93], v6 offset:28672
    ds_read_b64_tr_b16 a[94:95], v6 offset:29696
    ds_read_b64_tr_b16 a[96:97], v6 offset:32768
    ds_read_b64_tr_b16 a[98:99], v6 offset:33792
    ds_read_b64_tr_b16 a[100:101], v6 offset:36864
    ds_read_b64_tr_b16 a[102:103], v6 offset:37888
    ds_read_b64_tr_b16 a[104:105], v6 offset:40960
    ds_read_b64_tr_b16 a[106:107], v6 offset:41984
    ds_read_b64_tr_b16 a[108:109], v6 offset:45056
    ds_read_b64_tr_b16 a[110:111], v6 offset:46080
    ds_read_b64_tr_b16 a[112:113], v6 offset:49152
    ds_read_b64_tr_b16 a[114:115], v6 offset:50176
    ds_read_b64_tr_b16 a[116:117], v6 offset:53248
    ds_read_b64_tr_b16 a[118:119], v6 offset:54272
    ds_read_b64_tr_b16 a[120:121], v6 offset:57344
    ds_read_b64_tr_b16 a[122:123], v6 offset:58368
    ds_read_b64_tr_b16 a[124:125], v6 offset:61440
    ds_read_b64_tr_b16 a[126:127], v6 offset:62464
    s_waitcnt lgkmcnt(0)
    s_add_u32 s38, s28, 69206016
    s_addc_u32 s39, s29, 0
    s_mul_i32 s61, s30, 8192
    s_add_u32 s38, s38, s61
    s_addc_u32 s39, s39, 0
    s_mul_i32 s44, s30, 8320
    v_and_b32 v4, 31, v1
    v_mul_u32_u24 v4, 1040, v4
    v_lshrrev_b32 v5, 5, v1
    v_lshl_add_u32 v4, v5, 4, v4
    s_cmp_lg_u32 s30, 0
    s_cbranch_scc1 L_wdn14
    v_mbcnt_lo_u32_b32 v6, -1, 0
    v_mbcnt_hi_u32_b32 v6, -1, v6
    v_lshlrev_b32 v6, 2, v6
    s_mov_b32 exec_lo, 0x0
    s_mov_b32 exec_hi, 0x202
    s_mov_b32 s54, 0
    s_branch L_wf14
L_wd14:
    s_sleep 4
L_wf14:
    global_load_dword v7, v6, s[26:27] sc1
    s_add_u32 s54, s54, 1
    s_cmp_gt_u32 s54, 400000
    s_cbranch_scc1 L_end
    s_waitcnt vmcnt(0)
    v_cmp_gt_u32 vcc, 32, v7
    s_cbranch_vccnz L_wd14
    s_mov_b64 exec, -1
L_wdn14:
    s_barrier
    s_cmp_eq_u32 s34, 2
    s_cbranch_scc1 L_gq8
    s_add_u32 s40, s28, 33554432
    s_addc_u32 s41, s29, 0
    s_mul_i32 s61, s31, 1064960
    s_add_u32 s40, s40, s61
    s_addc_u32 s41, s41, 0
    s_mul_i32 s61, s34, 8192
    s_add_u32 s40, s40, s61
    s_addc_u32 s41, s41, 0
    s_mul_i32 s61, s30, 2048
    s_add_u32 s40, s40, s61
    s_addc_u32 s41, s41, 0
    s_mov_b32 s43, 16384
    s_cmp_eq_u32 s34, 0
    s_cbranch_scc1 L_gk8
    v_mov_b32 v80, -1
    v_mov_b32 v81, -1
    v_mov_b32 v82, -1
    v_mov_b32 v83, -1
    s_add_u32 s46, s28, 4198400
    s_addc_u32 s47, s29, 0
    s_mul_i32 s61, s31, 266240
    s_add_u32 s46, s46, s61
    s_addc_u32 s47, s47, 0
    s_mul_i32 s61, s30, 1024
    s_add_u32 s46, s46, s61
    s_addc_u32 s47, s47, 0
    s_mov_b32 m0, s44
    s_nop 0
    global_load_lds_dwordx4 v2, s[38:39] sc1
    s_add_u32 s38, s38, 1024
    s_addc_u32 s39, s39, 0
    s_add_u32 m0, m0, 1040
    s_nop 0
    global_load_lds_dwordx4 v2, s[38:39] sc1
    s_add_u32 s38, s38, 1024
    s_addc_u32 s39, s39, 0
    s_add_u32 m0, m0, 1040
    s_nop 0
    global_load_lds_dwordx4 v2, s[38:39] sc1
    s_add_u32 s38, s38, 1024
    s_addc_u32 s39, s39, 0
    s_add_u32 m0, m0, 1040
    s_nop 0
    global_load_lds_dwordx4 v2, s[38:39] sc1
    s_add_u32 s38, s38, 1024
    s_addc_u32 s39, s39, 0
    s_add_u32 m0, m0, 1040
    s_nop 0
    global_load_lds_dwordx4 v2, s[38:39] sc1
    s_add_u32 s38, s38, 1024
    s_addc_u32 s39, s39, 0
    s_add_u32 m0, m0, 1040
    s_nop 0
    global_load_lds_dwordx4 v2, s[38:39] sc1
    s_add_u32 s38, s38, 1024
    s_addc_u32 s39, s39, 0
    s_add_u32 m0, m0, 1040
    s_nop 0
    global_load_lds_dwordx4 v2, s[38:39] sc1
    s_add_u32 s38, s38, 1024
    s_addc_u32 s39, s39, 0
    s_add_u32 m0, m0, 1040
    s_nop 0
    global_load_lds_dwordx4 v2, s[38:39] sc1
    s_add_u32 s38, s38, 25600
    s_addc_u32 s39, s39, 0
    s_add_u32 s44, s44, 33280
    s_cmp_ge_u32 s44, 133120
    s_cselect_b32 s56, 133120, 0
    s_sub_u32 s44, s44, s56
    s_mov_b32 m0, s44
    s_nop 0
    global_load_lds_dwordx4 v2, s[38:39] sc1
    s_add_u32 s38, s38, 1024
    s_addc_u32 s39, s39, 0
    s_add_u32 m0, m0, 1040
    s_nop 0
    global_load_lds_dwordx4 v2, s[38:39] sc1
    s_add_u32 s38, s38, 1024
    s_addc_u32 s39, s39, 0
    s_add_u32 m0, m0, 1040
    s_nop 0
    global_load_lds_dwordx4 v2, s[38:39] sc1
    s_add_u32 s38, s38, 1024
    s_addc_u32 s39, s39, 0
    s_add_u32 m0, m0, 1040
    s_nop 0
    global_load_lds_dwordx4 v2, s[38:39] sc1
    s_add_u32 s38, s38, 1024
    s_addc_u32 s39, s39, 0
    s_add_u32 m0, m0, 1040
    s_nop 0
    global_load_lds_dwordx4 v2, s[38:39] sc1
    s_add_u32 s38, s38, 1024
    s_addc_u32 s39, s39, 0
    s_add_u32 m0, m0, 1040
    s_nop 0
    global_load_lds_dwordx4 v2, s[38:39] sc1
    s_add_u32 s38, s38, 1024
    s_addc_u32 s39, s39, 0
    s_add_u32 m0, m0, 1040
    s_nop 0
    global_load_lds_dwordx4 v2, s[38:39] sc1
    s_add_u32 s38, s38, 1024
    s_addc_u32 s39, s39, 0
    s_add_u32 m0, m0, 1040
    s_nop 0
    global_load_lds_dwordx4 v2, s[38:39] sc1
    s_add_u32 s38, s38, 25600
    s_addc_u32 s39, s39, 0
    s_add_u32 s44, s44, 33280
    s_cmp_ge_u32 s44, 133120
    s_cselect_b32 s56, 133120, 0
    s_sub_u32 s44, s44, s56
    s_mov_b32 m0, s44
    s_nop 0
    global_load_lds_dwordx4 v2, s[38:39] sc1
    s_add_u32 s38, s38, 1024
    s_addc_u32 s39, s39, 0
    s_add_u32 m0, m0, 1040
    s_nop 0
    global_load_lds_dwordx4 v2, s[38:39] sc1
    s_add_u32 s38, s38, 1024
    s_addc_u32 s39, s39, 0
    s_add_u32 m0, m0, 1040
    s_nop 0
    global_load_lds_dwordx4 v2, s[38:39] sc1
    s_add_u32 s38, s38, 1024
    s_addc_u32 s39, s39, 0
    s_add_u32 m0, m0, 1040
    s_nop 0
    global_load_lds_dwordx4 v2, s[38:39] sc1
    s_add_u32 s38, s38, 1024
    s_addc_u32 s39, s39, 0
    s_add_u32 m0, m0, 1040
    s_nop 0
    global_load_lds_dwordx4 v2, s[38:39] sc1
    s_add_u32 s38, s38, 1024
    s_addc_u32 s39, s39, 0
    s_add_u32 m0, m0, 1040
    s_nop 0
    global_load_lds_dwordx4 v2, s[38:39] sc1
    s_add_u32 s38, s38, 1024
    s_addc_u32 s39, s39, 0
    s_add_u32 m0, m0, 1040
    s_nop 0
    global_load_lds_dwordx4 v2, s[38:39] sc1
    s_add_u32 s38, s38, 1024
    s_addc_u32 s39, s39, 0
    s_add_u32 m0, m0, 1040
    s_nop 0
    global_load_lds_dwordx4 v2, s[38:39] sc1
    s_add_u32 s38, s38, 25600
    s_addc_u32 s39, s39, 0
    s_add_u32 s44, s44, 33280
    s_cmp_ge_u32 s44, 133120
    s_cselect_b32 s56, 133120, 0
    s_sub_u32 s44, s44, s56
    s_waitcnt vmcnt(16)
    s_barrier
    ds_read_b128 v[8:11], v4 offset:0
    ds_read_b128 v[12:15], v4 offset:32
    ds_read_b128 v[16:19], v4 offset:64
    ds_read_b128 v[20:23], v4 offset:96
    ds_read_b128 v[24:27], v4 offset:128
    ds_read_b128 v[28:31], v4 offset:160
    s_waitcnt lgkmcnt(5)
    v_mfma_f32_32x32x16_bf16 v[40:55], v[8:11], a[0:3], 0
    ds_read_b128 v[32:35], v4 offset:192
    s_mov_b32 m0, s44
    s_nop 0
    global_load_lds_dwordx4 v2, s[38:39] sc1
    s_add_u32 s38, s38, 1024
    s_waitcnt lgkmcnt(5)
    v_mfma_f32_32x32x16_bf16 v[40:55], v[12:15], a[4:7], v[40:55]
    ds_read_b128 v[36:39], v4 offset:224
    s_addc_u32 s39, s39, 0
    s_add_u32 m0, m0, 1040
    s_nop 0
    global_load_lds_dwordx4 v2, s[38:39] sc1
    s_waitcnt lgkmcnt(5)
    v_mfma_f32_32x32x16_bf16 v[40:55], v[16:19], a[8:11], v[40:55]
    ds_read_b128 v[8:11], v4 offset:256
    s_add_u32 s38, s38, 1024
    s_addc_u32 s39, s39, 0
    s_add_u32 m0, m0, 1040
    s_waitcnt lgkmcnt(5)
    v_mfma_f32_32x32x16_bf16 v[40:55], v[20:23], a[12:15], v[40:55]
    ds_read_b128 v[12:15], v4 offset:288
    global_load_lds_dwordx4 v2, s[38:39] sc1
    s_add_u32 s38, s38, 1024
    s_addc_u32 s39, s39, 0
    s_waitcnt lgkmcnt(5)
    v_mfma_f32_32x32x16_bf16 v[40:55], v[24:27], a[16:19], v[40:55]
    ds_read_b128 v[16:19], v4 offset:320
    s_add_u32 m0, m0, 1040
    s_nop 0
    global_load_lds_dwordx4 v2, s[38:39] sc1
    s_add_u32 s38, s38, 1024
    s_waitcnt lgkmcnt(5)
    v_mfma_f32_32x32x16_bf16 v[40:55], v[28:31], a[20:23], v[40:55]
    ds_read_b128 v[20:23], v4 offset:352
    s_addc_u32 s39, s39, 0
    s_add_u32 m0, m0, 1040
    s_nop 0
    global_load_lds_dwordx4 v2, s[38:39] sc1
    s_waitcnt lgkmcnt(5)
    v_mfma_f32_32x32x16_bf16 v[40:55], v[32:35], a[24:27], v[40:55]
    ds_read_b128 v[24:27], v4 offset:384
    s_add_u32 s38, s38, 1024
    s_addc_u32 s39, s39, 0
    s_add_u32 m0, m0, 1040
    s_waitcnt lgkmcnt(5)
    v_mfma_f32_32x32x16_bf16 v[40:55], v[36:39], a[28:31], v[40:55]
    ds_read_b128 v[28:31], v4 offset:416
    global_load_lds_dwordx4 v2, s[38:39] sc1
    s_add_u32 s38, s38, 1024
    s_addc_u32 s39, s39, 0
    s_waitcnt lgkmcnt(5)
    v_mfma_f32_32x32x16_bf16 v[40:55], v[8:11], a[32:35], v[40:55]
    ds_read_b128 v[32:35], v4 offset:448
    s_add_u32 m0, m0, 1040
    s_nop 0
    global_load_lds_dwordx4 v2, s[38:39] sc1
    s_add_u32 s38, s38, 1024
    s_waitcnt lgkmcnt(5)
    v_mfma_f32_32x32x16_bf16 v[40:55], v[12:15], a[36:39], v[40:55]
    ds_read_b128 v[36:39], v4 offset:480
    s_addc_u32 s39, s39, 0
    s_add_u32 m0, m0, 1040
    s_nop 0
    global_load_lds_dwordx4 v2, s[38:39] sc1
    s_waitcnt lgkmcnt(5)
    v_mfma_f32_32x32x16_bf16 v[40:55], v[16:19], a[40:43], v[40:55]
    ds_read_b128 v[8:11], v4 offset:512
    s_add_u32 s38, s38, 25600
    s_addc_u32 s39, s39, 0
    s_add_u32 s44, s44, 33280
    s_waitcnt lgkmcnt(5)
    v_mfma_f32_32x32x16_bf16 v[40:55], v[20:23], a[44:47], v[40:55]
    ds_read_b128 v[12:15], v4 offset:544
    s_cmp_ge_u32 s44, 133120
    s_cselect_b32 s56, 133120, 0
    s_sub_u32 s44, s44, s56
    s_waitcnt lgkmcnt(5)
    v_mfma_f32_32x32x16_bf16 v[40:55], v[24:27], a[48:51], v[40:55]
    ds_read_b128 v[16:19], v4 offset:576
    s_waitcnt lgkmcnt(5)
    v_mfma_f32_32x32x16_bf16 v[40:55], v[28:31], a[52:55], v[40:55]
    ds_read_b128 v[20:23], v4 offset:608
    s_waitcnt lgkmcnt(5)
    v_mfma_f32_32x32x16_bf16 v[40:55], v[32:35], a[56:59], v[40:55]
    ds_read_b128 v[24:27], v4 offset:640
    s_waitcnt lgkmcnt(5)
    v_mfma_f32_32x32x16_bf16 v[40:55], v[36:39], a[60:63], v[40:55]
    ds_read_b128 v[28:31], v4 offset:672
    s_waitcnt lgkmcnt(5)
    v_mfma_f32_32x32x16_bf16 v[40:55], v[8:11], a[64:67], v[40:55]
    ds_read_b128 v[32:35], v4 offset:704
    s_waitcnt lgkmcnt(5)
    v_mfma_f32_32x32x16_bf16 v[40:55], v[12:15], a[68:71], v[40:55]
    ds_read_b128 v[36:39], v4 offset:736
    s_waitcnt lgkmcnt(5)
    v_mfma_f32_32x32x16_bf16 v[40:55], v[16:19], a[72:75], v[40:55]
    ds_read_b128 v[8:11], v4 offset:768
    s_waitcnt lgkmcnt(5)
    v_mfma_f32_32x32x16_bf16 v[40:55], v[20:23], a[76:79], v[40:55]
    ds_read_b128 v[12:15], v4 offset:800
    s_waitcnt lgkmcnt(5)
    v_mfma_f32_32x32x16_bf16 v[40:55], v[24:27], a[80:83], v[40:55]
    ds_read_b128 v[16:19], v4 offset:832
    s_waitcnt lgkmcnt(5)
    v_mfma_f32_32x32x16_bf16 v[40:55], v[28:31], a[84:87], v[40:55]
    ds_read_b128 v[20:23], v4 offset:864
    s_waitcnt lgkmcnt(5)
    v_mfma_f32_32x32x16_bf16 v[40:55], v[32:35], a[88:91], v[40:55]
    ds_read_b128 v[24:27], v4 offset:896
    s_waitcnt lgkmcnt(5)
    v_mfma_f32_32x32x16_bf16 v[40:55], v[36:39], a[92:95], v[40:55]
    ds_read_b128 v[28:31], v4 offset:928
    s_waitcnt lgkmcnt(5)
    v_mfma_f32_32x32x16_bf16 v[40:55], v[8:11], a[96:99], v[40:55]
    ds_read_b128 v[32:35], v4 offset:960
    s_waitcnt lgkmcnt(5)
    v_mfma_f32_32x32x16_bf16 v[40:55], v[12:15], a[100:103], v[40:55]
    ds_read_b128 v[36:39], v4 offset:992
    s_waitcnt lgkmcnt(5)
    v_mfma_f32_32x32x16_bf16 v[40:55], v[16:19], a[104:107], v[40:55]
    v_add_u32 v4, 33280, v4
    v_subrev_u32 v5, 133120, v4
    v_min_u32 v4, v4, v5
    s_waitcnt lgkmcnt(4)
    v_mfma_f32_32x32x16_bf16 v[40:55], v[20:23], a[108:111], v[40:55]
    s_waitcnt lgkmcnt(3)
    v_mfma_f32_32x32x16_bf16 v[40:55], v[24:27], a[112:115], v[40:55]
    s_waitcnt lgkmcnt(0)
    s_waitcnt vmcnt(16)
    s_barrier
    ds_read_b128 v[8:11], v4 offset:0
    ds_read_b128 v[12:15], v4 offset:32
    ds_read_b128 v[16:19], v4 offset:64
    v_mfma_f32_32x32x16_bf16 v[40:55], v[28:31], a[116:119], v[40:55]
    ds_read_b128 v[20:23], v4 offset:96
    v_mfma_f32_32x32x16_bf16 v[40:55], v[32:35], a[120:123], v[40:55]
    ds_read_b128 v[24:27], v4 offset:128
    v_mfma_f32_32x32x16_bf16 v[40:55], v[36:39], a[124:127], v[40:55]
    ds_read_b128 v[28:31], v4 offset:160
    s_waitcnt lgkmcnt(5)
    v_mfma_f32_32x32x16_bf16 v[56:71], v[8:11], a[0:3], 0
    ds_read_b128 v[32:35], v4 offset:192
    s_mov_b32 m0, s44
    s_nop 0
    global_load_lds_dwordx4 v2, s[38:39] sc1
    s_add_u32 s38, s38, 1024
    s_waitcnt lgkmcnt(5)
    v_mfma_f32_32x32x16_bf16 v[56:71], v[12:15], a[4:7], v[56:71]
    ds_read_b128 v[36:39], v4 offset:224
    s_addc_u32 s39, s39, 0
    s_add_u32 m0, m0, 1040
    s_nop 0
    global_load_lds_dwordx4 v2, s[38:39] sc1
    s_waitcnt lgkmcnt(5)
    v_mfma_f32_32x32x16_bf16 v[56:71], v[16:19], a[8:11], v[56:71]
    ds_read_b128 v[8:11], v4 offset:256
    s_add_u32 s38, s38, 1024
    s_addc_u32 s39, s39, 0
    s_add_u32 m0, m0, 1040
    s_waitcnt lgkmcnt(5)
    v_mfma_f32_32x32x16_bf16 v[56:71], v[20:23], a[12:15], v[56:71]
    ds_read_b128 v[12:15], v4 offset:288
    global_load_lds_dwordx4 v2, s[38:39] sc1
    s_add_u32 s38, s38, 1024
    s_addc_u32 s39, s39, 0
    s_waitcnt lgkmcnt(5)
    v_mfma_f32_32x32x16_bf16 v[56:71], v[24:27], a[16:19], v[56:71]
    ds_read_b128 v[16:19], v4 offset:320
    s_add_u32 m0, m0, 1040
    s_nop 0
    global_load_lds_dwordx4 v2, s[38:39] sc1
    s_add_u32 s38, s38, 1024
    s_waitcnt lgkmcnt(5)
    v_mfma_f32_32x32x16_bf16 v[56:71], v[28:31], a[20:23], v[56:71]
    ds_read_b128 v[20:23], v4 offset:352
    s_addc_u32 s39, s39, 0
    s_add_u32 m0, m0, 1040
    s_nop 0
    global_load_lds_dwordx4 v2, s[38:39] sc1
    s_waitcnt lgkmcnt(5)
    v_mfma_f32_32x32x16_bf16 v[56:71], v[32:35], a[24:27], v[56:71]
    ds_read_b128 v[24:27], v4 offset:384
    s_add_u32 s38, s38, 1024
    s_addc_u32 s39, s39, 0
    s_add_u32 m0, m0, 1040
    s_waitcnt lgkmcnt(5)
    v_mfma_f32_32x32x16_bf16 v[56:71], v[36:39], a[28:31], v[56:71]
    ds_read_b128 v[28:31], v4 offset:416
    global_load_lds_dwordx4 v2, s[38:39] sc1
    s_add_u32 s38, s38, 1024
    s_addc_u32 s39, s39, 0
    s_waitcnt lgkmcnt(5)
    v_mfma_f32_32x32x16_bf16 v[56:71], v[8:11], a[32:35], v[56:71]
    ds_read_b128 v[32:35], v4 offset:448
    s_add_u32 m0, m0, 1040
    s_nop 0
    global_load_lds_dwordx4 v2, s[38:39] sc1
    s_add_u32 s38, s38, 1024
    s_waitcnt lgkmcnt(5)
    v_mfma_f32_32x32x16_bf16 v[56:71], v[12:15], a[36:39], v[56:71]
    ds_read_b128 v[36:39], v4 offset:480
    s_addc_u32 s39, s39, 0
    s_add_u32 m0, m0, 1040
    s_nop 0
    global_load_lds_dwordx4 v2, s[38:39] sc1
    s_waitcnt lgkmcnt(5)
    v_mfma_f32_32x32x16_bf16 v[56:71], v[16:19], a[40:43], v[56:71]
    ds_read_b128 v[8:11], v4 offset:512
    s_add_u32 s38, s38, 25600
    s_addc_u32 s39, s39, 0
    s_add_u32 s44, s44, 33280
    s_waitcnt lgkmcnt(5)
    v_mfma_f32_32x32x16_bf16 v[56:71], v[20:23], a[44:47], v[56:71]
    ds_read_b128 v[12:15], v4 offset:544
    s_cmp_ge_u32 s44, 133120
    s_cselect_b32 s56, 133120, 0
    s_sub_u32 s44, s44, s56
    s_waitcnt lgkmcnt(5)
    v_mfma_f32_32x32x16_bf16 v[56:71], v[24:27], a[48:51], v[56:71]
    ds_read_b128 v[16:19], v4 offset:576
    v_cvt_pk_bf16_f32 v72, v40, v41
    v_cvt_pk_bf16_f32 v73, v48, v49
    v_cvt_pk_bf16_f32 v74, v44, v45
    s_waitcnt lgkmcnt(5)
    v_mfma_f32_32x32x16_bf16 v[56:71], v[28:31], a[52:55], v[56:71]
    ds_read_b128 v[20:23], v4 offset:608
    v_cvt_pk_bf16_f32 v75, v52, v53
    global_store_dwordx4 v2, v[72:75], s[40:41] offset:0 sc1
    s_waitcnt lgkmcnt(5)
    v_mfma_f32_32x32x16_bf16 v[56:71], v[32:35], a[56:59], v[56:71]
    ds_read_b128 v[24:27], v4 offset:640
    v_cvt_pk_bf16_f32 v76, v42, v43
    v_cvt_pk_bf16_f32 v77, v50, v51
    v_cvt_pk_bf16_f32 v78, v46, v47
    s_waitcnt lgkmcnt(5)
    v_mfma_f32_32x32x16_bf16 v[56:71], v[36:39], a[60:63], v[56:71]
    ds_read_b128 v[28:31], v4 offset:672
    v_cvt_pk_bf16_f32 v79, v54, v55
    global_store_dwordx4 v2, v[76:79], s[40:41] offset:1024 sc1
    s_waitcnt lgkmcnt(5)
    v_mfma_f32_32x32x16_bf16 v[56:71], v[8:11], a[64:67], v[56:71]
    ds_read_b128 v[32:35], v4 offset:704
    s_add_u32 s40, s40, s43
    s_addc_u32 s41, s41, 0
    global_store_dwordx4 v2, v[80:83], s[46:47] sc1
    s_waitcnt lgkmcnt(5)
    v_mfma_f32_32x32x16_bf16 v[56:71], v[12:15], a[68:71], v[56:71]
    ds_read_b128 v[36:39], v4 offset:736
    s_add_u32 s46, s46, 4096
    s_addc_u32 s47, s47, 0
    s_waitcnt lgkmcnt(5)
    v_mfma_f32_32x32x16_bf16 v[56:71], v[16:19], a[72:75], v[56:71]
    ds_read_b128 v[8:11], v4 offset:768
    s_waitcnt lgkmcnt(5)
    v_mfma_f32_32x32x16_bf16 v[56:71], v[20:23], a[76:79], v[56:71]
    ds_read_b128 v[12:15], v4 offset:800
    s_waitcnt lgkmcnt(5)
    v_mfma_f32_32x32x16_bf16 v[56:71], v[24:27], a[80:83], v[56:71]
    ds_read_b128 v[16:19], v4 offset:832
    s_waitcnt lgkmcnt(5)
    v_mfma_f32_32x32x16_bf16 v[56:71], v[28:31], a[84:87], v[56:71]
    ds_read_b128 v[20:23], v4 offset:864
    s_waitcnt lgkmcnt(5)
    v_mfma_f32_32x32x16_bf16 v[56:71], v[32:35], a[88:91], v[56:71]
    ds_read_b128 v[24:27], v4 offset:896
    s_waitcnt lgkmcnt(5)
    v_mfma_f32_32x32x16_bf16 v[56:71], v[36:39], a[92:95], v[56:71]
    ds_read_b128 v[28:31], v4 offset:928
    s_waitcnt lgkmcnt(5)
    v_mfma_f32_32x32x16_bf16 v[56:71], v[8:11], a[96:99], v[56:71]
    ds_read_b128 v[32:35], v4 offset:960
    s_waitcnt lgkmcnt(5)
    v_mfma_f32_32x32x16_bf16 v[56:71], v[12:15], a[100:103], v[56:71]
    ds_read_b128 v[36:39], v4 offset:992
    s_waitcnt lgkmcnt(5)
    v_mfma_f32_32x32x16_bf16 v[56:71], v[16:19], a[104:107], v[56:71]
    v_add_u32 v4, 33280, v4
    v_subrev_u32 v5, 133120, v4
    v_min_u32 v4, v4, v5
    s_waitcnt lgkmcnt(4)
    v_mfma_f32_32x32x16_bf16 v[56:71], v[20:23], a[108:111], v[56:71]
    s_waitcnt lgkmcnt(3)
    v_mfma_f32_32x32x16_bf16 v[56:71], v[24:27], a[112:115], v[56:71]
    s_waitcnt lgkmcnt(0)
    s_waitcnt vmcnt(19)
    s_barrier
    ds_read_b128 v[8:11], v4 offset:0
    ds_read_b128 v[12:15], v4 offset:32
    ds_read_b128 v[16:19], v4 offset:64
    v_mfma_f32_32x32x16_bf16 v[56:71], v[28:31], a[116:119], v[56:71]
    ds_read_b128 v[20:23], v4 offset:96
    v_mfma_f32_32x32x16_bf16 v[56:71], v[32:35], a[120:123], v[56:71]
    ds_read_b128 v[24:27], v4 offset:128
    v_mfma_f32_32x32x16_bf16 v[56:71], v[36:39], a[124:127], v[56:71]
    ds_read_b128 v[28:31], v4 offset:160
    s_mov_b32 s42, 2
    s_branch L_gl15
.p2align 6
L_gl15:
    s_waitcnt lgkmcnt(5)
    v_mfma_f32_32x32x16_bf16 v[40:55], v[8:11], a[0:3], 0
    ds_read_b128 v[32:35], v4 offset:192
    s_mov_b32 m0, s44
    s_nop 0
    global_load_lds_dwordx4 v2, s[38:39] sc1
    s_add_u32 s38, s38, 1024
    s_waitcnt lgkmcnt(5)
    v_mfma_f32_32x32x16_bf16 v[40:55], v[12:15], a[4:7], v[40:55]
    ds_read_b128 v[36:39], v4 offset:224
    s_addc_u32 s39, s39, 0
    s_add_u32 m0, m0, 1040
    s_nop 0
    global_load_lds_dwordx4 v2, s[38:39] sc1
    s_waitcnt lgkmcnt(5)
    v_mfma_f32_32x32x16_bf16 v[40:55], v[16:19], a[8:11], v[40:55]
    ds_read_b128 v[8:11], v4 offset:256
    s_add_u32 s38, s38, 1024
    s_addc_u32 s39, s39, 0
    s_add_u32 m0, m0, 1040
    s_waitcnt lgkmcnt(5)
    v_mfma_f32_32x32x16_bf16 v[40:55], v[20:23], a[12:15], v[40:55]
    ds_read_b128 v[12:15], v4 offset:288
    global_load_lds_dwordx4 v2, s[38:39] sc1
    s_add_u32 s38, s38, 1024
    s_addc_u32 s39, s39, 0
    s_waitcnt lgkmcnt(5)
    v_mfma_f32_32x32x16_bf16 v[40:55], v[24:27], a[16:19], v[40:55]
    ds_read_b128 v[16:19], v4 offset:320
    s_add_u32 m0, m0, 1040
    s_nop 0
    global_load_lds_dwordx4 v2, s[38:39] sc1
    s_add_u32 s38, s38, 1024
    s_waitcnt lgkmcnt(5)
    v_mfma_f32_32x32x16_bf16 v[40:55], v[28:31], a[20:23], v[40:55]
    ds_read_b128 v[20:23], v4 offset:352
    s_addc_u32 s39, s39, 0
    s_add_u32 m0, m0, 1040
    s_nop 0
    global_load_lds_dwordx4 v2, s[38:39] sc1
    s_waitcnt lgkmcnt(5)
    v_mfma_f32_32x32x16_bf16 v[40:55], v[32:35], a[24:27], v[40:55]
    ds_read_b128 v[24:27], v4 offset:384
    s_add_u32 s38, s38, 1024
    s_addc_u32 s39, s39, 0
    s_add_u32 m0, m0, 1040
    s_waitcnt lgkmcnt(5)
    v_mfma_f32_32x32x16_bf16 v[40:55], v[36:39], a[28:31], v[40:55]
    ds_read_b128 v[28:31], v4 offset:416
    global_load_lds_dwordx4 v2, s[38:39] sc1
    s_add_u32 s38, s38, 1024
    s_addc_u32 s39, s39, 0
    s_waitcnt lgkmcnt(5)
    v_mfma_f32_32x32x16_bf16 v[40:55], v[8:11], a[32:35], v[40:55]
    ds_read_b128 v[32:35], v4 offset:448
    s_add_u32 m0, m0, 1040
    s_nop 0
    global_load_lds_dwordx4 v2, s[38:39] sc1
    s_add_u32 s38, s38, 1024
    s_waitcnt lgkmcnt(5)
    v_mfma_f32_32x32x16_bf16 v[40:55], v[12:15], a[36:39], v[40:55]
    ds_read_b128 v[36:39], v4 offset:480
    s_addc_u32 s39, s39, 0
    s_add_u32 m0, m0, 1040
    s_nop 0
    global_load_lds_dwordx4 v2, s[38:39] sc1
    s_waitcnt lgkmcnt(5)
    v_mfma_f32_32x32x16_bf16 v[40:55], v[16:19], a[40:43], v[40:55]
    ds_read_b128 v[8:11], v4 offset:512
    s_add_u32 s38, s38, 25600
    s_addc_u32 s39, s39, 0
    s_add_u32 s44, s44, 33280
    s_waitcnt lgkmcnt(5)
    v_mfma_f32_32x32x16_bf16 v[40:55], v[20:23], a[44:47], v[40:55]
    ds_read_b128 v[12:15], v4 offset:544
    s_cmp_ge_u32 s44, 133120
    s_cselect_b32 s56, 133120, 0
    s_sub_u32 s44, s44, s56
    s_waitcnt lgkmcnt(5)
    v_mfma_f32_32x32x16_bf16 v[40:55], v[24:27], a[48:51], v[40:55]
    ds_read_b128 v[16:19], v4 offset:576
    v_cvt_pk_bf16_f32 v72, v56, v57
    v_cvt_pk_bf16_f32 v73, v64, v65
    v_cvt_pk_bf16_f32 v74, v60, v61
    s_waitcnt lgkmcnt(5)
    v_mfma_f32_32x32x16_bf16 v[40:55], v[28:31], a[52:55], v[40:55]
    ds_read_b128 v[20:23], v4 offset:608
    v_cvt_pk_bf16_f32 v75, v68, v69
    global_store_dwordx4 v2, v[72:75], s[40:41] offset:0 sc1
    s_waitcnt lgkmcnt(5)
    v_mfma_f32_32x32x16_bf16 v[40:55], v[32:35], a[56:59], v[40:55]
    ds_read_b128 v[24:27], v4 offset:640
    v_cvt_pk_bf16_f32 v76, v58, v59
    v_cvt_pk_bf16_f32 v77, v66, v67
    v_cvt_pk_bf16_f32 v78, v62, v63
    s_waitcnt lgkmcnt(5)
    v_mfma_f32_32x32x16_bf16 v[40:55], v[36:39], a[60:63], v[40:55]
    ds_read_b128 v[28:31], v4 offset:672
    v_cvt_pk_bf16_f32 v79, v70, v71
    global_store_dwordx4 v2, v[76:79], s[40:41] offset:1024 sc1
    s_waitcnt lgkmcnt(5)
    v_mfma_f32_32x32x16_bf16 v[40:55], v[8:11], a[64:67], v[40:55]
    ds_read_b128 v[32:35], v4 offset:704
    s_add_u32 s40, s40, s43
    s_addc_u32 s41, s41, 0
    global_store_dwordx4 v2, v[80:83], s[46:47] sc1
    s_waitcnt lgkmcnt(5)
    v_mfma_f32_32x32x16_bf16 v[40:55], v[12:15], a[68:71], v[40:55]
    ds_read_b128 v[36:39], v4 offset:736
    s_add_u32 s46, s46, 4096
    s_addc_u32 s47, s47, 0
    s_waitcnt lgkmcnt(5)
    v_mfma_f32_32x32x16_bf16 v[40:55], v[16:19], a[72:75], v[40:55]
    ds_read_b128 v[8:11], v4 offset:768
    s_waitcnt lgkmcnt(5)
    v_mfma_f32_32x32x16_bf16 v[40:55], v[20:23], a[76:79], v[40:55]
    ds_read_b128 v[12:15], v4 offset:800
    s_waitcnt lgkmcnt(5)
    v_mfma_f32_32x32x16_bf16 v[40:55], v[24:27], a[80:83], v[40:55]
    ds_read_b128 v[16:19], v4 offset:832
    s_waitcnt lgkmcnt(5)
    v_mfma_f32_32x32x16_bf16 v[40:55], v[28:31], a[84:87], v[40:55]
    ds_read_b128 v[20:23], v4 offset:864
    s_waitcnt lgkmcnt(5)
    v_mfma_f32_32x32x16_bf16 v[40:55], v[32:35], a[88:91], v[40:55]
    ds_read_b128 v[24:27], v4 offset:896
    s_waitcnt lgkmcnt(5)
    v_mfma_f32_32x32x16_bf16 v[40:55], v[36:39], a[92:95], v[40:55]
    ds_read_b128 v[28:31], v4 offset:928
    s_waitcnt lgkmcnt(5)
    v_mfma_f32_32x32x16_bf16 v[40:55], v[8:11], a[96:99], v[40:55]
    ds_read_b128 v[32:35], v4 offset:960
    s_waitcnt lgkmcnt(5)
    v_mfma_f32_32x32x16_bf16 v[40:55], v[12:15], a[100:103], v[40:55]
    ds_read_b128 v[36:39], v4 offset:992
    s_waitcnt lgkmcnt(5)
    v_mfma_f32_32x32x16_bf16 v[40:55], v[16:19], a[104:107], v[40:55]
    v_add_u32 v4, 33280, v4
    v_subrev_u32 v5, 133120, v4
    v_min_u32 v4, v4, v5
    s_waitcnt lgkmcnt(4)
    v_mfma_f32_32x32x16_bf16 v[40:55], v[20:23], a[108:111], v[40:55]
    s_waitcnt lgkmcnt(3)
    v_mfma_f32_32x32x16_bf16 v[40:55], v[24:27], a[112:115], v[40:55]
    s_waitcnt lgkmcnt(0)
    s_waitcnt vmcnt(22)
    s_barrier
    ds_read_b128 v[8:11], v4 offset:0
    ds_read_b128 v[12:15], v4 offset:32
    ds_read_b128 v[16:19], v4 offset:64
    v_mfma_f32_32x32x16_bf16 v[40:55], v[28:31], a[116:119], v[40:55]
    ds_read_b128 v[20:23], v4 offset:96
    v_mfma_f32_32x32x16_bf16 v[40:55], v[32:35], a[120:123], v[40:55]
    ds_read_b128 v[24:27], v4 offset:128
    v_mfma_f32_32x32x16_bf16 v[40:55], v[36:39], a[124:127], v[40:55]
    ds_read_b128 v[28:31], v4 offset:160
    s_waitcnt lgkmcnt(5)
    v_mfma_f32_32x32x16_bf16 v[56:71], v[8:11], a[0:3], 0
    ds_read_b128 v[32:35], v4 offset:192
    s_mov_b32 m0, s44
    s_nop 0
    global_load_lds_dwordx4 v2, s[38:39] sc1
    s_add_u32 s38, s38, 1024
    s_waitcnt lgkmcnt(5)
    v_mfma_f32_32x32x16_bf16 v[56:71], v[12:15], a[4:7], v[56:71]
    ds_read_b128 v[36:39], v4 offset:224
    s_addc_u32 s39, s39, 0
    s_add_u32 m0, m0, 1040
    s_nop 0
    global_load_lds_dwordx4 v2, s[38:39] sc1
    s_waitcnt lgkmcnt(5)
    v_mfma_f32_32x32x16_bf16 v[56:71], v[16:19], a[8:11], v[56:71]
    ds_read_b128 v[8:11], v4 offset:256
    s_add_u32 s38, s38, 1024
    s_addc_u32 s39, s39, 0
    s_add_u32 m0, m0, 1040
    s_waitcnt lgkmcnt(5)
    v_mfma_f32_32x32x16_bf16 v[56:71], v[20:23], a[12:15], v[56:71]
    ds_read_b128 v[12:15], v4 offset:288
    global_load_lds_dwordx4 v2, s[38:39] sc1
    s_add_u32 s38, s38, 1024
    s_addc_u32 s39, s39, 0
    s_waitcnt lgkmcnt(5)
    v_mfma_f32_32x32x16_bf16 v[56:71], v[24:27], a[16:19], v[56:71]
    ds_read_b128 v[16:19], v4 offset:320
    s_add_u32 m0, m0, 1040
    s_nop 0
    global_load_lds_dwordx4 v2, s[38:39] sc1
    s_add_u32 s38, s38, 1024
    s_waitcnt lgkmcnt(5)
    v_mfma_f32_32x32x16_bf16 v[56:71], v[28:31], a[20:23], v[56:71]
    ds_read_b128 v[20:23], v4 offset:352
    s_addc_u32 s39, s39, 0
    s_add_u32 m0, m0, 1040
    s_nop 0
    global_load_lds_dwordx4 v2, s[38:39] sc1
    s_waitcnt lgkmcnt(5)
    v_mfma_f32_32x32x16_bf16 v[56:71], v[32:35], a[24:27], v[56:71]
    ds_read_b128 v[24:27], v4 offset:384
    s_add_u32 s38, s38, 1024
    s_addc_u32 s39, s39, 0
    s_add_u32 m0, m0, 1040
    s_waitcnt lgkmcnt(5)
    v_mfma_f32_32x32x16_bf16 v[56:71], v[36:39], a[28:31], v[56:71]
    ds_read_b128 v[28:31], v4 offset:416
    global_load_lds_dwordx4 v2, s[38:39] sc1
    s_add_u32 s38, s38, 1024
    s_addc_u32 s39, s39, 0
    s_waitcnt lgkmcnt(5)
    v_mfma_f32_32x32x16_bf16 v[56:71], v[8:11], a[32:35], v[56:71]
    ds_read_b128 v[32:35], v4 offset:448
    s_add_u32 m0, m0, 1040
    s_nop 0
    global_load_lds_dwordx4 v2, s[38:39] sc1
    s_add_u32 s38, s38, 1024
    s_waitcnt lgkmcnt(5)
    v_mfma_f32_32x32x16_bf16 v[56:71], v[12:15], a[36:39], v[56:71]
    ds_read_b128 v[36:39], v4 offset:480
    s_addc_u32 s39, s39, 0
    s_add_u32 m0, m0, 1040
    s_nop 0
    global_load_lds_dwordx4 v2, s[38:39] sc1
    s_waitcnt lgkmcnt(5)
    v_mfma_f32_32x32x16_bf16 v[56:71], v[16:19], a[40:43], v[56:71]
    ds_read_b128 v[8:11], v4 offset:512
    s_add_u32 s38, s38, 25600
    s_addc_u32 s39, s39, 0
    s_add_u32 s44, s44, 33280
    s_waitcnt lgkmcnt(5)
    v_mfma_f32_32x32x16_bf16 v[56:71], v[20:23], a[44:47], v[56:71]
    ds_read_b128 v[12:15], v4 offset:544
    s_cmp_ge_u32 s44, 133120
    s_cselect_b32 s56, 133120, 0
    s_sub_u32 s44, s44, s56
    s_waitcnt lgkmcnt(5)
    v_mfma_f32_32x32x16_bf16 v[56:71], v[24:27], a[48:51], v[56:71]
    ds_read_b128 v[16:19], v4 offset:576
    v_cvt_pk_bf16_f32 v72, v40, v41
    v_cvt_pk_bf16_f32 v73, v48, v49
    v_cvt_pk_bf16_f32 v74, v44, v45
    s_waitcnt lgkmcnt(5)
    v_mfma_f32_32x32x16_bf16 v[56:71], v[28:31], a[52:55], v[56:71]
    ds_read_b128 v[20:23], v4 offset:608
    v_cvt_pk_bf16_f32 v75, v52, v53
    global_store_dwordx4 v2, v[72:75], s[40:41] offset:0 sc1
    s_waitcnt lgkmcnt(5)
    v_mfma_f32_32x32x16_bf16 v[56:71], v[32:35], a[56:59], v[56:71]
    ds_read_b128 v[24:27], v4 offset:640
    v_cvt_pk_bf16_f32 v76, v42, v43
    v_cvt_pk_bf16_f32 v77, v50, v51
    v_cvt_pk_bf16_f32 v78, v46, v47
    s_waitcnt lgkmcnt(5)
    v_mfma_f32_32x32x16_bf16 v[56:71], v[36:39], a[60:63], v[56:71]
    ds_read_b128 v[28:31], v4 offset:672
    v_cvt_pk_bf16_f32 v79, v54, v55
    global_store_dwordx4 v2, v[76:79], s[40:41] offset:1024 sc1
    s_waitcnt lgkmcnt(5)
    v_mfma_f32_32x32x16_bf16 v[56:71], v[8:11], a[64:67], v[56:71]
    ds_read_b128 v[32:35], v4 offset:704
    s_add_u32 s40, s40, s43
    s_addc_u32 s41, s41, 0
    global_store_dwordx4 v2, v[80:83], s[46:47] sc1
    s_waitcnt lgkmcnt(5)
    v_mfma_f32_32x32x16_bf16 v[56:71], v[12:15], a[68:71], v[56:71]
    ds_read_b128 v[36:39], v4 offset:736
    s_add_u32 s46, s46, 4096
    s_addc_u32 s47, s47, 0
    s_waitcnt lgkmcnt(5)
    v_mfma_f32_32x32x16_bf16 v[56:71], v[16:19], a[72:75], v[56:71]
    ds_read_b128 v[8:11], v4 offset:768
    s_waitcnt lgkmcnt(5)
    v_mfma_f32_32x32x16_bf16 v[56:71], v[20:23], a[76:79], v[56:71]
    ds_read_b128 v[12:15], v4 offset:800
    s_waitcnt lgkmcnt(5)
    v_mfma_f32_32x32x16_bf16 v[56:71], v[24:27], a[80:83], v[56:71]
    ds_read_b128 v[16:19], v4 offset:832
    s_waitcnt lgkmcnt(5)
    v_mfma_f32_32x32x16_bf16 v[56:71], v[28:31], a[84:87], v[56:71]
    ds_read_b128 v[20:23], v4 offset:864
    s_waitcnt lgkmcnt(5)
    v_mfma_f32_32x32x16_bf16 v[56:71], v[32:35], a[88:91], v[56:71]
    ds_read_b128 v[24:27], v4 offset:896
    s_waitcnt lgkmcnt(5)
    v_mfma_f32_32x32x16_bf16 v[56:71], v[36:39], a[92:95], v[56:71]
    ds_read_b128 v[28:31], v4 offset:928
    s_waitcnt lgkmcnt(5)
    v_mfma_f32_32x32x16_bf16 v[56:71], v[8:11], a[96:99], v[56:71]
    ds_read_b128 v[32:35], v4 offset:960
    s_waitcnt lgkmcnt(5)
    v_mfma_f32_32x32x16_bf16 v[56:71], v[12:15], a[100:103], v[56:71]
    ds_read_b128 v[36:39], v4 offset:992
    s_waitcnt lgkmcnt(5)
    v_mfma_f32_32x32x16_bf16 v[56:71], v[16:19], a[104:107], v[56:71]
    v_add_u32 v4, 33280, v4
    v_subrev_u32 v5, 133120, v4
    v_min_u32 v4, v4, v5
    s_waitcnt lgkmcnt(4)
    v_mfma_f32_32x32x16_bf16 v[56:71], v[20:23], a[108:111], v[56:71]
    s_waitcnt lgkmcnt(3)
    v_mfma_f32_32x32x16_bf16 v[56:71], v[24:27], a[112:115], v[56:71]
    s_waitcnt lgkmcnt(0)
    s_add_u32 s42, s42, 2
    s_cmp_eq_u32 s42, 4
    s_cselect_b32 s57, 2, 3
    s_cbranch_scc0 L_gn15
    s_waitcnt vmcnt(11)
L_gn15:
    s_waitcnt vmcnt(22)
    s_barrier
    s_sub_i32 s57, s42, s57
    s_cmp_lg_u32 s30, 0
    s_cbranch_scc1 L_pg16
    v_mov_b32 v6, 0
    v_mov_b32 v7, s57
    s_mov_b64 exec, 1
    global_store_dword v6, v7, s[48:49] sc1
    s_mov_b64 exec, -1
L_pg16:
    s_cmp_lg_u32 s42, 4
    s_cbranch_scc1 L_gh15
    s_cmp_lg_u32 s30, 0
    s_cbranch_scc1 L_wdn17
    v_mbcnt_lo_u32_b32 v6, -1, 0
    v_mbcnt_hi_u32_b32 v6, -1, v6
    v_lshlrev_b32 v6, 2, v6
    s_mov_b32 exec_lo, 0x0
    s_mov_b32 exec_hi, 0x404
    s_mov_b32 s54, 0
    s_branch L_wf17
L_wd17:
    s_sleep 2
L_wf17:
    global_load_dword v7, v6, s[26:27] sc1
    s_add_u32 s54, s54, 1
    s_cmp_gt_u32 s54, 400000
    s_cbranch_scc1 L_end
    s_waitcnt vmcnt(0)
    v_cmp_gt_u32 vcc, 32, v7
    s_cbranch_vccnz L_wd17
    s_mov_b64 exec, -1
L_wdn17:
    s_barrier
L_gh15:
    ds_read_b128 v[8:11], v4 offset:0
    ds_read_b128 v[12:15], v4 offset:32
    ds_read_b128 v[16:19], v4 offset:64
    v_mfma_f32_32x32x16_bf16 v[56:71], v[28:31], a[116:119], v[56:71]
    ds_read_b128 v[20:23], v4 offset:96
    v_mfma_f32_32x32x16_bf16 v[56:71], v[32:35], a[120:123], v[56:71]
    ds_read_b128 v[24:27], v4 offset:128
    v_mfma_f32_32x32x16_bf16 v[56:71], v[36:39], a[124:127], v[56:71]
    ds_read_b128 v[28:31], v4 offset:160
    s_cmp_lt_u32 s42, 64
    s_cbranch_scc1 L_gl15
    s_nop 8
    v_cvt_pk_bf16_f32 v72, v56, v57
    v_cvt_pk_bf16_f32 v73, v64, v65
    v_cvt_pk_bf16_f32 v74, v60, v61
    v_cvt_pk_bf16_f32 v75, v68, v69
    global_store_dwordx4 v2, v[72:75], s[40:41] offset:0 sc1
    v_cvt_pk_bf16_f32 v76, v58, v59
    v_cvt_pk_bf16_f32 v77, v66, v67
    v_cvt_pk_bf16_f32 v78, v62, v63
    v_cvt_pk_bf16_f32 v79, v70, v71
    global_store_dwordx4 v2, v[76:79], s[40:41] offset:1024 sc1
    s_add_u32 s40, s40, s43
    s_addc_u32 s41, s41, 0
    global_store_dwordx4 v2, v[80:83], s[46:47] sc1
    s_add_u32 s46, s46, 4096
    s_addc_u32 s47, s47, 0
    s_waitcnt vmcnt(0) lgkmcnt(0)
    s_barrier
    s_cmp_lg_u32 s30, 0
    s_cbranch_scc1 L_pg18
    v_mov_b32 v6, 0
    v_mov_b32 v7, 64
    s_mov_b64 exec, 1
    global_store_dword v6, v7, s[48:49] sc1
    s_mov_b64 exec, -1
L_pg18:
    s_branch L_gd8
L_gq8:
    s_add_u32 s40, s28, 14680064
    s_addc_u32 s41, s29, 0
    s_mul_i32 s61, s31, 532480
    s_add_u32 s40, s40, s61
    s_addc_u32 s41, s41, 0
    s_mul_i32 s61, s30, 2048
    s_add_u32 s40, s40, s61
    s_addc_u32 s41, s41, 0
    s_mov_b32 s43, 8192
L_gk8:
    s_mov_b32 m0, s44
    s_nop 0
    global_load_lds_dwordx4 v2, s[38:39] sc1
    s_add_u32 s38, s38, 1024
    s_addc_u32 s39, s39, 0
    s_add_u32 m0, m0, 1040
    s_nop 0
    global_load_lds_dwordx4 v2, s[38:39] sc1
    s_add_u32 s38, s38, 1024
    s_addc_u32 s39, s39, 0
    s_add_u32 m0, m0, 1040
    s_nop 0
    global_load_lds_dwordx4 v2, s[38:39] sc1
    s_add_u32 s38, s38, 1024
    s_addc_u32 s39, s39, 0
    s_add_u32 m0, m0, 1040
    s_nop 0
    global_load_lds_dwordx4 v2, s[38:39] sc1
    s_add_u32 s38, s38, 1024
    s_addc_u32 s39, s39, 0
    s_add_u32 m0, m0, 1040
    s_nop 0
    global_load_lds_dwordx4 v2, s[38:39] sc1
    s_add_u32 s38, s38, 1024
    s_addc_u32 s39, s39, 0
    s_add_u32 m0, m0, 1040
    s_nop 0
    global_load_lds_dwordx4 v2, s[38:39] sc1
    s_add_u32 s38, s38, 1024
    s_addc_u32 s39, s39, 0
    s_add_u32 m0, m0, 1040
    s_nop 0
    global_load_lds_dwordx4 v2, s[38:39] sc1
    s_add_u32 s38, s38, 1024
    s_addc_u32 s39, s39, 0
    s_add_u32 m0, m0, 1040
    s_nop 0
    global_load_lds_dwordx4 v2, s[38:39] sc1
    s_add_u32 s38, s38, 25600
    s_addc_u32 s39, s39, 0
    s_add_u32 s44, s44, 33280
    s_cmp_ge_u32 s44, 133120
    s_cselect_b32 s56, 133120, 0
    s_sub_u32 s44, s44, s56
    s_mov_b32 m0, s44
    s_nop 0
    global_load_lds_dwordx4 v2, s[38:39] sc1
    s_add_u32 s38, s38, 1024
    s_addc_u32 s39, s39, 0
    s_add_u32 m0, m0, 1040
    s_nop 0
    global_load_lds_dwordx4 v2, s[38:39] sc1
    s_add_u32 s38, s38, 1024
    s_addc_u32 s39, s39, 0
    s_add_u32 m0, m0, 1040
    s_nop 0
    global_load_lds_dwordx4 v2, s[38:39] sc1
    s_add_u32 s38, s38, 1024
    s_addc_u32 s39, s39, 0
    s_add_u32 m0, m0, 1040
    s_nop 0
    global_load_lds_dwordx4 v2, s[38:39] sc1
    s_add_u32 s38, s38, 1024
    s_addc_u32 s39, s39, 0
    s_add_u32 m0, m0, 1040
    s_nop 0
    global_load_lds_dwordx4 v2, s[38:39] sc1
    s_add_u32 s38, s38, 1024
    s_addc_u32 s39, s39, 0
    s_add_u32 m0, m0, 1040
    s_nop 0
    global_load_lds_dwordx4 v2, s[38:39] sc1
    s_add_u32 s38, s38, 1024
    s_addc_u32 s39, s39, 0
    s_add_u32 m0, m0, 1040
    s_nop 0
    global_load_lds_dwordx4 v2, s[38:39] sc1
    s_add_u32 s38, s38, 1024
    s_addc_u32 s39, s39, 0
    s_add_u32 m0, m0, 1040
    s_nop 0
    global_load_lds_dwordx4 v2, s[38:39] sc1
    s_add_u32 s38, s38, 25600
    s_addc_u32 s39, s39, 0
    s_add_u32 s44, s44, 33280
    s_cmp_ge_u32 s44, 133120
    s_cselect_b32 s56, 133120, 0
    s_sub_u32 s44, s44, s56
    s_mov_b32 m0, s44
    s_nop 0
    global_load_lds_dwordx4 v2, s[38:39] sc1
    s_add_u32 s38, s38, 1024
    s_addc_u32 s39, s39, 0
    s_add_u32 m0, m0, 1040
    s_nop 0
    global_load_lds_dwordx4 v2, s[38:39] sc1
    s_add_u32 s38, s38, 1024
    s_addc_u32 s39, s39, 0
    s_add_u32 m0, m0, 1040
    s_nop 0
    global_load_lds_dwordx4 v2, s[38:39] sc1
    s_add_u32 s38, s38, 1024
    s_addc_u32 s39, s39, 0
    s_add_u32 m0, m0, 1040
    s_nop 0
    global_load_lds_dwordx4 v2, s[38:39] sc1
    s_add_u32 s38, s38, 1024
    s_addc_u32 s39, s39, 0
    s_add_u32 m0, m0, 1040
    s_nop 0
    global_load_lds_dwordx4 v2, s[38:39] sc1
    s_add_u32 s38, s38, 1024
    s_addc_u32 s39, s39, 0
    s_add_u32 m0, m0, 1040
    s_nop 0
    global_load_lds_dwordx4 v2, s[38:39] sc1
    s_add_u32 s38, s38, 1024
    s_addc_u32 s39, s39, 0
    s_add_u32 m0, m0, 1040
    s_nop 0
    global_load_lds_dwordx4 v2, s[38:39] sc1
    s_add_u32 s38, s38, 1024
    s_addc_u32 s39, s39, 0
    s_add_u32 m0, m0, 1040
    s_nop 0
    global_load_lds_dwordx4 v2, s[38:39] sc1
    s_add_u32 s38, s38, 25600
    s_addc_u32 s39, s39, 0
    s_add_u32 s44, s44, 33280
    s_cmp_ge_u32 s44, 133120
    s_cselect_b32 s56, 133120, 0
    s_sub_u32 s44, s44, s56
    s_waitcnt vmcnt(16)
    s_barrier
    ds_read_b128 v[8:11], v4 offset:0
    ds_read_b128 v[12:15], v4 offset:32
    ds_read_b128 v[16:19], v4 offset:64
    ds_read_b128 v[20:23], v4 offset:96
    ds_read_b128 v[24:27], v4 offset:128
    ds_read_b128 v[28:31], v4 offset:160
    s_waitcnt lgkmcnt(5)
    v_mfma_f32_32x32x16_bf16 v[40:55], a[0:3], v[8:11], 0
    ds_read_b128 v[32:35], v4 offset:192
    s_mov_b32 m0, s44
    s_nop 0
    global_load_lds_dwordx4 v2, s[38:39] sc1
    s_add_u32 s38, s38, 1024
    s_waitcnt lgkmcnt(5)
    v_mfma_f32_32x32x16_bf16 v[40:55], a[4:7], v[12:15], v[40:55]
    ds_read_b128 v[36:39], v4 offset:224
    s_addc_u32 s39, s39, 0
    s_add_u32 m0, m0, 1040
    s_nop 0
    global_load_lds_dwordx4 v2, s[38:39] sc1
    s_waitcnt lgkmcnt(5)
    v_mfma_f32_32x32x16_bf16 v[40:55], a[8:11], v[16:19], v[40:55]
    ds_read_b128 v[8:11], v4 offset:256
    s_add_u32 s38, s38, 1024
    s_addc_u32 s39, s39, 0
    s_add_u32 m0, m0, 1040
    s_waitcnt lgkmcnt(5)
    v_mfma_f32_32x32x16_bf16 v[40:55], a[12:15], v[20:23], v[40:55]
    ds_read_b128 v[12:15], v4 offset:288
    global_load_lds_dwordx4 v2, s[38:39] sc1
    s_add_u32 s38, s38, 1024
    s_addc_u32 s39, s39, 0
    s_waitcnt lgkmcnt(5)
    v_mfma_f32_32x32x16_bf16 v[40:55], a[16:19], v[24:27], v[40:55]
    ds_read_b128 v[16:19], v4 offset:320
    s_add_u32 m0, m0, 1040
    s_nop 0
    global_load_lds_dwordx4 v2, s[38:39] sc1
    s_add_u32 s38, s38, 1024
    s_waitcnt lgkmcnt(5)
    v_mfma_f32_32x32x16_bf16 v[40:55], a[20:23], v[28:31], v[40:55]
    ds_read_b128 v[20:23], v4 offset:352
    s_addc_u32 s39, s39, 0
    s_add_u32 m0, m0, 1040
    s_nop 0
    global_load_lds_dwordx4 v2, s[38:39] sc1
    s_waitcnt lgkmcnt(5)
    v_mfma_f32_32x32x16_bf16 v[40:55], a[24:27], v[32:35], v[40:55]
    ds_read_b128 v[24:27], v4 offset:384
    s_add_u32 s38, s38, 1024
    s_addc_u32 s39, s39, 0
    s_add_u32 m0, m0, 1040
    s_waitcnt lgkmcnt(5)
    v_mfma_f32_32x32x16_bf16 v[40:55], a[28:31], v[36:39], v[40:55]
    ds_read_b128 v[28:31], v4 offset:416
    global_load_lds_dwordx4 v2, s[38:39] sc1
    s_add_u32 s38, s38, 1024
    s_addc_u32 s39, s39, 0
    s_waitcnt lgkmcnt(5)
    v_mfma_f32_32x32x16_bf16 v[40:55], a[32:35], v[8:11], v[40:55]
    ds_read_b128 v[32:35], v4 offset:448
    s_add_u32 m0, m0, 1040
    s_nop 0
    global_load_lds_dwordx4 v2, s[38:39] sc1
    s_add_u32 s38, s38, 1024
    s_waitcnt lgkmcnt(5)
    v_mfma_f32_32x32x16_bf16 v[40:55], a[36:39], v[12:15], v[40:55]
    ds_read_b128 v[36:39], v4 offset:480
    s_addc_u32 s39, s39, 0
    s_add_u32 m0, m0, 1040
    s_nop 0
    global_load_lds_dwordx4 v2, s[38:39] sc1
    s_waitcnt lgkmcnt(5)
    v_mfma_f32_32x32x16_bf16 v[40:55], a[40:43], v[16:19], v[40:55]
    ds_read_b128 v[8:11], v4 offset:512
    s_add_u32 s38, s38, 25600
    s_addc_u32 s39, s39, 0
    s_add_u32 s44, s44, 33280
    s_waitcnt lgkmcnt(5)
    v_mfma_f32_32x32x16_bf16 v[40:55], a[44:47], v[20:23], v[40:55]
    ds_read_b128 v[12:15], v4 offset:544
    s_cmp_ge_u32 s44, 133120
    s_cselect_b32 s56, 133120, 0
    s_sub_u32 s44, s44, s56
    s_waitcnt lgkmcnt(5)
    v_mfma_f32_32x32x16_bf16 v[40:55], a[48:51], v[24:27], v[40:55]
    ds_read_b128 v[16:19], v4 offset:576
    s_waitcnt lgkmcnt(5)
    v_mfma_f32_32x32x16_bf16 v[40:55], a[52:55], v[28:31], v[40:55]
    ds_read_b128 v[20:23], v4 offset:608
    s_waitcnt lgkmcnt(5)
    v_mfma_f32_32x32x16_bf16 v[40:55], a[56:59], v[32:35], v[40:55]
    ds_read_b128 v[24:27], v4 offset:640
    s_waitcnt lgkmcnt(5)
    v_mfma_f32_32x32x16_bf16 v[40:55], a[60:63], v[36:39], v[40:55]
    ds_read_b128 v[28:31], v4 offset:672
    s_waitcnt lgkmcnt(5)
    v_mfma_f32_32x32x16_bf16 v[40:55], a[64:67], v[8:11], v[40:55]
    ds_read_b128 v[32:35], v4 offset:704
    s_waitcnt lgkmcnt(5)
    v_mfma_f32_32x32x16_bf16 v[40:55], a[68:71], v[12:15], v[40:55]
    ds_read_b128 v[36:39], v4 offset:736
    s_waitcnt lgkmcnt(5)
    v_mfma_f32_32x32x16_bf16 v[40:55], a[72:75], v[16:19], v[40:55]
    ds_read_b128 v[8:11], v4 offset:768
    s_waitcnt lgkmcnt(5)
    v_mfma_f32_32x32x16_bf16 v[40:55], a[76:79], v[20:23], v[40:55]
    ds_read_b128 v[12:15], v4 offset:800
    s_waitcnt lgkmcnt(5)
    v_mfma_f32_32x32x16_bf16 v[40:55], a[80:83], v[24:27], v[40:55]
    ds_read_b128 v[16:19], v4 offset:832
    s_waitcnt lgkmcnt(5)
    v_mfma_f32_32x32x16_bf16 v[40:55], a[84:87], v[28:31], v[40:55]
    ds_read_b128 v[20:23], v4 offset:864
    s_waitcnt lgkmcnt(5)
    v_mfma_f32_32x32x16_bf16 v[40:55], a[88:91], v[32:35], v[40:55]
    ds_read_b128 v[24:27], v4 offset:896
    s_waitcnt lgkmcnt(5)
    v_mfma_f32_32x32x16_bf16 v[40:55], a[92:95], v[36:39], v[40:55]
    ds_read_b128 v[28:31], v4 offset:928
    s_waitcnt lgkmcnt(5)
    v_mfma_f32_32x32x16_bf16 v[40:55], a[96:99], v[8:11], v[40:55]
    ds_read_b128 v[32:35], v4 offset:960
    s_waitcnt lgkmcnt(5)
    v_mfma_f32_32x32x16_bf16 v[40:55], a[100:103], v[12:15], v[40:55]
    ds_read_b128 v[36:39], v4 offset:992
    s_waitcnt lgkmcnt(5)
    v_mfma_f32_32x32x16_bf16 v[40:55], a[104:107], v[16:19], v[40:55]
    v_add_u32 v4, 33280, v4
    v_subrev_u32 v5, 133120, v4
    v_min_u32 v4, v4, v5
    s_waitcnt lgkmcnt(4)
    v_mfma_f32_32x32x16_bf16 v[40:55], a[108:111], v[20:23], v[40:55]
    s_waitcnt lgkmcnt(3)
    v_mfma_f32_32x32x16_bf16 v[40:55], a[112:115], v[24:27], v[40:55]
    s_waitcnt lgkmcnt(0)
    s_waitcnt vmcnt(16)
    s_barrier
    ds_read_b128 v[8:11], v4 offset:0
    ds_read_b128 v[12:15], v4 offset:32
    ds_read_b128 v[16:19], v4 offset:64
    v_mfma_f32_32x32x16_bf16 v[40:55], a[116:119], v[28:31], v[40:55]
    ds_read_b128 v[20:23], v4 offset:96
    v_mfma_f32_32x32x16_bf16 v[40:55], a[120:123], v[32:35], v[40:55]
    ds_read_b128 v[24:27], v4 offset:128
    v_mfma_f32_32x32x16_bf16 v[40:55], a[124:127], v[36:39], v[40:55]
    ds_read_b128 v[28:31], v4 offset:160
    s_waitcnt lgkmcnt(5)
    v_mfma_f32_32x32x16_bf16 v[56:71], a[0:3], v[8:11], 0
    ds_read_b128 v[32:35], v4 offset:192
    s_mov_b32 m0, s44
    s_nop 0
    global_load_lds_dwordx4 v2, s[38:39] sc1
    s_add_u32 s38, s38, 1024
    s_waitcnt lgkmcnt(5)
    v_mfma_f32_32x32x16_bf16 v[56:71], a[4:7], v[12:15], v[56:71]
    ds_read_b128 v[36:39], v4 offset:224
    s_addc_u32 s39, s39, 0
    s_add_u32 m0, m0, 1040
    s_nop 0
    global_load_lds_dwordx4 v2, s[38:39] sc1
    s_waitcnt lgkmcnt(5)
    v_mfma_f32_32x32x16_bf16 v[56:71], a[8:11], v[16:19], v[56:71]
    ds_read_b128 v[8:11], v4 offset:256
    s_add_u32 s38, s38, 1024
    s_addc_u32 s39, s39, 0
    s_add_u32 m0, m0, 1040
    s_waitcnt lgkmcnt(5)
    v_mfma_f32_32x32x16_bf16 v[56:71], a[12:15], v[20:23], v[56:71]
    ds_read_b128 v[12:15], v4 offset:288
    global_load_lds_dwordx4 v2, s[38:39] sc1
    s_add_u32 s38, s38, 1024
    s_addc_u32 s39, s39, 0
    s_waitcnt lgkmcnt(5)
    v_mfma_f32_32x32x16_bf16 v[56:71], a[16:19], v[24:27], v[56:71]
    ds_read_b128 v[16:19], v4 offset:320
    s_add_u32 m0, m0, 1040
    s_nop 0
    global_load_lds_dwordx4 v2, s[38:39] sc1
    s_add_u32 s38, s38, 1024
    s_waitcnt lgkmcnt(5)
    v_mfma_f32_32x32x16_bf16 v[56:71], a[20:23], v[28:31], v[56:71]
    ds_read_b128 v[20:23], v4 offset:352
    s_addc_u32 s39, s39, 0
    s_add_u32 m0, m0, 1040
    s_nop 0
    global_load_lds_dwordx4 v2, s[38:39] sc1
    s_waitcnt lgkmcnt(5)
    v_mfma_f32_32x32x16_bf16 v[56:71], a[24:27], v[32:35], v[56:71]
    ds_read_b128 v[24:27], v4 offset:384
    s_add_u32 s38, s38, 1024
    s_addc_u32 s39, s39, 0
    s_add_u32 m0, m0, 1040
    s_waitcnt lgkmcnt(5)
    v_mfma_f32_32x32x16_bf16 v[56:71], a[28:31], v[36:39], v[56:71]
    ds_read_b128 v[28:31], v4 offset:416
    global_load_lds_dwordx4 v2, s[38:39] sc1
    s_add_u32 s38, s38, 1024
    s_addc_u32 s39, s39, 0
    s_waitcnt lgkmcnt(5)
    v_mfma_f32_32x32x16_bf16 v[56:71], a[32:35], v[8:11], v[56:71]
    ds_read_b128 v[32:35], v4 offset:448
    s_add_u32 m0, m0, 1040
    s_nop 0
    global_load_lds_dwordx4 v2, s[38:39] sc1
    s_add_u32 s38, s38, 1024
    s_waitcnt lgkmcnt(5)
    v_mfma_f32_32x32x16_bf16 v[56:71], a[36:39], v[12:15], v[56:71]
    ds_read_b128 v[36:39], v4 offset:480
    s_addc_u32 s39, s39, 0
    s_add_u32 m0, m0, 1040
    s_nop 0
    global_load_lds_dwordx4 v2, s[38:39] sc1
    s_waitcnt lgkmcnt(5)
    v_mfma_f32_32x32x16_bf16 v[56:71], a[40:43], v[16:19], v[56:71]
    ds_read_b128 v[8:11], v4 offset:512
    s_add_u32 s38, s38, 25600
    s_addc_u32 s39, s39, 0
    s_add_u32 s44, s44, 33280
    s_waitcnt lgkmcnt(5)
    v_mfma_f32_32x32x16_bf16 v[56:71], a[44:47], v[20:23], v[56:71]
    ds_read_b128 v[12:15], v4 offset:544
    s_cmp_ge_u32 s44, 133120
    s_cselect_b32 s56, 133120, 0
    s_sub_u32 s44, s44, s56
    s_waitcnt lgkmcnt(5)
    v_mfma_f32_32x32x16_bf16 v[56:71], a[48:51], v[24:27], v[56:71]
    ds_read_b128 v[16:19], v4 offset:576
    v_cvt_pk_bf16_f32 v72, v40, v41
    v_cvt_pk_bf16_f32 v73, v48, v49
    v_cvt_pk_bf16_f32 v74, v42, v43
    s_waitcnt lgkmcnt(5)
    v_mfma_f32_32x32x16_bf16 v[56:71], a[52:55], v[28:31], v[56:71]
    ds_read_b128 v[20:23], v4 offset:608
    v_cvt_pk_bf16_f32 v75, v50, v51
    global_store_dwordx4 v2, v[72:75], s[40:41] offset:0 sc1
    s_waitcnt lgkmcnt(5)
    v_mfma_f32_32x32x16_bf16 v[56:71], a[56:59], v[32:35], v[56:71]
    ds_read_b128 v[24:27], v4 offset:640
    v_cvt_pk_bf16_f32 v76, v44, v45
    v_cvt_pk_bf16_f32 v77, v52, v53
    v_cvt_pk_bf16_f32 v78, v46, v47
    s_waitcnt lgkmcnt(5)
    v_mfma_f32_32x32x16_bf16 v[56:71], a[60:63], v[36:39], v[56:71]
    ds_read_b128 v[28:31], v4 offset:672
    v_cvt_pk_bf16_f32 v79, v54, v55
    global_store_dwordx4 v2, v[76:79], s[40:41] offset:1024 sc1
    s_waitcnt lgkmcnt(5)
    v_mfma_f32_32x32x16_bf16 v[56:71], a[64:67], v[8:11], v[56:71]
    ds_read_b128 v[32:35], v4 offset:704
    s_add_u32 s40, s40, s43
    s_addc_u32 s41, s41, 0
    s_waitcnt lgkmcnt(5)
    v_mfma_f32_32x32x16_bf16 v[56:71], a[68:71], v[12:15], v[56:71]
    ds_read_b128 v[36:39], v4 offset:736
    s_waitcnt lgkmcnt(5)
    v_mfma_f32_32x32x16_bf16 v[56:71], a[72:75], v[16:19], v[56:71]
    ds_read_b128 v[8:11], v4 offset:768
    s_waitcnt lgkmcnt(5)
    v_mfma_f32_32x32x16_bf16 v[56:71], a[76:79], v[20:23], v[56:71]
    ds_read_b128 v[12:15], v4 offset:800
    s_waitcnt lgkmcnt(5)
    v_mfma_f32_32x32x16_bf16 v[56:71], a[80:83], v[24:27], v[56:71]
    ds_read_b128 v[16:19], v4 offset:832
    s_waitcnt lgkmcnt(5)
    v_mfma_f32_32x32x16_bf16 v[56:71], a[84:87], v[28:31], v[56:71]
    ds_read_b128 v[20:23], v4 offset:864
    s_waitcnt lgkmcnt(5)
    v_mfma_f32_32x32x16_bf16 v[56:71], a[88:91], v[32:35], v[56:71]
    ds_read_b128 v[24:27], v4 offset:896
    s_waitcnt lgkmcnt(5)
    v_mfma_f32_32x32x16_bf16 v[56:71], a[92:95], v[36:39], v[56:71]
    ds_read_b128 v[28:31], v4 offset:928
    s_waitcnt lgkmcnt(5)
    v_mfma_f32_32x32x16_bf16 v[56:71], a[96:99], v[8:11], v[56:71]
    ds_read_b128 v[32:35], v4 offset:960
    s_waitcnt lgkmcnt(5)
    v_mfma_f32_32x32x16_bf16 v[56:71], a[100:103], v[12:15], v[56:71]
    ds_read_b128 v[36:39], v4 offset:992
    s_waitcnt lgkmcnt(5)
    v_mfma_f32_32x32x16_bf16 v[56:71], a[104:107], v[16:19], v[56:71]
    v_add_u32 v4, 33280, v4
    v_subrev_u32 v5, 133120, v4
    v_min_u32 v4, v4, v5
    s_waitcnt lgkmcnt(4)
    v_mfma_f32_32x32x16_bf16 v[56:71], a[108:111], v[20:23], v[56:71]
    s_waitcnt lgkmcnt(3)
    v_mfma_f32_32x32x16_bf16 v[56:71], a[112:115], v[24:27], v[56:71]
    s_waitcnt lgkmcnt(0)
    s_waitcnt vmcnt(18)
    s_barrier
    ds_read_b128 v[8:11], v4 offset:0
    ds_read_b128 v[12:15], v4 offset:32
    ds_read_b128 v[16:19], v4 offset:64
    v_mfma_f32_32x32x16_bf16 v[56:71], a[116:119], v[28:31], v[56:71]
    ds_read_b128 v[20:23], v4 offset:96
    v_mfma_f32_32x32x16_bf16 v[56:71], a[120:123], v[32:35], v[56:71]
    ds_read_b128 v[24:27], v4 offset:128
    v_mfma_f32_32x32x16_bf16 v[56:71], a[124:127], v[36:39], v[56:71]
    ds_read_b128 v[28:31], v4 offset:160
    s_mov_b32 s42, 2
    s_branch L_gl19
.p2align 6
L_gl19:
    s_waitcnt lgkmcnt(5)
    v_mfma_f32_32x32x16_bf16 v[40:55], a[0:3], v[8:11], 0
    ds_read_b128 v[32:35], v4 offset:192
    s_mov_b32 m0, s44
    s_nop 0
    global_load_lds_dwordx4 v2, s[38:39] sc1
    s_add_u32 s38, s38, 1024
    s_waitcnt lgkmcnt(5)
    v_mfma_f32_32x32x16_bf16 v[40:55], a[4:7], v[12:15], v[40:55]
    ds_read_b128 v[36:39], v4 offset:224
    s_addc_u32 s39, s39, 0
    s_add_u32 m0, m0, 1040
    s_nop 0
    global_load_lds_dwordx4 v2, s[38:39] sc1
    s_waitcnt lgkmcnt(5)
    v_mfma_f32_32x32x16_bf16 v[40:55], a[8:11], v[16:19], v[40:55]
    ds_read_b128 v[8:11], v4 offset:256
    s_add_u32 s38, s38, 1024
    s_addc_u32 s39, s39, 0
    s_add_u32 m0, m0, 1040
    s_waitcnt lgkmcnt(5)
    v_mfma_f32_32x32x16_bf16 v[40:55], a[12:15], v[20:23], v[40:55]
    ds_read_b128 v[12:15], v4 offset:288
    global_load_lds_dwordx4 v2, s[38:39] sc1
    s_add_u32 s38, s38, 1024
    s_addc_u32 s39, s39, 0
    s_waitcnt lgkmcnt(5)
    v_mfma_f32_32x32x16_bf16 v[40:55], a[16:19], v[24:27], v[40:55]
    ds_read_b128 v[16:19], v4 offset:320
    s_add_u32 m0, m0, 1040
    s_nop 0
    global_load_lds_dwordx4 v2, s[38:39] sc1
    s_add_u32 s38, s38, 1024
    s_waitcnt lgkmcnt(5)
    v_mfma_f32_32x32x16_bf16 v[40:55], a[20:23], v[28:31], v[40:55]
    ds_read_b128 v[20:23], v4 offset:352
    s_addc_u32 s39, s39, 0
    s_add_u32 m0, m0, 1040
    s_nop 0
    global_load_lds_dwordx4 v2, s[38:39] sc1
    s_waitcnt lgkmcnt(5)
    v_mfma_f32_32x32x16_bf16 v[40:55], a[24:27], v[32:35], v[40:55]
    ds_read_b128 v[24:27], v4 offset:384
    s_add_u32 s38, s38, 1024
    s_addc_u32 s39, s39, 0
    s_add_u32 m0, m0, 1040
    s_waitcnt lgkmcnt(5)
    v_mfma_f32_32x32x16_bf16 v[40:55], a[28:31], v[36:39], v[40:55]
    ds_read_b128 v[28:31], v4 offset:416
    global_load_lds_dwordx4 v2, s[38:39] sc1
    s_add_u32 s38, s38, 1024
    s_addc_u32 s39, s39, 0
    s_waitcnt lgkmcnt(5)
    v_mfma_f32_32x32x16_bf16 v[40:55], a[32:35], v[8:11], v[40:55]
    ds_read_b128 v[32:35], v4 offset:448
    s_add_u32 m0, m0, 1040
    s_nop 0
    global_load_lds_dwordx4 v2, s[38:39] sc1
    s_add_u32 s38, s38, 1024
    s_waitcnt lgkmcnt(5)
    v_mfma_f32_32x32x16_bf16 v[40:55], a[36:39], v[12:15], v[40:55]
    ds_read_b128 v[36:39], v4 offset:480
    s_addc_u32 s39, s39, 0
    s_add_u32 m0, m0, 1040
    s_nop 0
    global_load_lds_dwordx4 v2, s[38:39] sc1
    s_waitcnt lgkmcnt(5)
    v_mfma_f32_32x32x16_bf16 v[40:55], a[40:43], v[16:19], v[40:55]
    ds_read_b128 v[8:11], v4 offset:512
    s_add_u32 s38, s38, 25600
    s_addc_u32 s39, s39, 0
    s_add_u32 s44, s44, 33280
    s_waitcnt lgkmcnt(5)
    v_mfma_f32_32x32x16_bf16 v[40:55], a[44:47], v[20:23], v[40:55]
    ds_read_b128 v[12:15], v4 offset:544
    s_cmp_ge_u32 s44, 133120
    s_cselect_b32 s56, 133120, 0
    s_sub_u32 s44, s44, s56
    s_waitcnt lgkmcnt(5)
    v_mfma_f32_32x32x16_bf16 v[40:55], a[48:51], v[24:27], v[40:55]
    ds_read_b128 v[16:19], v4 offset:576
    v_cvt_pk_bf16_f32 v72, v56, v57
    v_cvt_pk_bf16_f32 v73, v64, v65
    v_cvt_pk_bf16_f32 v74, v58, v59
    s_waitcnt lgkmcnt(5)
    v_mfma_f32_32x32x16_bf16 v[40:55], a[52:55], v[28:31], v[40:55]
    ds_read_b128 v[20:23], v4 offset:608
    v_cvt_pk_bf16_f32 v75, v66, v67
    global_store_dwordx4 v2, v[72:75], s[40:41] offset:0 sc1
    s_waitcnt lgkmcnt(5)
    v_mfma_f32_32x32x16_bf16 v[40:55], a[56:59], v[32:35], v[40:55]
    ds_read_b128 v[24:27], v4 offset:640
    v_cvt_pk_bf16_f32 v76, v60, v61
    v_cvt_pk_bf16_f32 v77, v68, v69
    v_cvt_pk_bf16_f32 v78, v62, v63
    s_waitcnt lgkmcnt(5)
    v_mfma_f32_32x32x16_bf16 v[40:55], a[60:63], v[36:39], v[40:55]
    ds_read_b128 v[28:31], v4 offset:672
    v_cvt_pk_bf16_f32 v79, v70, v71
    global_store_dwordx4 v2, v[76:79], s[40:41] offset:1024 sc1
    s_waitcnt lgkmcnt(5)
    v_mfma_f32_32x32x16_bf16 v[40:55], a[64:67], v[8:11], v[40:55]
    ds_read_b128 v[32:35], v4 offset:704
    s_add_u32 s40, s40, s43
    s_addc_u32 s41, s41, 0
    s_waitcnt lgkmcnt(5)
    v_mfma_f32_32x32x16_bf16 v[40:55], a[68:71], v[12:15], v[40:55]
    ds_read_b128 v[36:39], v4 offset:736
    s_waitcnt lgkmcnt(5)
    v_mfma_f32_32x32x16_bf16 v[40:55], a[72:75], v[16:19], v[40:55]
    ds_read_b128 v[8:11], v4 offset:768
    s_waitcnt lgkmcnt(5)
    v_mfma_f32_32x32x16_bf16 v[40:55], a[76:79], v[20:23], v[40:55]
    ds_read_b128 v[12:15], v4 offset:800
    s_waitcnt lgkmcnt(5)
    v_mfma_f32_32x32x16_bf16 v[40:55], a[80:83], v[24:27], v[40:55]
    ds_read_b128 v[16:19], v4 offset:832
    s_waitcnt lgkmcnt(5)
    v_mfma_f32_32x32x16_bf16 v[40:55], a[84:87], v[28:31], v[40:55]
    ds_read_b128 v[20:23], v4 offset:864
    s_waitcnt lgkmcnt(5)
    v_mfma_f32_32x32x16_bf16 v[40:55], a[88:91], v[32:35], v[40:55]
    ds_read_b128 v[24:27], v4 offset:896
    s_waitcnt lgkmcnt(5)
    v_mfma_f32_32x32x16_bf16 v[40:55], a[92:95], v[36:39], v[40:55]
    ds_read_b128 v[28:31], v4 offset:928
    s_waitcnt lgkmcnt(5)
    v_mfma_f32_32x32x16_bf16 v[40:55], a[96:99], v[8:11], v[40:55]
    ds_read_b128 v[32:35], v4 offset:960
    s_waitcnt lgkmcnt(5)
    v_mfma_f32_32x32x16_bf16 v[40:55], a[100:103], v[12:15], v[40:55]
    ds_read_b128 v[36:39], v4 offset:992
    s_waitcnt lgkmcnt(5)
    v_mfma_f32_32x32x16_bf16 v[40:55], a[104:107], v[16:19], v[40:55]
    v_add_u32 v4, 33280, v4
    v_subrev_u32 v5, 133120, v4
    v_min_u32_e64 v4, v4, v5
    s_waitcnt lgkmcnt(4)
    v_mfma_f32_32x32x16_bf16 v[40:55], a[108:111], v[20:23], v[40:55]
    s_waitcnt lgkmcnt(3)
    v_mfma_f32_32x32x16_bf16 v[40:55], a[112:115], v[24:27], v[40:55]
    s_waitcnt lgkmcnt(0)
    s_waitcnt vmcnt(20)
    s_barrier
    ds_read_b128 v[8:11], v4 offset:0
    ds_read_b128 v[12:15], v4 offset:32
    ds_read_b128 v[16:19], v4 offset:64
    v_mfma_f32_32x32x16_bf16 v[40:55], a[116:119], v[28:31], v[40:55]
    ds_read_b128 v[20:23], v4 offset:96
    v_mfma_f32_32x32x16_bf16 v[40:55], a[120:123], v[32:35], v[40:55]
    ds_read_b128 v[24:27], v4 offset:128
    v_mfma_f32_32x32x16_bf16 v[40:55], a[124:127], v[36:39], v[40:55]
    ds_read_b128 v[28:31], v4 offset:160
    s_waitcnt lgkmcnt(5)
    v_mfma_f32_32x32x16_bf16 v[56:71], a[0:3], v[8:11], 0
    ds_read_b128 v[32:35], v4 offset:192
    s_mov_b32 m0, s44
    s_nop 0
    global_load_lds_dwordx4 v2, s[38:39] sc1
    s_add_u32 s38, s38, 1024
    s_waitcnt lgkmcnt(5)
    v_mfma_f32_32x32x16_bf16 v[56:71], a[4:7], v[12:15], v[56:71]
    ds_read_b128 v[36:39], v4 offset:224
    s_addc_u32 s39, s39, 0
    s_add_u32 m0, m0, 1040
    s_nop 0
    global_load_lds_dwordx4 v2, s[38:39] sc1
    s_waitcnt lgkmcnt(5)
    v_mfma_f32_32x32x16_bf16 v[56:71], a[8:11], v[16:19], v[56:71]
    ds_read_b128 v[8:11], v4 offset:256
    s_add_u32 s38, s38, 1024
    s_addc_u32 s39, s39, 0
    s_add_u32 m0, m0, 1040
    s_waitcnt lgkmcnt(5)
    v_mfma_f32_32x32x16_bf16 v[56:71], a[12:15], v[20:23], v[56:71]
    ds_read_b128 v[12:15], v4 offset:288
    global_load_lds_dwordx4 v2, s[38:39] sc1
    s_add_u32 s38, s38, 1024
    s_addc_u32 s39, s39, 0
    s_waitcnt lgkmcnt(5)
    v_mfma_f32_32x32x16_bf16 v[56:71], a[16:19], v[24:27], v[56:71]
    ds_read_b128 v[16:19], v4 offset:320
    s_add_u32 m0, m0, 1040
    s_nop 0
    global_load_lds_dwordx4 v2, s[38:39] sc1
    s_add_u32 s38, s38, 1024
    s_waitcnt lgkmcnt(5)
    v_mfma_f32_32x32x16_bf16 v[56:71], a[20:23], v[28:31], v[56:71]
    ds_read_b128 v[20:23], v4 offset:352
    s_addc_u32 s39, s39, 0
    s_add_u32 m0, m0, 1040
    s_nop 0
    global_load_lds_dwordx4 v2, s[38:39] sc1
    s_waitcnt lgkmcnt(5)
    v_mfma_f32_32x32x16_bf16 v[56:71], a[24:27], v[32:35], v[56:71]
    ds_read_b128 v[24:27], v4 offset:384
    s_add_u32 s38, s38, 1024
    s_addc_u32 s39, s39, 0
    s_add_u32 m0, m0, 1040
    s_waitcnt lgkmcnt(5)
    v_mfma_f32_32x32x16_bf16 v[56:71], a[28:31], v[36:39], v[56:71]
    ds_read_b128 v[28:31], v4 offset:416
    global_load_lds_dwordx4 v2, s[38:39] sc1
    s_add_u32 s38, s38, 1024
    s_addc_u32 s39, s39, 0
    s_waitcnt lgkmcnt(5)
    v_mfma_f32_32x32x16_bf16 v[56:71], a[32:35], v[8:11], v[56:71]
    ds_read_b128 v[32:35], v4 offset:448
    s_add_u32 m0, m0, 1040
    s_nop 0
    global_load_lds_dwordx4 v2, s[38:39] sc1
    s_add_u32 s38, s38, 1024
    s_waitcnt lgkmcnt(5)
    v_mfma_f32_32x32x16_bf16 v[56:71], a[36:39], v[12:15], v[56:71]
    ds_read_b128 v[36:39], v4 offset:480
    s_addc_u32 s39, s39, 0
    s_add_u32 m0, m0, 1040
    s_nop 0
    global_load_lds_dwordx4 v2, s[38:39] sc1
    s_waitcnt lgkmcnt(5)
    v_mfma_f32_32x32x16_bf16 v[56:71], a[40:43], v[16:19], v[56:71]
    ds_read_b128 v[8:11], v4 offset:512
    s_add_u32 s38, s38, 25600
    s_addc_u32 s39, s39, 0
    s_add_u32 s44, s44, 33280
    s_waitcnt lgkmcnt(5)
    v_mfma_f32_32x32x16_bf16 v[56:71], a[44:47], v[20:23], v[56:71]
    ds_read_b128 v[12:15], v4 offset:544
    s_cmp_ge_u32 s44, 133120
    s_cselect_b32 s56, 133120, 0
    s_sub_u32 s44, s44, s56
    s_waitcnt lgkmcnt(5)
    v_mfma_f32_32x32x16_bf16 v[56:71], a[48:51], v[24:27], v[56:71]
    ds_read_b128 v[16:19], v4 offset:576
    v_cvt_pk_bf16_f32 v72, v40, v41
    v_cvt_pk_bf16_f32 v73, v48, v49
    v_cvt_pk_bf16_f32 v74, v42, v43
    s_waitcnt lgkmcnt(5)
    v_mfma_f32_32x32x16_bf16 v[56:71], a[52:55], v[28:31], v[56:71]
    ds_read_b128 v[20:23], v4 offset:608
    v_cvt_pk_bf16_f32 v75, v50, v51
    global_store_dwordx4 v2, v[72:75], s[40:41] offset:0 sc1
    s_waitcnt lgkmcnt(5)
    v_mfma_f32_32x32x16_bf16 v[56:71], a[56:59], v[32:35], v[56:71]
    ds_read_b128 v[24:27], v4 offset:640
    v_cvt_pk_bf16_f32 v76, v44, v45
    v_cvt_pk_bf16_f32 v77, v52, v53
    v_cvt_pk_bf16_f32 v78, v46, v47
    s_waitcnt lgkmcnt(5)
    v_mfma_f32_32x32x16_bf16 v[56:71], a[60:63], v[36:39], v[56:71]
    ds_read_b128 v[28:31], v4 offset:672
    v_cvt_pk_bf16_f32 v79, v54, v55
    global_store_dwordx4 v2, v[76:79], s[40:41] offset:1024 sc1
    s_waitcnt lgkmcnt(5)
    v_mfma_f32_32x32x16_bf16 v[56:71], a[64:67], v[8:11], v[56:71]
    ds_read_b128 v[32:35], v4 offset:704
    s_add_u32 s40, s40, s43
    s_addc_u32 s41, s41, 0
    s_waitcnt lgkmcnt(5)
    v_mfma_f32_32x32x16_bf16 v[56:71], a[68:71], v[12:15], v[56:71]
    ds_read_b128 v[36:39], v4 offset:736
    s_waitcnt lgkmcnt(5)
    v_mfma_f32_32x32x16_bf16 v[56:71], a[72:75], v[16:19], v[56:71]
    ds_read_b128 v[8:11], v4 offset:768
    s_waitcnt lgkmcnt(5)
    v_mfma_f32_32x32x16_bf16 v[56:71], a[76:79], v[20:23], v[56:71]
    ds_read_b128 v[12:15], v4 offset:800
    s_waitcnt lgkmcnt(5)
    v_mfma_f32_32x32x16_bf16 v[56:71], a[80:83], v[24:27], v[56:71]
    ds_read_b128 v[16:19], v4 offset:832
    s_waitcnt lgkmcnt(5)
    v_mfma_f32_32x32x16_bf16 v[56:71], a[84:87], v[28:31], v[56:71]
    ds_read_b128 v[20:23], v4 offset:864
    s_waitcnt lgkmcnt(5)
    v_mfma_f32_32x32x16_bf16 v[56:71], a[88:91], v[32:35], v[56:71]
    ds_read_b128 v[24:27], v4 offset:896
    s_waitcnt lgkmcnt(5)
    v_mfma_f32_32x32x16_bf16 v[56:71], a[92:95], v[36:39], v[56:71]
    ds_read_b128 v[28:31], v4 offset:928
    s_waitcnt lgkmcnt(5)
    v_mfma_f32_32x32x16_bf16 v[56:71], a[96:99], v[8:11], v[56:71]
    ds_read_b128 v[32:35], v4 offset:960
    s_waitcnt lgkmcnt(5)
    v_mfma_f32_32x32x16_bf16 v[56:71], a[100:103], v[12:15], v[56:71]
    ds_read_b128 v[36:39], v4 offset:992
    s_waitcnt lgkmcnt(5)
    v_mfma_f32_32x32x16_bf16 v[56:71], a[104:107], v[16:19], v[56:71]
    v_add_u32 v4, 33280, v4
    v_subrev_u32 v5, 133120, v4
    v_min_u32 v4, v4, v5
    s_waitcnt lgkmcnt(4)
    v_mfma_f32_32x32x16_bf16 v[56:71], a[108:111], v[20:23], v[56:71]
    s_waitcnt lgkmcnt(3)
    v_mfma_f32_32x32x16_bf16 v[56:71], a[112:115], v[24:27], v[56:71]
    s_waitcnt lgkmcnt(0)
    s_add_u32 s42, s42, 2
    s_cmp_eq_u32 s42, 4
    s_cselect_b32 s57, 2, 3
    s_cbranch_scc0 L_gn19
    s_waitcnt vmcnt(10)
L_gn19:
    s_waitcnt vmcnt(20)
    s_barrier
    s_sub_i32 s57, s42, s57
    s_cmp_lg_u32 s30, 0
    s_cbranch_scc1 L_pg20
    v_mov_b32 v6, 0
    v_mov_b32_e64 v7, s57
    s_mov_b64 exec, 1
    global_store_dword v6, v7, s[48:49] sc1
    s_mov_b64 exec, -1
L_pg20:
    s_cmp_lg_u32 s42, 4
    s_cbranch_scc1 L_gh19
    s_cmp_lg_u32 s30, 0
    s_cbranch_scc1 L_wdn21
    v_mbcnt_lo_u32_b32 v6, -1, 0
    v_mbcnt_hi_u32_b32 v6, -1, v6
    v_lshlrev_b32 v6, 2, v6
    s_mov_b32 exec_lo, 0x0
    s_mov_b32 exec_hi, 0x404
    s_mov_b32 s54, 0
    s_branch L_wf21
L_wd21:
    s_sleep 2
L_wf21:
    global_load_dword v7, v6, s[26:27] sc1
    s_add_u32 s54, s54, 1
    s_cmp_gt_u32 s54, 400000
    s_cbranch_scc1 L_end
    s_waitcnt vmcnt(0)
    v_cmp_gt_u32 vcc, 32, v7
    s_cbranch_vccnz L_wd21
    s_mov_b64 exec, -1
L_wdn21:
    s_barrier
L_gh19:
    ds_read_b128 v[8:11], v4 offset:0
    ds_read_b128 v[12:15], v4 offset:32
    ds_read_b128 v[16:19], v4 offset:64
    v_mfma_f32_32x32x16_bf16 v[56:71], a[116:119], v[28:31], v[56:71]
    ds_read_b128 v[20:23], v4 offset:96
    v_mfma_f32_32x32x16_bf16 v[56:71], a[120:123], v[32:35], v[56:71]
    ds_read_b128 v[24:27], v4 offset:128
    v_mfma_f32_32x32x16_bf16 v[56:71], a[124:127], v[36:39], v[56:71]
    ds_read_b128 v[28:31], v4 offset:160
    s_cmp_lt_u32 s42, 64
    s_cbranch_scc1 L_gl19
    s_nop 8
    v_cvt_pk_bf16_f32 v72, v56, v57
    v_cvt_pk_bf16_f32 v73, v64, v65
    v_cvt_pk_bf16_f32 v74, v58, v59
    v_cvt_pk_bf16_f32 v75, v66, v67
    global_store_dwordx4 v2, v[72:75], s[40:41] offset:0 sc1
    v_cvt_pk_bf16_f32 v76, v60, v61
    v_cvt_pk_bf16_f32 v77, v68, v69
    v_cvt_pk_bf16_f32 v78, v62, v63
    v_cvt_pk_bf16_f32 v79, v70, v71
    global_store_dwordx4 v2, v[76:79], s[40:41] offset:1024 sc1
    s_add_u32 s40, s40, s43
    s_addc_u32 s41, s41, 0
    s_waitcnt vmcnt(0) lgkmcnt(0)
    s_barrier
    s_cmp_lg_u32 s30, 0
    s_cbranch_scc1 L_pg22
    v_mov_b32 v6, 0
    v_mov_b32 v7, 64
    s_mov_b64 exec, 1
    global_store_dword v6, v7, s[48:49] sc1
    s_mov_b64 exec, -1
L_pg22:
L_gd8:
    s_branch L_post
L_w4:
    s_cmp_gt_u32 s32, 5
    s_cbranch_scc1 L_w6
    s_sub_u32 s35, s32, 4
    s_add_u32 s56, s4, 0
    s_addc_u32 s57, s5, 0
    s_mul_i32 s61, s35, 131072
    s_add_u32 s56, s56, s61
    s_addc_u32 s57, s57, 0
    s_mul_i32 s61, s31, 4096
    s_add_u32 s56, s56, s61
    s_addc_u32 s57, s57, 0
    s_mul_i32 s61, s30, 1024
    s_add_u32 s56, s56, s61
    s_addc_u32 s57, s57, 0
    global_load_dwordx4 v[64:67], v2, s[56:57]
    s_add_u32 s56, s56, 262144
    s_addc_u32 s57, s57, 0
    global_load_dwordx4 v[68:71], v2, s[56:57]
    s_add_u32 s56, s56, 262144
    s_addc_u32 s57, s57, 0
    global_load_dwordx4 v[72:75], v2, s[56:57]
    s_add_u32 s56, s56, 262144
    s_addc_u32 s57, s57, 0
    global_load_dwordx4 v[76:79], v2, s[56:57]
    s_add_u32 s56, s56, 262144
    s_addc_u32 s57, s57, 0
    global_load_dwordx4 v[80:83], v2, s[56:57]
    s_add_u32 s56, s56, 262144
    s_addc_u32 s57, s57, 0
    global_load_dwordx4 v[84:87], v2, s[56:57]
    s_add_u32 s56, s56, 262144
    s_addc_u32 s57, s57, 0
    global_load_dwordx4 v[88:91], v2, s[56:57]
    s_add_u32 s56, s56, 262144
    s_addc_u32 s57, s57, 0
    global_load_dwordx4 v[92:95], v2, s[56:57]
    s_add_u32 s56, s56, 262144
    s_addc_u32 s57, s57, 0
    s_cmp_eq_u32 s55, 1
    s_cbranch_scc1 L_cf23
    v_mov_b32 v252, 163836
    s_cmp_lg_u32 s30, 0
    s_cbranch_scc1 L_cg23
    s_waitcnt vmcnt(8)
    s_mov_b64 exec, 1
    ds_write_b32 v252, v253
    s_waitcnt lgkmcnt(0)
    s_mov_b64 exec, -1
L_cg23:
    s_barrier
    ds_read_b32 v253, v252
    s_waitcnt lgkmcnt(0)
    v_readfirstlane_b32 s56, v253
    s_barrier
    s_bitcmp1_b32 s56, s31
    s_cbranch_scc1 L_lost
L_cf23:
    s_waitcnt vmcnt(7)
    v_lshlrev_b32 v96, 16, v64
    v_and_b32 v97, 0xffff0000, v64
    v_lshlrev_b32 v98, 16, v65
    v_and_b32 v99, 0xffff0000, v65
    v_lshlrev_b32 v100, 16, v66
    v_and_b32 v101, 0xffff0000, v66
    v_lshlrev_b32 v102, 16, v67
    v_and_b32 v103, 0xffff0000, v67
    s_waitcnt vmcnt(6)
    v_lshlrev_b32 v104, 16, v68
    v_and_b32 v105, 0xffff0000, v68
    v_lshlrev_b32 v106, 16, v69
    v_and_b32 v107, 0xffff0000, v69
    v_lshlrev_b32 v108, 16, v70
    v_and_b32 v109, 0xffff0000, v70
    v_lshlrev_b32 v110, 16, v71
    v_and_b32 v111, 0xffff0000, v71
    s_waitcnt vmcnt(5)
    v_lshlrev_b32 v112, 16, v72
    v_and_b32 v113, 0xffff0000, v72
    v_lshlrev_b32 v114, 16, v73
    v_and_b32 v115, 0xffff0000, v73
    v_lshlrev_b32 v116, 16, v74
    v_and_b32 v117, 0xffff0000, v74
    v_lshlrev_b32 v118, 16, v75
    v_and_b32 v119, 0xffff0000, v75
    s_waitcnt vmcnt(4)
    v_lshlrev_b32 v120, 16, v76
    v_and_b32 v121, 0xffff0000, v76
    v_lshlrev_b32 v122, 16, v77
    v_and_b32 v123, 0xffff0000, v77
    v_lshlrev_b32 v124, 16, v78
    v_and_b32 v125, 0xffff0000, v78
    v_lshlrev_b32 v126, 16, v79
    v_and_b32 v127, 0xffff0000, v79
    s_waitcnt vmcnt(3)
    v_lshlrev_b32 v128, 16, v80
    v_and_b32 v129, 0xffff0000, v80
    v_lshlrev_b32 v130, 16, v81
    v_and_b32 v131, 0xffff0000, v81
    v_lshlrev_b32 v132, 16, v82
    v_and_b32 v133, 0xffff0000, v82
    v_lshlrev_b32 v134, 16, v83
    v_and_b32 v135, 0xffff0000, v83
    s_waitcnt vmcnt(2)
    v_lshlrev_b32 v136, 16, v84
    v_and_b32 v137, 0xffff0000, v84
    v_lshlrev_b32 v138, 16, v85
    v_and_b32 v139, 0xffff0000, v85
    v_lshlrev_b32 v140, 16, v86
    v_and_b32 v141, 0xffff0000, v86
    v_lshlrev_b32 v142, 16, v87
    v_and_b32 v143, 0xffff0000, v87
    s_waitcnt vmcnt(1)
    v_lshlrev_b32 v144, 16, v88
    v_and_b32 v145, 0xffff0000, v88
    v_lshlrev_b32 v146, 16, v89
    v_and_b32 v147, 0xffff0000, v89
    v_lshlrev_b32 v148, 16, v90
    v_and_b32 v149, 0xffff0000, v90
    v_lshlrev_b32 v150, 16, v91
    v_and_b32 v151, 0xffff0000, v91
    s_waitcnt vmcnt(0)
    v_lshlrev_b32 v152, 16, v92
    v_and_b32 v153, 0xffff0000, v92
    v_lshlrev_b32 v154, 16, v93
    v_and_b32 v155, 0xffff0000, v93
    v_lshlrev_b32 v156, 16, v94
    v_and_b32 v157, 0xffff0000, v94
    v_lshlrev_b32 v158, 16, v95
    v_and_b32 v159, 0xffff0000, v95
    v_pk_add_f32 v[192:193], v[96:97], v[98:99]
    v_pk_add_f32 v[194:195], v[100:101], v[102:103]
    v_pk_add_f32 v[192:193], v[192:193], v[194:195]
    v_add_f32 v160, v192, v193
    v_pk_add_f32 v[192:193], v[104:105], v[106:107]
    v_pk_add_f32 v[194:195], v[108:109], v[110:111]
    v_pk_add_f32 v[192:193], v[192:193], v[194:195]
    v_add_f32 v161, v192, v193
    v_pk_add_f32 v[192:193], v[112:113], v[114:115]
    v_pk_add_f32 v[194:195], v[116:117], v[118:119]
    v_pk_add_f32 v[192:193], v[192:193], v[194:195]
    v_add_f32 v162, v192, v193
    v_pk_add_f32 v[192:193], v[120:121], v[122:123]
    v_pk_add_f32 v[194:195], v[124:125], v[126:127]
    v_pk_add_f32 v[192:193], v[192:193], v[194:195]
    v_add_f32 v163, v192, v193
    v_pk_add_f32 v[192:193], v[128:129], v[130:131]
    v_pk_add_f32 v[194:195], v[132:133], v[134:135]
    v_pk_add_f32 v[192:193], v[192:193], v[194:195]
    v_add_f32 v164, v192, v193
    v_pk_add_f32 v[192:193], v[136:137], v[138:139]
    v_pk_add_f32 v[194:195], v[140:141], v[142:143]
    v_pk_add_f32 v[192:193], v[192:193], v[194:195]
    v_add_f32 v165, v192, v193
    v_pk_add_f32 v[192:193], v[144:145], v[146:147]
    v_pk_add_f32 v[194:195], v[148:149], v[150:151]
    v_pk_add_f32 v[192:193], v[192:193], v[194:195]
    v_add_f32 v166, v192, v193
    v_pk_add_f32 v[192:193], v[152:153], v[154:155]
    v_pk_add_f32 v[194:195], v[156:157], v[158:159]
    v_pk_add_f32 v[192:193], v[192:193], v[194:195]
    v_add_f32 v167, v192, v193
    v_add_f32_dpp v160, v160, v160 row_ror:8 row_mask:0xf bank_mask:0xf
    v_add_f32_dpp v161, v161, v161 row_ror:8 row_mask:0xf bank_mask:0xf
    v_add_f32_dpp v162, v162, v162 row_ror:8 row_mask:0xf bank_mask:0xf
    v_add_f32_dpp v163, v163, v163 row_ror:8 row_mask:0xf bank_mask:0xf
    v_add_f32_dpp v164, v164, v164 row_ror:8 row_mask:0xf bank_mask:0xf
    v_add_f32_dpp v165, v165, v165 row_ror:8 row_mask:0xf bank_mask:0xf
    v_add_f32_dpp v166, v166, v166 row_ror:8 row_mask:0xf bank_mask:0xf
    v_add_f32_dpp v167, v167, v167 row_ror:8 row_mask:0xf bank_mask:0xf
    v_add_f32_dpp v160, v160, v160 row_ror:4 row_mask:0xf bank_mask:0xf
    v_add_f32_dpp v161, v161, v161 row_ror:4 row_mask:0xf bank_mask:0xf
    v_add_f32_dpp v162, v162, v162 row_ror:4 row_mask:0xf bank_mask:0xf
    v_add_f32_dpp v163, v163, v163 row_ror:4 row_mask:0xf bank_mask:0xf
    v_add_f32_dpp v164, v164, v164 row_ror:4 row_mask:0xf bank_mask:0xf
    v_add_f32_dpp v165, v165, v165 row_ror:4 row_mask:0xf bank_mask:0xf
    v_add_f32_dpp v166, v166, v166 row_ror:4 row_mask:0xf bank_mask:0xf
    v_add_f32_dpp v167, v167, v167 row_ror:4 row_mask:0xf bank_mask:0xf
    v_add_f32_dpp v160, v160, v160 row_ror:2 row_mask:0xf bank_mask:0xf
    v_add_f32_dpp v161, v161, v161 row_ror:2 row_mask:0xf bank_mask:0xf
    v_add_f32_dpp v162, v162, v162 row_ror:2 row_mask:0xf bank_mask:0xf
    v_add_f32_dpp v163, v163, v163 row_ror:2 row_mask:0xf bank_mask:0xf
    v_add_f32_dpp v164, v164, v164 row_ror:2 row_mask:0xf bank_mask:0xf
    v_add_f32_dpp v165, v165, v165 row_ror:2 row_mask:0xf bank_mask:0xf
    v_add_f32_dpp v166, v166, v166 row_ror:2 row_mask:0xf bank_mask:0xf
    v_add_f32_dpp v167, v167, v167 row_ror:2 row_mask:0xf bank_mask:0xf
    v_add_f32_dpp v160, v160, v160 row_ror:1 row_mask:0xf bank_mask:0xf
    v_add_f32_dpp v161, v161, v161 row_ror:1 row_mask:0xf bank_mask:0xf
    v_add_f32_dpp v162, v162, v162 row_ror:1 row_mask:0xf bank_mask:0xf
    v_add_f32_dpp v163, v163, v163 row_ror:1 row_mask:0xf bank_mask:0xf
    v_add_f32_dpp v164, v164, v164 row_ror:1 row_mask:0xf bank_mask:0xf
    v_add_f32_dpp v165, v165, v165 row_ror:1 row_mask:0xf bank_mask:0xf
    v_add_f32_dpp v166, v166, v166 row_ror:1 row_mask:0xf bank_mask:0xf
    v_add_f32_dpp v167, v167, v167 row_ror:1 row_mask:0xf bank_mask:0xf
    v_mov_b32 v168, v160
    v_mov_b32 v169, v161
    v_mov_b32 v170, v162
    v_mov_b32 v171, v163
    v_mov_b32 v172, v164
    v_mov_b32 v173, v165
    v_mov_b32 v174, v166
    v_mov_b32 v175, v167
    v_permlane16_swap_b32 v160, v168
    v_permlane16_swap_b32 v161, v169
    v_permlane16_swap_b32 v162, v170
    v_permlane16_swap_b32 v163, v171
    v_permlane16_swap_b32 v164, v172
    v_permlane16_swap_b32 v165, v173
    v_permlane16_swap_b32 v166, v174
    v_permlane16_swap_b32 v167, v175
    v_add_f32 v160, v160, v168
    v_add_f32 v161, v161, v169
    v_add_f32 v162, v162, v170
    v_add_f32 v163, v163, v171
    v_add_f32 v164, v164, v172
    v_add_f32 v165, v165, v173
    v_add_f32 v166, v166, v174
    v_add_f32 v167, v167, v175
    v_mov_b32 v168, v160
    v_mov_b32 v169, v161
    v_mov_b32 v170, v162
    v_mov_b32 v171, v163
    v_mov_b32 v172, v164
    v_mov_b32 v173, v165
    v_mov_b32 v174, v166
    v_mov_b32 v175, v167
    v_permlane32_swap_b32 v160, v168
    v_permlane32_swap_b32 v161, v169
    v_permlane32_swap_b32 v162, v170
    v_permlane32_swap_b32 v163, v171
    v_permlane32_swap_b32 v164, v172
    v_permlane32_swap_b32 v165, v173
    v_permlane32_swap_b32 v166, v174
    v_permlane32_swap_b32 v167, v175
    v_add_f32 v160, v160, v168
    v_add_f32 v161, v161, v169
    v_add_f32 v162, v162, v170
    v_add_f32 v163, v163, v171
    v_add_f32 v164, v164, v172
    v_add_f32 v165, v165, v173
    v_add_f32 v166, v166, v174
    v_add_f32 v167, v167, v175
    v_mul_f32 v176, 0x3b000000, v160
    v_mul_f32 v177, 0x3b000000, v161
    v_mul_f32 v178, 0x3b000000, v162
    v_mul_f32 v179, 0x3b000000, v163
    v_mul_f32 v180, 0x3b000000, v164
    v_mul_f32 v181, 0x3b000000, v165
    v_mul_f32 v182, 0x3b000000, v166
    v_mul_f32 v183, 0x3b000000, v167
    v_pk_add_f32 v[192:193], v[96:97], v[176:177] op_sel:[0,0] op_sel_hi:[1,0] neg_lo:[0,1] neg_hi:[0,1]
    v_pk_add_f32 v[194:195], v[98:99], v[176:177] op_sel:[0,0] op_sel_hi:[1,0] neg_lo:[0,1] neg_hi:[0,1]
    v_pk_add_f32 v[196:197], v[100:101], v[176:177] op_sel:[0,0] op_sel_hi:[1,0] neg_lo:[0,1] neg_hi:[0,1]
    v_pk_add_f32 v[198:199], v[102:103], v[176:177] op_sel:[0,0] op_sel_hi:[1,0] neg_lo:[0,1] neg_hi:[0,1]
    v_pk_mul_f32 v[192:193], v[192:193], v[192:193]
    v_pk_fma_f32 v[192:193], v[194:195], v[194:195], v[192:193]
    v_pk_fma_f32 v[192:193], v[196:197], v[196:197], v[192:193]
    v_pk_fma_f32 v[192:193], v[198:199], v[198:199], v[192:193]
    v_add_f32 v160, v192, v193
    v_pk_add_f32 v[192:193], v[104:105], v[176:177] op_sel:[0,1] op_sel_hi:[1,1] neg_lo:[0,1] neg_hi:[0,1]
    v_pk_add_f32 v[194:195], v[106:107], v[176:177] op_sel:[0,1] op_sel_hi:[1,1] neg_lo:[0,1] neg_hi:[0,1]
    v_pk_add_f32 v[196:197], v[108:109], v[176:177] op_sel:[0,1] op_sel_hi:[1,1] neg_lo:[0,1] neg_hi:[0,1]
    v_pk_add_f32 v[198:199], v[110:111], v[176:177] op_sel:[0,1] op_sel_hi:[1,1] neg_lo:[0,1] neg_hi:[0,1]
    v_pk_mul_f32 v[192:193], v[192:193], v[192:193]
    v_pk_fma_f32 v[192:193], v[194:195], v[194:195], v[192:193]
    v_pk_fma_f32 v[192:193], v[196:197], v[196:197], v[192:193]
    v_pk_fma_f32 v[192:193], v[198:199], v[198:199], v[192:193]
    v_add_f32 v161, v192, v193
    v_pk_add_f32 v[192:193], v[112:113], v[178:179] op_sel:[0,0] op_sel_hi:[1,0] neg_lo:[0,1] neg_hi:[0,1]
    v_pk_add_f32 v[194:195], v[114:115], v[178:179] op_sel:[0,0] op_sel_hi:[1,0] neg_lo:[0,1] neg_hi:[0,1]
    v_pk_add_f32 v[196:197], v[116:117], v[178:179] op_sel:[0,0] op_sel_hi:[1,0] neg_lo:[0,1] neg_hi:[0,1]
    v_pk_add_f32 v[198:199], v[118:119], v[178:179] op_sel:[0,0] op_sel_hi:[1,0] neg_lo:[0,1] neg_hi:[0,1]
    v_pk_mul_f32 v[192:193], v[192:193], v[192:193]
    v_pk_fma_f32 v[192:193], v[194:195], v[194:195], v[192:193]
    v_pk_fma_f32 v[192:193], v[196:197], v[196:197], v[192:193]
    v_pk_fma_f32 v[192:193], v[198:199], v[198:199], v[192:193]
    v_add_f32 v162, v192, v193
    v_pk_add_f32 v[192:193], v[120:121], v[178:179] op_sel:[0,1] op_sel_hi:[1,1] neg_lo:[0,1] neg_hi:[0,1]
    v_pk_add_f32 v[194:195], v[122:123], v[178:179] op_sel:[0,1] op_sel_hi:[1,1] neg_lo:[0,1] neg_hi:[0,1]
    v_pk_add_f32 v[196:197], v[124:125], v[178:179] op_sel:[0,1] op_sel_hi:[1,1] neg_lo:[0,1] neg_hi:[0,1]
    v_pk_add_f32 v[198:199], v[126:127], v[178:179] op_sel:[0,1] op_sel_hi:[1,1] neg_lo:[0,1] neg_hi:[0,1]
    v_pk_mul_f32 v[192:193], v[192:193], v[192:193]
    v_pk_fma_f32 v[192:193], v[194:195], v[194:195], v[192:193]
    v_pk_fma_f32 v[192:193], v[196:197], v[196:197], v[192:193]
    v_pk_fma_f32 v[192:193], v[198:199], v[198:199], v[192:193]
    v_add_f32 v163, v192, v193
    v_pk_add_f32 v[192:193], v[128:129], v[180:181] op_sel:[0,0] op_sel_hi:[1,0] neg_lo:[0,1] neg_hi:[0,1]
    v_pk_add_f32 v[194:195], v[130:131], v[180:181] op_sel:[0,0] op_sel_hi:[1,0] neg_lo:[0,1] neg_hi:[0,1]
    v_pk_add_f32 v[196:197], v[132:133], v[180:181] op_sel:[0,0] op_sel_hi:[1,0] neg_lo:[0,1] neg_hi:[0,1]
    v_pk_add_f32 v[198:199], v[134:135], v[180:181] op_sel:[0,0] op_sel_hi:[1,0] neg_lo:[0,1] neg_hi:[0,1]
    v_pk_mul_f32 v[192:193], v[192:193], v[192:193]
    v_pk_fma_f32 v[192:193], v[194:195], v[194:195], v[192:193]
    v_pk_fma_f32 v[192:193], v[196:197], v[196:197], v[192:193]
    v_pk_fma_f32 v[192:193], v[198:199], v[198:199], v[192:193]
    v_add_f32 v164, v192, v193
    v_pk_add_f32 v[192:193], v[136:137], v[180:181] op_sel:[0,1] op_sel_hi:[1,1] neg_lo:[0,1] neg_hi:[0,1]
    v_pk_add_f32 v[194:195], v[138:139], v[180:181] op_sel:[0,1] op_sel_hi:[1,1] neg_lo:[0,1] neg_hi:[0,1]
    v_pk_add_f32 v[196:197], v[140:141], v[180:181] op_sel:[0,1] op_sel_hi:[1,1] neg_lo:[0,1] neg_hi:[0,1]
    v_pk_add_f32 v[198:199], v[142:143], v[180:181] op_sel:[0,1] op_sel_hi:[1,1] neg_lo:[0,1] neg_hi:[0,1]
    v_pk_mul_f32 v[192:193], v[192:193], v[192:193]
    v_pk_fma_f32 v[192:193], v[194:195], v[194:195], v[192:193]
    v_pk_fma_f32 v[192:193], v[196:197], v[196:197], v[192:193]
    v_pk_fma_f32 v[192:193], v[198:199], v[198:199], v[192:193]
    v_add_f32 v165, v192, v193
    v_pk_add_f32 v[192:193], v[144:145], v[182:183] op_sel:[0,0] op_sel_hi:[1,0] neg_lo:[0,1] neg_hi:[0,1]
    v_pk_add_f32 v[194:195], v[146:147], v[182:183] op_sel:[0,0] op_sel_hi:[1,0] neg_lo:[0,1] neg_hi:[0,1]
    v_pk_add_f32 v[196:197], v[148:149], v[182:183] op_sel:[0,0] op_sel_hi:[1,0] neg_lo:[0,1] neg_hi:[0,1]
    v_pk_add_f32 v[198:199], v[150:151], v[182:183] op_sel:[0,0] op_sel_hi:[1,0] neg_lo:[0,1] neg_hi:[0,1]
    v_pk_mul_f32 v[192:193], v[192:193], v[192:193]
    v_pk_fma_f32 v[192:193], v[194:195], v[194:195], v[192:193]
    v_pk_fma_f32 v[192:193], v[196:197], v[196:197], v[192:193]
    v_pk_fma_f32 v[192:193], v[198:199], v[198:199], v[192:193]
    v_add_f32 v166, v192, v193
    v_pk_add_f32 v[192:193], v[152:153], v[182:183] op_sel:[0,1] op_sel_hi:[1,1] neg_lo:[0,1] neg_hi:[0,1]
    v_pk_add_f32 v[194:195], v[154:155], v[182:183] op_sel:[0,1] op_sel_hi:[1,1] neg_lo:[0,1] neg_hi:[0,1]
    v_pk_add_f32 v[196:197], v[156:157], v[182:183] op_sel:[0,1] op_sel_hi:[1,1] neg_lo:[0,1] neg_hi:[0,1]
    v_pk_add_f32 v[198:199], v[158:159], v[182:183] op_sel:[0,1] op_sel_hi:[1,1] neg_lo:[0,1] neg_hi:[0,1]
    v_pk_mul_f32 v[192:193], v[192:193], v[192:193]
    v_pk_fma_f32 v[192:193], v[194:195], v[194:195], v[192:193]
    v_pk_fma_f32 v[192:193], v[196:197], v[196:197], v[192:193]
    v_pk_fma_f32 v[192:193], v[198:199], v[198:199], v[192:193]
    v_add_f32 v167, v192, v193
    v_add_f32_dpp v160, v160, v160 row_ror:8 row_mask:0xf bank_mask:0xf
    v_add_f32_dpp v161, v161, v161 row_ror:8 row_mask:0xf bank_mask:0xf
    v_add_f32_dpp v162, v162, v162 row_ror:8 row_mask:0xf bank_mask:0xf
    v_add_f32_dpp v163, v163, v163 row_ror:8 row_mask:0xf bank_mask:0xf
    v_add_f32_dpp v164, v164, v164 row_ror:8 row_mask:0xf bank_mask:0xf
    v_add_f32_dpp v165, v165, v165 row_ror:8 row_mask:0xf bank_mask:0xf
    v_add_f32_dpp v166, v166, v166 row_ror:8 row_mask:0xf bank_mask:0xf
    v_add_f32_dpp v167, v167, v167 row_ror:8 row_mask:0xf bank_mask:0xf
    v_add_f32_dpp v160, v160, v160 row_ror:4 row_mask:0xf bank_mask:0xf
    v_add_f32_dpp v161, v161, v161 row_ror:4 row_mask:0xf bank_mask:0xf
    v_add_f32_dpp v162, v162, v162 row_ror:4 row_mask:0xf bank_mask:0xf
    v_add_f32_dpp v163, v163, v163 row_ror:4 row_mask:0xf bank_mask:0xf
    v_add_f32_dpp v164, v164, v164 row_ror:4 row_mask:0xf bank_mask:0xf
    v_add_f32_dpp v165, v165, v165 row_ror:4 row_mask:0xf bank_mask:0xf
    v_add_f32_dpp v166, v166, v166 row_ror:4 row_mask:0xf bank_mask:0xf
    v_add_f32_dpp v167, v167, v167 row_ror:4 row_mask:0xf bank_mask:0xf
    v_add_f32_dpp v160, v160, v160 row_ror:2 row_mask:0xf bank_mask:0xf
    v_add_f32_dpp v161, v161, v161 row_ror:2 row_mask:0xf bank_mask:0xf
    v_add_f32_dpp v162, v162, v162 row_ror:2 row_mask:0xf bank_mask:0xf
    v_add_f32_dpp v163, v163, v163 row_ror:2 row_mask:0xf bank_mask:0xf
    v_add_f32_dpp v164, v164, v164 row_ror:2 row_mask:0xf bank_mask:0xf
    v_add_f32_dpp v165, v165, v165 row_ror:2 row_mask:0xf bank_mask:0xf
    v_add_f32_dpp v166, v166, v166 row_ror:2 row_mask:0xf bank_mask:0xf
    v_add_f32_dpp v167, v167, v167 row_ror:2 row_mask:0xf bank_mask:0xf
    v_add_f32_dpp v160, v160, v160 row_ror:1 row_mask:0xf bank_mask:0xf
    v_add_f32_dpp v161, v161, v161 row_ror:1 row_mask:0xf bank_mask:0xf
    v_add_f32_dpp v162, v162, v162 row_ror:1 row_mask:0xf bank_mask:0xf
    v_add_f32_dpp v163, v163, v163 row_ror:1 row_mask:0xf bank_mask:0xf
    v_add_f32_dpp v164, v164, v164 row_ror:1 row_mask:0xf bank_mask:0xf
    v_add_f32_dpp v165, v165, v165 row_ror:1 row_mask:0xf bank_mask:0xf
    v_add_f32_dpp v166, v166, v166 row_ror:1 row_mask:0xf bank_mask:0xf
    v_add_f32_dpp v167, v167, v167 row_ror:1 row_mask:0xf bank_mask:0xf
    v_mov_b32 v168, v160
    v_mov_b32 v169, v161
    v_mov_b32 v170, v162
    v_mov_b32 v171, v163
    v_mov_b32 v172, v164
    v_mov_b32 v173, v165
    v_mov_b32 v174, v166
    v_mov_b32 v175, v167
    v_permlane16_swap_b32 v160, v168
    v_permlane16_swap_b32 v161, v169
    v_permlane16_swap_b32 v162, v170
    v_permlane16_swap_b32 v163, v171
    v_permlane16_swap_b32 v164, v172
    v_permlane16_swap_b32 v165, v173
    v_permlane16_swap_b32 v166, v174
    v_permlane16_swap_b32 v167, v175
    v_add_f32 v160, v160, v168
    v_add_f32 v161, v161, v169
    v_add_f32 v162, v162, v170
    v_add_f32 v163, v163, v171
    v_add_f32 v164, v164, v172
    v_add_f32 v165, v165, v173
    v_add_f32 v166, v166, v174
    v_add_f32 v167, v167, v175
    v_mov_b32 v168, v160
    v_mov_b32 v169, v161
    v_mov_b32 v170, v162
    v_mov_b32 v171, v163
    v_mov_b32 v172, v164
    v_mov_b32 v173, v165
    v_mov_b32 v174, v166
    v_mov_b32 v175, v167
    v_permlane32_swap_b32 v160, v168
    v_permlane32_swap_b32 v161, v169
    v_permlane32_swap_b32 v162, v170
    v_permlane32_swap_b32 v163, v171
    v_permlane32_swap_b32 v164, v172
    v_permlane32_swap_b32 v165, v173
    v_permlane32_swap_b32 v166, v174
    v_permlane32_swap_b32 v167, v175
    v_add_f32 v160, v160, v168
    v_add_f32 v161, v161, v169
    v_add_f32 v162, v162, v170
    v_add_f32 v163, v163, v171
    v_add_f32 v164, v164, v172
    v_add_f32 v165, v165, v173
    v_add_f32 v166, v166, v174
    v_add_f32 v167, v167, v175
    v_mul_f32 v184, 0x3b000000, v160
    v_mul_f32 v185, 0x3b000000, v161
    v_mul_f32 v186, 0x3b000000, v162
    v_mul_f32 v187, 0x3b000000, v163
    v_mul_f32 v188, 0x3b000000, v164
    v_mul_f32 v189, 0x3b000000, v165
    v_mul_f32 v190, 0x3b000000, v166
    v_mul_f32 v191, 0x3b000000, v167
    v_cvt_pk_bf16_f32 v168, v184, v185
    v_lshlrev_b32 v184, 16, v168
    v_and_b32 v185, 0xffff0000, v168
    v_cvt_pk_bf16_f32 v169, v176, v177
    v_lshlrev_b32 v176, 16, v169
    v_and_b32 v177, 0xffff0000, v169
    v_cvt_pk_bf16_f32 v168, v186, v187
    v_lshlrev_b32 v186, 16, v168
    v_and_b32 v187, 0xffff0000, v168
    v_cvt_pk_bf16_f32 v169, v178, v179
    v_lshlrev_b32 v178, 16, v169
    v_and_b32 v179, 0xffff0000, v169
    v_cvt_pk_bf16_f32 v168, v188, v189
    v_lshlrev_b32 v188, 16, v168
    v_and_b32 v189, 0xffff0000, v168
    v_cvt_pk_bf16_f32 v169, v180, v181
    v_lshlrev_b32 v180, 16, v169
    v_and_b32 v181, 0xffff0000, v169
    v_cvt_pk_bf16_f32 v168, v190, v191
    v_lshlrev_b32 v190, 16, v168
    v_and_b32 v191, 0xffff0000, v168
    v_cvt_pk_bf16_f32 v169, v182, v183
    v_lshlrev_b32 v182, 16, v169
    v_and_b32 v183, 0xffff0000, v169
    v_add_f32 v184, 0x3727c5ac, v184
    v_add_f32 v185, 0x3727c5ac, v185
    v_add_f32 v186, 0x3727c5ac, v186
    v_add_f32 v187, 0x3727c5ac, v187
    v_add_f32 v188, 0x3727c5ac, v188
    v_add_f32 v189, 0x3727c5ac, v189
    v_add_f32 v190, 0x3727c5ac, v190
    v_add_f32 v191, 0x3727c5ac, v191
    v_cvt_pk_bf16_f32 v168, v184, v185
    v_lshlrev_b32 v184, 16, v168
    v_and_b32 v185, 0xffff0000, v168
    v_cvt_pk_bf16_f32 v168, v186, v187
    v_lshlrev_b32 v186, 16, v168
    v_and_b32 v187, 0xffff0000, v168
    v_cvt_pk_bf16_f32 v168, v188, v189
    v_lshlrev_b32 v188, 16, v168
    v_and_b32 v189, 0xffff0000, v168
    v_cvt_pk_bf16_f32 v168, v190, v191
    v_lshlrev_b32 v190, 16, v168
    v_and_b32 v191, 0xffff0000, v168
    v_sqrt_f32 v184, v184
    v_sqrt_f32 v185, v185
    v_sqrt_f32 v186, v186
    v_sqrt_f32 v187, v187
    v_sqrt_f32 v188, v188
    v_sqrt_f32 v189, v189
    v_sqrt_f32 v190, v190
    v_sqrt_f32 v191, v191
    v_cvt_pk_bf16_f32 v168, v184, v185
    v_lshlrev_b32 v184, 16, v168
    v_and_b32 v185, 0xffff0000, v168
    v_cvt_pk_bf16_f32 v168, v186, v187
    v_lshlrev_b32 v186, 16, v168
    v_and_b32 v187, 0xffff0000, v168
    v_cvt_pk_bf16_f32 v168, v188, v189
    v_lshlrev_b32 v188, 16, v168
    v_and_b32 v189, 0xffff0000, v168
    v_cvt_pk_bf16_f32 v168, v190, v191
    v_lshlrev_b32 v190, 16, v168
    v_and_b32 v191, 0xffff0000, v168
    v_rcp_f32 v184, v184
    v_rcp_f32 v185, v185
    v_rcp_f32 v186, v186
    v_rcp_f32 v187, v187
    v_rcp_f32 v188, v188
    v_rcp_f32 v189, v189
    v_rcp_f32 v190, v190
    v_rcp_f32 v191, v191
    v_pk_add_f32 v[96:97], v[96:97], v[176:177] op_sel:[0,0] op_sel_hi:[1,0] neg_lo:[0,1] neg_hi:[0,1]
    v_pk_add_f32 v[98:99], v[98:99], v[176:177] op_sel:[0,0] op_sel_hi:[1,0] neg_lo:[0,1] neg_hi:[0,1]
    v_pk_add_f32 v[100:101], v[100:101], v[176:177] op_sel:[0,0] op_sel_hi:[1,0] neg_lo:[0,1] neg_hi:[0,1]
    v_pk_add_f32 v[102:103], v[102:103], v[176:177] op_sel:[0,0] op_sel_hi:[1,0] neg_lo:[0,1] neg_hi:[0,1]
    v_cvt_pk_bf16_f32 v168, v96, v97
    v_lshlrev_b32 v96, 16, v168
    v_and_b32 v97, 0xffff0000, v168
    v_cvt_pk_bf16_f32 v169, v98, v99
    v_lshlrev_b32 v98, 16, v169
    v_and_b32 v99, 0xffff0000, v169
    v_cvt_pk_bf16_f32 v170, v100, v101
    v_lshlrev_b32 v100, 16, v170
    v_and_b32 v101, 0xffff0000, v170
    v_cvt_pk_bf16_f32 v171, v102, v103
    v_lshlrev_b32 v102, 16, v171
    v_and_b32 v103, 0xffff0000, v171
    v_pk_mul_f32 v[96:97], v[96:97], v[184:185] op_sel:[0,0] op_sel_hi:[1,0]
    v_pk_mul_f32 v[98:99], v[98:99], v[184:185] op_sel:[0,0] op_sel_hi:[1,0]
    v_pk_mul_f32 v[100:101], v[100:101], v[184:185] op_sel:[0,0] op_sel_hi:[1,0]
    v_pk_mul_f32 v[102:103], v[102:103], v[184:185] op_sel:[0,0] op_sel_hi:[1,0]
    v_cvt_pk_bf16_f32 v168, v96, v97
    v_lshlrev_b32 v96, 16, v168
    v_and_b32 v97, 0xffff0000, v168
    v_cvt_pk_bf16_f32 v169, v98, v99
    v_lshlrev_b32 v98, 16, v169
    v_and_b32 v99, 0xffff0000, v169
    v_cvt_pk_bf16_f32 v170, v100, v101
    v_lshlrev_b32 v100, 16, v170
    v_and_b32 v101, 0xffff0000, v170
    v_cvt_pk_bf16_f32 v171, v102, v103
    v_lshlrev_b32 v102, 16, v171
    v_and_b32 v103, 0xffff0000, v171
    v_pk_add_f32 v[104:105], v[104:105], v[176:177] op_sel:[0,1] op_sel_hi:[1,1] neg_lo:[0,1] neg_hi:[0,1]
    v_pk_add_f32 v[106:107], v[106:107], v[176:177] op_sel:[0,1] op_sel_hi:[1,1] neg_lo:[0,1] neg_hi:[0,1]
    v_pk_add_f32 v[108:109], v[108:109], v[176:177] op_sel:[0,1] op_sel_hi:[1,1] neg_lo:[0,1] neg_hi:[0,1]
    v_pk_add_f32 v[110:111], v[110:111], v[176:177] op_sel:[0,1] op_sel_hi:[1,1] neg_lo:[0,1] neg_hi:[0,1]
    v_cvt_pk_bf16_f32 v168, v104, v105
    v_lshlrev_b32 v104, 16, v168
    v_and_b32 v105, 0xffff0000, v168
    v_cvt_pk_bf16_f32 v169, v106, v107
    v_lshlrev_b32 v106, 16, v169
    v_and_b32 v107, 0xffff0000, v169
    v_cvt_pk_bf16_f32 v170, v108, v109
    v_lshlrev_b32 v108, 16, v170
    v_and_b32 v109, 0xffff0000, v170
    v_cvt_pk_bf16_f32 v171, v110, v111
    v_lshlrev_b32 v110, 16, v171
    v_and_b32 v111, 0xffff0000, v171
    v_pk_mul_f32 v[104:105], v[104:105], v[184:185] op_sel:[0,1] op_sel_hi:[1,1]
    v_pk_mul_f32 v[106:107], v[106:107], v[184:185] op_sel:[0,1] op_sel_hi:[1,1]
    v_pk_mul_f32 v[108:109], v[108:109], v[184:185] op_sel:[0,1] op_sel_hi:[1,1]
    v_pk_mul_f32 v[110:111], v[110:111], v[184:185] op_sel:[0,1] op_sel_hi:[1,1]
    v_cvt_pk_bf16_f32 v168, v104, v105
    v_lshlrev_b32 v104, 16, v168
    v_and_b32 v105, 0xffff0000, v168
    v_cvt_pk_bf16_f32 v169, v106, v107
    v_lshlrev_b32 v106, 16, v169
    v_and_b32 v107, 0xffff0000, v169
    v_cvt_pk_bf16_f32 v170, v108, v109
    v_lshlrev_b32 v108, 16, v170
    v_and_b32 v109, 0xffff0000, v170
    v_cvt_pk_bf16_f32 v171, v110, v111
    v_lshlrev_b32 v110, 16, v171
    v_and_b32 v111, 0xffff0000, v171
    v_pk_add_f32 v[112:113], v[112:113], v[178:179] op_sel:[0,0] op_sel_hi:[1,0] neg_lo:[0,1] neg_hi:[0,1]
    v_pk_add_f32 v[114:115], v[114:115], v[178:179] op_sel:[0,0] op_sel_hi:[1,0] neg_lo:[0,1] neg_hi:[0,1]
    v_pk_add_f32 v[116:117], v[116:117], v[178:179] op_sel:[0,0] op_sel_hi:[1,0] neg_lo:[0,1] neg_hi:[0,1]
    v_pk_add_f32 v[118:119], v[118:119], v[178:179] op_sel:[0,0] op_sel_hi:[1,0] neg_lo:[0,1] neg_hi:[0,1]
    v_cvt_pk_bf16_f32 v168, v112, v113
    v_lshlrev_b32 v112, 16, v168
    v_and_b32 v113, 0xffff0000, v168
    v_cvt_pk_bf16_f32 v169, v114, v115
    v_lshlrev_b32 v114, 16, v169
    v_and_b32 v115, 0xffff0000, v169
    v_cvt_pk_bf16_f32 v170, v116, v117
    v_lshlrev_b32 v116, 16, v170
    v_and_b32 v117, 0xffff0000, v170
    v_cvt_pk_bf16_f32 v171, v118, v119
    v_lshlrev_b32 v118, 16, v171
    v_and_b32 v119, 0xffff0000, v171
    v_pk_mul_f32 v[112:113], v[112:113], v[186:187] op_sel:[0,0] op_sel_hi:[1,0]
    v_pk_mul_f32 v[114:115], v[114:115], v[186:187] op_sel:[0,0] op_sel_hi:[1,0]
    v_pk_mul_f32 v[116:117], v[116:117], v[186:187] op_sel:[0,0] op_sel_hi:[1,0]
    v_pk_mul_f32 v[118:119], v[118:119], v[186:187] op_sel:[0,0] op_sel_hi:[1,0]
    v_cvt_pk_bf16_f32 v168, v112, v113
    v_lshlrev_b32 v112, 16, v168
    v_and_b32 v113, 0xffff0000, v168
    v_cvt_pk_bf16_f32 v169, v114, v115
    v_lshlrev_b32 v114, 16, v169
    v_and_b32 v115, 0xffff0000, v169
    v_cvt_pk_bf16_f32 v170, v116, v117
    v_lshlrev_b32 v116, 16, v170
    v_and_b32 v117, 0xffff0000, v170
    v_cvt_pk_bf16_f32 v171, v118, v119
    v_lshlrev_b32 v118, 16, v171
    v_and_b32 v119, 0xffff0000, v171
    v_pk_add_f32 v[120:121], v[120:121], v[178:179] op_sel:[0,1] op_sel_hi:[1,1] neg_lo:[0,1] neg_hi:[0,1]
    v_pk_add_f32 v[122:123], v[122:123], v[178:179] op_sel:[0,1] op_sel_hi:[1,1] neg_lo:[0,1] neg_hi:[0,1]
    v_pk_add_f32 v[124:125], v[124:125], v[178:179] op_sel:[0,1] op_sel_hi:[1,1] neg_lo:[0,1] neg_hi:[0,1]
    v_pk_add_f32 v[126:127], v[126:127], v[178:179] op_sel:[0,1] op_sel_hi:[1,1] neg_lo:[0,1] neg_hi:[0,1]
    v_cvt_pk_bf16_f32 v168, v120, v121
    v_lshlrev_b32 v120, 16, v168
    v_and_b32 v121, 0xffff0000, v168
    v_cvt_pk_bf16_f32 v169, v122, v123
    v_lshlrev_b32 v122, 16, v169
    v_and_b32 v123, 0xffff0000, v169
    v_cvt_pk_bf16_f32 v170, v124, v125
    v_lshlrev_b32 v124, 16, v170
    v_and_b32 v125, 0xffff0000, v170
    v_cvt_pk_bf16_f32 v171, v126, v127
    v_lshlrev_b32 v126, 16, v171
    v_and_b32 v127, 0xffff0000, v171
    v_pk_mul_f32 v[120:121], v[120:121], v[186:187] op_sel:[0,1] op_sel_hi:[1,1]
    v_pk_mul_f32 v[122:123], v[122:123], v[186:187] op_sel:[0,1] op_sel_hi:[1,1]
    v_pk_mul_f32 v[124:125], v[124:125], v[186:187] op_sel:[0,1] op_sel_hi:[1,1]
    v_pk_mul_f32 v[126:127], v[126:127], v[186:187] op_sel:[0,1] op_sel_hi:[1,1]
    v_cvt_pk_bf16_f32 v168, v120, v121
    v_lshlrev_b32 v120, 16, v168
    v_and_b32 v121, 0xffff0000, v168
    v_cvt_pk_bf16_f32 v169, v122, v123
    v_lshlrev_b32 v122, 16, v169
    v_and_b32 v123, 0xffff0000, v169
    v_cvt_pk_bf16_f32 v170, v124, v125
    v_lshlrev_b32 v124, 16, v170
    v_and_b32 v125, 0xffff0000, v170
    v_cvt_pk_bf16_f32 v171, v126, v127
    v_lshlrev_b32 v126, 16, v171
    v_and_b32 v127, 0xffff0000, v171
    v_pk_add_f32 v[128:129], v[128:129], v[180:181] op_sel:[0,0] op_sel_hi:[1,0] neg_lo:[0,1] neg_hi:[0,1]
    v_pk_add_f32 v[130:131], v[130:131], v[180:181] op_sel:[0,0] op_sel_hi:[1,0] neg_lo:[0,1] neg_hi:[0,1]
    v_pk_add_f32 v[132:133], v[132:133], v[180:181] op_sel:[0,0] op_sel_hi:[1,0] neg_lo:[0,1] neg_hi:[0,1]
    v_pk_add_f32 v[134:135], v[134:135], v[180:181] op_sel:[0,0] op_sel_hi:[1,0] neg_lo:[0,1] neg_hi:[0,1]
    v_cvt_pk_bf16_f32 v168, v128, v129
    v_lshlrev_b32 v128, 16, v168
    v_and_b32 v129, 0xffff0000, v168
    v_cvt_pk_bf16_f32 v169, v130, v131
    v_lshlrev_b32 v130, 16, v169
    v_and_b32 v131, 0xffff0000, v169
    v_cvt_pk_bf16_f32 v170, v132, v133
    v_lshlrev_b32 v132, 16, v170
    v_and_b32 v133, 0xffff0000, v170
    v_cvt_pk_bf16_f32 v171, v134, v135
    v_lshlrev_b32 v134, 16, v171
    v_and_b32 v135, 0xffff0000, v171
    v_pk_mul_f32 v[128:129], v[128:129], v[188:189] op_sel:[0,0] op_sel_hi:[1,0]
    v_pk_mul_f32 v[130:131], v[130:131], v[188:189] op_sel:[0,0] op_sel_hi:[1,0]
    v_pk_mul_f32 v[132:133], v[132:133], v[188:189] op_sel:[0,0] op_sel_hi:[1,0]
    v_pk_mul_f32 v[134:135], v[134:135], v[188:189] op_sel:[0,0] op_sel_hi:[1,0]
    v_cvt_pk_bf16_f32 v168, v128, v129
    v_lshlrev_b32 v128, 16, v168
    v_and_b32 v129, 0xffff0000, v168
    v_cvt_pk_bf16_f32 v169, v130, v131
    v_lshlrev_b32 v130, 16, v169
    v_and_b32 v131, 0xffff0000, v169
    v_cvt_pk_bf16_f32 v170, v132, v133
    v_lshlrev_b32 v132, 16, v170
    v_and_b32 v133, 0xffff0000, v170
    v_cvt_pk_bf16_f32 v171, v134, v135
    v_lshlrev_b32 v134, 16, v171
    v_and_b32 v135, 0xffff0000, v171
    v_pk_add_f32 v[136:137], v[136:137], v[180:181] op_sel:[0,1] op_sel_hi:[1,1] neg_lo:[0,1] neg_hi:[0,1]
    v_pk_add_f32 v[138:139], v[138:139], v[180:181] op_sel:[0,1] op_sel_hi:[1,1] neg_lo:[0,1] neg_hi:[0,1]
    v_pk_add_f32 v[140:141], v[140:141], v[180:181] op_sel:[0,1] op_sel_hi:[1,1] neg_lo:[0,1] neg_hi:[0,1]
    v_pk_add_f32 v[142:143], v[142:143], v[180:181] op_sel:[0,1] op_sel_hi:[1,1] neg_lo:[0,1] neg_hi:[0,1]
    v_cvt_pk_bf16_f32 v168, v136, v137
    v_lshlrev_b32 v136, 16, v168
    v_and_b32 v137, 0xffff0000, v168
    v_cvt_pk_bf16_f32 v169, v138, v139
    v_lshlrev_b32 v138, 16, v169
    v_and_b32 v139, 0xffff0000, v169
    v_cvt_pk_bf16_f32 v170, v140, v141
    v_lshlrev_b32 v140, 16, v170
    v_and_b32 v141, 0xffff0000, v170
    v_cvt_pk_bf16_f32 v171, v142, v143
    v_lshlrev_b32 v142, 16, v171
    v_and_b32 v143, 0xffff0000, v171
    v_pk_mul_f32 v[136:137], v[136:137], v[188:189] op_sel:[0,1] op_sel_hi:[1,1]
    v_pk_mul_f32 v[138:139], v[138:139], v[188:189] op_sel:[0,1] op_sel_hi:[1,1]
    v_pk_mul_f32 v[140:141], v[140:141], v[188:189] op_sel:[0,1] op_sel_hi:[1,1]
    v_pk_mul_f32 v[142:143], v[142:143], v[188:189] op_sel:[0,1] op_sel_hi:[1,1]
    v_cvt_pk_bf16_f32 v168, v136, v137
    v_lshlrev_b32 v136, 16, v168
    v_and_b32 v137, 0xffff0000, v168
    v_cvt_pk_bf16_f32 v169, v138, v139
    v_lshlrev_b32 v138, 16, v169
    v_and_b32 v139, 0xffff0000, v169
    v_cvt_pk_bf16_f32 v170, v140, v141
    v_lshlrev_b32 v140, 16, v170
    v_and_b32 v141, 0xffff0000, v170
    v_cvt_pk_bf16_f32 v171, v142, v143
    v_lshlrev_b32 v142, 16, v171
    v_and_b32 v143, 0xffff0000, v171
    v_pk_add_f32 v[144:145], v[144:145], v[182:183] op_sel:[0,0] op_sel_hi:[1,0] neg_lo:[0,1] neg_hi:[0,1]
    v_pk_add_f32 v[146:147], v[146:147], v[182:183] op_sel:[0,0] op_sel_hi:[1,0] neg_lo:[0,1] neg_hi:[0,1]
    v_pk_add_f32 v[148:149], v[148:149], v[182:183] op_sel:[0,0] op_sel_hi:[1,0] neg_lo:[0,1] neg_hi:[0,1]
    v_pk_add_f32 v[150:151], v[150:151], v[182:183] op_sel:[0,0] op_sel_hi:[1,0] neg_lo:[0,1] neg_hi:[0,1]
    v_cvt_pk_bf16_f32 v168, v144, v145
    v_lshlrev_b32 v144, 16, v168
    v_and_b32 v145, 0xffff0000, v168
    v_cvt_pk_bf16_f32 v169, v146, v147
    v_lshlrev_b32 v146, 16, v169
    v_and_b32 v147, 0xffff0000, v169
    v_cvt_pk_bf16_f32 v170, v148, v149
    v_lshlrev_b32 v148, 16, v170
    v_and_b32 v149, 0xffff0000, v170
    v_cvt_pk_bf16_f32 v171, v150, v151
    v_lshlrev_b32 v150, 16, v171
    v_and_b32 v151, 0xffff0000, v171
    v_pk_mul_f32 v[144:145], v[144:145], v[190:191] op_sel:[0,0] op_sel_hi:[1,0]
    v_pk_mul_f32 v[146:147], v[146:147], v[190:191] op_sel:[0,0] op_sel_hi:[1,0]
    v_pk_mul_f32 v[148:149], v[148:149], v[190:191] op_sel:[0,0] op_sel_hi:[1,0]
    v_pk_mul_f32 v[150:151], v[150:151], v[190:191] op_sel:[0,0] op_sel_hi:[1,0]
    v_cvt_pk_bf16_f32 v168, v144, v145
    v_lshlrev_b32 v144, 16, v168
    v_and_b32 v145, 0xffff0000, v168
    v_cvt_pk_bf16_f32 v169, v146, v147
    v_lshlrev_b32 v146, 16, v169
    v_and_b32 v147, 0xffff0000, v169
    v_cvt_pk_bf16_f32 v170, v148, v149
    v_lshlrev_b32 v148, 16, v170
    v_and_b32 v149, 0xffff0000, v170
    v_cvt_pk_bf16_f32 v171, v150, v151
    v_lshlrev_b32 v150, 16, v171
    v_and_b32 v151, 0xffff0000, v171
    v_pk_add_f32 v[152:153], v[152:153], v[182:183] op_sel:[0,1] op_sel_hi:[1,1] neg_lo:[0,1] neg_hi:[0,1]
    v_pk_add_f32 v[154:155], v[154:155], v[182:183] op_sel:[0,1] op_sel_hi:[1,1] neg_lo:[0,1] neg_hi:[0,1]
    v_pk_add_f32 v[156:157], v[156:157], v[182:183] op_sel:[0,1] op_sel_hi:[1,1] neg_lo:[0,1] neg_hi:[0,1]
    v_pk_add_f32 v[158:159], v[158:159], v[182:183] op_sel:[0,1] op_sel_hi:[1,1] neg_lo:[0,1] neg_hi:[0,1]
    v_cvt_pk_bf16_f32 v168, v152, v153
    v_lshlrev_b32 v152, 16, v168
    v_and_b32 v153, 0xffff0000, v168
    v_cvt_pk_bf16_f32 v169, v154, v155
    v_lshlrev_b32 v154, 16, v169
    v_and_b32 v155, 0xffff0000, v169
    v_cvt_pk_bf16_f32 v170, v156, v157
    v_lshlrev_b32 v156, 16, v170
    v_and_b32 v157, 0xffff0000, v170
    v_cvt_pk_bf16_f32 v171, v158, v159
    v_lshlrev_b32 v158, 16, v171
    v_and_b32 v159, 0xffff0000, v171
    v_pk_mul_f32 v[152:153], v[152:153], v[190:191] op_sel:[0,1] op_sel_hi:[1,1]
    v_pk_mul_f32 v[154:155], v[154:155], v[190:191] op_sel:[0,1] op_sel_hi:[1,1]
    v_pk_mul_f32 v[156:157], v[156:157], v[190:191] op_sel:[0,1] op_sel_hi:[1,1]
    v_pk_mul_f32 v[158:159], v[158:159], v[190:191] op_sel:[0,1] op_sel_hi:[1,1]
    v_cvt_pk_bf16_f32 v168, v152, v153
    v_lshlrev_b32 v152, 16, v168
    v_and_b32 v153, 0xffff0000, v168
    v_cvt_pk_bf16_f32 v169, v154, v155
    v_lshlrev_b32 v154, 16, v169
    v_and_b32 v155, 0xffff0000, v169
    v_cvt_pk_bf16_f32 v170, v156, v157
    v_lshlrev_b32 v156, 16, v170
    v_and_b32 v157, 0xffff0000, v170
    v_cvt_pk_bf16_f32 v171, v158, v159
    v_lshlrev_b32 v158, 16, v171
    v_and_b32 v159, 0xffff0000, v171
    s_cmp_lg_u32 s30, 0
    s_cbranch_scc1 L_wdn24
    v_mbcnt_lo_u32_b32 v6, -1, 0
    v_mbcnt_hi_u32_b32 v6, -1, v6
    v_lshlrev_b32 v6, 2, v6
    s_mov_b32 exec_lo, 0x0
    s_mov_b32 exec_hi, 0x2000000
    s_mov_b32 s54, 0
    s_branch L_wf24
L_wd24:
    s_sleep 2
L_wf24:
    global_load_dword v7, v6, s[26:27] sc1
    s_add_u32 s54, s54, 1
    s_cmp_gt_u32 s54, 400000
    s_cbranch_scc1 L_end
    s_waitcnt vmcnt(0)
    v_cmp_gt_u32 vcc, 32, v7
    s_cbranch_vccnz L_wd24
    s_mov_b64 exec, -1
L_wdn24:
    s_barrier
    s_add_u32 s56, s28, 524288
    s_addc_u32 s57, s29, 0
    global_load_dwordx4 v[176:179], v2, s[56:57] sc1
    global_load_dwordx4 v[180:183], v2, s[56:57] offset:1024 sc1
    s_add_u32 s38, s28, 69206016
    s_addc_u32 s39, s29, 0
    s_mul_i32 s61, s35, 131072
    s_add_u32 s38, s38, s61
    s_addc_u32 s39, s39, 0
    s_mul_i32 s61, s31, 4096
    s_add_u32 s38, s38, s61
    s_addc_u32 s39, s39, 0
    s_mul_i32 s61, s30, 1024
    s_add_u32 s38, s38, s61
    s_addc_u32 s39, s39, 0
    s_waitcnt vmcnt(1)
    v_lshlrev_b32 v160, 16, v176
    v_and_b32 v161, 0xffff0000, v176
    v_lshlrev_b32 v162, 16, v177
    v_and_b32 v163, 0xffff0000, v177
    v_lshlrev_b32 v164, 16, v178
    v_and_b32 v165, 0xffff0000, v178
    v_lshlrev_b32 v166, 16, v179
    v_and_b32 v167, 0xffff0000, v179
    s_waitcnt vmcnt(0)
    v_lshlrev_b32 v168, 16, v180
    v_and_b32 v169, 0xffff0000, v180
    v_lshlrev_b32 v170, 16, v181
    v_and_b32 v171, 0xffff0000, v181
    v_lshlrev_b32 v172, 16, v182
    v_and_b32 v173, 0xffff0000, v182
    v_lshlrev_b32 v174, 16, v183
    v_and_b32 v175, 0xffff0000, v183
    v_add_f32 v168, 1.0, v168
    v_add_f32 v169, 1.0, v169
    v_add_f32 v170, 1.0, v170
    v_add_f32 v171, 1.0, v171
    v_add_f32 v172, 1.0, v172
    v_add_f32 v173, 1.0, v173
    v_add_f32 v174, 1.0, v174
    v_add_f32 v175, 1.0, v175
    v_cvt_pk_bf16_f32 v184, v168, v169
    v_lshlrev_b32 v168, 16, v184
    v_and_b32 v169, 0xffff0000, v184
    v_cvt_pk_bf16_f32 v185, v170, v171
    v_lshlrev_b32 v170, 16, v185
    v_and_b32 v171, 0xffff0000, v185
    v_cvt_pk_bf16_f32 v186, v172, v173
    v_lshlrev_b32 v172, 16, v186
    v_and_b32 v173, 0xffff0000, v186
    v_cvt_pk_bf16_f32 v187, v174, v175
    v_lshlrev_b32 v174, 16, v187
    v_and_b32 v175, 0xffff0000, v187
    v_pk_mul_f32 v[96:97], v[96:97], v[168:169]
    v_pk_mul_f32 v[98:99], v[98:99], v[170:171]
    v_pk_mul_f32 v[100:101], v[100:101], v[172:173]
    v_pk_mul_f32 v[102:103], v[102:103], v[174:175]
    v_cvt_pk_bf16_f32 v184, v96, v97
    v_lshlrev_b32 v96, 16, v184
    v_and_b32 v97, 0xffff0000, v184
    v_cvt_pk_bf16_f32 v185, v98, v99
    v_lshlrev_b32 v98, 16, v185
    v_and_b32 v99, 0xffff0000, v185
    v_cvt_pk_bf16_f32 v186, v100, v101
    v_lshlrev_b32 v100, 16, v186
    v_and_b32 v101, 0xffff0000, v186
    v_cvt_pk_bf16_f32 v187, v102, v103
    v_lshlrev_b32 v102, 16, v187
    v_and_b32 v103, 0xffff0000, v187
    v_pk_add_f32 v[96:97], v[96:97], v[160:161]
    v_pk_add_f32 v[98:99], v[98:99], v[162:163]
    v_pk_add_f32 v[100:101], v[100:101], v[164:165]
    v_pk_add_f32 v[102:103], v[102:103], v[166:167]
    v_cvt_pk_bf16_f32 v64, v96, v97
    v_cvt_pk_bf16_f32 v65, v98, v99
    v_cvt_pk_bf16_f32 v66, v100, v101
    v_cvt_pk_bf16_f32 v67, v102, v103
    global_store_dwordx4 v2, v[64:67], s[38:39] sc1
    v_pk_mul_f32 v[104:105], v[104:105], v[168:169]
    v_pk_mul_f32 v[106:107], v[106:107], v[170:171]
    v_pk_mul_f32 v[108:109], v[108:109], v[172:173]
    v_pk_mul_f32 v[110:111], v[110:111], v[174:175]
    v_cvt_pk_bf16_f32 v184, v104, v105
    v_lshlrev_b32 v104, 16, v184
    v_and_b32 v105, 0xffff0000, v184
    v_cvt_pk_bf16_f32 v185, v106, v107
    v_lshlrev_b32 v106, 16, v185
    v_and_b32 v107, 0xffff0000, v185
    v_cvt_pk_bf16_f32 v186, v108, v109
    v_lshlrev_b32 v108, 16, v186
    v_and_b32 v109, 0xffff0000, v186
    v_cvt_pk_bf16_f32 v187, v110, v111
    v_lshlrev_b32 v110, 16, v187
    v_and_b32 v111, 0xffff0000, v187
    v_pk_add_f32 v[104:105], v[104:105], v[160:161]
    v_pk_add_f32 v[106:107], v[106:107], v[162:163]
    v_pk_add_f32 v[108:109], v[108:109], v[164:165]
    v_pk_add_f32 v[110:111], v[110:111], v[166:167]
    v_cvt_pk_bf16_f32 v68, v104, v105
    v_cvt_pk_bf16_f32 v69, v106, v107
    v_cvt_pk_bf16_f32 v70, v108, v109
    v_cvt_pk_bf16_f32 v71, v110, v111
    v_pk_mul_f32 v[112:113], v[112:113], v[168:169]
    v_pk_mul_f32 v[114:115], v[114:115], v[170:171]
    v_pk_mul_f32 v[116:117], v[116:117], v[172:173]
    v_pk_mul_f32 v[118:119], v[118:119], v[174:175]
    v_cvt_pk_bf16_f32 v184, v112, v113
    v_lshlrev_b32 v112, 16, v184
    v_and_b32 v113, 0xffff0000, v184
    v_cvt_pk_bf16_f32 v185, v114, v115
    v_lshlrev_b32 v114, 16, v185
    v_and_b32 v115, 0xffff0000, v185
    v_cvt_pk_bf16_f32 v186, v116, v117
    v_lshlrev_b32 v116, 16, v186
    v_and_b32 v117, 0xffff0000, v186
    v_cvt_pk_bf16_f32 v187, v118, v119
    v_lshlrev_b32 v118, 16, v187
    v_and_b32 v119, 0xffff0000, v187
    v_pk_add_f32 v[112:113], v[112:113], v[160:161]
    v_pk_add_f32 v[114:115], v[114:115], v[162:163]
    v_pk_add_f32 v[116:117], v[116:117], v[164:165]
    v_pk_add_f32 v[118:119], v[118:119], v[166:167]
    v_cvt_pk_bf16_f32 v72, v112, v113
    v_cvt_pk_bf16_f32 v73, v114, v115
    v_cvt_pk_bf16_f32 v74, v116, v117
    v_cvt_pk_bf16_f32 v75, v118, v119
    v_pk_mul_f32 v[120:121], v[120:121], v[168:169]
    v_pk_mul_f32 v[122:123], v[122:123], v[170:171]
    v_pk_mul_f32 v[124:125], v[124:125], v[172:173]
    v_pk_mul_f32 v[126:127], v[126:127], v[174:175]
    v_cvt_pk_bf16_f32 v184, v120, v121
    v_lshlrev_b32 v120, 16, v184
    v_and_b32 v121, 0xffff0000, v184
    v_cvt_pk_bf16_f32 v185, v122, v123
    v_lshlrev_b32 v122, 16, v185
    v_and_b32 v123, 0xffff0000, v185
    v_cvt_pk_bf16_f32 v186, v124, v125
    v_lshlrev_b32 v124, 16, v186
    v_and_b32 v125, 0xffff0000, v186
    v_cvt_pk_bf16_f32 v187, v126, v127
    v_lshlrev_b32 v126, 16, v187
    v_and_b32 v127, 0xffff0000, v187
    v_pk_add_f32 v[120:121], v[120:121], v[160:161]
    v_pk_add_f32 v[122:123], v[122:123], v[162:163]
    v_pk_add_f32 v[124:125], v[124:125], v[164:165]
    v_pk_add_f32 v[126:127], v[126:127], v[166:167]
    v_cvt_pk_bf16_f32 v76, v120, v121
    v_cvt_pk_bf16_f32 v77, v122, v123
    v_cvt_pk_bf16_f32 v78, v124, v125
    v_cvt_pk_bf16_f32 v79, v126, v127
    v_pk_mul_f32 v[128:129], v[128:129], v[168:169]
    v_pk_mul_f32 v[130:131], v[130:131], v[170:171]
    v_pk_mul_f32 v[132:133], v[132:133], v[172:173]
    v_pk_mul_f32 v[134:135], v[134:135], v[174:175]
    v_cvt_pk_bf16_f32 v184, v128, v129
    v_lshlrev_b32 v128, 16, v184
    v_and_b32 v129, 0xffff0000, v184
    v_cvt_pk_bf16_f32 v185, v130, v131
    v_lshlrev_b32 v130, 16, v185
    v_and_b32 v131, 0xffff0000, v185
    v_cvt_pk_bf16_f32 v186, v132, v133
    v_lshlrev_b32 v132, 16, v186
    v_and_b32 v133, 0xffff0000, v186
    v_cvt_pk_bf16_f32 v187, v134, v135
    v_lshlrev_b32 v134, 16, v187
    v_and_b32 v135, 0xffff0000, v187
    v_pk_add_f32 v[128:129], v[128:129], v[160:161]
    v_pk_add_f32 v[130:131], v[130:131], v[162:163]
    v_pk_add_f32 v[132:133], v[132:133], v[164:165]
    v_pk_add_f32 v[134:135], v[134:135], v[166:167]
    v_cvt_pk_bf16_f32 v80, v128, v129
    v_cvt_pk_bf16_f32 v81, v130, v131
    v_cvt_pk_bf16_f32 v82, v132, v133
    v_cvt_pk_bf16_f32 v83, v134, v135
    s_waitcnt vmcnt(0)
    s_barrier
    s_cmp_lg_u32 s30, 0
    s_cbranch_scc1 L_arr25
    s_lshl_b32 s56, s32, 5
    v_mov_b32 v6, s56
    v_mov_b32 v7, 1
    s_mov_b64 exec, 1
    global_atomic_add v6, v7, s[26:27] offset:4
    s_mov_b64 exec, -1
L_arr25:
    s_add_u32 s38, s38, 262144
    s_addc_u32 s39, s39, 0
    global_store_dwordx4 v2, v[68:71], s[38:39] sc1
    s_add_u32 s38, s38, 262144
    s_addc_u32 s39, s39, 0
    global_store_dwordx4 v2, v[72:75], s[38:39] sc1
    s_add_u32 s38, s38, 262144
    s_addc_u32 s39, s39, 0
    global_store_dwordx4 v2, v[76:79], s[38:39] sc1
    s_add_u32 s38, s38, 262144
    s_addc_u32 s39, s39, 0
    global_store_dwordx4 v2, v[80:83], s[38:39] sc1
    v_pk_mul_f32 v[136:137], v[136:137], v[168:169]
    v_pk_mul_f32 v[138:139], v[138:139], v[170:171]
    v_pk_mul_f32 v[140:141], v[140:141], v[172:173]
    v_pk_mul_f32 v[142:143], v[142:143], v[174:175]
    v_cvt_pk_bf16_f32 v184, v136, v137
    v_lshlrev_b32 v136, 16, v184
    v_and_b32 v137, 0xffff0000, v184
    v_cvt_pk_bf16_f32 v185, v138, v139
    v_lshlrev_b32 v138, 16, v185
    v_and_b32 v139, 0xffff0000, v185
    v_cvt_pk_bf16_f32 v186, v140, v141
    v_lshlrev_b32 v140, 16, v186
    v_and_b32 v141, 0xffff0000, v186
    v_cvt_pk_bf16_f32 v187, v142, v143
    v_lshlrev_b32 v142, 16, v187
    v_and_b32 v143, 0xffff0000, v187
    v_pk_add_f32 v[136:137], v[136:137], v[160:161]
    v_pk_add_f32 v[138:139], v[138:139], v[162:163]
    v_pk_add_f32 v[140:141], v[140:141], v[164:165]
    v_pk_add_f32 v[142:143], v[142:143], v[166:167]
    v_cvt_pk_bf16_f32 v84, v136, v137
    v_cvt_pk_bf16_f32 v85, v138, v139
    v_cvt_pk_bf16_f32 v86, v140, v141
    v_cvt_pk_bf16_f32 v87, v142, v143
    s_add_u32 s38, s38, 262144
    s_addc_u32 s39, s39, 0
    global_store_dwordx4 v2, v[84:87], s[38:39] sc1
    v_pk_mul_f32 v[144:145], v[144:145], v[168:169]
    v_pk_mul_f32 v[146:147], v[146:147], v[170:171]
    v_pk_mul_f32 v[148:149], v[148:149], v[172:173]
    v_pk_mul_f32 v[150:151], v[150:151], v[174:175]
    v_cvt_pk_bf16_f32 v184, v144, v145
    v_lshlrev_b32 v144, 16, v184
    v_and_b32 v145, 0xffff0000, v184
    v_cvt_pk_bf16_f32 v185, v146, v147
    v_lshlrev_b32 v146, 16, v185
    v_and_b32 v147, 0xffff0000, v185
    v_cvt_pk_bf16_f32 v186, v148, v149
    v_lshlrev_b32 v148, 16, v186
    v_and_b32 v149, 0xffff0000, v186
    v_cvt_pk_bf16_f32 v187, v150, v151
    v_lshlrev_b32 v150, 16, v187
    v_and_b32 v151, 0xffff0000, v187
    v_pk_add_f32 v[144:145], v[144:145], v[160:161]
    v_pk_add_f32 v[146:147], v[146:147], v[162:163]
    v_pk_add_f32 v[148:149], v[148:149], v[164:165]
    v_pk_add_f32 v[150:151], v[150:151], v[166:167]
    v_cvt_pk_bf16_f32 v88, v144, v145
    v_cvt_pk_bf16_f32 v89, v146, v147
    v_cvt_pk_bf16_f32 v90, v148, v149
    v_cvt_pk_bf16_f32 v91, v150, v151
    s_add_u32 s38, s38, 262144
    s_addc_u32 s39, s39, 0
    global_store_dwordx4 v2, v[88:91], s[38:39] sc1
    v_pk_mul_f32 v[152:153], v[152:153], v[168:169]
    v_pk_mul_f32 v[154:155], v[154:155], v[170:171]
    v_pk_mul_f32 v[156:157], v[156:157], v[172:173]
    v_pk_mul_f32 v[158:159], v[158:159], v[174:175]
    v_cvt_pk_bf16_f32 v184, v152, v153
    v_lshlrev_b32 v152, 16, v184
    v_and_b32 v153, 0xffff0000, v184
    v_cvt_pk_bf16_f32 v185, v154, v155
    v_lshlrev_b32 v154, 16, v185
    v_and_b32 v155, 0xffff0000, v185
    v_cvt_pk_bf16_f32 v186, v156, v157
    v_lshlrev_b32 v156, 16, v186
    v_and_b32 v157, 0xffff0000, v186
    v_cvt_pk_bf16_f32 v187, v158, v159
    v_lshlrev_b32 v158, 16, v187
    v_and_b32 v159, 0xffff0000, v187
    v_pk_add_f32 v[152:153], v[152:153], v[160:161]
    v_pk_add_f32 v[154:155], v[154:155], v[162:163]
    v_pk_add_f32 v[156:157], v[156:157], v[164:165]
    v_pk_add_f32 v[158:159], v[158:159], v[166:167]
    v_cvt_pk_bf16_f32 v92, v152, v153
    v_cvt_pk_bf16_f32 v93, v154, v155
    v_cvt_pk_bf16_f32 v94, v156, v157
    v_cvt_pk_bf16_f32 v95, v158, v159
    s_add_u32 s38, s38, 262144
    s_addc_u32 s39, s39, 0
    global_store_dwordx4 v2, v[92:95], s[38:39] sc1
    s_waitcnt vmcnt(0)
    s_barrier
    s_cmp_lg_u32 s30, 0
    s_cbranch_scc1 L_arr26
    s_lshl_b32 s56, s32, 5
    v_mov_b32 v6, s56
    v_mov_b32 v7, 1
    s_mov_b64 exec, 1
    global_atomic_add v6, v7, s[26:27] offset:8
    s_mov_b64 exec, -1
L_arr26:
    s_cmp_lg_u32 s32, 4
    s_cbranch_scc1 L_post
    v_mov_b32 v8, -1
    v_mov_b32 v9, -1
    v_mov_b32 v10, -1
    v_mov_b32 v11, -1
    v_lshlrev_b32 v12, 4, v0
    v_lshlrev_b32 v13, 2, v0
    s_add_u32 s56, s28, 89128960
    s_addc_u32 s57, s29, 0
    s_mul_i32 s61, s31, 32768
    s_add_u32 s56, s56, s61
    s_addc_u32 s57, s57, 0
    global_store_dwordx4 v12, v[8:11], s[56:57] sc1
    s_add_u32 s56, s56, 4096
    s_addc_u32 s57, s57, 0
    s_waitcnt vmcnt(0)
    s_sleep 1
    global_store_dwordx4 v12, v[8:11], s[56:57] sc1
    s_add_u32 s56, s56, 4096
    s_addc_u32 s57, s57, 0
    s_waitcnt vmcnt(0)
    s_sleep 1
    global_store_dwordx4 v12, v[8:11], s[56:57] sc1
    s_add_u32 s56, s56, 4096
    s_addc_u32 s57, s57, 0
    s_waitcnt vmcnt(0)
    s_sleep 1
    global_store_dwordx4 v12, v[8:11], s[56:57] sc1
    s_add_u32 s56, s56, 4096
    s_addc_u32 s57, s57, 0
    s_waitcnt vmcnt(0)
    s_sleep 1
    global_store_dwordx4 v12, v[8:11], s[56:57] sc1
    s_add_u32 s56, s56, 4096
    s_addc_u32 s57, s57, 0
    s_waitcnt vmcnt(0)
    s_sleep 1
    global_store_dwordx4 v12, v[8:11], s[56:57] sc1
    s_add_u32 s56, s56, 4096
    s_addc_u32 s57, s57, 0
    s_waitcnt vmcnt(0)
    s_sleep 1
    global_store_dwordx4 v12, v[8:11], s[56:57] sc1
    s_add_u32 s56, s56, 4096
    s_addc_u32 s57, s57, 0
    s_waitcnt vmcnt(0)
    s_sleep 1
    global_store_dwordx4 v12, v[8:11], s[56:57] sc1
    s_add_u32 s56, s56, 4096
    s_addc_u32 s57, s57, 0
    s_waitcnt vmcnt(0)
    s_sleep 1
    s_add_u32 s56, s28, 1212416
    s_addc_u32 s57, s29, 0
    s_mul_i32 s61, s31, 1024
    s_add_u32 s56, s56, s61
    s_addc_u32 s57, s57, 0
    global_store_dword v13, v8, s[56:57] sc1
    s_add_u32 s56, s28, 91226112
    s_addc_u32 s57, s29, 0
    s_mul_i32 s61, s31, 32768
    s_add_u32 s56, s56, s61
    s_addc_u32 s57, s57, 0
    global_store_dwordx4 v12, v[8:11], s[56:57] sc1
    s_add_u32 s56, s56, 4096
    s_addc_u32 s57, s57, 0
    s_waitcnt vmcnt(0)
    s_sleep 1
    global_store_dwordx4 v12, v[8:11], s[56:57] sc1
    s_add_u32 s56, s56, 4096
    s_addc_u32 s57, s57, 0
    s_waitcnt vmcnt(0)
    s_sleep 1
    global_store_dwordx4 v12, v[8:11], s[56:57] sc1
    s_add_u32 s56, s56, 4096
    s_addc_u32 s57, s57, 0
    s_waitcnt vmcnt(0)
    s_sleep 1
    global_store_dwordx4 v12, v[8:11], s[56:57] sc1
    s_add_u32 s56, s56, 4096
    s_addc_u32 s57, s57, 0
    s_waitcnt vmcnt(0)
    s_sleep 1
    global_store_dwordx4 v12, v[8:11], s[56:57] sc1
    s_add_u32 s56, s56, 4096
    s_addc_u32 s57, s57, 0
    s_waitcnt vmcnt(0)
    s_sleep 1
    global_store_dwordx4 v12, v[8:11], s[56:57] sc1
    s_add_u32 s56, s56, 4096
    s_addc_u32 s57, s57, 0
    s_waitcnt vmcnt(0)
    s_sleep 1
    global_store_dwordx4 v12, v[8:11], s[56:57] sc1
    s_add_u32 s56, s56, 4096
    s_addc_u32 s57, s57, 0
    s_waitcnt vmcnt(0)
    s_sleep 1
    global_store_dwordx4 v12, v[8:11], s[56:57] sc1
    s_add_u32 s56, s56, 4096
    s_addc_u32 s57, s57, 0
    s_waitcnt vmcnt(0)
    s_sleep 1
    s_add_u32 s56, s28, 1277952
    s_addc_u32 s57, s29, 0
    s_mul_i32 s61, s31, 1024
    s_add_u32 s56, s56, s61
    s_addc_u32 s57, s57, 0
    global_store_dword v13, v8, s[56:57] sc1
    s_add_u32 s56, s28, 90177536
    s_addc_u32 s57, s29, 0
    s_mul_i32 s61, s31, 32768
    s_add_u32 s56, s56, s61
    s_addc_u32 s57, s57, 0
    global_store_dwordx4 v12, v[8:11], s[56:57] sc1
    s_add_u32 s56, s56, 4096
    s_addc_u32 s57, s57, 0
    s_waitcnt vmcnt(0)
    s_sleep 1
    global_store_dwordx4 v12, v[8:11], s[56:57] sc1
    s_add_u32 s56, s56, 4096
    s_addc_u32 s57, s57, 0
    s_waitcnt vmcnt(0)
    s_sleep 1
    global_store_dwordx4 v12, v[8:11], s[56:57] sc1
    s_add_u32 s56, s56, 4096
    s_addc_u32 s57, s57, 0
    s_waitcnt vmcnt(0)
    s_sleep 1
    global_store_dwordx4 v12, v[8:11], s[56:57] sc1
    s_add_u32 s56, s56, 4096
    s_addc_u32 s57, s57, 0
    s_waitcnt vmcnt(0)
    s_sleep 1
    global_store_dwordx4 v12, v[8:11], s[56:57] sc1
    s_add_u32 s56, s56, 4096
    s_addc_u32 s57, s57, 0
    s_waitcnt vmcnt(0)
    s_sleep 1
    global_store_dwordx4 v12, v[8:11], s[56:57] sc1
    s_add_u32 s56, s56, 4096
    s_addc_u32 s57, s57, 0
    s_waitcnt vmcnt(0)
    s_sleep 1
    global_store_dwordx4 v12, v[8:11], s[56:57] sc1
    s_add_u32 s56, s56, 4096
    s_addc_u32 s57, s57, 0
    s_waitcnt vmcnt(0)
    s_sleep 1
    global_store_dwordx4 v12, v[8:11], s[56:57] sc1
    s_add_u32 s56, s56, 4096
    s_addc_u32 s57, s57, 0
    s_waitcnt vmcnt(0)
    s_sleep 1
    s_add_u32 s56, s28, 1245184
    s_addc_u32 s57, s29, 0
    s_mul_i32 s61, s31, 1024
    s_add_u32 s56, s56, s61
    s_addc_u32 s57, s57, 0
    global_store_dword v13, v8, s[56:57] sc1
    s_waitcnt vmcnt(0)
    s_barrier
    s_cmp_lg_u32 s30, 0
    s_cbranch_scc1 L_arr27
    s_lshl_b32 s56, s32, 5
    v_mov_b32 v6, s56
    v_mov_b32 v7, 1
    s_mov_b64 exec, 1
    global_atomic_add v6, v7, s[26:27] offset:28
    s_mov_b64 exec, -1
L_arr27:
    s_add_u32 s56, s28, 84934656
    s_addc_u32 s57, s29, 0
    s_mul_i32 s61, s31, 32768
    s_add_u32 s56, s56, s61
    s_addc_u32 s57, s57, 0
    global_store_dwordx4 v12, v[8:11], s[56:57] sc1
    s_add_u32 s56, s56, 4096
    s_addc_u32 s57, s57, 0
    s_waitcnt vmcnt(0)
    s_sleep 32
    global_store_dwordx4 v12, v[8:11], s[56:57] sc1
    s_add_u32 s56, s56, 4096
    s_addc_u32 s57, s57, 0
    s_waitcnt vmcnt(0)
    s_sleep 32
    global_store_dwordx4 v12, v[8:11], s[56:57] sc1
    s_add_u32 s56, s56, 4096
    s_addc_u32 s57, s57, 0
    s_waitcnt vmcnt(0)
    s_sleep 32
    global_store_dwordx4 v12, v[8:11], s[56:57] sc1
    s_add_u32 s56, s56, 4096
    s_addc_u32 s57, s57, 0
    s_waitcnt vmcnt(0)
    s_sleep 32
    global_store_dwordx4 v12, v[8:11], s[56:57] sc1
    s_add_u32 s56, s56, 4096
    s_addc_u32 s57, s57, 0
    s_waitcnt vmcnt(0)
    s_sleep 32
    global_store_dwordx4 v12, v[8:11], s[56:57] sc1
    s_add_u32 s56, s56, 4096
    s_addc_u32 s57, s57, 0
    s_waitcnt vmcnt(0)
    s_sleep 32
    global_store_dwordx4 v12, v[8:11], s[56:57] sc1
    s_add_u32 s56, s56, 4096
    s_addc_u32 s57, s57, 0
    s_waitcnt vmcnt(0)
    s_sleep 32
    global_store_dwordx4 v12, v[8:11], s[56:57] sc1
    s_add_u32 s56, s56, 4096
    s_addc_u32 s57, s57, 0
    s_waitcnt vmcnt(0)
    s_sleep 32
    s_add_u32 s56, s28, 1081344
    s_addc_u32 s57, s29, 0
    s_mul_i32 s61, s31, 1024
    s_add_u32 s56, s56, s61
    s_addc_u32 s57, s57, 0
    global_store_dword v13, v8, s[56:57] sc1
    s_add_u32 s56, s28, 87031808
    s_addc_u32 s57, s29, 0
    s_mul_i32 s61, s31, 32768
    s_add_u32 s56, s56, s61
    s_addc_u32 s57, s57, 0
    global_store_dwordx4 v12, v[8:11], s[56:57] sc1
    s_add_u32 s56, s56, 4096
    s_addc_u32 s57, s57, 0
    s_waitcnt vmcnt(0)
    s_sleep 32
    global_store_dwordx4 v12, v[8:11], s[56:57] sc1
    s_add_u32 s56, s56, 4096
    s_addc_u32 s57, s57, 0
    s_waitcnt vmcnt(0)
    s_sleep 32
    global_store_dwordx4 v12, v[8:11], s[56:57] sc1
    s_add_u32 s56, s56, 4096
    s_addc_u32 s57, s57, 0
    s_waitcnt vmcnt(0)
    s_sleep 32
    global_store_dwordx4 v12, v[8:11], s[56:57] sc1
    s_add_u32 s56, s56, 4096
    s_addc_u32 s57, s57, 0
    s_waitcnt vmcnt(0)
    s_sleep 32
    global_store_dwordx4 v12, v[8:11], s[56:57] sc1
    s_add_u32 s56, s56, 4096
    s_addc_u32 s57, s57, 0
    s_waitcnt vmcnt(0)
    s_sleep 32
    global_store_dwordx4 v12, v[8:11], s[56:57] sc1
    s_add_u32 s56, s56, 4096
    s_addc_u32 s57, s57, 0
    s_waitcnt vmcnt(0)
    s_sleep 32
    global_store_dwordx4 v12, v[8:11], s[56:57] sc1
    s_add_u32 s56, s56, 4096
    s_addc_u32 s57, s57, 0
    s_waitcnt vmcnt(0)
    s_sleep 32
    global_store_dwordx4 v12, v[8:11], s[56:57] sc1
    s_add_u32 s56, s56, 4096
    s_addc_u32 s57, s57, 0
    s_waitcnt vmcnt(0)
    s_sleep 32
    s_add_u32 s56, s28, 1146880
    s_addc_u32 s57, s29, 0
    s_mul_i32 s61, s31, 1024
    s_add_u32 s56, s56, s61
    s_addc_u32 s57, s57, 0
    global_store_dword v13, v8, s[56:57] sc1
    s_add_u32 s56, s28, 85983232
    s_addc_u32 s57, s29, 0
    s_mul_i32 s61, s31, 32768
    s_add_u32 s56, s56, s61
    s_addc_u32 s57, s57, 0
    global_store_dwordx4 v12, v[8:11], s[56:57] sc1
    s_add_u32 s56, s56, 4096
    s_addc_u32 s57, s57, 0
    s_waitcnt vmcnt(0)
    s_sleep 32
    global_store_dwordx4 v12, v[8:11], s[56:57] sc1
    s_add_u32 s56, s56, 4096
    s_addc_u32 s57, s57, 0
    s_waitcnt vmcnt(0)
    s_sleep 32
    global_store_dwordx4 v12, v[8:11], s[56:57] sc1
    s_add_u32 s56, s56, 4096
    s_addc_u32 s57, s57, 0
    s_waitcnt vmcnt(0)
    s_sleep 32
    global_store_dwordx4 v12, v[8:11], s[56:57] sc1
    s_add_u32 s56, s56, 4096
    s_addc_u32 s57, s57, 0
    s_waitcnt vmcnt(0)
    s_sleep 32
    global_store_dwordx4 v12, v[8:11], s[56:57] sc1
    s_add_u32 s56, s56, 4096
    s_addc_u32 s57, s57, 0
    s_waitcnt vmcnt(0)
    s_sleep 32
    global_store_dwordx4 v12, v[8:11], s[56:57] sc1
    s_add_u32 s56, s56, 4096
    s_addc_u32 s57, s57, 0
    s_waitcnt vmcnt(0)
    s_sleep 32
    global_store_dwordx4 v12, v[8:11], s[56:57] sc1
    s_add_u32 s56, s56, 4096
    s_addc_u32 s57, s57, 0
    s_waitcnt vmcnt(0)
    s_sleep 32
    global_store_dwordx4 v12, v[8:11], s[56:57] sc1
    s_add_u32 s56, s56, 4096
    s_addc_u32 s57, s57, 0
    s_waitcnt vmcnt(0)
    s_sleep 32
    s_add_u32 s56, s28, 1114112
    s_addc_u32 s57, s29, 0
    s_mul_i32 s61, s31, 1024
    s_add_u32 s56, s56, s61
    s_addc_u32 s57, s57, 0
    global_store_dword v13, v8, s[56:57] sc1
    s_waitcnt vmcnt(0)
    s_barrier
    s_cmp_lg_u32 s30, 0
    s_cbranch_scc1 L_arr28
    s_lshl_b32 s56, s32, 5
    v_mov_b32 v6, s56
    v_mov_b32 v7, 1
    s_mov_b64 exec, 1
    global_atomic_add v6, v7, s[26:27] offset:24
    s_mov_b64 exec, -1
L_arr28:
    s_branch L_fin
L_w6:
    s_cmp_gt_u32 s30, 1
    s_cbranch_scc1 L_tm29
    v_lshrrev_b32 v250, 4, v0
    v_mul_u32_u24 v250, 6144, v250
    v_and_b32 v251, 15, v0
    v_lshl_add_u32 v250, v251, 7, v250
    s_and_b32 s58, s32, 1
    s_add_u32 s56, s22, 0
    s_addc_u32 s57, s23, 0
    s_mul_i32 s61, s31, 98304
    s_add_u32 s56, s56, s61
    s_addc_u32 s57, s57, 0
    s_mul_i32 s61, s58, 49152
    s_add_u32 s56, s56, s61
    s_addc_u32 s57, s57, 0
    global_load_dword v254, v250, s[56:57]
L_tm29:
    s_cmp_eq_u32 s32, 7
    s_cbranch_scc1 L_w7
    s_cmp_eq_u32 s55, 1
    s_cbranch_scc1 L_cf30
    v_mov_b32 v252, 163836
    s_cmp_lg_u32 s30, 0
    s_cbranch_scc1 L_cg30
    s_waitcnt vmcnt(0)
    s_mov_b64 exec, 1
    ds_write_b32 v252, v253
    s_waitcnt lgkmcnt(0)
    s_mov_b64 exec, -1
L_cg30:
    s_barrier
    ds_read_b32 v253, v252
    s_waitcnt lgkmcnt(0)
    v_readfirstlane_b32 s56, v253
    s_barrier
    s_bitcmp1_b32 s56, s31
    s_cbranch_scc1 L_lost
L_cf30:
    v_mov_b32 v8, -1
    v_mov_b32 v9, -1
    v_mov_b32 v10, -1
    v_mov_b32 v11, -1
    v_lshlrev_b32 v12, 4, v0
    s_add_u32 s56, s28, 0
    s_addc_u32 s57, s29, 0
    s_mul_i32 s61, s31, 8192
    s_add_u32 s56, s56, s61
    s_addc_u32 s57, s57, 0
    global_store_dwordx4 v12, v[8:11], s[56:57] sc1
    s_add_u32 s56, s56, 4096
    s_addc_u32 s57, s57, 0
    global_store_dwordx4 v12, v[8:11], s[56:57] sc1
    v_lshlrev_b32 v12, 1, v0
    s_add_u32 s56, s28, 262144
    s_addc_u32 s57, s29, 0
    s_mul_i32 s61, s31, 512
    s_add_u32 s56, s56, s61
    s_addc_u32 s57, s57, 0
    global_store_short v12, v8, s[56:57] sc1
    s_waitcnt vmcnt(0)
    s_barrier
    s_cmp_lg_u32 s30, 0
    s_cbranch_scc1 L_arr31
    s_lshl_b32 s56, s32, 5
    v_mov_b32 v6, s56
    v_mov_b32 v7, 1
    s_mov_b64 exec, 1
    global_atomic_add v6, v7, s[26:27] offset:8
    s_mov_b64 exec, -1
L_arr31:
    s_cmp_lg_u32 s30, 0
    s_cbranch_scc1 L_wdn32
    v_mbcnt_lo_u32_b32 v6, -1, 0
    v_mbcnt_hi_u32_b32 v6, -1, v6
    v_lshlrev_b32 v6, 2, v6
    s_mov_b32 exec_lo, 0x20200
    s_mov_b32 exec_hi, 0x0
    s_mov_b32 s54, 0
    s_branch L_wf32
L_wd32:
    s_sleep 8
L_wf32:
    global_load_dword v7, v6, s[26:27] sc1
    s_add_u32 s54, s54, 1
    s_cmp_gt_u32 s54, 400000
    s_cbranch_scc1 L_end
    s_waitcnt vmcnt(0)
    v_cmp_gt_u32 vcc, 1, v7
    s_cbranch_vccnz L_wd32
    s_mov_b64 exec, -1
L_wdn32:
    s_barrier
    v_lshlrev_b32 v250, 7, v0
    s_cmp_lg_u32 s32, 6
    s_cbranch_scc1 L_tc33_6
    s_add_u32 s56, s14, 0
    s_addc_u32 s57, s15, 0
    s_mul_i32 s61, s31, 32768
    s_add_u32 s56, s56, s61
    s_addc_u32 s57, s57, 0
    global_load_dword v254, v250, s[56:57]
    s_add_u32 s56, s14, 1048576
    s_addc_u32 s57, s15, 0
    s_mul_i32 s61, s31, 32768
    s_add_u32 s56, s56, s61
    s_addc_u32 s57, s57, 0
    global_load_dword v254, v250, s[56:57]
    s_add_u32 s56, s14, 2097152
    s_addc_u32 s57, s15, 0
    s_mul_i32 s61, s31, 32768
    s_add_u32 s56, s56, s61
    s_addc_u32 s57, s57, 0
    global_load_dword v254, v250, s[56:57]
    s_add_u32 s56, s14, 3145728
    s_addc_u32 s57, s15, 0
    s_mul_i32 s61, s31, 32768
    s_add_u32 s56, s56, s61
    s_addc_u32 s57, s57, 0
    global_load_dword v254, v250, s[56:57]
L_tc33_6:
    s_cmp_lg_u32 s30, 0
    s_cbranch_scc1 L_wdn34
    v_mbcnt_lo_u32_b32 v6, -1, 0
    v_mbcnt_hi_u32_b32 v6, -1, v6
    v_lshlrev_b32 v6, 2, v6
    s_mov_b32 exec_lo, 0x0
    s_mov_b32 exec_hi, 0x202
    s_mov_b32 s54, 0
    s_branch L_wf34
L_wd34:
    s_sleep 16
L_wf34:
    global_load_dword v7, v6, s[26:27] sc1
    s_add_u32 s54, s54, 1
    s_cmp_gt_u32 s54, 400000
    s_cbranch_scc1 L_end
    s_waitcnt vmcnt(0)
    v_cmp_gt_u32 vcc, 32, v7
    s_cbranch_vccnz L_wd34
    s_mov_b64 exec, -1
L_wdn34:
    s_barrier
    v_lshlrev_b32 v4, 2, v0
    global_load_dword v8, v4, s[20:21]
    v_lshrrev_b32 v4, 3, v1
    v_mul_u32_u24 v4, 6144, v4
    v_and_b32 v5, 7, v1
    v_lshl_add_u32 v4, v5, 4, v4
    s_add_u32 s56, s22, 2048
    s_addc_u32 s57, s23, 0
    s_mul_i32 s61, s31, 128
    s_add_u32 s56, s56, s61
    s_addc_u32 s57, s57, 0
    s_mul_i32 s61, s30, 786432
    s_add_u32 s56, s56, s61
    s_addc_u32 s57, s57, 0
    s_mul_i32 s58, s30, 16384
    s_add_u32 s58, s58, 4096
    s_mov_b32 m0, s58
    s_add_u32 s58, s58, 1024
    global_load_lds_dwordx4 v4, s[56:57]
    s_add_u32 s56, s56, 49152
    s_addc_u32 s57, s57, 0
    s_mov_b32 m0, s58
    s_add_u32 s58, s58, 1024
    global_load_lds_dwordx4 v4, s[56:57]
    s_add_u32 s56, s56, 49152
    s_addc_u32 s57, s57, 0
    s_mov_b32 m0, s58
    s_add_u32 s58, s58, 1024
    global_load_lds_dwordx4 v4, s[56:57]
    s_add_u32 s56, s56, 49152
    s_addc_u32 s57, s57, 0
    s_mov_b32 m0, s58
    s_add_u32 s58, s58, 1024
    global_load_lds_dwordx4 v4, s[56:57]
    s_add_u32 s56, s56, 49152
    s_addc_u32 s57, s57, 0
    s_mov_b32 m0, s58
    s_add_u32 s58, s58, 1024
    global_load_lds_dwordx4 v4, s[56:57]
    s_add_u32 s56, s56, 49152
    s_addc_u32 s57, s57, 0
    s_mov_b32 m0, s58
    s_add_u32 s58, s58, 1024
    global_load_lds_dwordx4 v4, s[56:57]
    s_add_u32 s56, s56, 49152
    s_addc_u32 s57, s57, 0
    s_mov_b32 m0, s58
    s_add_u32 s58, s58, 1024
    global_load_lds_dwordx4 v4, s[56:57]
    s_add_u32 s56, s56, 49152
    s_addc_u32 s57, s57, 0
    s_mov_b32 m0, s58
    s_add_u32 s58, s58, 1024
    global_load_lds_dwordx4 v4, s[56:57]
    s_add_u32 s56, s56, 49152
    s_addc_u32 s57, s57, 0
    s_mov_b32 m0, s58
    s_add_u32 s58, s58, 1024
    global_load_lds_dwordx4 v4, s[56:57]
    s_add_u32 s56, s56, 49152
    s_addc_u32 s57, s57, 0
    s_mov_b32 m0, s58
    s_add_u32 s58, s58, 1024
    global_load_lds_dwordx4 v4, s[56:57]
    s_add_u32 s56, s56, 49152
    s_addc_u32 s57, s57, 0
    s_mov_b32 m0, s58
    s_add_u32 s58, s58, 1024
    global_load_lds_dwordx4 v4, s[56:57]
    s_add_u32 s56, s56, 49152
    s_addc_u32 s57, s57, 0
    s_mov_b32 m0, s58
    s_add_u32 s58, s58, 1024
    global_load_lds_dwordx4 v4, s[56:57]
    s_add_u32 s56, s56, 49152
    s_addc_u32 s57, s57, 0
    s_mov_b32 m0, s58
    s_add_u32 s58, s58, 1024
    global_load_lds_dwordx4 v4, s[56:57]
    s_add_u32 s56, s56, 49152
    s_addc_u32 s57, s57, 0
    s_mov_b32 m0, s58
    s_add_u32 s58, s58, 1024
    global_load_lds_dwordx4 v4, s[56:57]
    s_add_u32 s56, s56, 49152
    s_addc_u32 s57, s57, 0
    s_mov_b32 m0, s58
    s_add_u32 s58, s58, 1024
    global_load_lds_dwordx4 v4, s[56:57]
    s_add_u32 s56, s56, 49152
    s_addc_u32 s57, s57, 0
    s_mov_b32 m0, s58
    s_add_u32 s58, s58, 1024
    global_load_lds_dwordx4 v4, s[56:57]
    s_add_u32 s56, s56, 49152
    s_addc_u32 s57, s57, 0
    s_waitcnt vmcnt(16)
    v_lshlrev_b32 v10, 16, v8
    v_and_b32 v11, 0xffff0000, v8
    v_mul_f32 v12, 0xbfb8aa3b, v10
    v_exp_f32 v12, v12
    v_mul_f32 v13, 0xbfb8aa3b, v11
    v_exp_f32 v13, v13
    v_add_f32 v12, 1.0, v12
    v_rcp_f32 v12, v12
    v_add_f32 v13, 1.0, v13
    v_rcp_f32 v13, v13
    v_mul_f32 v10, v10, v12
    v_mul_f32 v11, v11, v13
    v_cvt_pk_bf16_f32 v10, v10, v11
    v_lshlrev_b32 v4, 2, v0
    v_add_u32 v4, 0, v4
    ds_write_b32 v4, v10
    s_waitcnt vmcnt(0)
    s_waitcnt lgkmcnt(0)
    s_barrier
    v_lshrrev_b32 v4, 4, v1
    v_bfe_u32 v5, v1, 2, 2
    v_lshl_add_u32 v5, v4, 3, v5
    v_mul_u32_u24 v5, 128, v5
    v_and_b32 v6, 3, v1
    v_lshl_add_u32 v5, v6, 3, v5
    s_lshl_b32 s56, s30, 5
    s_add_u32 s56, s56, 4096
    v_add_u32 v5, s56, v5
    v_lshlrev_b32 v4, 4, v4
    v_add_u32 v4, 0, v4
    ds_read_b128 v[16:19], v4 offset:0
    ds_read_b64_tr_b16 v[20:21], v5 offset:0
    ds_read_b64_tr_b16 v[22:23], v5 offset:512
    ds_read_b128 v[24:27], v4 offset:64
    ds_read_b64_tr_b16 v[28:29], v5 offset:4096
    ds_read_b64_tr_b16 v[30:31], v5 offset:4608
    ds_read_b128 v[32:35], v4 offset:128
    ds_read_b64_tr_b16 v[36:37], v5 offset:8192
    ds_read_b64_tr_b16 v[38:39], v5 offset:8704
    ds_read_b128 v[40:43], v4 offset:192
    ds_read_b64_tr_b16 v[44:45], v5 offset:12288
    ds_read_b64_tr_b16 v[46:47], v5 offset:12800
    s_waitcnt lgkmcnt(9)
    v_mfma_f32_16x16x32_bf16 v[12:15], v[16:19], v[20:23], 0
    ds_read_b128 v[16:19], v4 offset:256
    ds_read_b64_tr_b16 v[20:21], v5 offset:16384
    ds_read_b64_tr_b16 v[22:23], v5 offset:16896
    s_waitcnt lgkmcnt(9)
    v_mfma_f32_16x16x32_bf16 v[12:15], v[24:27], v[28:31], v[12:15]
    ds_read_b128 v[24:27], v4 offset:320
    ds_read_b64_tr_b16 v[28:29], v5 offset:20480
    ds_read_b64_tr_b16 v[30:31], v5 offset:20992
    s_waitcnt lgkmcnt(9)
    v_mfma_f32_16x16x32_bf16 v[12:15], v[32:35], v[36:39], v[12:15]
    ds_read_b128 v[32:35], v4 offset:384
    ds_read_b64_tr_b16 v[36:37], v5 offset:24576
    ds_read_b64_tr_b16 v[38:39], v5 offset:25088
    s_waitcnt lgkmcnt(9)
    v_mfma_f32_16x16x32_bf16 v[12:15], v[40:43], v[44:47], v[12:15]
    ds_read_b128 v[40:43], v4 offset:448
    ds_read_b64_tr_b16 v[44:45], v5 offset:28672
    ds_read_b64_tr_b16 v[46:47], v5 offset:29184
    s_waitcnt lgkmcnt(9)
    v_mfma_f32_16x16x32_bf16 v[12:15], v[16:19], v[20:23], v[12:15]
    ds_read_b128 v[16:19], v4 offset:512
    ds_read_b64_tr_b16 v[20:21], v5 offset:32768
    ds_read_b64_tr_b16 v[22:23], v5 offset:33280
    s_waitcnt lgkmcnt(9)
    v_mfma_f32_16x16x32_bf16 v[12:15], v[24:27], v[28:31], v[12:15]
    ds_read_b128 v[24:27], v4 offset:576
    ds_read_b64_tr_b16 v[28:29], v5 offset:36864
    ds_read_b64_tr_b16 v[30:31], v5 offset:37376
    s_waitcnt lgkmcnt(9)
    v_mfma_f32_16x16x32_bf16 v[12:15], v[32:35], v[36:39], v[12:15]
    ds_read_b128 v[32:35], v4 offset:640
    ds_read_b64_tr_b16 v[36:37], v5 offset:40960
    ds_read_b64_tr_b16 v[38:39], v5 offset:41472
    s_waitcnt lgkmcnt(9)
    v_mfma_f32_16x16x32_bf16 v[12:15], v[40:43], v[44:47], v[12:15]
    ds_read_b128 v[40:43], v4 offset:704
    ds_read_b64_tr_b16 v[44:45], v5 offset:45056
    ds_read_b64_tr_b16 v[46:47], v5 offset:45568
    s_waitcnt lgkmcnt(9)
    v_mfma_f32_16x16x32_bf16 v[12:15], v[16:19], v[20:23], v[12:15]
    ds_read_b128 v[16:19], v4 offset:768
    ds_read_b64_tr_b16 v[20:21], v5 offset:49152
    ds_read_b64_tr_b16 v[22:23], v5 offset:49664
    s_waitcnt lgkmcnt(9)
    v_mfma_f32_16x16x32_bf16 v[12:15], v[24:27], v[28:31], v[12:15]
    ds_read_b128 v[24:27], v4 offset:832
    ds_read_b64_tr_b16 v[28:29], v5 offset:53248
    ds_read_b64_tr_b16 v[30:31], v5 offset:53760
    s_waitcnt lgkmcnt(9)
    v_mfma_f32_16x16x32_bf16 v[12:15], v[32:35], v[36:39], v[12:15]
    ds_read_b128 v[32:35], v4 offset:896
    ds_read_b64_tr_b16 v[36:37], v5 offset:57344
    ds_read_b64_tr_b16 v[38:39], v5 offset:57856
    s_waitcnt lgkmcnt(9)
    v_mfma_f32_16x16x32_bf16 v[12:15], v[40:43], v[44:47], v[12:15]
    ds_read_b128 v[40:43], v4 offset:960
    ds_read_b64_tr_b16 v[44:45], v5 offset:61440
    ds_read_b64_tr_b16 v[46:47], v5 offset:61952
    s_waitcnt lgkmcnt(9)
    v_mfma_f32_16x16x32_bf16 v[12:15], v[16:19], v[20:23], v[12:15]
    s_waitcnt lgkmcnt(6)
    v_mfma_f32_16x16x32_bf16 v[12:15], v[24:27], v[28:31], v[12:15]
    s_waitcnt lgkmcnt(3)
    v_mfma_f32_16x16x32_bf16 v[12:15], v[32:35], v[36:39], v[12:15]
    s_waitcnt lgkmcnt(0)
    v_mfma_f32_16x16x32_bf16 v[12:15], v[40:43], v[44:47], v[12:15]
    s_add_u32 s56, s28, 526336
    s_addc_u32 s57, s29, 0
    s_mul_i32 s61, s31, 128
    s_add_u32 s56, s56, s61
    s_addc_u32 s57, s57, 0
    s_mul_i32 s61, s30, 32
    s_add_u32 s56, s56, s61
    s_addc_u32 s57, s57, 0
    v_lshlrev_b32 v4, 1, v1
    v_cvt_pk_bf16_f32 v12, v12, v12
    s_mov_b64 exec, 0xffff
    global_store_short v4, v12, s[56:57] sc1
    s_mov_b64 exec, -1
    s_waitcnt vmcnt(0)
    s_barrier
    s_cmp_lg_u32 s30, 0
    s_cbranch_scc1 L_arr36
    s_lshl_b32 s56, s32, 5
    v_mov_b32 v6, s56
    v_mov_b32 v7, 1
    s_mov_b64 exec, 1
    global_atomic_add v6, v7, s[26:27] offset:4
    s_mov_b64 exec, -1
L_arr36:
    s_branch L_post
L_w7:
    v_lshlrev_b32 v4, 2, v0
    global_load_dword v8, v4, s[20:21]
    v_lshrrev_b32 v4, 2, v1
    v_mul_u32_u24 v4, 6144, v4
    v_and_b32 v5, 3, v1
    v_lshl_add_u32 v4, v5, 4, v4
    s_add_u32 s56, s22, 0
    s_addc_u32 s57, s23, 0
    s_mul_i32 s61, s31, 64
    s_add_u32 s56, s56, s61
    s_addc_u32 s57, s57, 0
    s_mul_i32 s61, s30, 786432
    s_add_u32 s56, s56, s61
    s_addc_u32 s57, s57, 0
    s_mul_i32 s58, s30, 8192
    s_add_u32 s58, s58, 4096
    s_mov_b32 m0, s58
    s_add_u32 s58, s58, 1024
    global_load_lds_dwordx4 v4, s[56:57]
    s_add_u32 s56, s56, 98304
    s_addc_u32 s57, s57, 0
    s_mov_b32 m0, s58
    s_add_u32 s58, s58, 1024
    global_load_lds_dwordx4 v4, s[56:57]
    s_add_u32 s56, s56, 98304
    s_addc_u32 s57, s57, 0
    s_mov_b32 m0, s58
    s_add_u32 s58, s58, 1024
    global_load_lds_dwordx4 v4, s[56:57]
    s_add_u32 s56, s56, 98304
    s_addc_u32 s57, s57, 0
    s_mov_b32 m0, s58
    s_add_u32 s58, s58, 1024
    global_load_lds_dwordx4 v4, s[56:57]
    s_add_u32 s56, s56, 98304
    s_addc_u32 s57, s57, 0
    s_mov_b32 m0, s58
    s_add_u32 s58, s58, 1024
    global_load_lds_dwordx4 v4, s[56:57]
    s_add_u32 s56, s56, 98304
    s_addc_u32 s57, s57, 0
    s_mov_b32 m0, s58
    s_add_u32 s58, s58, 1024
    global_load_lds_dwordx4 v4, s[56:57]
    s_add_u32 s56, s56, 98304
    s_addc_u32 s57, s57, 0
    s_mov_b32 m0, s58
    s_add_u32 s58, s58, 1024
    global_load_lds_dwordx4 v4, s[56:57]
    s_add_u32 s56, s56, 98304
    s_addc_u32 s57, s57, 0
    s_mov_b32 m0, s58
    s_add_u32 s58, s58, 1024
    global_load_lds_dwordx4 v4, s[56:57]
    s_add_u32 s56, s56, 98304
    s_addc_u32 s57, s57, 0
    s_cmp_eq_u32 s55, 1
    s_cbranch_scc1 L_cf37
    v_mov_b32 v252, 163836
    s_cmp_lg_u32 s30, 0
    s_cbranch_scc1 L_cg37
    s_waitcnt vmcnt(9)
    s_mov_b64 exec, 1
    ds_write_b32 v252, v253
    s_waitcnt lgkmcnt(0)
    s_mov_b64 exec, -1
L_cg37:
    s_barrier
    ds_read_b32 v253, v252
    s_waitcnt lgkmcnt(0)
    v_readfirstlane_b32 s56, v253
    s_barrier
    s_bitcmp1_b32 s56, s31
    s_cbranch_scc1 L_lost
L_cf37:
    s_waitcnt vmcnt(8)
    v_lshlrev_b32 v10, 16, v8
    v_and_b32 v11, 0xffff0000, v8
    v_mul_f32 v12, 0xbfb8aa3b, v10
    v_exp_f32 v12, v12
    v_mul_f32 v13, 0xbfb8aa3b, v11
    v_exp_f32 v13, v13
    v_add_f32 v12, 1.0, v12
    v_rcp_f32 v12, v12
    v_add_f32 v13, 1.0, v13
    v_rcp_f32 v13, v13
    v_mul_f32 v10, v10, v12
    v_mul_f32 v11, v11, v13
    v_cvt_pk_bf16_f32 v10, v10, v11
    v_lshlrev_b32 v4, 2, v0
    v_add_u32 v4, 0, v4
    ds_write_b32 v4, v10
    s_waitcnt vmcnt(0)
    s_waitcnt lgkmcnt(0)
    s_barrier
    s_cmp_ge_u32 s30, 2
    s_cbranch_scc1 L_md38
    v_lshrrev_b32 v4, 4, v1
    v_bfe_u32 v5, v1, 2, 2
    v_lshl_add_u32 v5, v4, 3, v5
    v_mul_u32_u24 v5, 64, v5
    v_and_b32 v6, 3, v1
    v_lshl_add_u32 v5, v6, 3, v5
    s_lshl_b32 s56, s30, 5
    s_add_u32 s56, s56, 4096
    v_add_u32 v5, s56, v5
    v_lshlrev_b32 v4, 4, v4
    v_add_u32 v4, 0, v4
    ds_read_b128 v[16:19], v4 offset:0
    ds_read_b64_tr_b16 v[20:21], v5 offset:0
    ds_read_b64_tr_b16 v[22:23], v5 offset:256
    ds_read_b128 v[24:27], v4 offset:64
    ds_read_b64_tr_b16 v[28:29], v5 offset:2048
    ds_read_b64_tr_b16 v[30:31], v5 offset:2304
    ds_read_b128 v[32:35], v4 offset:128
    ds_read_b64_tr_b16 v[36:37], v5 offset:4096
    ds_read_b64_tr_b16 v[38:39], v5 offset:4352
    ds_read_b128 v[40:43], v4 offset:192
    ds_read_b64_tr_b16 v[44:45], v5 offset:6144
    ds_read_b64_tr_b16 v[46:47], v5 offset:6400
    s_waitcnt lgkmcnt(9)
    v_mfma_f32_16x16x32_bf16 v[12:15], v[16:19], v[20:23], 0
    ds_read_b128 v[16:19], v4 offset:256
    ds_read_b64_tr_b16 v[20:21], v5 offset:8192
    ds_read_b64_tr_b16 v[22:23], v5 offset:8448
    s_waitcnt lgkmcnt(9)
    v_mfma_f32_16x16x32_bf16 v[12:15], v[24:27], v[28:31], v[12:15]
    ds_read_b128 v[24:27], v4 offset:320
    ds_read_b64_tr_b16 v[28:29], v5 offset:10240
    ds_read_b64_tr_b16 v[30:31], v5 offset:10496
    s_waitcnt lgkmcnt(9)
    v_mfma_f32_16x16x32_bf16 v[12:15], v[32:35], v[36:39], v[12:15]
    ds_read_b128 v[32:35], v4 offset:384
    ds_read_b64_tr_b16 v[36:37], v5 offset:12288
    ds_read_b64_tr_b16 v[38:39], v5 offset:12544
    s_waitcnt lgkmcnt(9)
    v_mfma_f32_16x16x32_bf16 v[12:15], v[40:43], v[44:47], v[12:15]
    ds_read_b128 v[40:43], v4 offset:448
    ds_read_b64_tr_b16 v[44:45], v5 offset:14336
    ds_read_b64_tr_b16 v[46:47], v5 offset:14592
    s_waitcnt lgkmcnt(9)
    v_mfma_f32_16x16x32_bf16 v[12:15], v[16:19], v[20:23], v[12:15]
    ds_read_b128 v[16:19], v4 offset:512
    ds_read_b64_tr_b16 v[20:21], v5 offset:16384
    ds_read_b64_tr_b16 v[22:23], v5 offset:16640
    s_waitcnt lgkmcnt(9)
    v_mfma_f32_16x16x32_bf16 v[12:15], v[24:27], v[28:31], v[12:15]
    ds_read_b128 v[24:27], v4 offset:576
    ds_read_b64_tr_b16 v[28:29], v5 offset:18432
    ds_read_b64_tr_b16 v[30:31], v5 offset:18688
    s_waitcnt lgkmcnt(9)
    v_mfma_f32_16x16x32_bf16 v[12:15], v[32:35], v[36:39], v[12:15]
    ds_read_b128 v[32:35], v4 offset:640
    ds_read_b64_tr_b16 v[36:37], v5 offset:20480
    ds_read_b64_tr_b16 v[38:39], v5 offset:20736
    s_waitcnt lgkmcnt(9)
    v_mfma_f32_16x16x32_bf16 v[12:15], v[40:43], v[44:47], v[12:15]
    ds_read_b128 v[40:43], v4 offset:704
    ds_read_b64_tr_b16 v[44:45], v5 offset:22528
    ds_read_b64_tr_b16 v[46:47], v5 offset:22784
    s_waitcnt lgkmcnt(9)
    v_mfma_f32_16x16x32_bf16 v[12:15], v[16:19], v[20:23], v[12:15]
    ds_read_b128 v[16:19], v4 offset:768
    ds_read_b64_tr_b16 v[20:21], v5 offset:24576
    ds_read_b64_tr_b16 v[22:23], v5 offset:24832
    s_waitcnt lgkmcnt(9)
    v_mfma_f32_16x16x32_bf16 v[12:15], v[24:27], v[28:31], v[12:15]
    ds_read_b128 v[24:27], v4 offset:832
    ds_read_b64_tr_b16 v[28:29], v5 offset:26624
    ds_read_b64_tr_b16 v[30:31], v5 offset:26880
    s_waitcnt lgkmcnt(9)
    v_mfma_f32_16x16x32_bf16 v[12:15], v[32:35], v[36:39], v[12:15]
    ds_read_b128 v[32:35], v4 offset:896
    ds_read_b64_tr_b16 v[36:37], v5 offset:28672
    ds_read_b64_tr_b16 v[38:39], v5 offset:28928
    s_waitcnt lgkmcnt(9)
    v_mfma_f32_16x16x32_bf16 v[12:15], v[40:43], v[44:47], v[12:15]
    ds_read_b128 v[40:43], v4 offset:960
    ds_read_b64_tr_b16 v[44:45], v5 offset:30720
    ds_read_b64_tr_b16 v[46:47], v5 offset:30976
    s_waitcnt lgkmcnt(9)
    v_mfma_f32_16x16x32_bf16 v[12:15], v[16:19], v[20:23], v[12:15]
    s_waitcnt lgkmcnt(6)
    v_mfma_f32_16x16x32_bf16 v[12:15], v[24:27], v[28:31], v[12:15]
    s_waitcnt lgkmcnt(3)
    v_mfma_f32_16x16x32_bf16 v[12:15], v[32:35], v[36:39], v[12:15]
    s_waitcnt lgkmcnt(0)
    v_mfma_f32_16x16x32_bf16 v[12:15], v[40:43], v[44:47], v[12:15]
    s_add_u32 s56, s28, 524288
    s_addc_u32 s57, s29, 0
    s_mul_i32 s61, s31, 64
    s_add_u32 s56, s56, s61
    s_addc_u32 s57, s57, 0
    s_mul_i32 s61, s30, 32
    s_add_u32 s56, s56, s61
    s_addc_u32 s57, s57, 0
    v_lshlrev_b32 v4, 1, v1
    v_cvt_pk_bf16_f32 v12, v12, v12
    s_mov_b64 exec, 0xffff
    global_store_short v4, v12, s[56:57] sc1
    s_mov_b64 exec, -1
    s_waitcnt vmcnt(0)
L_md38:
    s_barrier
    s_cmp_lg_u32 s30, 0
    s_cbranch_scc1 L_arr39
    s_lshl_b32 s56, s32, 5
    v_mov_b32 v6, s56
    v_mov_b32 v7, 1
    s_mov_b64 exec, 1
    global_atomic_add v6, v7, s[26:27] offset:4
    s_mov_b64 exec, -1
L_arr39:
L_post:
    s_cmp_lg_u32 s30, 0
    s_cbranch_scc1 L_wdn40
    v_mbcnt_lo_u32_b32 v6, -1, 0
    v_mbcnt_hi_u32_b32 v6, -1, v6
    v_lshlrev_b32 v6, 2, v6
    s_mov_b32 exec_lo, 0x0
    s_mov_b32 exec_hi, 0x202
    s_mov_b32 s54, 0
    s_branch L_wf40
L_wd40:
    s_sleep 16
L_wf40:
    global_load_dword v7, v6, s[26:27] sc1
    s_add_u32 s54, s54, 1
    s_cmp_gt_u32 s54, 400000
    s_cbranch_scc1 L_end
    s_waitcnt vmcnt(0)
    v_cmp_gt_u32 vcc, 32, v7
    s_cbranch_vccnz L_wd40
    s_mov_b64 exec, -1
L_wdn40:
    s_barrier
    s_waitcnt vmcnt(0) lgkmcnt(0)
    s_barrier
    s_cmp_lt_u32 s32, 8
    s_cselect_b64 vcc, -1, 0
    v_lshrrev_b32 v52, 2, v1
    v_mul_u32_u24 v52, 1056, v52
    v_and_b32 v53, 3, v1
    v_lshl_add_u32 v52, v53, 3, v52
    s_lshl_b32 s56, s30, 8
    v_add_u32 v52, s56, v52
    v_add_u32 v53, 67584, v52
    v_lshrrev_b32 v54, 3, v1
    v_mul_u32_u24 v54, 3584, v54
    v_and_b32 v55, 7, v1
    v_lshl_add_u32 v54, v55, 4, v54
    s_min_u32 s59, s31, 27
    s_add_u32 s56, s14, 0
    s_addc_u32 s57, s15, 0
    s_mul_i32 s61, s31, 131072
    s_add_u32 s56, s56, s61
    s_addc_u32 s57, s57, 0
    s_mul_i32 s61, s30, 16384
    s_add_u32 s56, s56, s61
    s_addc_u32 s57, s57, 0
    s_mul_i32 s58, s30, 16896
    s_add_u32 s58, s58, 0
    s_mov_b32 m0, s58
    s_add_u32 s58, s58, 1056
    global_load_lds_dwordx4 v2, s[56:57]
    s_cbranch_vccz L_th42
    s_waitcnt vmcnt(3)
L_th42:
    s_add_u32 s56, s56, 1024
    s_addc_u32 s57, s57, 0
    s_mov_b32 m0, s58
    s_add_u32 s58, s58, 1056
    global_load_lds_dwordx4 v2, s[56:57]
    s_cbranch_vccz L_th43
    s_waitcnt vmcnt(3)
L_th43:
    s_add_u32 s56, s56, 1024
    s_addc_u32 s57, s57, 0
    s_mov_b32 m0, s58
    s_add_u32 s58, s58, 1056
    global_load_lds_dwordx4 v2, s[56:57]
    s_cbranch_vccz L_th44
    s_waitcnt vmcnt(3)
L_th44:
    s_add_u32 s56, s56, 1024
    s_addc_u32 s57, s57, 0
    s_mov_b32 m0, s58
    s_add_u32 s58, s58, 1056
    global_load_lds_dwordx4 v2, s[56:57]
    s_cbranch_vccz L_th45
    s_waitcnt vmcnt(3)
L_th45:
    s_add_u32 s56, s56, 1024
    s_addc_u32 s57, s57, 0
    s_mov_b32 m0, s58
    s_add_u32 s58, s58, 1056
    global_load_lds_dwordx4 v2, s[56:57]
    s_cbranch_vccz L_th46
    s_waitcnt vmcnt(3)
L_th46:
    s_add_u32 s56, s56, 1024
    s_addc_u32 s57, s57, 0
    s_mov_b32 m0, s58
    s_add_u32 s58, s58, 1056
    global_load_lds_dwordx4 v2, s[56:57]
    s_cbranch_vccz L_th47
    s_waitcnt vmcnt(3)
L_th47:
    s_add_u32 s56, s56, 1024
    s_addc_u32 s57, s57, 0
    s_mov_b32 m0, s58
    s_add_u32 s58, s58, 1056
    global_load_lds_dwordx4 v2, s[56:57]
    s_cbranch_vccz L_th48
    s_waitcnt vmcnt(3)
L_th48:
    s_add_u32 s56, s56, 1024
    s_addc_u32 s57, s57, 0
    s_mov_b32 m0, s58
    s_add_u32 s58, s58, 1056
    global_load_lds_dwordx4 v2, s[56:57]
    s_cbranch_vccz L_th49
    s_waitcnt vmcnt(3)
L_th49:
    s_add_u32 s56, s56, 1024
    s_addc_u32 s57, s57, 0
    s_mov_b32 m0, s58
    s_add_u32 s58, s58, 1056
    global_load_lds_dwordx4 v2, s[56:57]
    s_cbranch_vccz L_th50
    s_waitcnt vmcnt(3)
L_th50:
    s_add_u32 s56, s56, 1024
    s_addc_u32 s57, s57, 0
    s_mov_b32 m0, s58
    s_add_u32 s58, s58, 1056
    global_load_lds_dwordx4 v2, s[56:57]
    s_cbranch_vccz L_th51
    s_waitcnt vmcnt(3)
L_th51:
    s_add_u32 s56, s56, 1024
    s_addc_u32 s57, s57, 0
    s_mov_b32 m0, s58
    s_add_u32 s58, s58, 1056
    global_load_lds_dwordx4 v2, s[56:57]
    s_cbranch_vccz L_th52
    s_waitcnt vmcnt(3)
L_th52:
    s_add_u32 s56, s56, 1024
    s_addc_u32 s57, s57, 0
    s_mov_b32 m0, s58
    s_add_u32 s58, s58, 1056
    global_load_lds_dwordx4 v2, s[56:57]
    s_cbranch_vccz L_th53
    s_waitcnt vmcnt(3)
L_th53:
    s_add_u32 s56, s56, 1024
    s_addc_u32 s57, s57, 0
    s_mov_b32 m0, s58
    s_add_u32 s58, s58, 1056
    global_load_lds_dwordx4 v2, s[56:57]
    s_cbranch_vccz L_th54
    s_waitcnt vmcnt(3)
L_th54:
    s_add_u32 s56, s56, 1024
    s_addc_u32 s57, s57, 0
    s_mov_b32 m0, s58
    s_add_u32 s58, s58, 1056
    global_load_lds_dwordx4 v2, s[56:57]
    s_cbranch_vccz L_th55
    s_waitcnt vmcnt(3)
L_th55:
    s_add_u32 s56, s56, 1024
    s_addc_u32 s57, s57, 0
    s_mov_b32 m0, s58
    s_add_u32 s58, s58, 1056
    global_load_lds_dwordx4 v2, s[56:57]
    s_cbranch_vccz L_th56
    s_waitcnt vmcnt(3)
L_th56:
    s_add_u32 s56, s56, 1024
    s_addc_u32 s57, s57, 0
    s_mov_b32 m0, s58
    s_add_u32 s58, s58, 1056
    global_load_lds_dwordx4 v2, s[56:57]
    s_cbranch_vccz L_th57
    s_waitcnt vmcnt(3)
L_th57:
    s_add_u32 s56, s56, 1024
    s_addc_u32 s57, s57, 0
    s_add_u32 s56, s14, 65536
    s_addc_u32 s57, s15, 0
    s_mul_i32 s61, s31, 131072
    s_add_u32 s56, s56, s61
    s_addc_u32 s57, s57, 0
    s_mul_i32 s61, s30, 16384
    s_add_u32 s56, s56, s61
    s_addc_u32 s57, s57, 0
    s_mul_i32 s58, s30, 16896
    s_add_u32 s58, s58, 67584
    s_mov_b32 m0, s58
    s_add_u32 s58, s58, 1056
    global_load_lds_dwordx4 v2, s[56:57]
    s_cbranch_vccz L_th58
    s_waitcnt vmcnt(3)
L_th58:
    s_add_u32 s56, s56, 1024
    s_addc_u32 s57, s57, 0
    s_mov_b32 m0, s58
    s_add_u32 s58, s58, 1056
    global_load_lds_dwordx4 v2, s[56:57]
    s_cbranch_vccz L_th59
    s_waitcnt vmcnt(3)
L_th59:
    s_add_u32 s56, s56, 1024
    s_addc_u32 s57, s57, 0
    s_mov_b32 m0, s58
    s_add_u32 s58, s58, 1056
    global_load_lds_dwordx4 v2, s[56:57]
    s_cbranch_vccz L_th60
    s_waitcnt vmcnt(3)
L_th60:
    s_add_u32 s56, s56, 1024
    s_addc_u32 s57, s57, 0
    s_mov_b32 m0, s58
    s_add_u32 s58, s58, 1056
    global_load_lds_dwordx4 v2, s[56:57]
    s_cbranch_vccz L_th61
    s_waitcnt vmcnt(3)
L_th61:
    s_add_u32 s56, s56, 1024
    s_addc_u32 s57, s57, 0
    s_mov_b32 m0, s58
    s_add_u32 s58, s58, 1056
    global_load_lds_dwordx4 v2, s[56:57]
    s_cbranch_vccz L_th62
    s_waitcnt vmcnt(3)
L_th62:
    s_add_u32 s56, s56, 1024
    s_addc_u32 s57, s57, 0
    s_mov_b32 m0, s58
    s_add_u32 s58, s58, 1056
    global_load_lds_dwordx4 v2, s[56:57]
    s_cbranch_vccz L_th63
    s_waitcnt vmcnt(3)
L_th63:
    s_add_u32 s56, s56, 1024
    s_addc_u32 s57, s57, 0
    s_mov_b32 m0, s58
    s_add_u32 s58, s58, 1056
    global_load_lds_dwordx4 v2, s[56:57]
    s_cbranch_vccz L_th64
    s_waitcnt vmcnt(3)
L_th64:
    s_add_u32 s56, s56, 1024
    s_addc_u32 s57, s57, 0
    s_mov_b32 m0, s58
    s_add_u32 s58, s58, 1056
    global_load_lds_dwordx4 v2, s[56:57]
    s_cbranch_vccz L_th65
    s_waitcnt vmcnt(3)
L_th65:
    s_add_u32 s56, s56, 1024
    s_addc_u32 s57, s57, 0
    s_mov_b32 m0, s58
    s_add_u32 s58, s58, 1056
    global_load_lds_dwordx4 v2, s[56:57]
    s_cbranch_vccz L_th66
    s_waitcnt vmcnt(3)
L_th66:
    s_add_u32 s56, s56, 1024
    s_addc_u32 s57, s57, 0
    s_mov_b32 m0, s58
    s_add_u32 s58, s58, 1056
    global_load_lds_dwordx4 v2, s[56:57]
    s_cbranch_vccz L_th67
    s_waitcnt vmcnt(3)
L_th67:
    s_add_u32 s56, s56, 1024
    s_addc_u32 s57, s57, 0
    s_mov_b32 m0, s58
    s_add_u32 s58, s58, 1056
    global_load_lds_dwordx4 v2, s[56:57]
    s_cbranch_vccz L_th68
    s_waitcnt vmcnt(3)
L_th68:
    s_add_u32 s56, s56, 1024
    s_addc_u32 s57, s57, 0
    s_mov_b32 m0, s58
    s_add_u32 s58, s58, 1056
    global_load_lds_dwordx4 v2, s[56:57]
    s_cbranch_vccz L_th69
    s_waitcnt vmcnt(3)
L_th69:
    s_add_u32 s56, s56, 1024
    s_addc_u32 s57, s57, 0
    s_mov_b32 m0, s58
    s_add_u32 s58, s58, 1056
    global_load_lds_dwordx4 v2, s[56:57]
    s_cbranch_vccz L_th70
    s_waitcnt vmcnt(3)
L_th70:
    s_add_u32 s56, s56, 1024
    s_addc_u32 s57, s57, 0
    s_mov_b32 m0, s58
    s_add_u32 s58, s58, 1056
    global_load_lds_dwordx4 v2, s[56:57]
    s_cbranch_vccz L_th71
    s_waitcnt vmcnt(3)
L_th71:
    s_add_u32 s56, s56, 1024
    s_addc_u32 s57, s57, 0
    s_mov_b32 m0, s58
    s_add_u32 s58, s58, 1056
    global_load_lds_dwordx4 v2, s[56:57]
    s_cbranch_vccz L_th72
    s_waitcnt vmcnt(3)
L_th72:
    s_add_u32 s56, s56, 1024
    s_addc_u32 s57, s57, 0
    s_mov_b32 m0, s58
    s_add_u32 s58, s58, 1056
    global_load_lds_dwordx4 v2, s[56:57]
    s_cbranch_vccz L_th73
    s_waitcnt vmcnt(3)
L_th73:
    s_add_u32 s56, s56, 1024
    s_addc_u32 s57, s57, 0
    s_waitcnt vmcnt(16)
    s_barrier
    ds_read_b64_tr_b16 a[0:1], v52 offset:0
    ds_read_b64_tr_b16 a[2:3], v52 offset:16896
    ds_read_b64_tr_b16 a[16:17], v52 offset:32
    ds_read_b64_tr_b16 a[18:19], v52 offset:16928
    ds_read_b64_tr_b16 a[32:33], v52 offset:64
    ds_read_b64_tr_b16 a[34:35], v52 offset:16960
    ds_read_b64_tr_b16 a[48:49], v52 offset:96
    ds_read_b64_tr_b16 a[50:51], v52 offset:16992
    ds_read_b64_tr_b16 a[64:65], v52 offset:128
    ds_read_b64_tr_b16 a[66:67], v52 offset:17024
    ds_read_b64_tr_b16 a[80:81], v52 offset:160
    ds_read_b64_tr_b16 a[82:83], v52 offset:17056
    ds_read_b64_tr_b16 a[96:97], v52 offset:192
    ds_read_b64_tr_b16 a[98:99], v52 offset:17088
    ds_read_b64_tr_b16 a[112:113], v52 offset:224
    ds_read_b64_tr_b16 a[114:115], v52 offset:17120
    ds_read_b64_tr_b16 a[4:5], v52 offset:33792
    ds_read_b64_tr_b16 a[6:7], v52 offset:50688
    ds_read_b64_tr_b16 a[20:21], v52 offset:33824
    ds_read_b64_tr_b16 a[22:23], v52 offset:50720
    ds_read_b64_tr_b16 a[36:37], v52 offset:33856
    ds_read_b64_tr_b16 a[38:39], v52 offset:50752
    ds_read_b64_tr_b16 a[52:53], v52 offset:33888
    ds_read_b64_tr_b16 a[54:55], v52 offset:50784
    ds_read_b64_tr_b16 a[68:69], v52 offset:33920
    ds_read_b64_tr_b16 a[70:71], v52 offset:50816
    ds_read_b64_tr_b16 a[84:85], v52 offset:33952
    ds_read_b64_tr_b16 a[86:87], v52 offset:50848
    ds_read_b64_tr_b16 a[100:101], v52 offset:33984
    ds_read_b64_tr_b16 a[102:103], v52 offset:50880
    ds_read_b64_tr_b16 a[116:117], v52 offset:34016
    ds_read_b64_tr_b16 a[118:119], v52 offset:50912
    s_waitcnt lgkmcnt(0)
    s_barrier
    s_add_u32 s56, s18, 0
    s_addc_u32 s57, s19, 0
    s_mul_i32 s61, s59, 65536
    s_add_u32 s56, s56, s61
    s_addc_u32 s57, s57, 0
    s_mul_i32 s61, s30, 16384
    s_add_u32 s56, s56, s61
    s_addc_u32 s57, s57, 0
    s_mul_i32 s58, s30, 16896
    s_add_u32 s58, s58, 0
    s_mov_b32 m0, s58
    s_add_u32 s58, s58, 1056
    global_load_lds_dwordx4 v2, s[56:57]
    s_cbranch_vccz L_th74
    s_waitcnt vmcnt(3)
L_th74:
    s_add_u32 s56, s56, 1024
    s_addc_u32 s57, s57, 0
    s_mov_b32 m0, s58
    s_add_u32 s58, s58, 1056
    global_load_lds_dwordx4 v2, s[56:57]
    s_cbranch_vccz L_th75
    s_waitcnt vmcnt(3)
L_th75:
    s_add_u32 s56, s56, 1024
    s_addc_u32 s57, s57, 0
    s_mov_b32 m0, s58
    s_add_u32 s58, s58, 1056
    global_load_lds_dwordx4 v2, s[56:57]
    s_cbranch_vccz L_th76
    s_waitcnt vmcnt(3)
L_th76:
    s_add_u32 s56, s56, 1024
    s_addc_u32 s57, s57, 0
    s_mov_b32 m0, s58
    s_add_u32 s58, s58, 1056
    global_load_lds_dwordx4 v2, s[56:57]
    s_cbranch_vccz L_th77
    s_waitcnt vmcnt(3)
L_th77:
    s_add_u32 s56, s56, 1024
    s_addc_u32 s57, s57, 0
    s_mov_b32 m0, s58
    s_add_u32 s58, s58, 1056
    global_load_lds_dwordx4 v2, s[56:57]
    s_cbranch_vccz L_th78
    s_waitcnt vmcnt(3)
L_th78:
    s_add_u32 s56, s56, 1024
    s_addc_u32 s57, s57, 0
    s_mov_b32 m0, s58
    s_add_u32 s58, s58, 1056
    global_load_lds_dwordx4 v2, s[56:57]
    s_cbranch_vccz L_th79
    s_waitcnt vmcnt(3)
L_th79:
    s_add_u32 s56, s56, 1024
    s_addc_u32 s57, s57, 0
    s_mov_b32 m0, s58
    s_add_u32 s58, s58, 1056
    global_load_lds_dwordx4 v2, s[56:57]
    s_cbranch_vccz L_th80
    s_waitcnt vmcnt(3)
L_th80:
    s_add_u32 s56, s56, 1024
    s_addc_u32 s57, s57, 0
    s_mov_b32 m0, s58
    s_add_u32 s58, s58, 1056
    global_load_lds_dwordx4 v2, s[56:57]
    s_cbranch_vccz L_th81
    s_waitcnt vmcnt(3)
L_th81:
    s_add_u32 s56, s56, 1024
    s_addc_u32 s57, s57, 0
    s_mov_b32 m0, s58
    s_add_u32 s58, s58, 1056
    global_load_lds_dwordx4 v2, s[56:57]
    s_cbranch_vccz L_th82
    s_waitcnt vmcnt(3)
L_th82:
    s_add_u32 s56, s56, 1024
    s_addc_u32 s57, s57, 0
    s_mov_b32 m0, s58
    s_add_u32 s58, s58, 1056
    global_load_lds_dwordx4 v2, s[56:57]
    s_cbranch_vccz L_th83
    s_waitcnt vmcnt(3)
L_th83:
    s_add_u32 s56, s56, 1024
    s_addc_u32 s57, s57, 0
    s_mov_b32 m0, s58
    s_add_u32 s58, s58, 1056
    global_load_lds_dwordx4 v2, s[56:57]
    s_cbranch_vccz L_th84
    s_waitcnt vmcnt(3)
L_th84:
    s_add_u32 s56, s56, 1024
    s_addc_u32 s57, s57, 0
    s_mov_b32 m0, s58
    s_add_u32 s58, s58, 1056
    global_load_lds_dwordx4 v2, s[56:57]
    s_cbranch_vccz L_th85
    s_waitcnt vmcnt(3)
L_th85:
    s_add_u32 s56, s56, 1024
    s_addc_u32 s57, s57, 0
    s_mov_b32 m0, s58
    s_add_u32 s58, s58, 1056
    global_load_lds_dwordx4 v2, s[56:57]
    s_cbranch_vccz L_th86
    s_waitcnt vmcnt(3)
L_th86:
    s_add_u32 s56, s56, 1024
    s_addc_u32 s57, s57, 0
    s_mov_b32 m0, s58
    s_add_u32 s58, s58, 1056
    global_load_lds_dwordx4 v2, s[56:57]
    s_cbranch_vccz L_th87
    s_waitcnt vmcnt(3)
L_th87:
    s_add_u32 s56, s56, 1024
    s_addc_u32 s57, s57, 0
    s_mov_b32 m0, s58
    s_add_u32 s58, s58, 1056
    global_load_lds_dwordx4 v2, s[56:57]
    s_cbranch_vccz L_th88
    s_waitcnt vmcnt(3)
L_th88:
    s_add_u32 s56, s56, 1024
    s_addc_u32 s57, s57, 0
    s_mov_b32 m0, s58
    s_add_u32 s58, s58, 1056
    global_load_lds_dwordx4 v2, s[56:57]
    s_cbranch_vccz L_th89
    s_waitcnt vmcnt(3)
L_th89:
    s_add_u32 s56, s56, 1024
    s_addc_u32 s57, s57, 0
    s_waitcnt vmcnt(16)
    s_barrier
    ds_read_b64_tr_b16 a[8:9], v53 offset:0
    ds_read_b64_tr_b16 a[10:11], v53 offset:16896
    ds_read_b64_tr_b16 a[24:25], v53 offset:32
    ds_read_b64_tr_b16 a[26:27], v53 offset:16928
    ds_read_b64_tr_b16 a[40:41], v53 offset:64
    ds_read_b64_tr_b16 a[42:43], v53 offset:16960
    ds_read_b64_tr_b16 a[56:57], v53 offset:96
    ds_read_b64_tr_b16 a[58:59], v53 offset:16992
    ds_read_b64_tr_b16 a[72:73], v53 offset:128
    ds_read_b64_tr_b16 a[74:75], v53 offset:17024
    ds_read_b64_tr_b16 a[88:89], v53 offset:160
    ds_read_b64_tr_b16 a[90:91], v53 offset:17056
    ds_read_b64_tr_b16 a[104:105], v53 offset:192
    ds_read_b64_tr_b16 a[106:107], v53 offset:17088
    ds_read_b64_tr_b16 a[120:121], v53 offset:224
    ds_read_b64_tr_b16 a[122:123], v53 offset:17120
    ds_read_b64_tr_b16 a[12:13], v53 offset:33792
    ds_read_b64_tr_b16 a[14:15], v53 offset:50688
    ds_read_b64_tr_b16 a[28:29], v53 offset:33824
    ds_read_b64_tr_b16 a[30:31], v53 offset:50720
    ds_read_b64_tr_b16 a[44:45], v53 offset:33856
    ds_read_b64_tr_b16 a[46:47], v53 offset:50752
    ds_read_b64_tr_b16 a[60:61], v53 offset:33888
    ds_read_b64_tr_b16 a[62:63], v53 offset:50784
    ds_read_b64_tr_b16 a[76:77], v53 offset:33920
    ds_read_b64_tr_b16 a[78:79], v53 offset:50816
    ds_read_b64_tr_b16 a[92:93], v53 offset:33952
    ds_read_b64_tr_b16 a[94:95], v53 offset:50848
    ds_read_b64_tr_b16 a[108:109], v53 offset:33984
    ds_read_b64_tr_b16 a[110:111], v53 offset:50880
    ds_read_b64_tr_b16 a[124:125], v53 offset:34016
    ds_read_b64_tr_b16 a[126:127], v53 offset:50912
    s_waitcnt lgkmcnt(0)
    s_barrier
    s_add_u32 s56, s16, 0
    s_addc_u32 s57, s17, 0
    s_mul_i32 s61, s59, 128
    s_add_u32 s56, s56, s61
    s_addc_u32 s57, s57, 0
    s_mul_i32 s61, s30, 458752
    s_add_u32 s56, s56, s61
    s_addc_u32 s57, s57, 0
    s_mul_i32 s58, s30, 16384
    s_add_u32 s58, s58, 67584
    s_mov_b32 m0, s58
    s_add_u32 s58, s58, 1024
    global_load_lds_dwordx4 v54, s[56:57]
    s_cbranch_vccz L_th90
    s_waitcnt vmcnt(3)
L_th90:
    s_add_u32 s56, s56, 28672
    s_addc_u32 s57, s57, 0
    s_mov_b32 m0, s58
    s_add_u32 s58, s58, 1024
    global_load_lds_dwordx4 v54, s[56:57]
    s_cbranch_vccz L_th91
    s_waitcnt vmcnt(3)
L_th91:
    s_add_u32 s56, s56, 28672
    s_addc_u32 s57, s57, 0
    s_mov_b32 m0, s58
    s_add_u32 s58, s58, 1024
    global_load_lds_dwordx4 v54, s[56:57]
    s_cbranch_vccz L_th92
    s_waitcnt vmcnt(3)
L_th92:
    s_add_u32 s56, s56, 28672
    s_addc_u32 s57, s57, 0
    s_mov_b32 m0, s58
    s_add_u32 s58, s58, 1024
    global_load_lds_dwordx4 v54, s[56:57]
    s_cbranch_vccz L_th93
    s_waitcnt vmcnt(3)
L_th93:
    s_add_u32 s56, s56, 28672
    s_addc_u32 s57, s57, 0
    s_mov_b32 m0, s58
    s_add_u32 s58, s58, 1024
    global_load_lds_dwordx4 v54, s[56:57]
    s_cbranch_vccz L_th94
    s_waitcnt vmcnt(3)
L_th94:
    s_add_u32 s56, s56, 28672
    s_addc_u32 s57, s57, 0
    s_mov_b32 m0, s58
    s_add_u32 s58, s58, 1024
    global_load_lds_dwordx4 v54, s[56:57]
    s_cbranch_vccz L_th95
    s_waitcnt vmcnt(3)
L_th95:
    s_add_u32 s56, s56, 28672
    s_addc_u32 s57, s57, 0
    s_mov_b32 m0, s58
    s_add_u32 s58, s58, 1024
    global_load_lds_dwordx4 v54, s[56:57]
    s_cbranch_vccz L_th96
    s_waitcnt vmcnt(3)
L_th96:
    s_add_u32 s56, s56, 28672
    s_addc_u32 s57, s57, 0
    s_mov_b32 m0, s58
    s_add_u32 s58, s58, 1024
    global_load_lds_dwordx4 v54, s[56:57]
    s_cbranch_vccz L_th97
    s_waitcnt vmcnt(3)
L_th97:
    s_add_u32 s56, s56, 28672
    s_addc_u32 s57, s57, 0
    s_mov_b32 m0, s58
    s_add_u32 s58, s58, 1024
    global_load_lds_dwordx4 v54, s[56:57]
    s_cbranch_vccz L_th98
    s_waitcnt vmcnt(3)
L_th98:
    s_add_u32 s56, s56, 28672
    s_addc_u32 s57, s57, 0
    s_mov_b32 m0, s58
    s_add_u32 s58, s58, 1024
    global_load_lds_dwordx4 v54, s[56:57]
    s_cbranch_vccz L_th99
    s_waitcnt vmcnt(3)
L_th99:
    s_add_u32 s56, s56, 28672
    s_addc_u32 s57, s57, 0
    s_mov_b32 m0, s58
    s_add_u32 s58, s58, 1024
    global_load_lds_dwordx4 v54, s[56:57]
    s_cbranch_vccz L_th100
    s_waitcnt vmcnt(3)
L_th100:
    s_add_u32 s56, s56, 28672
    s_addc_u32 s57, s57, 0
    s_mov_b32 m0, s58
    s_add_u32 s58, s58, 1024
    global_load_lds_dwordx4 v54, s[56:57]
    s_cbranch_vccz L_th101
    s_waitcnt vmcnt(3)
L_th101:
    s_add_u32 s56, s56, 28672
    s_addc_u32 s57, s57, 0
    s_mov_b32 m0, s58
    s_add_u32 s58, s58, 1024
    global_load_lds_dwordx4 v54, s[56:57]
    s_cbranch_vccz L_th102
    s_waitcnt vmcnt(3)
L_th102:
    s_add_u32 s56, s56, 28672
    s_addc_u32 s57, s57, 0
    s_mov_b32 m0, s58
    s_add_u32 s58, s58, 1024
    global_load_lds_dwordx4 v54, s[56:57]
    s_cbranch_vccz L_th103
    s_waitcnt vmcnt(3)
L_th103:
    s_add_u32 s56, s56, 28672
    s_addc_u32 s57, s57, 0
    s_mov_b32 m0, s58
    s_add_u32 s58, s58, 1024
    global_load_lds_dwordx4 v54, s[56:57]
    s_cbranch_vccz L_th104
    s_waitcnt vmcnt(3)
L_th104:
    s_add_u32 s56, s56, 28672
    s_addc_u32 s57, s57, 0
    s_mov_b32 m0, s58
    s_add_u32 s58, s58, 1024
    global_load_lds_dwordx4 v54, s[56:57]
    s_cbranch_vccz L_th105
    s_waitcnt vmcnt(3)
L_th105:
    s_add_u32 s56, s56, 28672
    s_addc_u32 s57, s57, 0
    s_waitcnt vmcnt(16)
    s_barrier
    ds_read_b64_tr_b16 a[192:193], v52 offset:0
    ds_read_b64_tr_b16 a[194:195], v52 offset:16896
    ds_read_b64_tr_b16 a[200:201], v52 offset:32
    ds_read_b64_tr_b16 a[202:203], v52 offset:16928
    ds_read_b64_tr_b16 a[208:209], v52 offset:64
    ds_read_b64_tr_b16 a[210:211], v52 offset:16960
    ds_read_b64_tr_b16 a[216:217], v52 offset:96
    ds_read_b64_tr_b16 a[218:219], v52 offset:16992
    ds_read_b64_tr_b16 a[224:225], v52 offset:128
    ds_read_b64_tr_b16 a[226:227], v52 offset:17024
    ds_read_b64_tr_b16 a[232:233], v52 offset:160
    ds_read_b64_tr_b16 a[234:235], v52 offset:17056
    ds_read_b64_tr_b16 a[240:241], v52 offset:192
    ds_read_b64_tr_b16 a[242:243], v52 offset:17088
    ds_read_b64_tr_b16 a[248:249], v52 offset:224
    ds_read_b64_tr_b16 a[250:251], v52 offset:17120
    ds_read_b64_tr_b16 a[196:197], v52 offset:33792
    ds_read_b64_tr_b16 a[198:199], v52 offset:50688
    ds_read_b64_tr_b16 a[204:205], v52 offset:33824
    ds_read_b64_tr_b16 a[206:207], v52 offset:50720
    ds_read_b64_tr_b16 a[212:213], v52 offset:33856
    ds_read_b64_tr_b16 a[214:215], v52 offset:50752
    ds_read_b64_tr_b16 a[220:221], v52 offset:33888
    ds_read_b64_tr_b16 a[222:223], v52 offset:50784
    ds_read_b64_tr_b16 a[228:229], v52 offset:33920
    ds_read_b64_tr_b16 a[230:231], v52 offset:50816
    ds_read_b64_tr_b16 a[236:237], v52 offset:33952
    ds_read_b64_tr_b16 a[238:239], v52 offset:50848
    ds_read_b64_tr_b16 a[244:245], v52 offset:33984
    ds_read_b64_tr_b16 a[246:247], v52 offset:50880
    ds_read_b64_tr_b16 a[252:253], v52 offset:34016
    ds_read_b64_tr_b16 a[254:255], v52 offset:50912
    s_waitcnt lgkmcnt(0)
    s_barrier
    v_lshrrev_b32 v53, 4, v1
    v_bfe_u32 v54, v1, 2, 2
    v_lshl_add_u32 v53, v53, 3, v54
    v_lshlrev_b32 v53, 7, v53
    v_and_b32 v54, 3, v1
    v_lshl_add_u32 v53, v54, 3, v53
    s_lshl_b32 s56, s30, 5
    s_add_u32 s56, s56, 67584
    v_add_u32 v53, s56, v53
    s_waitcnt vmcnt(0)
    s_barrier
    ds_read_b64_tr_b16 a[128:129], v53 offset:0
    ds_read_b64_tr_b16 a[130:131], v53 offset:512
    ds_read_b64_tr_b16 a[132:133], v53 offset:4096
    ds_read_b64_tr_b16 a[134:135], v53 offset:4608
    ds_read_b64_tr_b16 a[136:137], v53 offset:8192
    ds_read_b64_tr_b16 a[138:139], v53 offset:8704
    ds_read_b64_tr_b16 a[140:141], v53 offset:12288
    ds_read_b64_tr_b16 a[142:143], v53 offset:12800
    ds_read_b64_tr_b16 a[144:145], v53 offset:16384
    ds_read_b64_tr_b16 a[146:147], v53 offset:16896
    ds_read_b64_tr_b16 a[148:149], v53 offset:20480
    ds_read_b64_tr_b16 a[150:151], v53 offset:20992
    ds_read_b64_tr_b16 a[152:153], v53 offset:24576
    ds_read_b64_tr_b16 a[154:155], v53 offset:25088
    ds_read_b64_tr_b16 a[156:157], v53 offset:28672
    ds_read_b64_tr_b16 a[158:159], v53 offset:29184
    ds_read_b64_tr_b16 a[160:161], v53 offset:32768
    ds_read_b64_tr_b16 a[162:163], v53 offset:33280
    ds_read_b64_tr_b16 a[164:165], v53 offset:36864
    ds_read_b64_tr_b16 a[166:167], v53 offset:37376
    ds_read_b64_tr_b16 a[168:169], v53 offset:40960
    ds_read_b64_tr_b16 a[170:171], v53 offset:41472
    ds_read_b64_tr_b16 a[172:173], v53 offset:45056
    ds_read_b64_tr_b16 a[174:175], v53 offset:45568
    ds_read_b64_tr_b16 a[176:177], v53 offset:49152
    ds_read_b64_tr_b16 a[178:179], v53 offset:49664
    ds_read_b64_tr_b16 a[180:181], v53 offset:53248
    ds_read_b64_tr_b16 a[182:183], v53 offset:53760
    ds_read_b64_tr_b16 a[184:185], v53 offset:57344
    ds_read_b64_tr_b16 a[186:187], v53 offset:57856
    ds_read_b64_tr_b16 a[188:189], v53 offset:61440
    ds_read_b64_tr_b16 a[190:191], v53 offset:61952
    s_waitcnt lgkmcnt(0)
    s_barrier
    s_cmp_lg_u32 s33, 0
    s_cbranch_scc1 L_rm106
    v_mbcnt_lo_u32_b32 v52, -1, 0
    v_and_b32 v52, 7, v52
    v_lshlrev_b32 v52, 5, v52
    s_mov_b32 s54, 0
    s_branch L_cm107
L_cn107:
    s_sleep 8
L_cm107:
    global_load_dwordx2 v[54:55], v52, s[26:27] offset:16 sc1
    s_add_u32 s54, s54, 1
    s_cmp_gt_u32 s54, 400000
    s_cbranch_scc1 L_end
    s_waitcnt vmcnt(0)
    v_bcnt_u32_b32 v53, v54, v55
    s_nop 0
    v_readlane_b32 s56, v53, s32
    s_and_b32 s56, s56, 0xffff
    s_cmp_ge_u32 s56, 32
    s_cbranch_scc1 L_rm106
    v_readlane_b32 s70, v53, 0
    v_readlane_b32 s71, v53, 1
    v_readlane_b32 s72, v53, 2
    v_readlane_b32 s73, v53, 3
    v_readlane_b32 s74, v53, 4
    v_readlane_b32 s75, v53, 5
    v_readlane_b32 s76, v53, 6
    v_readlane_b32 s77, v53, 7
    s_lshr_b32 s56, s77, 16
    s_and_b32 s77, s77, 0xffff
    s_add_u32 s56, s56, s70
    s_add_u32 s56, s56, s71
    s_add_u32 s56, s56, s72
    s_add_u32 s56, s56, s73
    s_add_u32 s56, s56, s74
    s_add_u32 s56, s56, s75
    s_add_u32 s56, s56, s76
    s_add_u32 s56, s56, s77
    s_cmp_lt_u32 s56, 256
    s_cbranch_scc1 L_cn107
    s_mov_b32 s33, 1
L_rm106:
    v_and_b32 v52, 15, v1
    v_lshrrev_b32 v53, 4, v1
    s_and_b32 s56, s30, 1
    s_lshr_b32 s57, s30, 1
    v_lshlrev_b32 v54, 9, v53
    v_lshl_add_u32 v54, v52, 4, v54
    s_lshl_b32 s58, s56, 8
    s_add_u32 s58, s58, 65536
    v_add_u32 v3, s58, v54
    s_lshl_b32 s58, s57, 12
    s_add_u32 s58, s58, 81920
    v_add_u32 v5, s58, v54
    v_bfe_u32 v54, v52, 1, 1
    v_lshlrev_b32 v54, 4, v54
    v_and_b32 v55, 5, v52
    v_add_u32 v54, v54, v55
    v_lshrrev_b32 v55, 3, v52
    v_lshl_add_u32 v54, v55, 1, v54
    v_lshlrev_b32 v54, 4, v54
    v_lshl_add_u32 v4, v53, 9, v54
    v_add_u32 v4, 73728, v4
    v_and_b32 v54, 7, v52
    v_lshlrev_b32 v54, 5, v54
    v_lshl_add_u32 v54, v53, 3, v54
    s_lshl_b32 s58, s30, 8
    v_add_u32 v6, s58, v54
    v_lshlrev_b32 v54, 4, v52
    v_lshl_add_u32 v7, v53, 17, v54
    v_lshl_add_u32 v8, v53, 10, v54
    v_mul_u32_u24 v54, 72, v52
    v_lshl_add_u32 v55, v53, 2, v54
    s_mul_i32 s58, s30, 1152
    v_add_u32 v9, s58, v55
    v_and_b32 v55, 1, v53
    v_lshl_add_u32 v55, v55, 3, v54
    s_mul_i32 s58, s57, 2304
    s_add_u32 s58, s58, 32
    v_add_u32 v11, s58, v55
    v_bfe_u32 v54, v1, 2, 1
    v_lshl_add_u32 v54, v53, 2, v54
    v_mul_u32_u24 v54, 72, v54
    v_bfe_u32 v55, v1, 3, 1
    v_lshl_add_u32 v54, v55, 4, v54
    v_and_b32 v55, 1, v1
    v_lshl_add_u32 v10, v55, 3, v54
    s_lshl_b32 s58, s56, 12
    s_lshl_b32 s59, s57, 11
    s_add_u32 s58, s58, s59
    s_add_u32 s58, s58, 8192
    v_add_u32 v12, s58, v2
    s_lshl_b32 s58, s57, 10
    s_lshl_b32 s59, s56, 3
    s_add_u32 s58, s58, s59
    s_add_u32 s58, s58, 16384
    v_add_u32 v13, s58, v2
    s_mul_i32 s58, s30, 8448
    s_add_u32 s58, s58, 24576
    v_add_u32 v14, s58, v2
    v_mul_u32_u24 v54, 1056, v52
    v_lshl_add_u32 v54, v53, 4, v54
    v_add_u32 v15, 24576, v54
    s_lshl_b32 s58, s30, 3
    s_add_u32 s58, s58, 20480
    v_mov_b32 v16, s58
    v_mov_b32 v17, 20480
    v_and_b32 v54, 1, v52
    v_lshlrev_b32 v54, 4, v54
    v_mov_b32 v55, 0x3f80
    v_lshlrev_b32 v55, v54, v55
    v_bfe_u32 v54, v52, 1, 2
    v_mov_b32 v56, 0
    v_cmp_eq_u32 vcc, 0, v54
    s_nop 1
    v_cndmask_b32 v20, v56, v55, vcc
    v_cmp_eq_u32 vcc, 1, v54
    s_nop 1
    v_cndmask_b32 v21, v56, v55, vcc
    v_cmp_eq_u32 vcc, 2, v54
    s_nop 1
    v_cndmask_b32 v22, v56, v55, vcc
    v_cmp_eq_u32 vcc, 3, v54
    s_nop 1
    v_cndmask_b32 v23, v56, v55, vcc
    v_and_b32 v54, 1, v53
    v_lshlrev_b32 v54, 2, v54
    v_and_b32 v55, 2, v53
    v_add_u32 v54, v54, v55
    s_lshl_b32 s58, s56, 4
    v_add_u32 v55, s58, v52
    v_sub_u32 v54, v55, v54
    v_cmp_le_i32 s[62:63], 0, v54
    v_cmp_le_i32 s[64:65], 1, v54
    v_cmp_le_i32 s[66:67], 16, v54
    v_cmp_le_i32 s[68:69], 17, v54
    v_cmp_le_i32 s[70:71], 8, v54
    v_cmp_le_i32 s[72:73], 9, v54
    v_cmp_le_i32 s[74:75], 24, v54
    v_cmp_le_i32 s[76:77], 25, v54
    s_mov_b32 s78, 0x00ff00ff
    s_mov_b32 s79, 0x00ff00ff
    v_mov_b32 v46, 0xce6e6b28
    v_cmp_gt_u32 vcc, 2, v53
    s_nop 1
    v_cndmask_b32 v18, 0, 1.0, vcc
    v_lshlrev_b32 v19, 2, v1
    s_mov_b32 s6, 0x3fb8aa3b
    s_mov_b32 s7, s6
    s_mov_b32 s8, 0x3db504f3
    s_mov_b32 s9, s8
    v_mov_b32 v48, -1
    v_mov_b32 v49, -1
    v_mov_b32 v50, -1
    v_mov_b32 v51, -1
    s_cmp_eq_u32 s32, 3
    s_cselect_b32 s22, 0x8000000, s22
    s_cselect_b32 s23, 0x82082082, s23
    s_cmp_eq_u32 s32, 1
    s_cselect_b32 s22, 0x4000000, s22
    s_cselect_b32 s23, 0x41041041, s23
    s_cmp_eq_u32 s32, 2
    s_cselect_b32 s22, 0x80000000, s22
    s_cselect_b32 s23, 0x20820820, s23
    s_cmp_eq_u32 s32, 5
    s_cselect_b32 s22, 0x42492492, s22
    s_cselect_b32 s23, 0x10410410, s23
    s_cmp_eq_u32 s32, 7
    s_cselect_b32 s22, 0x21249249, s22
    s_cselect_b32 s23, 0x8208208, s23
    s_cmp_eq_u32 s32, 6
    s_cselect_b32 s22, 0x10924924, s22
    s_cselect_b32 s23, 0x4104104, s23
    s_ff1_i32_b64 s34, s[22:23]
    s_mov_b32 s35, 0
    s_mov_b32 s10, 0
    s_add_u32 s36, s28, 14680064
    s_addc_u32 s37, s29, 0
    s_mul_i32 s61, s31, 532480
    s_add_u32 s36, s36, s61
    s_addc_u32 s37, s37, 0
    s_mul_i32 s61, s34, 8192
    s_add_u32 s36, s36, s61
    s_addc_u32 s37, s37, 0
    s_mul_i32 s61, s30, 2048
    s_add_u32 s36, s36, s61
    s_addc_u32 s37, s37, 0
    s_add_u32 s38, s28, 33554432
    s_addc_u32 s39, s29, 0
    s_mul_i32 s61, s31, 1064960
    s_add_u32 s38, s38, s61
    s_addc_u32 s39, s39, 0
    s_mul_i32 s61, s34, 16384
    s_add_u32 s38, s38, s61
    s_addc_u32 s39, s39, 0
    s_mul_i32 s61, s30, 4096
    s_add_u32 s38, s38, s61
    s_addc_u32 s39, s39, 0
    s_lshl_b32 s12, s30, 11
    s_lshl_b32 s13, s30, 12
    s_add_u32 s12, s12, 65536
    s_add_u32 s13, s13, 73728
    s_add_u32 s40, s28, 4198400
    s_addc_u32 s41, s29, 0
    s_mul_i32 s61, s31, 266240
    s_add_u32 s40, s40, s61
    s_addc_u32 s41, s41, 0
    s_mul_i32 s61, s34, 4096
    s_add_u32 s40, s40, s61
    s_addc_u32 s41, s41, 0
    s_mul_i32 s61, s30, 1024
    s_add_u32 s40, s40, s61
    s_addc_u32 s41, s41, 0
    s_add_u32 s42, s4, 0
    s_addc_u32 s43, s5, 0
    s_mul_i32 s61, s34, 32768
    s_add_u32 s42, s42, s61
    s_addc_u32 s43, s43, 0
    s_mul_i32 s61, s31, 1024
    s_add_u32 s42, s42, s61
    s_addc_u32 s43, s43, 0
    s_add_u32 s44, s24, 0
    s_addc_u32 s45, s25, 0
    s_mul_i32 s61, s34, 32768
    s_add_u32 s44, s44, s61
    s_addc_u32 s45, s45, 0
    s_mul_i32 s61, s31, 1024
    s_add_u32 s44, s44, s61
    s_addc_u32 s45, s45, 0
    s_add_u32 s46, s28, 83886080
    s_addc_u32 s47, s29, 0
    s_mul_i32 s61, s32, 1048576
    s_add_u32 s46, s46, s61
    s_addc_u32 s47, s47, 0
    s_mul_i32 s61, s31, 1024
    s_add_u32 s46, s46, s61
    s_addc_u32 s47, s47, 0
    s_mul_i32 s61, s30, 256
    s_add_u32 s46, s46, s61
    s_addc_u32 s47, s47, 0
    s_add_u32 s48, s28, 83886080
    s_addc_u32 s49, s29, 0
    s_mul_i32 s61, s32, 1048576
    s_add_u32 s48, s48, s61
    s_addc_u32 s49, s49, 0
    s_mul_i32 s61, s31, 32768
    s_add_u32 s48, s48, s61
    s_addc_u32 s49, s49, 0
    s_mul_i32 s61, s30, 256
    s_add_u32 s48, s48, s61
    s_addc_u32 s49, s49, 0
    s_add_u32 s50, s28, 1048576
    s_addc_u32 s51, s29, 0
    s_mul_i32 s61, s32, 32768
    s_add_u32 s50, s50, s61
    s_addc_u32 s51, s51, 0
    s_mul_i32 s61, s31, 1024
    s_add_u32 s50, s50, s61
    s_addc_u32 s51, s51, 0
    s_add_u32 s52, s28, 1052672
    s_addc_u32 s53, s29, 0
    s_mul_i32 s61, s32, 32768
    s_add_u32 s52, s52, s61
    s_addc_u32 s53, s53, 0
    s_mul_i32 s61, s30, 8192
    s_add_u32 s52, s52, s61
    s_addc_u32 s53, s53, 0
    s_add_u32 s4, s28, 589828
    s_addc_u32 s5, s29, 0
    s_mul_i32 s61, s31, 128
    s_add_u32 s4, s4, s61
    s_addc_u32 s5, s5, 0
    s_cmp_lg_u32 s30, 0
    s_cbranch_scc1 L_wdn108
    v_mbcnt_lo_u32_b32 v52, -1, 0
    v_mbcnt_hi_u32_b32 v52, -1, v52
    v_lshlrev_b32 v52, 2, v52
    s_mov_b32 exec_lo, 0x2020200
    s_mov_b32 exec_hi, 0x20080
    s_mov_b32 s54, 0
    s_branch L_wf108
L_wd108:
    s_sleep 8
L_wf108:
    global_load_dword v53, v52, s[26:27] sc1
    s_add_u32 s54, s54, 1
    s_cmp_gt_u32 s54, 400000
    s_cbranch_scc1 L_end
    s_waitcnt vmcnt(0)
    v_cmp_gt_u32 vcc, 32, v53
    s_cbranch_vccnz L_wd108
    s_mov_b64 exec, -1
L_wdn108:
    s_barrier
    s_cmp_gt_u32 s32, 3
    s_cbranch_scc1 L_pi2
    s_cmp_lg_u32 s30, 0
    s_cbranch_scc1 L_wdn109
    v_mbcnt_lo_u32_b32 v52, -1, 0
    v_mbcnt_hi_u32_b32 v52, -1, v52
    v_lshlrev_b32 v52, 2, v52
    s_mov_b32 exec_lo, 0x0
    s_mov_b32 exec_hi, 0x40
    s_mov_b32 s54, 0
    s_branch L_wf109
L_wd109:
    s_sleep 8
L_wf109:
    global_load_dword v53, v52, s[26:27] sc1
    s_add_u32 s54, s54, 1
    s_cmp_gt_u32 s54, 400000
    s_cbranch_scc1 L_end
    s_waitcnt vmcnt(0)
    v_cmp_gt_u32 vcc, 32, v53
    s_cbranch_vccnz L_wd109
    s_mov_b64 exec, -1
L_wdn109:
    s_barrier
L_pi2:
    s_add_u32 s56, s28, 526336
    s_addc_u32 s57, s29, 0
    global_load_dwordx2 v[52:53], v6, s[56:57] offset:0 sc1
    global_load_dwordx2 v[54:55], v6, s[56:57] offset:1024 sc1
    global_load_dwordx2 v[56:57], v6, s[56:57] offset:2048 sc1
    global_load_dwordx2 v[58:59], v6, s[56:57] offset:3072 sc1
    s_waitcnt vmcnt(3)
    v_lshlrev_b32 v24, 16, v52
    v_and_b32 v25, 0xffff0000, v52
    v_lshlrev_b32 v26, 16, v53
    v_and_b32 v27, 0xffff0000, v53
    s_waitcnt vmcnt(2)
    v_lshlrev_b32 v28, 16, v54
    v_and_b32 v29, 0xffff0000, v54
    v_lshlrev_b32 v30, 16, v55
    v_and_b32 v31, 0xffff0000, v55
    s_waitcnt vmcnt(1)
    v_lshlrev_b32 v32, 16, v56
    v_and_b32 v33, 0xffff0000, v56
    v_lshlrev_b32 v34, 16, v57
    v_and_b32 v35, 0xffff0000, v57
    s_waitcnt vmcnt(0)
    v_lshlrev_b32 v36, 16, v58
    v_and_b32 v37, 0xffff0000, v58
    v_lshlrev_b32 v38, 16, v59
    v_and_b32 v39, 0xffff0000, v59
    v_add_f32 v32, 1.0, v32
    v_add_f32 v33, 1.0, v33
    v_add_f32 v34, 1.0, v34
    v_add_f32 v35, 1.0, v35
    v_cvt_pk_bf16_f32 v52, v32, v33
    v_lshlrev_b32 v32, 16, v52
    v_and_b32 v33, 0xffff0000, v52
    v_cvt_pk_bf16_f32 v53, v34, v35
    v_lshlrev_b32 v34, 16, v53
    v_and_b32 v35, 0xffff0000, v53
    s_cmp_lg_u32 s33, 0
    s_cbranch_scc1 L_pslow
    v_mov_b32 v47, 0
    s_add_u32 s58, s34, 1
    s_mov_b64 exec, 7
    s_mov_b32 s54, 0
    s_branch L_pz1f
L_pz0f:
    s_sleep 8
    global_load_dword v47, v19, s[4:5] sc1
    s_add_u32 s54, s54, 1
    s_cmp_gt_u32 s54, 400000
    s_cbranch_scc1 L_end
    s_waitcnt vmcnt(0)
L_pz1f:
    v_cmp_gt_u32 vcc, s58, v47
    s_cbranch_vccnz L_pz0f
    s_mov_b64 exec, -1
    s_mov_b32 m0, s12
    global_load_dwordx2 v[44:45], v6, s[42:43]
    global_load_lds_dwordx4 v2, s[36:37] offset:0 sc1
    global_load_lds_dwordx4 v2, s[36:37] offset:1024 sc1
    s_mov_b32 m0, s13
    s_nop 0
    global_load_lds_dwordx4 v2, s[38:39] offset:0 sc1
    global_load_lds_dwordx4 v2, s[38:39] offset:1024 sc1
    global_load_lds_dwordx4 v2, s[38:39] offset:2048 sc1
    global_load_lds_dwordx4 v2, s[38:39] offset:3072 sc1
    s_waitcnt vmcnt(0)
    s_barrier
    s_branch L_plf
.p2align 6
L_plf:
    v_lshlrev_b32 v63, 7, v1
    global_load_dword v47, v19, s[4:5] sc1
    global_load_dword v62, v63, s[52:53] offset:-4096 sc1
    global_load_dwordx4 v[180:183], v2, s[40:41] sc1
    s_bitset0_b64 s[22:23], s34
    s_ff1_i32_b64 s11, s[22:23]
    s_min_u32 s11, s11, 64
    s_sub_u32 s20, s11, s34
    s_lshl_b32 s56, s20, 13
    s_add_u32 s36, s36, s56
    s_addc_u32 s37, s37, 0
    s_lshl_b32 s56, s20, 14
    s_add_u32 s38, s38, s56
    s_addc_u32 s39, s39, 0
    s_lshl_b32 s56, s20, 15
    s_add_u32 s42, s42, s56
    s_addc_u32 s43, s43, 0
    ds_read_b128 v[188:191], v3 offset:0
    ds_read_b128 v[204:207], v4 offset:0
    ds_read_b128 v[220:223], v4 offset:128
    ds_read_b128 v[192:195], v3 offset:2048
    ds_read_b128 v[208:211], v4 offset:2048
    ds_read_b128 v[224:227], v4 offset:2176
    ds_read_b128 v[196:199], v3 offset:4096
    ds_read_b128 v[212:215], v4 offset:4096
    ds_read_b128 v[228:231], v4 offset:4224
    ds_read_b128 v[200:203], v3 offset:6144
    ds_read_b128 v[216:219], v4 offset:6144
    ds_read_b128 v[232:235], v4 offset:6272
    s_waitcnt lgkmcnt(10)
    v_mfma_f32_16x16x32_bf16 v[128:131], v[204:207], v[188:191], 0
    s_waitcnt lgkmcnt(9)
    v_mfma_f32_16x16x32_bf16 v[132:135], v[220:223], v[188:191], 0
    s_waitcnt lgkmcnt(7)
    v_mfma_f32_16x16x32_bf16 v[128:131], v[208:211], v[192:195], v[128:131]
    s_waitcnt lgkmcnt(6)
    v_mfma_f32_16x16x32_bf16 v[132:135], v[224:227], v[192:195], v[132:135]
    s_waitcnt lgkmcnt(4)
    v_mfma_f32_16x16x32_bf16 v[128:131], v[212:215], v[196:199], v[128:131]
    s_waitcnt lgkmcnt(3)
    v_mfma_f32_16x16x32_bf16 v[132:135], v[228:231], v[196:199], v[132:135]
    s_waitcnt lgkmcnt(1)
    v_mfma_f32_16x16x32_bf16 v[128:131], v[216:219], v[200:203], v[128:131]
    s_waitcnt lgkmcnt(0)
    v_mfma_f32_16x16x32_bf16 v[132:135], v[232:235], v[200:203], v[132:135]
    ds_read_b128 v[236:239], v5 offset:0
    ds_read_b128 v[240:243], v5 offset:256
    ds_read_b128 v[244:247], v5 offset:2048
    ds_read_b128 v[248:251], v5 offset:2304
    v_lshlrev_b32 v40, 16, v44
    v_and_b32 v41, 0xffff0000, v44
    v_lshlrev_b32 v42, 16, v45
    v_and_b32 v43, 0xffff0000, v45
    v_cvt_pk_bf16_f32 v52, v128, v129
    v_lshlrev_b32_e64 v128, 16, v52
    v_and_b32 v129, 0xffff0000, v52
    v_cvt_pk_bf16_f32 v53, v130, v131
    v_lshlrev_b32 v130, 16, v53
    v_and_b32 v131, 0xffff0000, v53
    v_cvt_pk_bf16_f32 v54, v132, v133
    v_lshlrev_b32 v132, 16, v54
    v_and_b32 v133, 0xffff0000, v54
    v_cvt_pk_bf16_f32 v55, v134, v135
    v_lshlrev_b32_e64 v134, 16, v55
    v_and_b32 v135, 0xffff0000, v55
    v_pk_mul_f32 v[128:129], v[128:129], s[8:9]
    v_pk_mul_f32 v[130:131], v[130:131], s[8:9]
    v_pk_mul_f32 v[132:133], v[132:133], s[8:9]
    v_pk_mul_f32 v[134:135], v[134:135], s[8:9]
    v_cvt_pk_bf16_f32 v52, v128, v129
    v_lshlrev_b32 v128, 16, v52
    v_and_b32 v129, 0xffff0000, v52
    v_cvt_pk_bf16_f32 v53, v130, v131
    v_lshlrev_b32 v130, 16, v53
    v_and_b32 v131, 0xffff0000, v53
    v_cvt_pk_bf16_f32 v54, v132, v133
    v_lshlrev_b32_e64 v132, 16, v54
    v_and_b32 v133, 0xffff0000, v54
    v_cvt_pk_bf16_f32 v55, v134, v135
    v_lshlrev_b32_e64 v134, 16, v55
    v_and_b32 v135, 0xffff0000, v55
    v_cndmask_b32 v128, v46, v128, s[62:63]
    v_cndmask_b32 v129, v46, v129, s[64:65]
    v_cndmask_b32 v130, v46, v130, s[66:67]
    v_cndmask_b32 v131, v46, v131, s[68:69]
    v_cndmask_b32 v132, v46, v132, s[70:71]
    v_cndmask_b32 v133, v46, v133, s[72:73]
    v_cndmask_b32 v134, v46, v134, s[74:75]
    v_cndmask_b32 v135, v46, v135, s[76:77]
    v_max3_f32 v140, v128, v129, v130
    v_max3_f32 v140, v140, v131, v132
    v_max3_f32 v140, v140, v133, v134
    v_max_f32 v140, v140, v135
    v_mov_b32 v52, v140
    s_nop 1
    v_permlane16_swap_b32 v140, v52
    v_max_f32 v140, v140, v52
    v_mov_b32 v52, v140
    s_nop 1
    v_permlane32_swap_b32 v140, v52
    v_max_f32_e64 v140, v140, v52
    v_pk_add_f32 v[128:129], v[128:129], v[140:141] op_sel:[0,0] op_sel_hi:[1,0] neg_lo:[0,1] neg_hi:[0,1]
    v_pk_add_f32 v[130:131], v[130:131], v[140:141] op_sel:[0,0] op_sel_hi:[1,0] neg_lo:[0,1] neg_hi:[0,1]
    v_pk_add_f32 v[132:133], v[132:133], v[140:141] op_sel:[0,0] op_sel_hi:[1,0] neg_lo:[0,1] neg_hi:[0,1]
    v_pk_add_f32 v[134:135], v[134:135], v[140:141] op_sel:[0,0] op_sel_hi:[1,0] neg_lo:[0,1] neg_hi:[0,1]
    v_pk_mul_f32 v[128:129], v[128:129], s[6:7]
    v_pk_mul_f32 v[130:131], v[130:131], s[6:7]
    v_pk_mul_f32 v[132:133], v[132:133], s[6:7]
    v_pk_mul_f32 v[134:135], v[134:135], s[6:7]
    v_exp_f32 v128, v128
    v_exp_f32 v129, v129
    v_exp_f32 v130, v130
    v_exp_f32 v131, v131
    v_exp_f32 v132, v132
    v_exp_f32 v133, v133
    v_exp_f32 v134, v134
    v_exp_f32 v135, v135
    v_pk_add_f32 v[52:53], v[128:129], v[130:131]
    v_pk_add_f32 v[54:55], v[132:133], v[134:135]
    v_pk_add_f32 v[52:53], v[52:53], v[54:55]
    v_add_f32 v141, v52, v53
    v_mov_b32 v52, v141
    s_nop 1
    v_permlane16_swap_b32 v141, v52
    v_add_f32 v141, v141, v52
    v_mov_b32 v52, v141
    s_nop 1
    v_permlane32_swap_b32 v141, v52
    v_add_f32_e64 v141, v141, v52
    s_waitcnt vmcnt(0) lgkmcnt(0)
    s_add_u32 s58, s11, 1
    s_min_u32 s58, s58, 64
    s_mov_b64 exec, 7
    s_mov_b32 s54, 0
    s_branch L_pg1f
L_pg0f:
    s_sleep 8
    global_load_dword v47, v19, s[4:5] sc1
    s_add_u32 s54, s54, 1
    s_cmp_gt_u32 s54, 400000
    s_cbranch_scc1 L_end
    s_waitcnt vmcnt(0)
L_pg1f:
    v_cmp_gt_u32 vcc, s58, v47
    s_cbranch_vccnz L_pg0f
    s_mov_b64 exec, -1
    s_mov_b32 s54, 0
    s_branch L_pd1f
L_pd0f:
    global_load_dword v62, v63, s[52:53] offset:-4096 sc1
    s_add_u32 s54, s54, 1
    s_cmp_gt_u32 s54, 400000
    s_cbranch_scc1 L_end
    s_waitcnt vmcnt(0)
L_pd1f:
    v_cmp_ne_u32 vcc, -1, v62
    s_cbranch_vccnz L_pd0f
    s_mov_b32 s54, 0
    s_branch L_pk1f
L_pk0f:
    global_load_dwordx4 v[180:183], v2, s[40:41] sc1
    s_sleep 1
    s_add_u32 s54, s54, 1
    s_cmp_gt_u32 s54, 400000
    s_cbranch_scc1 L_end
    s_waitcnt vmcnt(2)
L_pk1f:
    v_max3_u32 v52, v180, v181, v182
    v_max_u32_e64 v52, v52, v183
    v_cmp_eq_u32_e64 vcc, -1, v52
    s_cbranch_vccnz L_pk0f
    ds_write2_b32 v9, v180, v181 offset0:0 offset1:4
    ds_write2_b32 v9, v182, v183 offset0:8 offset1:12
    s_waitcnt lgkmcnt(0)
    s_barrier
    ds_read_b64_tr_b16 v[144:145], v10 offset:0
    ds_read_b64_tr_b16 v[146:147], v10 offset:144
    ds_read_b64_tr_b16 v[148:149], v10 offset:1152
    ds_read_b64_tr_b16 v[150:151], v10 offset:1296
    ds_read_b64_tr_b16 v[152:153], v10 offset:2304
    ds_read_b64_tr_b16 v[154:155], v10 offset:2448
    ds_read_b64_tr_b16 v[156:157], v10 offset:3456
    ds_read_b64_tr_b16 v[158:159], v10 offset:3600
    s_cmp_ge_u32 s11, 64
    s_cbranch_scc1 L_pnf
    s_mov_b32 m0, s12
    global_load_dwordx2 v[44:45], v6, s[42:43]
    global_load_lds_dwordx4 v2, s[36:37] offset:0 sc1
    global_load_lds_dwordx4 v2, s[36:37] offset:1024 sc1
    s_mov_b32 m0, s13
    s_nop 0
    global_load_lds_dwordx4 v2, s[38:39] offset:0 sc1
    global_load_lds_dwordx4 v2, s[38:39] offset:1024 sc1
    global_load_lds_dwordx4 v2, s[38:39] offset:2048 sc1
    global_load_lds_dwordx4 v2, s[38:39] offset:3072 sc1
L_pnf:
    s_waitcnt lgkmcnt(6)
    v_mfma_f32_16x16x32_bf16 v[136:139], v[144:147], v[188:191], 0
    ds_read_b64 v[160:161], v11 offset:0
    s_waitcnt lgkmcnt(5)
    v_mfma_f32_16x16x32_bf16 v[136:139], v[148:151], v[192:195], v[136:139]
    ds_read_b64 v[162:163], v11 offset:16
    s_waitcnt lgkmcnt(4)
    v_mfma_f32_16x16x32_bf16 v[136:139], v[152:155], v[196:199], v[136:139]
    ds_read_b64 v[164:165], v11 offset:1152
    s_waitcnt lgkmcnt(3)
    v_mfma_f32_16x16x32_bf16 v[136:139], v[156:159], v[200:203], v[136:139]
    ds_read_b64 v[166:167], v11 offset:1168
    s_nop 6
    v_cvt_pk_bf16_f32 v52, v136, v137
    v_lshlrev_b32 v136, 16, v52
    v_and_b32 v137, 0xffff0000, v52
    v_cvt_pk_bf16_f32 v53, v138, v139
    v_lshlrev_b32_e64 v138, 16, v53
    v_and_b32 v139, 0xffff0000, v53
    v_pk_mul_f32 v[136:137], v[136:137], s[8:9]
    v_pk_mul_f32 v[138:139], v[138:139], s[8:9]
    v_cvt_pk_bf16_f32 v52, v136, v137
    v_lshlrev_b32 v136, 16, v52
    v_and_b32 v137, 0xffff0000, v52
    v_cvt_pk_bf16_f32 v53, v138, v139
    v_lshlrev_b32 v138, 16, v53
    v_and_b32 v139, 0xffff0000, v53
    v_max3_f32 v60, v140, v136, v137
    v_max3_f32 v60, v60, v138, v139
    v_mov_b32 v52, v60
    s_nop 1
    v_permlane16_swap_b32 v60, v52
    v_max_f32 v60, v60, v52
    v_pk_add_f32 v[136:137], v[136:137], v[60:61] op_sel:[0,0] op_sel_hi:[1,0] neg_lo:[0,1] neg_hi:[0,1]
    v_pk_add_f32 v[138:139], v[138:139], v[60:61] op_sel:[0,0] op_sel_hi:[1,0] neg_lo:[0,1] neg_hi:[0,1]
    v_sub_f32_e64 v140, v140, v60
    v_pk_mul_f32 v[136:137], v[136:137], s[6:7]
    v_pk_mul_f32 v[138:139], v[138:139], s[6:7]
    v_mul_f32 v140, s6, v140
    v_exp_f32 v136, v136
    v_exp_f32 v137, v137
    v_exp_f32 v138, v138
    v_exp_f32 v139, v139
    v_exp_f32 v140, v140
    v_pk_add_f32 v[52:53], v[136:137], v[138:139]
    v_add_f32 v61, v52, v53
    v_mov_b32 v52, v61
    s_nop 1
    v_permlane16_swap_b32 v61, v52
    v_add_f32 v61, v61, v52
    v_fmac_f32 v61, v140, v141
    v_rcp_f32 v61, v61
    s_nop 0
    v_mul_f32 v60, v61, v140
    v_mul_f32 v61, v61, v18
    v_pk_mul_f32 v[128:129], v[128:129], v[60:61] op_sel:[0,0] op_sel_hi:[1,0]
    v_pk_mul_f32 v[130:131], v[130:131], v[60:61] op_sel:[0,0] op_sel_hi:[1,0]
    v_pk_mul_f32 v[132:133], v[132:133], v[60:61] op_sel:[0,0] op_sel_hi:[1,0]
    v_pk_mul_f32 v[134:135], v[134:135], v[60:61] op_sel:[0,0] op_sel_hi:[1,0]
    v_pk_mul_f32 v[136:137], v[136:137], v[60:61] op_sel:[0,1] op_sel_hi:[1,1]
    v_pk_mul_f32 v[138:139], v[138:139], v[60:61] op_sel:[0,1] op_sel_hi:[1,1]
    v_cvt_pk_bf16_f32 v172, v128, v129
    v_cvt_pk_bf16_f32 v173, v130, v131
    v_cvt_pk_bf16_f32 v174, v132, v133
    v_cvt_pk_bf16_f32 v175, v134, v135
    v_cvt_pk_bf16_f32 v176, v136, v137
    v_cvt_pk_bf16_f32 v177, v138, v139
    v_mfma_f32_16x16x32_bf16 v[64:67], v[236:239], v[172:175], 0
    v_mfma_f32_16x16x32_bf16 v[68:71], v[240:243], v[172:175], 0
    s_waitcnt lgkmcnt(3)
    v_mfma_f32_16x16x16_bf16 v[64:67], v[160:161], v[176:177], v[64:67]
    s_waitcnt lgkmcnt(2)
    v_mfma_f32_16x16x16_bf16 v[68:71], v[162:163], v[176:177], v[68:71]
    v_mfma_f32_16x16x32_bf16 v[72:75], v[244:247], v[172:175], 0
    v_mfma_f32_16x16x32_bf16 v[76:79], v[248:251], v[172:175], 0
    s_waitcnt lgkmcnt(1)
    v_mfma_f32_16x16x16_bf16 v[72:75], v[164:165], v[176:177], v[72:75]
    s_waitcnt lgkmcnt(0)
    v_mfma_f32_16x16x16_bf16 v[76:79], v[166:167], v[176:177], v[76:79]
    v_cvt_pk_bf16_f32 v52, v64, v65
    v_cvt_pk_bf16_f32 v53, v66, v67
    v_cvt_pk_bf16_f32 v54, v68, v69
    v_cvt_pk_bf16_f32 v55, v70, v71
    ds_write_b128 v12, v[52:55] offset:0
    s_nop 0
    v_cvt_pk_bf16_f32 v56, v72, v73
    v_cvt_pk_bf16_f32 v57, v74, v75
    v_cvt_pk_bf16_f32 v58, v76, v77
    v_cvt_pk_bf16_f32 v59, v78, v79
    ds_write_b128 v12, v[56:59] offset:1024
    s_waitcnt lgkmcnt(0)
    s_barrier
    ds_read_b128 v[128:131], v2 offset:8192
    ds_read_b128 v[132:135], v2 offset:9216
    ds_read_b128 v[136:139], v2 offset:10240
    ds_read_b128 v[140:143], v2 offset:11264
    ds_read_b128 v[144:147], v2 offset:12288
    ds_read_b128 v[148:151], v2 offset:13312
    ds_read_b128 v[152:155], v2 offset:14336
    ds_read_b128 v[156:159], v2 offset:15360
    s_waitcnt lgkmcnt(7)
    v_mfma_f32_16x16x32_bf16 v[64:67], v[128:131], a[0:3], 0
    s_waitcnt lgkmcnt(6)
    v_mfma_f32_16x16x32_bf16 v[64:67], v[132:135], a[4:7], v[64:67]
    s_waitcnt lgkmcnt(5)
    v_mfma_f32_16x16x32_bf16 v[64:67], v[136:139], a[8:11], v[64:67]
    s_waitcnt lgkmcnt(4)
    v_mfma_f32_16x16x32_bf16 v[64:67], v[140:143], a[12:15], v[64:67]
    v_mfma_f32_16x16x32_bf16 v[68:71], v[128:131], a[16:19], 0
    v_mfma_f32_16x16x32_bf16 v[68:71], v[132:135], a[20:23], v[68:71]
    v_mfma_f32_16x16x32_bf16 v[68:71], v[136:139], a[24:27], v[68:71]
    v_mfma_f32_16x16x32_bf16 v[68:71], v[140:143], a[28:31], v[68:71]
    v_mfma_f32_16x16x32_bf16 v[72:75], v[128:131], a[32:35], 0
    v_mfma_f32_16x16x32_bf16 v[72:75], v[132:135], a[36:39], v[72:75]
    v_mfma_f32_16x16x32_bf16 v[72:75], v[136:139], a[40:43], v[72:75]
    v_mfma_f32_16x16x32_bf16 v[72:75], v[140:143], a[44:47], v[72:75]
    v_mfma_f32_16x16x32_bf16 v[76:79], v[128:131], a[48:51], 0
    s_nop 2
    v_cvt_pk_bf16_f32 v204, v64, v68
    v_cvt_pk_bf16_f32 v208, v65, v69
    v_mfma_f32_16x16x32_bf16 v[76:79], v[132:135], a[52:55], v[76:79]
    v_cvt_pk_bf16_f32 v212, v66, v70
    v_cvt_pk_bf16_f32 v216, v67, v71
    v_mfma_f32_16x16x32_bf16 v[76:79], v[136:139], a[56:59], v[76:79]
    v_and_or_b32 v204, v204, -2, s10
    v_and_or_b32 v208, v208, -2, s10
    v_mfma_f32_16x16x32_bf16 v[76:79], v[140:143], a[60:63], v[76:79]
    v_and_or_b32 v212, v212, -2, s10
    v_and_or_b32 v216, v216, -2, s10
    v_mfma_f32_16x16x32_bf16 v[80:83], v[128:131], a[64:67], 0
    v_mfma_f32_16x16x32_bf16 v[80:83], v[132:135], a[68:71], v[80:83]
    v_mfma_f32_16x16x32_bf16 v[80:83], v[136:139], a[72:75], v[80:83]
    v_mfma_f32_16x16x32_bf16 v[80:83], v[140:143], a[76:79], v[80:83]
    v_mfma_f32_16x16x32_bf16 v[84:87], v[128:131], a[80:83], 0
    s_nop 0
    v_cvt_pk_bf16_f32 v205, v72, v76
    v_cvt_pk_bf16_f32 v209, v73, v77
    v_mfma_f32_16x16x32_bf16 v[84:87], v[132:135], a[84:87], v[84:87]
    v_cvt_pk_bf16_f32 v213, v74, v78
    v_cvt_pk_bf16_f32 v217, v75, v79
    v_mfma_f32_16x16x32_bf16 v[84:87], v[136:139], a[88:91], v[84:87]
    v_mfma_f32_16x16x32_bf16 v[84:87], v[140:143], a[92:95], v[84:87]
    v_mfma_f32_16x16x32_bf16 v[88:91], v[128:131], a[96:99], 0
    v_mfma_f32_16x16x32_bf16 v[88:91], v[132:135], a[100:103], v[88:91]
    v_mfma_f32_16x16x32_bf16 v[88:91], v[136:139], a[104:107], v[88:91]
    v_mfma_f32_16x16x32_bf16 v[88:91], v[140:143], a[108:111], v[88:91]
    v_mfma_f32_16x16x32_bf16 v[92:95], v[128:131], a[112:115], 0
    s_nop 2
    v_cvt_pk_bf16_f32 v206, v80, v84
    v_cvt_pk_bf16_f32 v210, v81, v85
    v_mfma_f32_16x16x32_bf16 v[92:95], v[132:135], a[116:119], v[92:95]
    v_cvt_pk_bf16_f32 v214, v82, v86
    v_cvt_pk_bf16_f32 v218, v83, v87
    v_mfma_f32_16x16x32_bf16 v[92:95], v[136:139], a[120:123], v[92:95]
    v_mfma_f32_16x16x32_bf16 v[92:95], v[140:143], a[124:127], v[92:95]
    s_waitcnt lgkmcnt(3)
    v_mfma_f32_16x16x32_bf16 v[96:99], v[144:147], a[0:3], 0
    s_nop 0
    s_nop 1
    s_waitcnt lgkmcnt(2)
    v_mfma_f32_16x16x32_bf16 v[96:99], v[148:151], a[4:7], v[96:99]
    s_nop 0
    v_cvt_pk_bf16_f32 v207, v88, v92
    v_cvt_pk_bf16_f32 v211, v89, v93
    s_waitcnt lgkmcnt(1)
    v_mfma_f32_16x16x32_bf16 v[96:99], v[152:155], a[8:11], v[96:99]
    v_cvt_pk_bf16_f32 v215, v90, v94
    v_cvt_pk_bf16_f32 v219, v91, v95
    s_waitcnt lgkmcnt(0)
    v_mfma_f32_16x16x32_bf16 v[96:99], v[156:159], a[12:15], v[96:99]
    s_add_u32 s56, s46, 0
    s_addc_u32 s57, s47, 0
    global_store_dwordx4 v7, v[204:207], s[56:57]
    v_mfma_f32_16x16x32_bf16 v[100:103], v[144:147], a[16:19], 0
    s_add_u32 s56, s46, 32768
    s_addc_u32 s57, s47, 0
    global_store_dwordx4 v7, v[208:211], s[56:57]
    v_mfma_f32_16x16x32_bf16 v[100:103], v[148:151], a[20:23], v[100:103]
    s_add_u32 s56, s46, 65536
    s_addc_u32 s57, s47, 0
    global_store_dwordx4 v7, v[212:215], s[56:57]
    v_mfma_f32_16x16x32_bf16 v[100:103], v[152:155], a[24:27], v[100:103]
    s_add_u32 s56, s46, 98304
    s_addc_u32 s57, s47, 0
    global_store_dwordx4 v7, v[216:219], s[56:57]
    v_mfma_f32_16x16x32_bf16 v[100:103], v[156:159], a[28:31], v[100:103]
    v_mfma_f32_16x16x32_bf16 v[104:107], v[144:147], a[32:35], 0
    v_mfma_f32_16x16x32_bf16 v[104:107], v[148:151], a[36:39], v[104:107]
    v_mfma_f32_16x16x32_bf16 v[104:107], v[152:155], a[40:43], v[104:107]
    v_mfma_f32_16x16x32_bf16 v[104:107], v[156:159], a[44:47], v[104:107]
    v_mfma_f32_16x16x32_bf16 v[108:111], v[144:147], a[48:51], 0
    s_nop 0
    s_nop 1
    v_cvt_pk_bf16_f32 v220, v96, v100
    v_cvt_pk_bf16_f32 v224, v97, v101
    v_mfma_f32_16x16x32_bf16 v[108:111], v[148:151], a[52:55], v[108:111]
    v_cvt_pk_bf16_f32 v228, v98, v102
    v_cvt_pk_bf16_f32 v232, v99, v103
    v_mfma_f32_16x16x32_bf16 v[108:111], v[152:155], a[56:59], v[108:111]
    v_and_or_b32 v220, v220, -2, s10
    v_and_or_b32 v224, v224, -2, s10
    v_mfma_f32_16x16x32_bf16 v[108:111], v[156:159], a[60:63], v[108:111]
    v_and_or_b32 v228, v228, -2, s10
    v_and_or_b32 v232, v232, -2, s10
    v_mfma_f32_16x16x32_bf16 v[112:115], v[144:147], a[64:67], 0
    v_mfma_f32_16x16x32_bf16 v[112:115], v[148:151], a[68:71], v[112:115]
    v_mfma_f32_16x16x32_bf16 v[112:115], v[152:155], a[72:75], v[112:115]
    v_mfma_f32_16x16x32_bf16 v[112:115], v[156:159], a[76:79], v[112:115]
    v_mfma_f32_16x16x32_bf16 v[116:119], v[144:147], a[80:83], 0
    s_nop 0
    v_cvt_pk_bf16_f32 v221, v104, v108
    v_cvt_pk_bf16_f32 v225, v105, v109
    v_mfma_f32_16x16x32_bf16 v[116:119], v[148:151], a[84:87], v[116:119]
    v_cvt_pk_bf16_f32 v229, v106, v110
    v_cvt_pk_bf16_f32 v233, v107, v111
    v_mfma_f32_16x16x32_bf16 v[116:119], v[152:155], a[88:91], v[116:119]
    v_mfma_f32_16x16x32_bf16 v[116:119], v[156:159], a[92:95], v[116:119]
    v_mfma_f32_16x16x32_bf16 v[120:123], v[144:147], a[96:99], 0
    v_mfma_f32_16x16x32_bf16 v[120:123], v[148:151], a[100:103], v[120:123]
    v_mfma_f32_16x16x32_bf16 v[120:123], v[152:155], a[104:107], v[120:123]
    v_mfma_f32_16x16x32_bf16 v[120:123], v[156:159], a[108:111], v[120:123]
    v_mfma_f32_16x16x32_bf16 v[124:127], v[144:147], a[112:115], 0
    s_nop 2
    v_cvt_pk_bf16_f32 v222, v112, v116
    v_cvt_pk_bf16_f32 v226, v113, v117
    v_mfma_f32_16x16x32_bf16 v[124:127], v[148:151], a[116:119], v[124:127]
    v_cvt_pk_bf16_f32 v230, v114, v118
    v_cvt_pk_bf16_f32 v234, v115, v119
    v_mfma_f32_16x16x32_bf16 v[124:127], v[152:155], a[120:123], v[124:127]
    v_mfma_f32_16x16x32_bf16 v[124:127], v[156:159], a[124:127], v[124:127]
    s_nop 0
    s_nop 0
    s_nop 5
    v_cvt_pk_bf16_f32 v223, v120, v124
    s_add_u32 s56, s46, 524288
    s_addc_u32 s57, s47, 0
    global_store_dwordx4 v7, v[220:223], s[56:57]
    v_cvt_pk_bf16_f32 v227, v121, v125
    s_add_u32 s56, s46, 557056
    s_addc_u32 s57, s47, 0
    global_store_dwordx4 v7, v[224:227], s[56:57]
    v_cvt_pk_bf16_f32 v231, v122, v126
    s_add_u32 s56, s46, 589824
    s_addc_u32 s57, s47, 0
    global_store_dwordx4 v7, v[228:231], s[56:57]
    v_cvt_pk_bf16_f32 v235, v123, v127
    s_add_u32 s56, s46, 622592
    s_addc_u32 s57, s47, 0
    global_store_dwordx4 v7, v[232:235], s[56:57]
    s_waitcnt vmcnt(0)
    s_mov_b32 s54, 0
L_pr1f:
    s_add_u32 s56, s48, 4096
    s_addc_u32 s57, s49, 0
    global_load_dwordx4 v[64:67], v8, s[56:57] offset:-4096 sc1
    global_load_dwordx4 v[68:71], v8, s[56:57] offset:0 sc1
    s_add_u32 s56, s48, 12288
    s_addc_u32 s57, s49, 0
    global_load_dwordx4 v[72:75], v8, s[56:57] offset:-4096 sc1
    global_load_dwordx4 v[76:79], v8, s[56:57] offset:0 sc1
    s_add_u32 s56, s48, 20480
    s_addc_u32 s57, s49, 0
    global_load_dwordx4 v[80:83], v8, s[56:57] offset:-4096 sc1
    global_load_dwordx4 v[84:87], v8, s[56:57] offset:0 sc1
    s_add_u32 s56, s48, 28672
    s_addc_u32 s57, s49, 0
    global_load_dwordx4 v[88:91], v8, s[56:57] offset:-4096 sc1
    global_load_dwordx4 v[92:95], v8, s[56:57] offset:0 sc1
    s_add_u32 s54, s54, 1
    s_cmp_gt_u32 s54, 400000
    s_cbranch_scc1 L_end
    s_waitcnt vmcnt(7)
    v_mfma_f32_16x16x32_bf16 v[56:59], v[64:67], v[20:23], 0
    v_xor_b32 v52, 0, v64
    s_waitcnt vmcnt(6)
    v_mfma_f32_16x16x32_bf16 v[56:59], v[68:71], v[20:23], v[56:59]
    v_bitop3_b32 v52, v52, 0, v68 bitop3:0xf6
    s_waitcnt vmcnt(5)
    v_mfma_f32_16x16x32_bf16 v[56:59], v[72:75], v[20:23], v[56:59]
    v_bitop3_b32 v52, v52, 0, v72 bitop3:0xf6
    s_waitcnt vmcnt(4)
    v_mfma_f32_16x16x32_bf16 v[56:59], v[76:79], v[20:23], v[56:59]
    v_bitop3_b32 v52, v52, 0, v76 bitop3:0xf6
    s_waitcnt vmcnt(3)
    v_mfma_f32_16x16x32_bf16 v[56:59], v[80:83], v[20:23], v[56:59]
    v_bitop3_b32 v52, v52, 0, v80 bitop3:0xf6
    s_waitcnt vmcnt(2)
    v_mfma_f32_16x16x32_bf16 v[56:59], v[84:87], v[20:23], v[56:59]
    v_bitop3_b32 v52, v52, 0, v84 bitop3:0xf6
    s_waitcnt vmcnt(1)
    v_mfma_f32_16x16x32_bf16 v[56:59], v[88:91], v[20:23], v[56:59]
    v_bitop3_b32 v52, v52, 0, v88 bitop3:0xf6
    s_waitcnt vmcnt(0)
    v_mfma_f32_16x16x32_bf16 v[56:59], v[92:95], v[20:23], v[56:59]
    v_bitop3_b32 v52, v52, s35, v92 bitop3:0xf6
    v_and_b32 v52, 1, v52
    v_cmp_ne_u32 vcc, 0, v52
    s_cbranch_vccnz L_pr1f
    s_nop 3
    v_cvt_pk_bf16_f32 v52, v56, v57
    v_lshlrev_b32_e64 v56, 16, v52
    v_and_b32 v57, 0xffff0000, v52
    v_cvt_pk_bf16_f32 v53, v58, v59
    v_lshlrev_b32_e64 v58, 16, v53
    v_and_b32 v59, 0xffff0000, v53
    v_pk_mul_f32 v[56:57], v[56:57], v[24:25]
    v_pk_mul_f32 v[58:59], v[58:59], v[26:27]
    v_cvt_pk_bf16_f32 v52, v56, v57
    v_lshlrev_b32_e64 v56, 16, v52
    v_and_b32 v57, 0xffff0000, v52
    v_cvt_pk_bf16_f32 v53, v58, v59
    v_lshlrev_b32_e64 v58, 16, v53
    v_and_b32 v59, 0xffff0000, v53
    v_pk_add_f32 v[40:41], v[40:41], v[56:57]
    v_pk_add_f32 v[42:43], v[42:43], v[58:59]
    v_cvt_pk_bf16_f32 v52, v40, v41
    v_lshlrev_b32_e64 v40, 16, v52
    v_and_b32 v41, 0xffff0000, v52
    v_cvt_pk_bf16_f32 v53, v42, v43
    v_lshlrev_b32 v42, 16, v53
    v_and_b32 v43, 0xffff0000, v53
    v_readfirstlane_b32 s58, v40
    v_readfirstlane_b32 s59, v40
    s_nop 1
    v_pk_add_f32 v[56:57], v[40:41], s[58:59] neg_lo:[0,1] neg_hi:[0,1]
    v_pk_add_f32 v[58:59], v[42:43], s[58:59] neg_lo:[0,1] neg_hi:[0,1]
    v_pk_add_f32 v[54:55], v[56:57], v[58:59]
    v_pk_mul_f32 v[56:57], v[56:57], v[56:57]
    v_add_f32_e64 v60, v54, v55
    v_pk_fma_f32 v[56:57], v[58:59], v[58:59], v[56:57]
    v_add_f32_e64 v61, v56, v57
    v_add_f32_dpp v60, v60, v60 row_ror:4 row_mask:0xf bank_mask:0xf
    s_nop 0
    v_add_f32_dpp v61, v61, v61 row_ror:4 row_mask:0xf bank_mask:0xf
    v_add_f32_dpp v60, v60, v60 row_ror:2 row_mask:0xf bank_mask:0xf
    s_nop 0
    v_add_f32_dpp v61, v61, v61 row_ror:2 row_mask:0xf bank_mask:0xf
    v_add_f32_dpp v60, v60, v60 row_ror:1 row_mask:0xf bank_mask:0xf
    s_nop 0
    v_add_f32_dpp v61, v61, v61 row_ror:1 row_mask:0xf bank_mask:0xf
    v_mov_b64 v[52:53], v[60:61]
    s_nop 1
    v_permlane16_swap_b32 v60, v52
    v_permlane16_swap_b32 v61, v53
    v_pk_add_f32 v[60:61], v[60:61], v[52:53]
    v_mov_b64 v[52:53], v[60:61]
    s_nop 0
    s_nop 0
    v_permlane32_swap_b32 v60, v52
    v_permlane32_swap_b32 v61, v53
    v_pk_add_f32 v[60:61], v[60:61], v[52:53]
    v_mul_f32 v52, 0x3c000000, v60
    v_fma_f32 v61, -v52, v60, v61
    v_add_f32_e64 v60, s58, v52
    ds_write_b64 v16, v[60:61]
    s_waitcnt lgkmcnt(0)
    s_barrier
    ds_read_b128 v[64:67], v17
    ds_read_b128 v[68:71], v17 offset:16
    s_waitcnt lgkmcnt(1)
    v_pk_add_f32 v[72:73], v[64:65], v[66:67]
    s_waitcnt lgkmcnt(0)
    v_pk_add_f32 v[74:75], v[68:69], v[70:71]
    v_pk_add_f32 v[72:73], v[72:73], v[74:75]
    v_mul_f32 v60, 0x3e800000, v72
    v_sub_f32 v64, v64, v60
    v_sub_f32 v66, v66, v60
    v_sub_f32 v68, v68, v60
    v_sub_f32 v70, v70, v60
    v_mul_f32 v64, v64, v64
    v_fmac_f32 v64, v66, v66
    v_fmac_f32 v64, v68, v68
    v_fmac_f32 v64, v70, v70
    v_mul_f32 v61, 0x3b000000, v73
    v_fmac_f32 v61, 0x3e800000, v64
    v_cvt_pk_bf16_f32 v52, v60, v61
    v_lshlrev_b32_e64 v60, 16, v52
    v_and_b32 v61, 0xffff0000, v52
    v_add_f32 v61, 0x3727c5ac, v61
    v_pk_add_f32 v[56:57], v[40:41], v[60:61] op_sel:[0,0] op_sel_hi:[1,0] neg_lo:[0,1] neg_hi:[0,1]
    v_pk_add_f32 v[58:59], v[42:43], v[60:61] op_sel:[0,0] op_sel_hi:[1,0] neg_lo:[0,1] neg_hi:[0,1]
    v_cvt_pk_bf16_f32 v52, v60, v61
    v_lshlrev_b32 v60, 16, v52
    v_and_b32 v61, 0xffff0000, v52
    v_sqrt_f32 v61, v61
    v_cvt_pk_bf16_f32 v53, v56, v57
    v_lshlrev_b32 v56, 16, v53
    v_and_b32 v57, 0xffff0000, v53
    v_cvt_pk_bf16_f32 v52, v60, v61
    v_lshlrev_b32 v60, 16, v52
    v_and_b32 v61, 0xffff0000, v52
    v_cvt_pk_bf16_f32 v54, v58, v59
    v_lshlrev_b32 v58, 16, v54
    v_and_b32 v59, 0xffff0000, v54
    v_rcp_f32 v61, v61
    s_nop 0
    v_pk_mul_f32 v[56:57], v[56:57], v[60:61] op_sel:[0,1] op_sel_hi:[1,1]
    v_pk_mul_f32 v[58:59], v[58:59], v[60:61] op_sel:[0,1] op_sel_hi:[1,1]
    v_cvt_pk_bf16_f32 v52, v56, v57
    v_lshlrev_b32 v56, 16, v52
    v_and_b32 v57, 0xffff0000, v52
    v_cvt_pk_bf16_f32 v53, v58, v59
    v_lshlrev_b32_e64 v58, 16, v53
    v_and_b32 v59, 0xffff0000, v53
    v_pk_mul_f32 v[56:57], v[56:57], v[32:33]
    v_pk_mul_f32 v[58:59], v[58:59], v[34:35]
    v_cvt_pk_bf16_f32 v52, v56, v57
    v_lshlrev_b32_e64 v56, 16, v52
    v_and_b32 v57, 0xffff0000, v52
    v_cvt_pk_bf16_f32 v53, v58, v59
    v_lshlrev_b32_e64 v58, 16, v53
    v_and_b32 v59, 0xffff0000, v53
    v_pk_add_f32 v[56:57], v[56:57], v[28:29]
    v_pk_add_f32 v[58:59], v[58:59], v[30:31]
    v_cvt_pk_bf16_f32 v52, v56, v57
    v_cvt_pk_bf16_f32 v53, v58, v59
    s_mov_b64 exec, s[78:79]
    global_store_dwordx2 v6, v[52:53], s[50:51]
    s_mov_b64 exec, -1
    s_cmp_ge_u32 s31, 28
    s_cbranch_scc1 L_pff
    s_waitcnt vmcnt(0)
    s_mov_b32 s54, 0
L_paf:
    global_load_dwordx4 v[64:67], v2, s[52:53] offset:-4096 sc1
    global_load_dwordx4 v[68:71], v2, s[52:53] offset:-3072 sc1
    global_load_dwordx4 v[72:75], v2, s[52:53] offset:-2048 sc1
    global_load_dwordx4 v[76:79], v2, s[52:53] offset:-1024 sc1
    global_load_dwordx4 v[80:83], v2, s[52:53] offset:0 sc1
    global_load_dwordx4 v[84:87], v2, s[52:53] offset:1024 sc1
    global_load_dwordx4 v[88:91], v2, s[52:53] offset:2048 sc1
    global_load_dwordx4 v[92:95], v2, s[52:53] offset:3072 sc1
    s_add_u32 s54, s54, 1
    s_cmp_gt_u32 s54, 400000
    s_cbranch_scc1 L_end
    s_waitcnt vmcnt(7)
    ds_write_b128 v14, v[64:67] offset:0
    v_max_u32 v52, v64, v66
    s_waitcnt vmcnt(6)
    ds_write_b128 v14, v[68:71] offset:1056
    v_max3_u32 v52, v52, v68, v70
    s_waitcnt vmcnt(5)
    ds_write_b128 v14, v[72:75] offset:2112
    v_max3_u32 v52, v52, v72, v74
    s_waitcnt vmcnt(4)
    ds_write_b128 v14, v[76:79] offset:3168
    v_max3_u32 v52, v52, v76, v78
    s_waitcnt vmcnt(3)
    ds_write_b128 v14, v[80:83] offset:4224
    v_max3_u32 v52, v52, v80, v82
    s_waitcnt vmcnt(2)
    ds_write_b128 v14, v[84:87] offset:5280
    v_max3_u32 v52, v52, v84, v86
    s_waitcnt vmcnt(1)
    ds_write_b128 v14, v[88:91] offset:6336
    v_max3_u32 v52, v52, v88, v90
    s_waitcnt vmcnt(0)
    ds_write_b128 v14, v[92:95] offset:7392
    v_max3_u32 v52, v52, v92, v94
    v_cmp_eq_u32_e64 vcc, -1, v52
    s_cbranch_vccnz L_paf
    s_waitcnt lgkmcnt(0)
    s_barrier
    ds_read_b128 v[144:147], v15 offset:0
    ds_read_b128 v[148:151], v15 offset:64
    ds_read_b128 v[152:155], v15 offset:128
    ds_read_b128 v[156:159], v15 offset:192
    ds_read_b128 v[160:163], v15 offset:256
    ds_read_b128 v[164:167], v15 offset:320
    s_waitcnt lgkmcnt(5)
    v_mfma_f32_16x16x32_bf16 v[56:59], a[128:131], v[144:147], 0
    ds_read_b128 v[168:171], v15 offset:384
    s_waitcnt lgkmcnt(5)
    v_mfma_f32_16x16x32_bf16 v[56:59], a[132:135], v[148:151], v[56:59]
    ds_read_b128 v[172:175], v15 offset:448
    s_waitcnt lgkmcnt(5)
    v_mfma_f32_16x16x32_bf16 v[56:59], a[136:139], v[152:155], v[56:59]
    ds_read_b128 v[144:147], v15 offset:512
    s_waitcnt lgkmcnt(5)
    v_mfma_f32_16x16x32_bf16 v[56:59], a[140:143], v[156:159], v[56:59]
    ds_read_b128 v[148:151], v15 offset:576
    s_waitcnt lgkmcnt(5)
    v_mfma_f32_16x16x32_bf16 v[56:59], a[144:147], v[160:163], v[56:59]
    ds_read_b128 v[152:155], v15 offset:640
    s_waitcnt lgkmcnt(5)
    v_mfma_f32_16x16x32_bf16 v[56:59], a[148:151], v[164:167], v[56:59]
    ds_read_b128 v[156:159], v15 offset:704
    s_waitcnt lgkmcnt(5)
    v_mfma_f32_16x16x32_bf16 v[56:59], a[152:155], v[168:171], v[56:59]
    ds_read_b128 v[160:163], v15 offset:768
    s_waitcnt lgkmcnt(5)
    v_mfma_f32_16x16x32_bf16 v[56:59], a[156:159], v[172:175], v[56:59]
    ds_read_b128 v[164:167], v15 offset:832
    s_waitcnt lgkmcnt(5)
    v_mfma_f32_16x16x32_bf16 v[56:59], a[160:163], v[144:147], v[56:59]
    ds_read_b128 v[168:171], v15 offset:896
    s_waitcnt lgkmcnt(5)
    v_mfma_f32_16x16x32_bf16 v[56:59], a[164:167], v[148:151], v[56:59]
    ds_read_b128 v[172:175], v15 offset:960
    s_waitcnt lgkmcnt(5)
    v_mfma_f32_16x16x32_bf16 v[56:59], a[168:171], v[152:155], v[56:59]
    ds_read_b128 v[144:147], v15 offset:16896
    s_waitcnt lgkmcnt(5)
    v_mfma_f32_16x16x32_bf16 v[56:59], a[172:175], v[156:159], v[56:59]
    ds_read_b128 v[148:151], v15 offset:16960
    s_waitcnt lgkmcnt(5)
    v_mfma_f32_16x16x32_bf16 v[56:59], a[176:179], v[160:163], v[56:59]
    ds_read_b128 v[152:155], v15 offset:17024
    s_waitcnt lgkmcnt(5)
    v_mfma_f32_16x16x32_bf16 v[56:59], a[180:183], v[164:167], v[56:59]
    ds_read_b128 v[156:159], v15 offset:17088
    s_waitcnt lgkmcnt(5)
    v_mfma_f32_16x16x32_bf16 v[56:59], a[184:187], v[168:171], v[56:59]
    ds_read_b128 v[160:163], v15 offset:17152
    s_waitcnt lgkmcnt(5)
    v_mfma_f32_16x16x32_bf16 v[56:59], a[188:191], v[172:175], v[56:59]
    ds_read_b128 v[164:167], v15 offset:17216
    s_waitcnt lgkmcnt(5)
    v_mfma_f32_16x16x32_bf16 v[60:63], a[128:131], v[144:147], 0
    ds_read_b128 v[168:171], v15 offset:17280
    s_waitcnt lgkmcnt(5)
    v_mfma_f32_16x16x32_bf16 v[60:63], a[132:135], v[148:151], v[60:63]
    ds_read_b128 v[172:175], v15 offset:17344
    s_waitcnt lgkmcnt(5)
    v_mfma_f32_16x16x32_bf16 v[60:63], a[136:139], v[152:155], v[60:63]
    ds_read_b128 v[144:147], v15 offset:17408
    v_max_f32 v56, 0, v56
    v_max_f32 v57, 0, v57
    s_waitcnt lgkmcnt(5)
    v_mfma_f32_16x16x32_bf16 v[60:63], a[140:143], v[156:159], v[60:63]
    ds_read_b128 v[148:151], v15 offset:17472
    v_max_f32 v58, 0, v58
    v_max_f32_e64 v59, 0, v59
    s_waitcnt lgkmcnt(5)
    v_mfma_f32_16x16x32_bf16 v[60:63], a[144:147], v[160:163], v[60:63]
    ds_read_b128 v[152:155], v15 offset:17536
    v_cvt_pk_bf16_f32 v52, v56, v57
    v_cvt_pk_bf16_f32 v53, v58, v59
    s_waitcnt lgkmcnt(5)
    v_mfma_f32_16x16x32_bf16 v[60:63], a[148:151], v[164:167], v[60:63]
    ds_read_b128 v[156:159], v15 offset:17600
    ds_write_b64 v13, v[52:53] offset:0
    s_waitcnt lgkmcnt(6)
    v_mfma_f32_16x16x32_bf16 v[60:63], a[152:155], v[168:171], v[60:63]
    ds_read_b128 v[160:163], v15 offset:17664
    s_waitcnt lgkmcnt(6)
    v_mfma_f32_16x16x32_bf16 v[60:63], a[156:159], v[172:175], v[60:63]
    ds_read_b128 v[164:167], v15 offset:17728
    s_waitcnt lgkmcnt(6)
    v_mfma_f32_16x16x32_bf16 v[60:63], a[160:163], v[144:147], v[60:63]
    ds_read_b128 v[168:171], v15 offset:17792
    s_waitcnt lgkmcnt(6)
    v_mfma_f32_16x16x32_bf16 v[60:63], a[164:167], v[148:151], v[60:63]
    ds_read_b128 v[172:175], v15 offset:17856
    s_waitcnt lgkmcnt(6)
    v_mfma_f32_16x16x32_bf16 v[60:63], a[168:171], v[152:155], v[60:63]
    s_waitcnt lgkmcnt(4)
    s_barrier
    ds_read_b128 v[128:131], v2 offset:16384
    ds_read_b128 v[132:135], v2 offset:17408
    v_mfma_f32_16x16x32_bf16 v[60:63], a[172:175], v[156:159], v[60:63]
    s_waitcnt lgkmcnt(5)
    v_mfma_f32_16x16x32_bf16 v[60:63], a[176:179], v[160:163], v[60:63]
    s_waitcnt lgkmcnt(4)
    v_mfma_f32_16x16x32_bf16 v[60:63], a[180:183], v[164:167], v[60:63]
    s_waitcnt lgkmcnt(3)
    v_mfma_f32_16x16x32_bf16 v[60:63], a[184:187], v[168:171], v[60:63]
    s_waitcnt lgkmcnt(2)
    v_mfma_f32_16x16x32_bf16 v[60:63], a[188:191], v[172:175], v[60:63]
    s_waitcnt lgkmcnt(1)
    v_mfma_f32_16x16x32_bf16 v[64:67], v[128:131], a[192:195], 0
    s_nop 2
    s_waitcnt lgkmcnt(0)
    v_mfma_f32_16x16x32_bf16 v[64:67], v[132:135], a[196:199], v[64:67]
    s_nop 0
    v_max_f32 v60, 0, v60
    v_max_f32 v61, 0, v61
    v_mfma_f32_16x16x32_bf16 v[68:71], v[128:131], a[200:203], 0
    v_max_f32 v62, 0, v62
    v_max_f32 v63, 0, v63
    v_mfma_f32_16x16x32_bf16 v[68:71], v[132:135], a[204:207], v[68:71]
    v_cvt_pk_bf16_f32 v54, v60, v61
    v_cvt_pk_bf16_f32 v55, v62, v63
    v_mfma_f32_16x16x32_bf16 v[72:75], v[128:131], a[208:211], 0
    ds_write_b64 v13, v[54:55] offset:2048
    v_mfma_f32_16x16x32_bf16 v[72:75], v[132:135], a[212:215], v[72:75]
    v_mfma_f32_16x16x32_bf16 v[76:79], v[128:131], a[216:219], 0
    v_mfma_f32_16x16x32_bf16 v[76:79], v[132:135], a[220:223], v[76:79]
    s_nop 0
    v_cvt_pk_bf16_f32 v204, v64, v68
    v_cvt_pk_bf16_f32 v208, v65, v69
    v_mfma_f32_16x16x32_bf16 v[80:83], v[128:131], a[224:227], 0
    v_cvt_pk_bf16_f32 v212, v66, v70
    v_cvt_pk_bf16_f32 v216, v67, v71
    v_mfma_f32_16x16x32_bf16 v[80:83], v[132:135], a[228:231], v[80:83]
    s_waitcnt lgkmcnt(0)
    s_barrier
    ds_read_b128 v[136:139], v2 offset:18432
    ds_read_b128 v[140:143], v2 offset:19456
    v_and_or_b32 v204, v204, -2, 1
    v_and_or_b32 v208, v208, -2, 1
    v_mfma_f32_16x16x32_bf16 v[84:87], v[128:131], a[232:235], 0
    v_and_or_b32 v212, v212, -2, 1
    v_and_or_b32 v216, v216, -2, 1
    v_mfma_f32_16x16x32_bf16 v[84:87], v[132:135], a[236:239], v[84:87]
    v_cvt_pk_bf16_f32 v205, v72, v76
    v_cvt_pk_bf16_f32 v209, v73, v77
    v_mfma_f32_16x16x32_bf16 v[88:91], v[128:131], a[240:243], 0
    v_cvt_pk_bf16_f32 v213, v74, v78
    v_cvt_pk_bf16_f32 v217, v75, v79
    v_mfma_f32_16x16x32_bf16 v[88:91], v[132:135], a[244:247], v[88:91]
    v_mfma_f32_16x16x32_bf16 v[92:95], v[128:131], a[248:251], 0
    v_mfma_f32_16x16x32_bf16 v[92:95], v[132:135], a[252:255], v[92:95]
    v_cvt_pk_bf16_f32 v206, v80, v84
    v_cvt_pk_bf16_f32 v210, v81, v85
    v_cvt_pk_bf16_f32 v214, v82, v86
    v_cvt_pk_bf16_f32 v218, v83, v87
    s_waitcnt lgkmcnt(1)
    v_mfma_f32_16x16x32_bf16 v[96:99], v[136:139], a[192:195], 0
    s_nop 0
    s_nop 1
    s_waitcnt lgkmcnt(0)
    v_mfma_f32_16x16x32_bf16 v[96:99], v[140:143], a[196:199], v[96:99]
    s_nop 0
    v_cvt_pk_bf16_f32 v207, v88, v92
    v_cvt_pk_bf16_f32 v211, v89, v93
    v_mfma_f32_16x16x32_bf16 v[100:103], v[136:139], a[200:203], 0
    v_cvt_pk_bf16_f32 v215, v90, v94
    v_cvt_pk_bf16_f32 v219, v91, v95
    v_mfma_f32_16x16x32_bf16 v[100:103], v[140:143], a[204:207], v[100:103]
    s_add_u32 s56, s46, 0
    s_addc_u32 s57, s47, 0
    global_store_dwordx4 v7, v[204:207], s[56:57]
    v_mfma_f32_16x16x32_bf16 v[104:107], v[136:139], a[208:211], 0
    s_add_u32 s56, s46, 32768
    s_addc_u32 s57, s47, 0
    global_store_dwordx4 v7, v[208:211], s[56:57]
    v_mfma_f32_16x16x32_bf16 v[104:107], v[140:143], a[212:215], v[104:107]
    s_add_u32 s56, s46, 65536
    s_addc_u32 s57, s47, 0
    global_store_dwordx4 v7, v[212:215], s[56:57]
    v_mfma_f32_16x16x32_bf16 v[108:111], v[136:139], a[216:219], 0
    s_add_u32 s56, s46, 98304
    s_addc_u32 s57, s47, 0
    global_store_dwordx4 v7, v[216:219], s[56:57]
    v_mfma_f32_16x16x32_bf16 v[108:111], v[140:143], a[220:223], v[108:111]
    v_cvt_pk_bf16_f32 v220, v96, v100
    v_cvt_pk_bf16_f32 v224, v97, v101
    v_mfma_f32_16x16x32_bf16 v[112:115], v[136:139], a[224:227], 0
    v_cvt_pk_bf16_f32 v228, v98, v102
    v_cvt_pk_bf16_f32 v232, v99, v103
    v_mfma_f32_16x16x32_bf16 v[112:115], v[140:143], a[228:231], v[112:115]
    v_and_or_b32 v220, v220, -2, 1
    v_and_or_b32 v224, v224, -2, 1
    v_mfma_f32_16x16x32_bf16 v[116:119], v[136:139], a[232:235], 0
    v_and_or_b32 v228, v228, -2, 1
    v_and_or_b32 v232, v232, -2, 1
    v_mfma_f32_16x16x32_bf16 v[116:119], v[140:143], a[236:239], v[116:119]
    v_cvt_pk_bf16_f32 v221, v104, v108
    v_cvt_pk_bf16_f32 v225, v105, v109
    v_mfma_f32_16x16x32_bf16 v[120:123], v[136:139], a[240:243], 0
    v_cvt_pk_bf16_f32 v229, v106, v110
    v_cvt_pk_bf16_f32 v233, v107, v111
    v_mfma_f32_16x16x32_bf16 v[120:123], v[140:143], a[244:247], v[120:123]
    v_mfma_f32_16x16x32_bf16 v[124:127], v[136:139], a[248:251], 0
    v_mfma_f32_16x16x32_bf16 v[124:127], v[140:143], a[252:255], v[124:127]
    v_cvt_pk_bf16_f32 v222, v112, v116
    v_cvt_pk_bf16_f32 v226, v113, v117
    v_cvt_pk_bf16_f32 v230, v114, v118
    v_cvt_pk_bf16_f32 v234, v115, v119
    s_nop 3
    v_cvt_pk_bf16_f32 v223, v120, v124
    s_add_u32 s56, s46, 524288
    s_addc_u32 s57, s47, 0
    global_store_dwordx4 v7, v[220:223], s[56:57]
    v_cvt_pk_bf16_f32 v227, v121, v125
    s_add_u32 s56, s46, 557056
    s_addc_u32 s57, s47, 0
    global_store_dwordx4 v7, v[224:227], s[56:57]
    v_cvt_pk_bf16_f32 v231, v122, v126
    s_add_u32 s56, s46, 589824
    s_addc_u32 s57, s47, 0
    global_store_dwordx4 v7, v[228:231], s[56:57]
    v_cvt_pk_bf16_f32 v235, v123, v127
    s_add_u32 s56, s46, 622592
    s_addc_u32 s57, s47, 0
    global_store_dwordx4 v7, v[232:235], s[56:57]
L_pff:
    s_waitcnt vmcnt(0)
    s_mov_b32 s54, 0
L_pr2f:
    s_add_u32 s56, s48, 4096
    s_addc_u32 s57, s49, 0
    global_load_dwordx4 v[64:67], v8, s[56:57] offset:-4096 sc1
    global_load_dwordx4 v[68:71], v8, s[56:57] offset:0 sc1
    s_add_u32 s56, s48, 12288
    s_addc_u32 s57, s49, 0
    global_load_dwordx4 v[72:75], v8, s[56:57] offset:-4096 sc1
    global_load_dwordx4 v[76:79], v8, s[56:57] offset:0 sc1
    s_add_u32 s56, s48, 20480
    s_addc_u32 s57, s49, 0
    global_load_dwordx4 v[80:83], v8, s[56:57] offset:-4096 sc1
    global_load_dwordx4 v[84:87], v8, s[56:57] offset:0 sc1
    s_add_u32 s56, s48, 28672
    s_addc_u32 s57, s49, 0
    global_load_dwordx4 v[88:91], v8, s[56:57] offset:-4096 sc1
    s_add_u32 s54, s54, 1
    s_cmp_gt_u32 s54, 400000
    s_cbranch_scc1 L_end
    s_waitcnt vmcnt(6)
    v_mfma_f32_16x16x32_bf16 v[56:59], v[64:67], v[20:23], 0
    v_xor_b32_e64 v52, 1, v64
    s_waitcnt vmcnt(5)
    v_mfma_f32_16x16x32_bf16 v[56:59], v[68:71], v[20:23], v[56:59]
    v_bitop3_b32 v52, v52, 1, v68 bitop3:0xf6
    s_waitcnt vmcnt(4)
    v_mfma_f32_16x16x32_bf16 v[56:59], v[72:75], v[20:23], v[56:59]
    v_bitop3_b32 v52, v52, 1, v72 bitop3:0xf6
    s_waitcnt vmcnt(3)
    v_mfma_f32_16x16x32_bf16 v[56:59], v[76:79], v[20:23], v[56:59]
    v_bitop3_b32 v52, v52, 1, v76 bitop3:0xf6
    s_waitcnt vmcnt(2)
    v_mfma_f32_16x16x32_bf16 v[56:59], v[80:83], v[20:23], v[56:59]
    v_bitop3_b32 v52, v52, 1, v80 bitop3:0xf6
    s_waitcnt vmcnt(1)
    v_mfma_f32_16x16x32_bf16 v[56:59], v[84:87], v[20:23], v[56:59]
    v_bitop3_b32 v52, v52, 1, v84 bitop3:0xf6
    s_waitcnt vmcnt(0)
    v_mfma_f32_16x16x32_bf16 v[56:59], v[88:91], v[20:23], v[56:59]
    v_bitop3_b32 v52, v52, 1, v88 bitop3:0xf6
    v_and_b32 v52, 1, v52
    v_cmp_ne_u32 vcc, 0, v52
    s_cbranch_vccnz L_pr2f
    s_nop 3
    v_cvt_pk_bf16_f32 v52, v56, v57
    v_lshlrev_b32 v56, 16, v52
    v_and_b32 v57, 0xffff0000, v52
    v_cvt_pk_bf16_f32 v53, v58, v59
    v_lshlrev_b32_e64 v58, 16, v53
    v_and_b32 v59, 0xffff0000, v53
    v_pk_mul_f32 v[56:57], v[56:57], v[36:37]
    v_pk_mul_f32 v[58:59], v[58:59], v[38:39]
    v_cvt_pk_bf16_f32 v52, v56, v57
    v_lshlrev_b32 v56, 16, v52
    v_and_b32 v57, 0xffff0000, v52
    v_cvt_pk_bf16_f32 v53, v58, v59
    v_lshlrev_b32 v58, 16, v53
    v_and_b32 v59, 0xffff0000, v53
    v_pk_add_f32 v[56:57], v[56:57], v[40:41]
    v_pk_add_f32 v[58:59], v[58:59], v[42:43]
    v_cvt_pk_bf16_f32 v52, v56, v57
    v_cvt_pk_bf16_f32 v53, v58, v59
    s_mov_b64 exec, s[78:79]
    global_store_dwordx2 v6, v[52:53], s[44:45]
    global_store_dwordx2 v6, v[48:49], s[50:51]
    s_mov_b64 exec, -1
    s_lshl_b32 s56, s20, 12
    s_add_u32 s40, s40, s56
    s_addc_u32 s41, s41, 0
    s_lshl_b32 s56, s20, 15
    s_add_u32 s44, s44, s56
    s_addc_u32 s45, s45, 0
    s_xor_b32 s35, s35, 1
    s_cmp_ge_u32 s31, 28
    s_cselect_b32 s10, s35, 0
    s_mov_b32 s34, s11
    s_cmp_lt_u32 s34, 64
    s_cbranch_scc1 L_plf
    s_branch L_pend
L_pslow:
    v_mov_b32 v47, 0
    s_add_u32 s58, s34, 1
    s_mov_b64 exec, 7
    s_mov_b32 s54, 0
    s_branch L_pz1s
L_pz0s:
    s_sleep 8
    global_load_dword v47, v19, s[4:5] sc1
    s_add_u32 s54, s54, 1
    s_cmp_gt_u32 s54, 400000
    s_cbranch_scc1 L_end
    s_waitcnt vmcnt(0)
L_pz1s:
    v_cmp_gt_u32 vcc, s58, v47
    s_cbranch_vccnz L_pz0s
    s_mov_b64 exec, -1
    s_mov_b32 m0, s12
    global_load_dwordx2 v[44:45], v6, s[42:43]
    global_load_lds_dwordx4 v2, s[36:37] offset:0 sc1
    global_load_lds_dwordx4 v2, s[36:37] offset:1024 sc1
    s_mov_b32 m0, s13
    s_nop 0
    global_load_lds_dwordx4 v2, s[38:39] offset:0 sc1
    global_load_lds_dwordx4 v2, s[38:39] offset:1024 sc1
    global_load_lds_dwordx4 v2, s[38:39] offset:2048 sc1
    global_load_lds_dwordx4 v2, s[38:39] offset:3072 sc1
    s_waitcnt vmcnt(0)
    s_barrier
    s_branch L_pls
.p2align 6
L_pls:
    v_lshlrev_b32 v63, 7, v1
    global_load_dword v47, v19, s[4:5] sc1
    global_load_dword v62, v63, s[52:53] offset:-4096 sc1
    global_load_dwordx4 v[180:183], v2, s[40:41] sc1
    s_bitset0_b64 s[22:23], s34
    s_ff1_i32_b64 s11, s[22:23]
    s_min_u32 s11, s11, 64
    s_sub_u32 s20, s11, s34
    s_lshl_b32 s56, s20, 13
    s_add_u32 s36, s36, s56
    s_addc_u32 s37, s37, 0
    s_lshl_b32 s56, s20, 14
    s_add_u32 s38, s38, s56
    s_addc_u32 s39, s39, 0
    s_lshl_b32 s56, s20, 15
    s_add_u32 s42, s42, s56
    s_addc_u32 s43, s43, 0
    ds_read_b128 v[188:191], v3 offset:0
    ds_read_b128 v[204:207], v4 offset:0
    ds_read_b128 v[220:223], v4 offset:128
    ds_read_b128 v[192:195], v3 offset:2048
    ds_read_b128 v[208:211], v4 offset:2048
    ds_read_b128 v[224:227], v4 offset:2176
    ds_read_b128 v[196:199], v3 offset:4096
    ds_read_b128 v[212:215], v4 offset:4096
    ds_read_b128 v[228:231], v4 offset:4224
    ds_read_b128 v[200:203], v3 offset:6144
    ds_read_b128 v[216:219], v4 offset:6144
    ds_read_b128 v[232:235], v4 offset:6272
    s_waitcnt lgkmcnt(10)
    v_mfma_f32_16x16x32_bf16 v[128:131], v[204:207], v[188:191], 0
    s_waitcnt lgkmcnt(9)
    v_mfma_f32_16x16x32_bf16 v[132:135], v[220:223], v[188:191], 0
    s_waitcnt lgkmcnt(7)
    v_mfma_f32_16x16x32_bf16 v[128:131], v[208:211], v[192:195], v[128:131]
    s_waitcnt lgkmcnt(6)
    v_mfma_f32_16x16x32_bf16 v[132:135], v[224:227], v[192:195], v[132:135]
    s_waitcnt lgkmcnt(4)
    v_mfma_f32_16x16x32_bf16 v[128:131], v[212:215], v[196:199], v[128:131]
    s_waitcnt lgkmcnt(3)
    v_mfma_f32_16x16x32_bf16 v[132:135], v[228:231], v[196:199], v[132:135]
    s_waitcnt lgkmcnt(1)
    v_mfma_f32_16x16x32_bf16 v[128:131], v[216:219], v[200:203], v[128:131]
    s_waitcnt lgkmcnt(0)
    v_mfma_f32_16x16x32_bf16 v[132:135], v[232:235], v[200:203], v[132:135]
    ds_read_b128 v[236:239], v5 offset:0
    ds_read_b128 v[240:243], v5 offset:256
    ds_read_b128 v[244:247], v5 offset:2048
    ds_read_b128 v[248:251], v5 offset:2304
    v_lshlrev_b32 v40, 16, v44
    v_and_b32 v41, 0xffff0000, v44
    v_lshlrev_b32 v42, 16, v45
    v_and_b32 v43, 0xffff0000, v45
    v_cvt_pk_bf16_f32 v52, v128, v129
    v_lshlrev_b32_e64 v128, 16, v52
    v_and_b32 v129, 0xffff0000, v52
    v_cvt_pk_bf16_f32 v53, v130, v131
    v_lshlrev_b32 v130, 16, v53
    v_and_b32 v131, 0xffff0000, v53
    v_cvt_pk_bf16_f32 v54, v132, v133
    v_lshlrev_b32 v132, 16, v54
    v_and_b32 v133, 0xffff0000, v54
    v_cvt_pk_bf16_f32 v55, v134, v135
    v_lshlrev_b32_e64 v134, 16, v55
    v_and_b32 v135, 0xffff0000, v55
    v_pk_mul_f32 v[128:129], v[128:129], s[8:9]
    v_pk_mul_f32 v[130:131], v[130:131], s[8:9]
    v_pk_mul_f32 v[132:133], v[132:133], s[8:9]
    v_pk_mul_f32 v[134:135], v[134:135], s[8:9]
    v_cvt_pk_bf16_f32 v52, v128, v129
    v_lshlrev_b32 v128, 16, v52
    v_and_b32 v129, 0xffff0000, v52
    v_cvt_pk_bf16_f32 v53, v130, v131
    v_lshlrev_b32 v130, 16, v53
    v_and_b32 v131, 0xffff0000, v53
    v_cvt_pk_bf16_f32 v54, v132, v133
    v_lshlrev_b32_e64 v132, 16, v54
    v_and_b32 v133, 0xffff0000, v54
    v_cvt_pk_bf16_f32 v55, v134, v135
    v_lshlrev_b32_e64 v134, 16, v55
    v_and_b32 v135, 0xffff0000, v55
    v_cndmask_b32 v128, v46, v128, s[62:63]
    v_cndmask_b32 v129, v46, v129, s[64:65]
    v_cndmask_b32 v130, v46, v130, s[66:67]
    v_cndmask_b32 v131, v46, v131, s[68:69]
    v_cndmask_b32 v132, v46, v132, s[70:71]
    v_cndmask_b32 v133, v46, v133, s[72:73]
    v_cndmask_b32 v134, v46, v134, s[74:75]
    v_cndmask_b32 v135, v46, v135, s[76:77]
    v_max3_f32 v140, v128, v129, v130
    v_max3_f32 v140, v140, v131, v132
    v_max3_f32 v140, v140, v133, v134
    v_max_f32 v140, v140, v135
    v_mov_b32 v52, v140
    s_nop 1
    v_permlane16_swap_b32 v140, v52
    v_max_f32 v140, v140, v52
    v_mov_b32 v52, v140
    s_nop 1
    v_permlane32_swap_b32 v140, v52
    v_max_f32_e64 v140, v140, v52
    v_pk_add_f32 v[128:129], v[128:129], v[140:141] op_sel:[0,0] op_sel_hi:[1,0] neg_lo:[0,1] neg_hi:[0,1]
    v_pk_add_f32 v[130:131], v[130:131], v[140:141] op_sel:[0,0] op_sel_hi:[1,0] neg_lo:[0,1] neg_hi:[0,1]
    v_pk_add_f32 v[132:133], v[132:133], v[140:141] op_sel:[0,0] op_sel_hi:[1,0] neg_lo:[0,1] neg_hi:[0,1]
    v_pk_add_f32 v[134:135], v[134:135], v[140:141] op_sel:[0,0] op_sel_hi:[1,0] neg_lo:[0,1] neg_hi:[0,1]
    v_pk_mul_f32 v[128:129], v[128:129], s[6:7]
    v_pk_mul_f32 v[130:131], v[130:131], s[6:7]
    v_pk_mul_f32 v[132:133], v[132:133], s[6:7]
    v_pk_mul_f32 v[134:135], v[134:135], s[6:7]
    v_exp_f32 v128, v128
    v_exp_f32 v129, v129
    v_exp_f32 v130, v130
    v_exp_f32 v131, v131
    v_exp_f32 v132, v132
    v_exp_f32 v133, v133
    v_exp_f32 v134, v134
    v_exp_f32 v135, v135
    v_pk_add_f32 v[52:53], v[128:129], v[130:131]
    v_pk_add_f32 v[54:55], v[132:133], v[134:135]
    v_pk_add_f32 v[52:53], v[52:53], v[54:55]
    v_add_f32 v141, v52, v53
    v_mov_b32 v52, v141
    s_nop 1
    v_permlane16_swap_b32 v141, v52
    v_add_f32 v141, v141, v52
    v_mov_b32 v52, v141
    s_nop 1
    v_permlane32_swap_b32 v141, v52
    v_add_f32_e64 v141, v141, v52
    s_waitcnt vmcnt(0) lgkmcnt(0)
    s_add_u32 s58, s11, 1
    s_min_u32 s58, s58, 64
    s_mov_b64 exec, 7
    s_mov_b32 s54, 0
    s_branch L_pg1s
L_pg0s:
    s_sleep 8
    global_load_dword v47, v19, s[4:5] sc1
    s_add_u32 s54, s54, 1
    s_cmp_gt_u32 s54, 400000
    s_cbranch_scc1 L_end
    s_waitcnt vmcnt(0)
L_pg1s:
    v_cmp_gt_u32 vcc, s58, v47
    s_cbranch_vccnz L_pg0s
    s_mov_b64 exec, -1
    s_mov_b32 s54, 0
    s_branch L_pd1s
L_pd0s:
    global_load_dword v62, v63, s[52:53] offset:-4096 sc1
    s_add_u32 s54, s54, 1
    s_cmp_gt_u32 s54, 400000
    s_cbranch_scc1 L_end
    s_waitcnt vmcnt(0)
L_pd1s:
    v_cmp_ne_u32 vcc, -1, v62
    s_cbranch_vccnz L_pd0s
    s_mov_b32 s54, 0
    s_branch L_pk1s
L_pk0s:
    global_load_dwordx4 v[180:183], v2, s[40:41] sc1
    s_sleep 1
    s_add_u32 s54, s54, 1
    s_cmp_gt_u32 s54, 400000
    s_cbranch_scc1 L_end
    s_waitcnt vmcnt(2)
L_pk1s:
    v_max3_u32 v52, v180, v181, v182
    v_max_u32_e64 v52, v52, v183
    v_cmp_eq_u32_e64 vcc, -1, v52
    s_cbranch_vccnz L_pk0s
    ds_write2_b32 v9, v180, v181 offset0:0 offset1:4
    ds_write2_b32 v9, v182, v183 offset0:8 offset1:12
    s_waitcnt lgkmcnt(0)
    s_barrier
    ds_read_b64_tr_b16 v[144:145], v10 offset:0
    ds_read_b64_tr_b16 v[146:147], v10 offset:144
    ds_read_b64_tr_b16 v[148:149], v10 offset:1152
    ds_read_b64_tr_b16 v[150:151], v10 offset:1296
    ds_read_b64_tr_b16 v[152:153], v10 offset:2304
    ds_read_b64_tr_b16 v[154:155], v10 offset:2448
    ds_read_b64_tr_b16 v[156:157], v10 offset:3456
    ds_read_b64_tr_b16 v[158:159], v10 offset:3600
    s_cmp_ge_u32 s11, 64
    s_cbranch_scc1 L_pns
    s_mov_b32 m0, s12
    global_load_dwordx2 v[44:45], v6, s[42:43]
    global_load_lds_dwordx4 v2, s[36:37] offset:0 sc1
    global_load_lds_dwordx4 v2, s[36:37] offset:1024 sc1
    s_mov_b32 m0, s13
    s_nop 0
    global_load_lds_dwordx4 v2, s[38:39] offset:0 sc1
    global_load_lds_dwordx4 v2, s[38:39] offset:1024 sc1
    global_load_lds_dwordx4 v2, s[38:39] offset:2048 sc1
    global_load_lds_dwordx4 v2, s[38:39] offset:3072 sc1
L_pns:
    s_waitcnt lgkmcnt(6)
    v_mfma_f32_16x16x32_bf16 v[136:139], v[144:147], v[188:191], 0
    ds_read_b64 v[160:161], v11 offset:0
    s_waitcnt lgkmcnt(5)
    v_mfma_f32_16x16x32_bf16 v[136:139], v[148:151], v[192:195], v[136:139]
    ds_read_b64 v[162:163], v11 offset:16
    s_waitcnt lgkmcnt(4)
    v_mfma_f32_16x16x32_bf16 v[136:139], v[152:155], v[196:199], v[136:139]
    ds_read_b64 v[164:165], v11 offset:1152
    s_waitcnt lgkmcnt(3)
    v_mfma_f32_16x16x32_bf16 v[136:139], v[156:159], v[200:203], v[136:139]
    ds_read_b64 v[166:167], v11 offset:1168
    s_nop 6
    v_cvt_pk_bf16_f32 v52, v136, v137
    v_lshlrev_b32 v136, 16, v52
    v_and_b32 v137, 0xffff0000, v52
    v_cvt_pk_bf16_f32 v53, v138, v139
    v_lshlrev_b32_e64 v138, 16, v53
    v_and_b32 v139, 0xffff0000, v53
    v_pk_mul_f32 v[136:137], v[136:137], s[8:9]
    v_pk_mul_f32 v[138:139], v[138:139], s[8:9]
    v_cvt_pk_bf16_f32 v52, v136, v137
    v_lshlrev_b32 v136, 16, v52
    v_and_b32 v137, 0xffff0000, v52
    v_cvt_pk_bf16_f32 v53, v138, v139
    v_lshlrev_b32 v138, 16, v53
    v_and_b32 v139, 0xffff0000, v53
    v_max3_f32 v60, v140, v136, v137
    v_max3_f32 v60, v60, v138, v139
    v_mov_b32 v52, v60
    s_nop 1
    v_permlane16_swap_b32 v60, v52
    v_max_f32 v60, v60, v52
    v_pk_add_f32 v[136:137], v[136:137], v[60:61] op_sel:[0,0] op_sel_hi:[1,0] neg_lo:[0,1] neg_hi:[0,1]
    v_pk_add_f32 v[138:139], v[138:139], v[60:61] op_sel:[0,0] op_sel_hi:[1,0] neg_lo:[0,1] neg_hi:[0,1]
    v_sub_f32_e64 v140, v140, v60
    v_pk_mul_f32 v[136:137], v[136:137], s[6:7]
    v_pk_mul_f32 v[138:139], v[138:139], s[6:7]
    v_mul_f32 v140, s6, v140
    v_exp_f32 v136, v136
    v_exp_f32 v137, v137
    v_exp_f32 v138, v138
    v_exp_f32 v139, v139
    v_exp_f32 v140, v140
    v_pk_add_f32 v[52:53], v[136:137], v[138:139]
    v_add_f32 v61, v52, v53
    v_mov_b32 v52, v61
    s_nop 1
    v_permlane16_swap_b32 v61, v52
    v_add_f32 v61, v61, v52
    v_fmac_f32 v61, v140, v141
    v_rcp_f32 v61, v61
    s_nop 0
    v_mul_f32 v60, v61, v140
    v_mul_f32 v61, v61, v18
    v_pk_mul_f32 v[128:129], v[128:129], v[60:61] op_sel:[0,0] op_sel_hi:[1,0]
    v_pk_mul_f32 v[130:131], v[130:131], v[60:61] op_sel:[0,0] op_sel_hi:[1,0]
    v_pk_mul_f32 v[132:133], v[132:133], v[60:61] op_sel:[0,0] op_sel_hi:[1,0]
    v_pk_mul_f32 v[134:135], v[134:135], v[60:61] op_sel:[0,0] op_sel_hi:[1,0]
    v_pk_mul_f32 v[136:137], v[136:137], v[60:61] op_sel:[0,1] op_sel_hi:[1,1]
    v_pk_mul_f32 v[138:139], v[138:139], v[60:61] op_sel:[0,1] op_sel_hi:[1,1]
    v_cvt_pk_bf16_f32 v172, v128, v129
    v_cvt_pk_bf16_f32 v173, v130, v131
    v_cvt_pk_bf16_f32 v174, v132, v133
    v_cvt_pk_bf16_f32 v175, v134, v135
    v_cvt_pk_bf16_f32 v176, v136, v137
    v_cvt_pk_bf16_f32 v177, v138, v139
    v_mfma_f32_16x16x32_bf16 v[64:67], v[236:239], v[172:175], 0
    v_mfma_f32_16x16x32_bf16 v[68:71], v[240:243], v[172:175], 0
    s_waitcnt lgkmcnt(3)
    v_mfma_f32_16x16x16_bf16 v[64:67], v[160:161], v[176:177], v[64:67]
    s_waitcnt lgkmcnt(2)
    v_mfma_f32_16x16x16_bf16 v[68:71], v[162:163], v[176:177], v[68:71]
    v_mfma_f32_16x16x32_bf16 v[72:75], v[244:247], v[172:175], 0
    v_mfma_f32_16x16x32_bf16 v[76:79], v[248:251], v[172:175], 0
    s_waitcnt lgkmcnt(1)
    v_mfma_f32_16x16x16_bf16 v[72:75], v[164:165], v[176:177], v[72:75]
    s_waitcnt lgkmcnt(0)
    v_mfma_f32_16x16x16_bf16 v[76:79], v[166:167], v[176:177], v[76:79]
    v_cvt_pk_bf16_f32 v52, v64, v65
    v_cvt_pk_bf16_f32 v53, v66, v67
    v_cvt_pk_bf16_f32 v54, v68, v69
    v_cvt_pk_bf16_f32 v55, v70, v71
    ds_write_b128 v12, v[52:55] offset:0
    s_nop 0
    v_cvt_pk_bf16_f32 v56, v72, v73
    v_cvt_pk_bf16_f32 v57, v74, v75
    v_cvt_pk_bf16_f32 v58, v76, v77
    v_cvt_pk_bf16_f32 v59, v78, v79
    ds_write_b128 v12, v[56:59] offset:1024
    s_waitcnt lgkmcnt(0)
    s_barrier
    ds_read_b128 v[128:131], v2 offset:8192
    ds_read_b128 v[132:135], v2 offset:9216
    ds_read_b128 v[136:139], v2 offset:10240
    ds_read_b128 v[140:143], v2 offset:11264
    ds_read_b128 v[144:147], v2 offset:12288
    ds_read_b128 v[148:151], v2 offset:13312
    ds_read_b128 v[152:155], v2 offset:14336
    ds_read_b128 v[156:159], v2 offset:15360
    s_waitcnt lgkmcnt(7)
    v_mfma_f32_16x16x32_bf16 v[64:67], v[128:131], a[0:3], 0
    s_waitcnt lgkmcnt(6)
    v_mfma_f32_16x16x32_bf16 v[64:67], v[132:135], a[4:7], v[64:67]
    s_waitcnt lgkmcnt(5)
    v_mfma_f32_16x16x32_bf16 v[64:67], v[136:139], a[8:11], v[64:67]
    s_waitcnt lgkmcnt(4)
    v_mfma_f32_16x16x32_bf16 v[64:67], v[140:143], a[12:15], v[64:67]
    v_mfma_f32_16x16x32_bf16 v[68:71], v[128:131], a[16:19], 0
    v_mfma_f32_16x16x32_bf16 v[68:71], v[132:135], a[20:23], v[68:71]
    v_mfma_f32_16x16x32_bf16 v[68:71], v[136:139], a[24:27], v[68:71]
    v_mfma_f32_16x16x32_bf16 v[68:71], v[140:143], a[28:31], v[68:71]
    v_mfma_f32_16x16x32_bf16 v[72:75], v[128:131], a[32:35], 0
    v_mfma_f32_16x16x32_bf16 v[72:75], v[132:135], a[36:39], v[72:75]
    v_mfma_f32_16x16x32_bf16 v[72:75], v[136:139], a[40:43], v[72:75]
    v_mfma_f32_16x16x32_bf16 v[72:75], v[140:143], a[44:47], v[72:75]
    v_mfma_f32_16x16x32_bf16 v[76:79], v[128:131], a[48:51], 0
    s_nop 2
    v_cvt_pk_bf16_f32 v204, v64, v68
    v_cvt_pk_bf16_f32 v208, v65, v69
    v_mfma_f32_16x16x32_bf16 v[76:79], v[132:135], a[52:55], v[76:79]
    v_cvt_pk_bf16_f32 v212, v66, v70
    v_cvt_pk_bf16_f32 v216, v67, v71
    v_mfma_f32_16x16x32_bf16 v[76:79], v[136:139], a[56:59], v[76:79]
    v_and_or_b32 v204, v204, -2, s10
    v_and_or_b32 v208, v208, -2, s10
    v_mfma_f32_16x16x32_bf16 v[76:79], v[140:143], a[60:63], v[76:79]
    v_and_or_b32 v212, v212, -2, s10
    v_and_or_b32 v216, v216, -2, s10
    v_mfma_f32_16x16x32_bf16 v[80:83], v[128:131], a[64:67], 0
    v_mfma_f32_16x16x32_bf16 v[80:83], v[132:135], a[68:71], v[80:83]
    v_mfma_f32_16x16x32_bf16 v[80:83], v[136:139], a[72:75], v[80:83]
    v_mfma_f32_16x16x32_bf16 v[80:83], v[140:143], a[76:79], v[80:83]
    v_mfma_f32_16x16x32_bf16 v[84:87], v[128:131], a[80:83], 0
    s_nop 0
    v_cvt_pk_bf16_f32 v205, v72, v76
    v_cvt_pk_bf16_f32 v209, v73, v77
    v_mfma_f32_16x16x32_bf16 v[84:87], v[132:135], a[84:87], v[84:87]
    v_cvt_pk_bf16_f32 v213, v74, v78
    v_cvt_pk_bf16_f32 v217, v75, v79
    v_mfma_f32_16x16x32_bf16 v[84:87], v[136:139], a[88:91], v[84:87]
    v_mfma_f32_16x16x32_bf16 v[84:87], v[140:143], a[92:95], v[84:87]
    v_mfma_f32_16x16x32_bf16 v[88:91], v[128:131], a[96:99], 0
    v_mfma_f32_16x16x32_bf16 v[88:91], v[132:135], a[100:103], v[88:91]
    v_mfma_f32_16x16x32_bf16 v[88:91], v[136:139], a[104:107], v[88:91]
    v_mfma_f32_16x16x32_bf16 v[88:91], v[140:143], a[108:111], v[88:91]
    v_mfma_f32_16x16x32_bf16 v[92:95], v[128:131], a[112:115], 0
    s_nop 2
    v_cvt_pk_bf16_f32 v206, v80, v84
    v_cvt_pk_bf16_f32 v210, v81, v85
    v_mfma_f32_16x16x32_bf16 v[92:95], v[132:135], a[116:119], v[92:95]
    v_cvt_pk_bf16_f32 v214, v82, v86
    v_cvt_pk_bf16_f32 v218, v83, v87
    v_mfma_f32_16x16x32_bf16 v[92:95], v[136:139], a[120:123], v[92:95]
    v_mfma_f32_16x16x32_bf16 v[92:95], v[140:143], a[124:127], v[92:95]
    s_waitcnt lgkmcnt(3)
    v_mfma_f32_16x16x32_bf16 v[96:99], v[144:147], a[0:3], 0
    s_nop 0
    s_nop 1
    s_waitcnt lgkmcnt(2)
    v_mfma_f32_16x16x32_bf16 v[96:99], v[148:151], a[4:7], v[96:99]
    s_nop 0
    v_cvt_pk_bf16_f32 v207, v88, v92
    v_cvt_pk_bf16_f32 v211, v89, v93
    s_waitcnt lgkmcnt(1)
    v_mfma_f32_16x16x32_bf16 v[96:99], v[152:155], a[8:11], v[96:99]
    v_cvt_pk_bf16_f32 v215, v90, v94
    v_cvt_pk_bf16_f32 v219, v91, v95
    s_waitcnt lgkmcnt(0)
    v_mfma_f32_16x16x32_bf16 v[96:99], v[156:159], a[12:15], v[96:99]
    s_add_u32 s56, s46, 0
    s_addc_u32 s57, s47, 0
    global_store_dwordx4 v7, v[204:207], s[56:57] sc1
    v_mfma_f32_16x16x32_bf16 v[100:103], v[144:147], a[16:19], 0
    s_add_u32 s56, s46, 32768
    s_addc_u32 s57, s47, 0
    global_store_dwordx4 v7, v[208:211], s[56:57] sc1
    v_mfma_f32_16x16x32_bf16 v[100:103], v[148:151], a[20:23], v[100:103]
    s_add_u32 s56, s46, 65536
    s_addc_u32 s57, s47, 0
    global_store_dwordx4 v7, v[212:215], s[56:57] sc1
    v_mfma_f32_16x16x32_bf16 v[100:103], v[152:155], a[24:27], v[100:103]
    s_add_u32 s56, s46, 98304
    s_addc_u32 s57, s47, 0
    global_store_dwordx4 v7, v[216:219], s[56:57] sc1
    v_mfma_f32_16x16x32_bf16 v[100:103], v[156:159], a[28:31], v[100:103]
    v_mfma_f32_16x16x32_bf16 v[104:107], v[144:147], a[32:35], 0
    v_mfma_f32_16x16x32_bf16 v[104:107], v[148:151], a[36:39], v[104:107]
    v_mfma_f32_16x16x32_bf16 v[104:107], v[152:155], a[40:43], v[104:107]
    v_mfma_f32_16x16x32_bf16 v[104:107], v[156:159], a[44:47], v[104:107]
    v_mfma_f32_16x16x32_bf16 v[108:111], v[144:147], a[48:51], 0
    s_nop 0
    s_nop 1
    v_cvt_pk_bf16_f32 v220, v96, v100
    v_cvt_pk_bf16_f32 v224, v97, v101
    v_mfma_f32_16x16x32_bf16 v[108:111], v[148:151], a[52:55], v[108:111]
    v_cvt_pk_bf16_f32 v228, v98, v102
    v_cvt_pk_bf16_f32 v232, v99, v103
    v_mfma_f32_16x16x32_bf16 v[108:111], v[152:155], a[56:59], v[108:111]
    v_and_or_b32 v220, v220, -2, s10
    v_and_or_b32 v224, v224, -2, s10
    v_mfma_f32_16x16x32_bf16 v[108:111], v[156:159], a[60:63], v[108:111]
    v_and_or_b32 v228, v228, -2, s10
    v_and_or_b32 v232, v232, -2, s10
    v_mfma_f32_16x16x32_bf16 v[112:115], v[144:147], a[64:67], 0
    v_mfma_f32_16x16x32_bf16 v[112:115], v[148:151], a[68:71], v[112:115]
    v_mfma_f32_16x16x32_bf16 v[112:115], v[152:155], a[72:75], v[112:115]
    v_mfma_f32_16x16x32_bf16 v[112:115], v[156:159], a[76:79], v[112:115]
    v_mfma_f32_16x16x32_bf16 v[116:119], v[144:147], a[80:83], 0
    s_nop 0
    v_cvt_pk_bf16_f32 v221, v104, v108
    v_cvt_pk_bf16_f32 v225, v105, v109
    v_mfma_f32_16x16x32_bf16 v[116:119], v[148:151], a[84:87], v[116:119]
    v_cvt_pk_bf16_f32 v229, v106, v110
    v_cvt_pk_bf16_f32 v233, v107, v111
    v_mfma_f32_16x16x32_bf16 v[116:119], v[152:155], a[88:91], v[116:119]
    v_mfma_f32_16x16x32_bf16 v[116:119], v[156:159], a[92:95], v[116:119]
    v_mfma_f32_16x16x32_bf16 v[120:123], v[144:147], a[96:99], 0
    v_mfma_f32_16x16x32_bf16 v[120:123], v[148:151], a[100:103], v[120:123]
    v_mfma_f32_16x16x32_bf16 v[120:123], v[152:155], a[104:107], v[120:123]
    v_mfma_f32_16x16x32_bf16 v[120:123], v[156:159], a[108:111], v[120:123]
    v_mfma_f32_16x16x32_bf16 v[124:127], v[144:147], a[112:115], 0
    s_nop 2
    v_cvt_pk_bf16_f32 v222, v112, v116
    v_cvt_pk_bf16_f32 v226, v113, v117
    v_mfma_f32_16x16x32_bf16 v[124:127], v[148:151], a[116:119], v[124:127]
    v_cvt_pk_bf16_f32 v230, v114, v118
    v_cvt_pk_bf16_f32 v234, v115, v119
    v_mfma_f32_16x16x32_bf16 v[124:127], v[152:155], a[120:123], v[124:127]
    v_mfma_f32_16x16x32_bf16 v[124:127], v[156:159], a[124:127], v[124:127]
    s_nop 0
    s_nop 0
    s_nop 5
    v_cvt_pk_bf16_f32 v223, v120, v124
    s_add_u32 s56, s46, 524288
    s_addc_u32 s57, s47, 0
    global_store_dwordx4 v7, v[220:223], s[56:57] sc1
    v_cvt_pk_bf16_f32 v227, v121, v125
    s_add_u32 s56, s46, 557056
    s_addc_u32 s57, s47, 0
    global_store_dwordx4 v7, v[224:227], s[56:57] sc1
    v_cvt_pk_bf16_f32 v231, v122, v126
    s_add_u32 s56, s46, 589824
    s_addc_u32 s57, s47, 0
    global_store_dwordx4 v7, v[228:231], s[56:57] sc1
    v_cvt_pk_bf16_f32 v235, v123, v127
    s_add_u32 s56, s46, 622592
    s_addc_u32 s57, s47, 0
    global_store_dwordx4 v7, v[232:235], s[56:57] sc1
    s_waitcnt vmcnt(0)
    s_mov_b32 s54, 0
L_pr1s:
    s_add_u32 s56, s48, 4096
    s_addc_u32 s57, s49, 0
    global_load_dwordx4 v[64:67], v8, s[56:57] offset:-4096 sc1
    global_load_dwordx4 v[68:71], v8, s[56:57] offset:0 sc1
    s_add_u32 s56, s48, 12288
    s_addc_u32 s57, s49, 0
    global_load_dwordx4 v[72:75], v8, s[56:57] offset:-4096 sc1
    global_load_dwordx4 v[76:79], v8, s[56:57] offset:0 sc1
    s_add_u32 s56, s48, 20480
    s_addc_u32 s57, s49, 0
    global_load_dwordx4 v[80:83], v8, s[56:57] offset:-4096 sc1
    global_load_dwordx4 v[84:87], v8, s[56:57] offset:0 sc1
    s_add_u32 s56, s48, 28672
    s_addc_u32 s57, s49, 0
    global_load_dwordx4 v[88:91], v8, s[56:57] offset:-4096 sc1
    global_load_dwordx4 v[92:95], v8, s[56:57] offset:0 sc1
    s_add_u32 s54, s54, 1
    s_cmp_gt_u32 s54, 400000
    s_cbranch_scc1 L_end
    s_waitcnt vmcnt(7)
    v_mfma_f32_16x16x32_bf16 v[56:59], v[64:67], v[20:23], 0
    v_xor_b32 v52, 0, v64
    s_waitcnt vmcnt(6)
    v_mfma_f32_16x16x32_bf16 v[56:59], v[68:71], v[20:23], v[56:59]
    v_bitop3_b32 v52, v52, 0, v68 bitop3:0xf6
    s_waitcnt vmcnt(5)
    v_mfma_f32_16x16x32_bf16 v[56:59], v[72:75], v[20:23], v[56:59]
    v_bitop3_b32 v52, v52, 0, v72 bitop3:0xf6
    s_waitcnt vmcnt(4)
    v_mfma_f32_16x16x32_bf16 v[56:59], v[76:79], v[20:23], v[56:59]
    v_bitop3_b32 v52, v52, 0, v76 bitop3:0xf6
    s_waitcnt vmcnt(3)
    v_mfma_f32_16x16x32_bf16 v[56:59], v[80:83], v[20:23], v[56:59]
    v_bitop3_b32 v52, v52, 0, v80 bitop3:0xf6
    s_waitcnt vmcnt(2)
    v_mfma_f32_16x16x32_bf16 v[56:59], v[84:87], v[20:23], v[56:59]
    v_bitop3_b32 v52, v52, 0, v84 bitop3:0xf6
    s_waitcnt vmcnt(1)
    v_mfma_f32_16x16x32_bf16 v[56:59], v[88:91], v[20:23], v[56:59]
    v_bitop3_b32 v52, v52, 0, v88 bitop3:0xf6
    s_waitcnt vmcnt(0)
    v_mfma_f32_16x16x32_bf16 v[56:59], v[92:95], v[20:23], v[56:59]
    v_bitop3_b32 v52, v52, s35, v92 bitop3:0xf6
    v_and_b32 v52, 1, v52
    v_cmp_ne_u32 vcc, 0, v52
    s_cbranch_vccnz L_pr1s
    s_nop 3
    v_cvt_pk_bf16_f32 v52, v56, v57
    v_lshlrev_b32_e64 v56, 16, v52
    v_and_b32 v57, 0xffff0000, v52
    v_cvt_pk_bf16_f32 v53, v58, v59
    v_lshlrev_b32_e64 v58, 16, v53
    v_and_b32 v59, 0xffff0000, v53
    v_pk_mul_f32 v[56:57], v[56:57], v[24:25]
    v_pk_mul_f32 v[58:59], v[58:59], v[26:27]
    v_cvt_pk_bf16_f32 v52, v56, v57
    v_lshlrev_b32_e64 v56, 16, v52
    v_and_b32 v57, 0xffff0000, v52
    v_cvt_pk_bf16_f32 v53, v58, v59
    v_lshlrev_b32_e64 v58, 16, v53
    v_and_b32 v59, 0xffff0000, v53
    v_pk_add_f32 v[40:41], v[40:41], v[56:57]
    v_pk_add_f32 v[42:43], v[42:43], v[58:59]
    v_cvt_pk_bf16_f32 v52, v40, v41
    v_lshlrev_b32_e64 v40, 16, v52
    v_and_b32 v41, 0xffff0000, v52
    v_cvt_pk_bf16_f32 v53, v42, v43
    v_lshlrev_b32 v42, 16, v53
    v_and_b32 v43, 0xffff0000, v53
    v_readfirstlane_b32 s58, v40
    v_readfirstlane_b32 s59, v40
    s_nop 1
    v_pk_add_f32 v[56:57], v[40:41], s[58:59] neg_lo:[0,1] neg_hi:[0,1]
    v_pk_add_f32 v[58:59], v[42:43], s[58:59] neg_lo:[0,1] neg_hi:[0,1]
    v_pk_add_f32 v[54:55], v[56:57], v[58:59]
    v_pk_mul_f32 v[56:57], v[56:57], v[56:57]
    v_add_f32_e64 v60, v54, v55
    v_pk_fma_f32 v[56:57], v[58:59], v[58:59], v[56:57]
    v_add_f32_e64 v61, v56, v57
    v_add_f32_dpp v60, v60, v60 row_ror:4 row_mask:0xf bank_mask:0xf
    s_nop 0
    v_add_f32_dpp v61, v61, v61 row_ror:4 row_mask:0xf bank_mask:0xf
    v_add_f32_dpp v60, v60, v60 row_ror:2 row_mask:0xf bank_mask:0xf
    s_nop 0
    v_add_f32_dpp v61, v61, v61 row_ror:2 row_mask:0xf bank_mask:0xf
    v_add_f32_dpp v60, v60, v60 row_ror:1 row_mask:0xf bank_mask:0xf
    s_nop 0
    v_add_f32_dpp v61, v61, v61 row_ror:1 row_mask:0xf bank_mask:0xf
    v_mov_b64 v[52:53], v[60:61]
    s_nop 1
    v_permlane16_swap_b32 v60, v52
    v_permlane16_swap_b32 v61, v53
    v_pk_add_f32 v[60:61], v[60:61], v[52:53]
    v_mov_b64 v[52:53], v[60:61]
    s_nop 0
    s_nop 0
    v_permlane32_swap_b32 v60, v52
    v_permlane32_swap_b32 v61, v53
    v_pk_add_f32 v[60:61], v[60:61], v[52:53]
    v_mul_f32 v52, 0x3c000000, v60
    v_fma_f32 v61, -v52, v60, v61
    v_add_f32_e64 v60, s58, v52
    ds_write_b64 v16, v[60:61]
    s_waitcnt lgkmcnt(0)
    s_barrier
    ds_read_b128 v[64:67], v17
    ds_read_b128 v[68:71], v17 offset:16
    s_waitcnt lgkmcnt(1)
    v_pk_add_f32 v[72:73], v[64:65], v[66:67]
    s_waitcnt lgkmcnt(0)
    v_pk_add_f32 v[74:75], v[68:69], v[70:71]
    v_pk_add_f32 v[72:73], v[72:73], v[74:75]
    v_mul_f32 v60, 0x3e800000, v72
    v_sub_f32 v64, v64, v60
    v_sub_f32 v66, v66, v60
    v_sub_f32 v68, v68, v60
    v_sub_f32 v70, v70, v60
    v_mul_f32 v64, v64, v64
    v_fmac_f32 v64, v66, v66
    v_fmac_f32 v64, v68, v68
    v_fmac_f32 v64, v70, v70
    v_mul_f32 v61, 0x3b000000, v73
    v_fmac_f32 v61, 0x3e800000, v64
    v_cvt_pk_bf16_f32 v52, v60, v61
    v_lshlrev_b32_e64 v60, 16, v52
    v_and_b32 v61, 0xffff0000, v52
    v_add_f32 v61, 0x3727c5ac, v61
    v_pk_add_f32 v[56:57], v[40:41], v[60:61] op_sel:[0,0] op_sel_hi:[1,0] neg_lo:[0,1] neg_hi:[0,1]
    v_pk_add_f32 v[58:59], v[42:43], v[60:61] op_sel:[0,0] op_sel_hi:[1,0] neg_lo:[0,1] neg_hi:[0,1]
    v_cvt_pk_bf16_f32 v52, v60, v61
    v_lshlrev_b32 v60, 16, v52
    v_and_b32 v61, 0xffff0000, v52
    v_sqrt_f32 v61, v61
    v_cvt_pk_bf16_f32 v53, v56, v57
    v_lshlrev_b32 v56, 16, v53
    v_and_b32 v57, 0xffff0000, v53
    v_cvt_pk_bf16_f32 v52, v60, v61
    v_lshlrev_b32 v60, 16, v52
    v_and_b32 v61, 0xffff0000, v52
    v_cvt_pk_bf16_f32 v54, v58, v59
    v_lshlrev_b32 v58, 16, v54
    v_and_b32 v59, 0xffff0000, v54
    v_rcp_f32 v61, v61
    s_nop 0
    v_pk_mul_f32 v[56:57], v[56:57], v[60:61] op_sel:[0,1] op_sel_hi:[1,1]
    v_pk_mul_f32 v[58:59], v[58:59], v[60:61] op_sel:[0,1] op_sel_hi:[1,1]
    v_cvt_pk_bf16_f32 v52, v56, v57
    v_lshlrev_b32 v56, 16, v52
    v_and_b32 v57, 0xffff0000, v52
    v_cvt_pk_bf16_f32 v53, v58, v59
    v_lshlrev_b32_e64 v58, 16, v53
    v_and_b32 v59, 0xffff0000, v53
    v_pk_mul_f32 v[56:57], v[56:57], v[32:33]
    v_pk_mul_f32 v[58:59], v[58:59], v[34:35]
    v_cvt_pk_bf16_f32 v52, v56, v57
    v_lshlrev_b32_e64 v56, 16, v52
    v_and_b32 v57, 0xffff0000, v52
    v_cvt_pk_bf16_f32 v53, v58, v59
    v_lshlrev_b32_e64 v58, 16, v53
    v_and_b32 v59, 0xffff0000, v53
    v_pk_add_f32 v[56:57], v[56:57], v[28:29]
    v_pk_add_f32 v[58:59], v[58:59], v[30:31]
    v_cvt_pk_bf16_f32 v52, v56, v57
    v_cvt_pk_bf16_f32 v53, v58, v59
    s_mov_b64 exec, s[78:79]
    global_store_dwordx2 v6, v[52:53], s[50:51] sc1
    s_mov_b64 exec, -1
    s_cmp_ge_u32 s31, 28
    s_cbranch_scc1 L_pfs
    s_waitcnt vmcnt(0)
    s_mov_b32 s54, 0
L_pas:
    global_load_dwordx4 v[64:67], v2, s[52:53] offset:-4096 sc1
    global_load_dwordx4 v[68:71], v2, s[52:53] offset:-3072 sc1
    global_load_dwordx4 v[72:75], v2, s[52:53] offset:-2048 sc1
    global_load_dwordx4 v[76:79], v2, s[52:53] offset:-1024 sc1
    global_load_dwordx4 v[80:83], v2, s[52:53] offset:0 sc1
    global_load_dwordx4 v[84:87], v2, s[52:53] offset:1024 sc1
    global_load_dwordx4 v[88:91], v2, s[52:53] offset:2048 sc1
    global_load_dwordx4 v[92:95], v2, s[52:53] offset:3072 sc1
    s_add_u32 s54, s54, 1
    s_cmp_gt_u32 s54, 400000
    s_cbranch_scc1 L_end
    s_waitcnt vmcnt(7)
    ds_write_b128 v14, v[64:67] offset:0
    v_max_u32 v52, v64, v66
    s_waitcnt vmcnt(6)
    ds_write_b128 v14, v[68:71] offset:1056
    v_max3_u32 v52, v52, v68, v70
    s_waitcnt vmcnt(5)
    ds_write_b128 v14, v[72:75] offset:2112
    v_max3_u32 v52, v52, v72, v74
    s_waitcnt vmcnt(4)
    ds_write_b128 v14, v[76:79] offset:3168
    v_max3_u32 v52, v52, v76, v78
    s_waitcnt vmcnt(3)
    ds_write_b128 v14, v[80:83] offset:4224
    v_max3_u32 v52, v52, v80, v82
    s_waitcnt vmcnt(2)
    ds_write_b128 v14, v[84:87] offset:5280
    v_max3_u32 v52, v52, v84, v86
    s_waitcnt vmcnt(1)
    ds_write_b128 v14, v[88:91] offset:6336
    v_max3_u32 v52, v52, v88, v90
    s_waitcnt vmcnt(0)
    ds_write_b128 v14, v[92:95] offset:7392
    v_max3_u32 v52, v52, v92, v94
    v_cmp_eq_u32_e64 vcc, -1, v52
    s_cbranch_vccnz L_pas
    s_waitcnt lgkmcnt(0)
    s_barrier
    ds_read_b128 v[144:147], v15 offset:0
    ds_read_b128 v[148:151], v15 offset:64
    ds_read_b128 v[152:155], v15 offset:128
    ds_read_b128 v[156:159], v15 offset:192
    ds_read_b128 v[160:163], v15 offset:256
    ds_read_b128 v[164:167], v15 offset:320
    s_waitcnt lgkmcnt(5)
    v_mfma_f32_16x16x32_bf16 v[56:59], a[128:131], v[144:147], 0
    ds_read_b128 v[168:171], v15 offset:384
    s_waitcnt lgkmcnt(5)
    v_mfma_f32_16x16x32_bf16 v[56:59], a[132:135], v[148:151], v[56:59]
    ds_read_b128 v[172:175], v15 offset:448
    s_waitcnt lgkmcnt(5)
    v_mfma_f32_16x16x32_bf16 v[56:59], a[136:139], v[152:155], v[56:59]
    ds_read_b128 v[144:147], v15 offset:512
    s_waitcnt lgkmcnt(5)
    v_mfma_f32_16x16x32_bf16 v[56:59], a[140:143], v[156:159], v[56:59]
    ds_read_b128 v[148:151], v15 offset:576
    s_waitcnt lgkmcnt(5)
    v_mfma_f32_16x16x32_bf16 v[56:59], a[144:147], v[160:163], v[56:59]
    ds_read_b128 v[152:155], v15 offset:640
    s_waitcnt lgkmcnt(5)
    v_mfma_f32_16x16x32_bf16 v[56:59], a[148:151], v[164:167], v[56:59]
    ds_read_b128 v[156:159], v15 offset:704
    s_waitcnt lgkmcnt(5)
    v_mfma_f32_16x16x32_bf16 v[56:59], a[152:155], v[168:171], v[56:59]
    ds_read_b128 v[160:163], v15 offset:768
    s_waitcnt lgkmcnt(5)
    v_mfma_f32_16x16x32_bf16 v[56:59], a[156:159], v[172:175], v[56:59]
    ds_read_b128 v[164:167], v15 offset:832
    s_waitcnt lgkmcnt(5)
    v_mfma_f32_16x16x32_bf16 v[56:59], a[160:163], v[144:147], v[56:59]
    ds_read_b128 v[168:171], v15 offset:896
    s_waitcnt lgkmcnt(5)
    v_mfma_f32_16x16x32_bf16 v[56:59], a[164:167], v[148:151], v[56:59]
    ds_read_b128 v[172:175], v15 offset:960
    s_waitcnt lgkmcnt(5)
    v_mfma_f32_16x16x32_bf16 v[56:59], a[168:171], v[152:155], v[56:59]
    ds_read_b128 v[144:147], v15 offset:16896
    s_waitcnt lgkmcnt(5)
    v_mfma_f32_16x16x32_bf16 v[56:59], a[172:175], v[156:159], v[56:59]
    ds_read_b128 v[148:151], v15 offset:16960
    s_waitcnt lgkmcnt(5)
    v_mfma_f32_16x16x32_bf16 v[56:59], a[176:179], v[160:163], v[56:59]
    ds_read_b128 v[152:155], v15 offset:17024
    s_waitcnt lgkmcnt(5)
    v_mfma_f32_16x16x32_bf16 v[56:59], a[180:183], v[164:167], v[56:59]
    ds_read_b128 v[156:159], v15 offset:17088
    s_waitcnt lgkmcnt(5)
    v_mfma_f32_16x16x32_bf16 v[56:59], a[184:187], v[168:171], v[56:59]
    ds_read_b128 v[160:163], v15 offset:17152
    s_waitcnt lgkmcnt(5)
    v_mfma_f32_16x16x32_bf16 v[56:59], a[188:191], v[172:175], v[56:59]
    ds_read_b128 v[164:167], v15 offset:17216
    s_waitcnt lgkmcnt(5)
    v_mfma_f32_16x16x32_bf16 v[60:63], a[128:131], v[144:147], 0
    ds_read_b128 v[168:171], v15 offset:17280
    s_waitcnt lgkmcnt(5)
    v_mfma_f32_16x16x32_bf16 v[60:63], a[132:135], v[148:151], v[60:63]
    ds_read_b128 v[172:175], v15 offset:17344
    s_waitcnt lgkmcnt(5)
    v_mfma_f32_16x16x32_bf16 v[60:63], a[136:139], v[152:155], v[60:63]
    ds_read_b128 v[144:147], v15 offset:17408
    v_max_f32 v56, 0, v56
    v_max_f32 v57, 0, v57
    s_waitcnt lgkmcnt(5)
    v_mfma_f32_16x16x32_bf16 v[60:63], a[140:143], v[156:159], v[60:63]
    ds_read_b128 v[148:151], v15 offset:17472
    v_max_f32 v58, 0, v58
    v_max_f32_e64 v59, 0, v59
    s_waitcnt lgkmcnt(5)
    v_mfma_f32_16x16x32_bf16 v[60:63], a[144:147], v[160:163], v[60:63]
    ds_read_b128 v[152:155], v15 offset:17536
    v_cvt_pk_bf16_f32 v52, v56, v57
    v_cvt_pk_bf16_f32 v53, v58, v59
    s_waitcnt lgkmcnt(5)
    v_mfma_f32_16x16x32_bf16 v[60:63], a[148:151], v[164:167], v[60:63]
    ds_read_b128 v[156:159], v15 offset:17600
    ds_write_b64 v13, v[52:53] offset:0
    s_waitcnt lgkmcnt(6)
    v_mfma_f32_16x16x32_bf16 v[60:63], a[152:155], v[168:171], v[60:63]
    ds_read_b128 v[160:163], v15 offset:17664
    s_waitcnt lgkmcnt(6)
    v_mfma_f32_16x16x32_bf16 v[60:63], a[156:159], v[172:175], v[60:63]
    ds_read_b128 v[164:167], v15 offset:17728
    s_waitcnt lgkmcnt(6)
    v_mfma_f32_16x16x32_bf16 v[60:63], a[160:163], v[144:147], v[60:63]
    ds_read_b128 v[168:171], v15 offset:17792
    s_waitcnt lgkmcnt(6)
    v_mfma_f32_16x16x32_bf16 v[60:63], a[164:167], v[148:151], v[60:63]
    ds_read_b128 v[172:175], v15 offset:17856
    s_waitcnt lgkmcnt(6)
    v_mfma_f32_16x16x32_bf16 v[60:63], a[168:171], v[152:155], v[60:63]
    s_waitcnt lgkmcnt(4)
    s_barrier
    ds_read_b128 v[128:131], v2 offset:16384
    ds_read_b128 v[132:135], v2 offset:17408
    v_mfma_f32_16x16x32_bf16 v[60:63], a[172:175], v[156:159], v[60:63]
    s_waitcnt lgkmcnt(5)
    v_mfma_f32_16x16x32_bf16 v[60:63], a[176:179], v[160:163], v[60:63]
    s_waitcnt lgkmcnt(4)
    v_mfma_f32_16x16x32_bf16 v[60:63], a[180:183], v[164:167], v[60:63]
    s_waitcnt lgkmcnt(3)
    v_mfma_f32_16x16x32_bf16 v[60:63], a[184:187], v[168:171], v[60:63]
    s_waitcnt lgkmcnt(2)
    v_mfma_f32_16x16x32_bf16 v[60:63], a[188:191], v[172:175], v[60:63]
    s_waitcnt lgkmcnt(1)
    v_mfma_f32_16x16x32_bf16 v[64:67], v[128:131], a[192:195], 0
    s_nop 2
    s_waitcnt lgkmcnt(0)
    v_mfma_f32_16x16x32_bf16 v[64:67], v[132:135], a[196:199], v[64:67]
    s_nop 0
    v_max_f32 v60, 0, v60
    v_max_f32 v61, 0, v61
    v_mfma_f32_16x16x32_bf16 v[68:71], v[128:131], a[200:203], 0
    v_max_f32 v62, 0, v62
    v_max_f32 v63, 0, v63
    v_mfma_f32_16x16x32_bf16 v[68:71], v[132:135], a[204:207], v[68:71]
    v_cvt_pk_bf16_f32 v54, v60, v61
    v_cvt_pk_bf16_f32 v55, v62, v63
    v_mfma_f32_16x16x32_bf16 v[72:75], v[128:131], a[208:211], 0
    ds_write_b64 v13, v[54:55] offset:2048
    v_mfma_f32_16x16x32_bf16 v[72:75], v[132:135], a[212:215], v[72:75]
    v_mfma_f32_16x16x32_bf16 v[76:79], v[128:131], a[216:219], 0
    v_mfma_f32_16x16x32_bf16 v[76:79], v[132:135], a[220:223], v[76:79]
    s_nop 0
    v_cvt_pk_bf16_f32 v204, v64, v68
    v_cvt_pk_bf16_f32 v208, v65, v69
    v_mfma_f32_16x16x32_bf16 v[80:83], v[128:131], a[224:227], 0
    v_cvt_pk_bf16_f32 v212, v66, v70
    v_cvt_pk_bf16_f32 v216, v67, v71
    v_mfma_f32_16x16x32_bf16 v[80:83], v[132:135], a[228:231], v[80:83]
    s_waitcnt lgkmcnt(0)
    s_barrier
    ds_read_b128 v[136:139], v2 offset:18432
    ds_read_b128 v[140:143], v2 offset:19456
    v_and_or_b32 v204, v204, -2, 1
    v_and_or_b32 v208, v208, -2, 1
    v_mfma_f32_16x16x32_bf16 v[84:87], v[128:131], a[232:235], 0
    v_and_or_b32 v212, v212, -2, 1
    v_and_or_b32 v216, v216, -2, 1
    v_mfma_f32_16x16x32_bf16 v[84:87], v[132:135], a[236:239], v[84:87]
    v_cvt_pk_bf16_f32 v205, v72, v76
    v_cvt_pk_bf16_f32 v209, v73, v77
    v_mfma_f32_16x16x32_bf16 v[88:91], v[128:131], a[240:243], 0
    v_cvt_pk_bf16_f32 v213, v74, v78
    v_cvt_pk_bf16_f32 v217, v75, v79
    v_mfma_f32_16x16x32_bf16 v[88:91], v[132:135], a[244:247], v[88:91]
    v_mfma_f32_16x16x32_bf16 v[92:95], v[128:131], a[248:251], 0
    v_mfma_f32_16x16x32_bf16 v[92:95], v[132:135], a[252:255], v[92:95]
    v_cvt_pk_bf16_f32 v206, v80, v84
    v_cvt_pk_bf16_f32 v210, v81, v85
    v_cvt_pk_bf16_f32 v214, v82, v86
    v_cvt_pk_bf16_f32 v218, v83, v87
    s_waitcnt lgkmcnt(1)
    v_mfma_f32_16x16x32_bf16 v[96:99], v[136:139], a[192:195], 0
    s_nop 0
    s_nop 1
    s_waitcnt lgkmcnt(0)
    v_mfma_f32_16x16x32_bf16 v[96:99], v[140:143], a[196:199], v[96:99]
    s_nop 0
    v_cvt_pk_bf16_f32 v207, v88, v92
    v_cvt_pk_bf16_f32 v211, v89, v93
    v_mfma_f32_16x16x32_bf16 v[100:103], v[136:139], a[200:203], 0
    v_cvt_pk_bf16_f32 v215, v90, v94
    v_cvt_pk_bf16_f32 v219, v91, v95
    v_mfma_f32_16x16x32_bf16 v[100:103], v[140:143], a[204:207], v[100:103]
    s_add_u32 s56, s46, 0
    s_addc_u32 s57, s47, 0
    global_store_dwordx4 v7, v[204:207], s[56:57] sc1
    v_mfma_f32_16x16x32_bf16 v[104:107], v[136:139], a[208:211], 0
    s_add_u32 s56, s46, 32768
    s_addc_u32 s57, s47, 0
    global_store_dwordx4 v7, v[208:211], s[56:57] sc1
    v_mfma_f32_16x16x32_bf16 v[104:107], v[140:143], a[212:215], v[104:107]
    s_add_u32 s56, s46, 65536
    s_addc_u32 s57, s47, 0
    global_store_dwordx4 v7, v[212:215], s[56:57] sc1
    v_mfma_f32_16x16x32_bf16 v[108:111], v[136:139], a[216:219], 0
    s_add_u32 s56, s46, 98304
    s_addc_u32 s57, s47, 0
    global_store_dwordx4 v7, v[216:219], s[56:57] sc1
    v_mfma_f32_16x16x32_bf16 v[108:111], v[140:143], a[220:223], v[108:111]
    v_cvt_pk_bf16_f32 v220, v96, v100
    v_cvt_pk_bf16_f32 v224, v97, v101
    v_mfma_f32_16x16x32_bf16 v[112:115], v[136:139], a[224:227], 0
    v_cvt_pk_bf16_f32 v228, v98, v102
    v_cvt_pk_bf16_f32 v232, v99, v103
    v_mfma_f32_16x16x32_bf16 v[112:115], v[140:143], a[228:231], v[112:115]
    v_and_or_b32 v220, v220, -2, 1
    v_and_or_b32 v224, v224, -2, 1
    v_mfma_f32_16x16x32_bf16 v[116:119], v[136:139], a[232:235], 0
    v_and_or_b32 v228, v228, -2, 1
    v_and_or_b32 v232, v232, -2, 1
    v_mfma_f32_16x16x32_bf16 v[116:119], v[140:143], a[236:239], v[116:119]
    v_cvt_pk_bf16_f32 v221, v104, v108
    v_cvt_pk_bf16_f32 v225, v105, v109
    v_mfma_f32_16x16x32_bf16 v[120:123], v[136:139], a[240:243], 0
    v_cvt_pk_bf16_f32 v229, v106, v110
    v_cvt_pk_bf16_f32 v233, v107, v111
    v_mfma_f32_16x16x32_bf16 v[120:123], v[140:143], a[244:247], v[120:123]
    v_mfma_f32_16x16x32_bf16 v[124:127], v[136:139], a[248:251], 0
    v_mfma_f32_16x16x32_bf16 v[124:127], v[140:143], a[252:255], v[124:127]
    v_cvt_pk_bf16_f32 v222, v112, v116
    v_cvt_pk_bf16_f32 v226, v113, v117
    v_cvt_pk_bf16_f32 v230, v114, v118
    v_cvt_pk_bf16_f32 v234, v115, v119
    s_nop 3
    v_cvt_pk_bf16_f32 v223, v120, v124
    s_add_u32 s56, s46, 524288
    s_addc_u32 s57, s47, 0
    global_store_dwordx4 v7, v[220:223], s[56:57] sc1
    v_cvt_pk_bf16_f32 v227, v121, v125
    s_add_u32 s56, s46, 557056
    s_addc_u32 s57, s47, 0
    global_store_dwordx4 v7, v[224:227], s[56:57] sc1
    v_cvt_pk_bf16_f32 v231, v122, v126
    s_add_u32 s56, s46, 589824
    s_addc_u32 s57, s47, 0
    global_store_dwordx4 v7, v[228:231], s[56:57] sc1
    v_cvt_pk_bf16_f32 v235, v123, v127
    s_add_u32 s56, s46, 622592
    s_addc_u32 s57, s47, 0
    global_store_dwordx4 v7, v[232:235], s[56:57] sc1
L_pfs:
    s_waitcnt vmcnt(0)
    s_mov_b32 s54, 0
L_pr2s:
    s_add_u32 s56, s48, 4096
    s_addc_u32 s57, s49, 0
    global_load_dwordx4 v[64:67], v8, s[56:57] offset:-4096 sc1
    global_load_dwordx4 v[68:71], v8, s[56:57] offset:0 sc1
    s_add_u32 s56, s48, 12288
    s_addc_u32 s57, s49, 0
    global_load_dwordx4 v[72:75], v8, s[56:57] offset:-4096 sc1
    global_load_dwordx4 v[76:79], v8, s[56:57] offset:0 sc1
    s_add_u32 s56, s48, 20480
    s_addc_u32 s57, s49, 0
    global_load_dwordx4 v[80:83], v8, s[56:57] offset:-4096 sc1
    global_load_dwordx4 v[84:87], v8, s[56:57] offset:0 sc1
    s_add_u32 s56, s48, 28672
    s_addc_u32 s57, s49, 0
    global_load_dwordx4 v[88:91], v8, s[56:57] offset:-4096 sc1
    s_add_u32 s54, s54, 1
    s_cmp_gt_u32 s54, 400000
    s_cbranch_scc1 L_end
    s_waitcnt vmcnt(6)
    v_mfma_f32_16x16x32_bf16 v[56:59], v[64:67], v[20:23], 0
    v_xor_b32_e64 v52, 1, v64
    s_waitcnt vmcnt(5)
    v_mfma_f32_16x16x32_bf16 v[56:59], v[68:71], v[20:23], v[56:59]
    v_bitop3_b32 v52, v52, 1, v68 bitop3:0xf6
    s_waitcnt vmcnt(4)
    v_mfma_f32_16x16x32_bf16 v[56:59], v[72:75], v[20:23], v[56:59]
    v_bitop3_b32 v52, v52, 1, v72 bitop3:0xf6
    s_waitcnt vmcnt(3)
    v_mfma_f32_16x16x32_bf16 v[56:59], v[76:79], v[20:23], v[56:59]
    v_bitop3_b32 v52, v52, 1, v76 bitop3:0xf6
    s_waitcnt vmcnt(2)
    v_mfma_f32_16x16x32_bf16 v[56:59], v[80:83], v[20:23], v[56:59]
    v_bitop3_b32 v52, v52, 1, v80 bitop3:0xf6
    s_waitcnt vmcnt(1)
    v_mfma_f32_16x16x32_bf16 v[56:59], v[84:87], v[20:23], v[56:59]
    v_bitop3_b32 v52, v52, 1, v84 bitop3:0xf6
    s_waitcnt vmcnt(0)
    v_mfma_f32_16x16x32_bf16 v[56:59], v[88:91], v[20:23], v[56:59]
    v_bitop3_b32 v52, v52, 1, v88 bitop3:0xf6
    v_and_b32 v52, 1, v52
    v_cmp_ne_u32 vcc, 0, v52
    s_cbranch_vccnz L_pr2s
    s_nop 3
    v_cvt_pk_bf16_f32 v52, v56, v57
    v_lshlrev_b32 v56, 16, v52
    v_and_b32 v57, 0xffff0000, v52
    v_cvt_pk_bf16_f32 v53, v58, v59
    v_lshlrev_b32_e64 v58, 16, v53
    v_and_b32 v59, 0xffff0000, v53
    v_pk_mul_f32 v[56:57], v[56:57], v[36:37]
    v_pk_mul_f32 v[58:59], v[58:59], v[38:39]
    v_cvt_pk_bf16_f32 v52, v56, v57
    v_lshlrev_b32 v56, 16, v52
    v_and_b32 v57, 0xffff0000, v52
    v_cvt_pk_bf16_f32 v53, v58, v59
    v_lshlrev_b32 v58, 16, v53
    v_and_b32 v59, 0xffff0000, v53
    v_pk_add_f32 v[56:57], v[56:57], v[40:41]
    v_pk_add_f32 v[58:59], v[58:59], v[42:43]
    v_cvt_pk_bf16_f32 v52, v56, v57
    v_cvt_pk_bf16_f32 v53, v58, v59
    s_mov_b64 exec, s[78:79]
    global_store_dwordx2 v6, v[52:53], s[44:45]
    global_store_dwordx2 v6, v[48:49], s[50:51] sc1
    s_mov_b64 exec, -1
    s_lshl_b32 s56, s20, 12
    s_add_u32 s40, s40, s56
    s_addc_u32 s41, s41, 0
    s_lshl_b32 s56, s20, 15
    s_add_u32 s44, s44, s56
    s_addc_u32 s45, s45, 0
    s_xor_b32 s35, s35, 1
    s_cmp_ge_u32 s31, 28
    s_cselect_b32 s10, s35, 0
    s_mov_b32 s34, s11
    s_cmp_lt_u32 s34, 64
    s_cbranch_scc1 L_pls
L_pend:
L_fin:
L_end:
    s_endpgm
.section .rodata,"a"
.p2align 6
.amdhsa_kernel adaLN_cond__memory_aug_recurrent_mem_tr__dense_activation_relu__prompt_kernel
  .amdhsa_next_free_vgpr 512
  .amdhsa_next_free_sgpr 102
  .amdhsa_accum_offset 256
  .amdhsa_group_segment_fixed_size 0
  .amdhsa_kernarg_size 120
  .amdhsa_user_sgpr_count 2
  .amdhsa_user_sgpr_kernarg_segment_ptr 1
  .amdhsa_system_sgpr_workgroup_id_x 1
  .amdhsa_float_denorm_mode_32 3
.end_amdhsa_kernel
```
